```python
import torch

def _softmax(x, axis=-1):
    return torch.softmax(x, dim=axis)
def _gelu(x):
    return torch.nn.functional.gelu(x, approximate="tanh")
def _silu(x):
    return torch.nn.functional.silu(x)
def _sigmoid(x):
    return torch.sigmoid(x)
def _layernorm(x, axis=-1, eps=1e-5):
    m = x.mean(dim=axis, keepdim=True)
    v = x.var(dim=axis, keepdim=True, unbiased=False)
    return (x - m) / torch.sqrt(v + eps)
def _scatter_add(tgt, idx, src, axis=0):
    return tgt.clone().index_add_(axis, idx, src)
def _segment_sum(src, seg, n):
    out = torch.zeros((n,) + src.shape[1:], dtype=src.dtype)
    return out.index_add_(0, seg, src)
def _pad(x, pw):
    flat = tuple(v for pair in reversed(pw) for v in pair)
    return torch.nn.functional.pad(x, flat)

kernel_name = 'concat_heads__gqa_block_cached__mha_block_cached__near_ridge'

def setup_inputs():

    _w = (lambda a: (lambda t: t.to(torch.bfloat16) if t.is_floating_point() else t)(torch.as_tensor(a)))
    def _A_setup():
        B, Sq, D = 8, 176, 448
        Hq, Hkv, Sk, Dh = 16, 8, 2048, 256
        assert Hq % Hkv == 0, (Hq, Hkv)
        return {
            "x": _w((lambda *s: torch.randn(*s, dtype=torch.bfloat16) * 0.8)(B, Sq, D)),
            "k_cache": _w((lambda *s: torch.randn(*s, dtype=torch.bfloat16) * 0.8)(B, Hkv, Sk, Dh)),
            "v_cache": _w((lambda *s: torch.randn(*s, dtype=torch.bfloat16) * 0.05)(B, Hkv, Sk, Dh)),
            "wq": _w((lambda *s: torch.randn(*s, dtype=torch.bfloat16) * 0.8)(D, Hq * Dh) * (D ** -0.5)),
            "wo": _w((lambda *s: torch.randn(*s, dtype=torch.bfloat16) * 0.05)(Hq * Dh, D) * ((Hq * Dh) ** -0.5)),
        }
    _A_in = _A_setup()

    def _B_setup():
        B, Sq, D = 8, 176, 448
        H, Sk, Dh = 16, 2048, 256
        return {
            "x": _w((lambda *s: torch.randn(*s, dtype=torch.bfloat16) * 0.8)(B, Sq, D)),
            "k_cache": _w((lambda *s: torch.randn(*s, dtype=torch.bfloat16) * 0.8)(B, H, Sk, Dh)),
            "v_cache": _w((lambda *s: torch.randn(*s, dtype=torch.bfloat16) * 0.05)(B, H, Sk, Dh)),
            "wq": _w((lambda *s: torch.randn(*s, dtype=torch.bfloat16) * 0.8)(D, H * Dh) * (D ** -0.5)),
            "wo": _w((lambda *s: torch.randn(*s, dtype=torch.bfloat16) * 0.05)(H * Dh, D) * ((H * Dh) ** -0.5)),
        }
    _B_in = _B_setup()

    return {
        "A_x": _A_in["x"],
        "A_k_cache": _A_in["k_cache"],
        "A_v_cache": _A_in["v_cache"],
        "A_wq": _A_in["wq"],
        "A_wo": _A_in["wo"],
        "B_x": _B_in["x"],
        "B_k_cache": _B_in["k_cache"],
        "B_v_cache": _B_in["v_cache"],
        "B_wq": _B_in["wq"],
        "B_wo": _B_in["wo"],
    }

def reference(A_x, A_k_cache, A_v_cache, A_wq, A_wo, B_x, B_k_cache, B_v_cache, B_wq, B_wo):
    def _A_ref(x, k_cache, v_cache, wq, wo):
        B, Sq, D = x.shape
        Hq, Dh = 16, 256
        Hkv = k_cache.shape[1]
        rep = Hq // Hkv
        q = (lambda x, *d: x.permute(*d))((x @ wq).reshape(B, Sq, Hq, Dh), 0, 2, 1, 3)
        k = (lambda x, n, axis: torch.repeat_interleave(x, n, dim=axis))(k_cache, rep, axis=1)
        v = (lambda x, n, axis: torch.repeat_interleave(x, n, dim=axis))(v_cache, rep, axis=1)
        scores = torch.einsum("bhqd,bhkd->bhqk", q, k) * (Dh ** -0.5)
        p = _softmax(scores, axis=-1)
        o = torch.einsum("bhqk,bhkd->bhqd", p, v)
        return (lambda x, *d: x.permute(*d))(o, 0, 2, 1, 3).reshape(B, Sq, Hq * Dh) @ wo

    def _B_ref(x, k_cache, v_cache, wq, wo):
        B, Sq, D = x.shape
        H, Dh = 16, 256
        q = (lambda x, *d: x.permute(*d))((x @ wq).reshape(B, Sq, H, Dh), 0, 2, 1, 3)
        scores = torch.einsum("bhqd,bhkd->bhqk", q, k_cache) * (Dh ** -0.5)
        p = _softmax(scores, axis=-1)
        o = torch.einsum("bhqk,bhkd->bhqd", p, v_cache)
        return (lambda x, *d: x.permute(*d))(o, 0, 2, 1, 3).reshape(B, Sq, H * Dh) @ wo

    a = _A_ref(A_x, A_k_cache, A_v_cache, A_wq, A_wo)
    b = _B_ref(B_x, B_k_cache, B_v_cache, B_wq, B_wo)
    return torch.concatenate([a, b], axis=-1)
```

```asm
; @launch grid=(256,1,1) block=(256,1,1) lds=163840
.amdgcn_target "amdgcn-amd-amdhsa--gfx950"
.text
.p2align 12
.fill 512, 4, 0xbf810000
.globl concat_heads__gqa_block_cached__mha_block_cached__near_ridge_kernel
.p2align 8
.type concat_heads__gqa_block_cached__mha_block_cached__near_ridge_kernel,@function
concat_heads__gqa_block_cached__mha_block_cached__near_ridge_kernel:
 s_cmp_ge_u32 s2, 256
 s_cbranch_scc1 L1_END
 s_load_dwordx16 s[16:31], s[0:1], 0
 s_load_dwordx8 s[32:39], s[0:1], 64
 s_load_dwordx2 s[40:41], s[0:1], 96
 s_and_b32 s4, s2, 7
 s_lshr_b32 s5, s2, 3
 s_getpc_b64 s[68:69]
L1_PC:
 s_lshl_b32 s6, s5, 12
 v_lshl_add_u32 v56, v0, 4, s6
 v_min_u32 v56, L2_END-L1_PC-16, v56
 v_mov_b32 v57, s69
 v_add_co_u32 v56, vcc, s68, v56
 v_addc_co_u32 v57, vcc, 0, v57, vcc
 global_load_dwordx4 v[52:55], v[56:57], off
 s_lshr_b32 s6, s5, 4
 s_xor_b32 s6, s6, 1
 s_bfe_u32 s7, s5, 0x30001
 s_and_b32 s8, s5, 1
 s_lshl_b32 s9, s4, 1
 s_add_u32 s8, s8, s9
 v_and_b32 v7, 63, v0
 v_lshrrev_b32 v9, 6, v0
 v_and_b32 v10, 15, v7
 v_readfirstlane_b32 s72, v9
 v_lshrrev_b32 v11, 4, v7
 v_and_b32 v14, 31, v7
 v_lshlrev_b32 v14, 4, v14
 v_and_b32 v15, 16, v7
 v_lshlrev_b32 v15, 1, v15
 v_xor_b32 v14, v15, v14
 v_lshl_add_u32 v14, v9, 17, v14
 v_lshrrev_b32 v15, 5, v7
 v_lshl_add_u32 v42, v15, 15, v14
 v_mul_u32_u24 v14, 48, v9
 v_lshrrev_b32 v16, 3, v7
 v_add_u32 v14, v14, v16
 v_mul_u32_u24 v14, 0x380, v14
 v_and_b32 v16, 7, v7
 v_xor_b32 v16, v16, v11
 v_lshl_add_u32 v43, v16, 4, v14
 v_xor_b32 v44, 64, v43
 v_add_u32 v44, 0x1c00, v44
 s_mul_i32 s74, s72, 8448
 s_mul_i32 s73, s72, 8320
 s_mul_i32 s71, s72, 0x1800
 s_add_u32 s71, s71, 0x21000
 s_mov_b32 s87, 14336
 s_mov_b32 s88, 28672
 s_lshl_b32 s11, s8, 9
 s_sub_u32 s12, 0x380000, s11
 s_mul_i32 s13, s7, 157696
 s_waitcnt lgkmcnt(0)
 s_cmp_eq_u32 s6, 1
 s_cselect_b64 s[56:57], s[32:33], s[22:23]
 s_cselect_b64 s[44:45], s[26:27], s[16:17]
 s_cselect_b64 s[48:49], s[28:29], s[18:19]
 s_cselect_b64 s[52:53], s[30:31], s[20:21]
 s_cselect_b64 s[60:61], s[34:35], s[24:25]
 s_add_u32 s56, s56, s11
 s_addc_u32 s57, s57, 0
 s_mov_b32 s58, s12
 s_mov_b32 s59, 0x20000
 s_add_u32 s44, s44, s13
 s_addc_u32 s45, s45, 0
 s_mov_b32 s46, 0x26800
 s_mov_b32 s47, 0x20000
 s_mov_b32 s82, 0x0
 s_add_u32 m0, s74, 0x10800
 s_nop 0
 buffer_load_dwordx4 v43, s[44:47], s82 offen lds
 s_mov_b32 s83, 0x0
 s_add_u32 m0, s74, 0x10c00
 s_nop 0
 buffer_load_dwordx4 v44, s[44:47], s83 offen lds
 s_mov_b32 s82, 0x3800
 s_add_u32 m0, s74, 0x11000
 s_nop 0
 buffer_load_dwordx4 v43, s[44:47], s82 offen lds
 s_mov_b32 s83, 0x3800
 s_add_u32 m0, s74, 0x11400
 s_nop 0
 buffer_load_dwordx4 v44, s[44:47], s83 offen lds
 s_mov_b32 s82, 0x7000
 s_add_u32 m0, s74, 0x11800
 s_nop 0
 buffer_load_dwordx4 v43, s[44:47], s82 offen lds
 s_mov_b32 s83, 0x7000
 s_add_u32 m0, s74, 0x11c00
 s_nop 0
 buffer_load_dwordx4 v44, s[44:47], s83 offen lds
 s_mov_b32 s82, 0x0
 s_add_u32 m0, s74, 0x18c00
 s_nop 0
 buffer_load_dwordx4 v42, s[56:59], s82 offen nt lds
 s_mov_b32 s83, 0x2000
 s_add_u32 m0, s74, 0x19028
 s_nop 0
 buffer_load_dwordx4 v42, s[56:59], s83 offen nt lds
 s_mov_b32 s82, 0x4000
 s_add_u32 m0, s74, 0x19440
 s_nop 0
 buffer_load_dwordx4 v42, s[56:59], s82 offen nt lds
 s_mov_b32 s83, 0x6000
 s_add_u32 m0, s74, 0x19868
 s_nop 0
 buffer_load_dwordx4 v42, s[56:59], s83 offen nt lds
 s_mov_b32 s82, 0x10000
 s_add_u32 m0, s74, 0x19c80
 s_nop 0
 buffer_load_dwordx4 v42, s[56:59], s82 offen nt lds
 s_mov_b32 s83, 0x12000
 s_add_u32 m0, s74, 0x1a0a8
 s_nop 0
 buffer_load_dwordx4 v42, s[56:59], s83 offen nt lds
 s_mov_b32 s82, 0x14000
 s_add_u32 m0, s74, 0x1a4c0
 s_nop 0
 buffer_load_dwordx4 v42, s[56:59], s82 offen nt lds
 s_mov_b32 s83, 0x16000
 s_add_u32 m0, s74, 0x1a8e8
 s_nop 0
 buffer_load_dwordx4 v42, s[56:59], s83 offen nt lds
 s_mov_b32 s82, 0x80
 s_add_u32 m0, s73, 0x0
 s_nop 0
 buffer_load_dwordx4 v43, s[44:47], s82 offen lds
 s_mov_b32 s83, 0x80
 s_add_u32 m0, s73, 0x400
 s_nop 0
 buffer_load_dwordx4 v44, s[44:47], s83 offen lds
 s_mov_b32 s82, 0x3880
 s_add_u32 m0, s73, 0x800
 s_nop 0
 buffer_load_dwordx4 v43, s[44:47], s82 offen lds
 s_mov_b32 s83, 0x3880
 s_add_u32 m0, s73, 0xc00
 s_nop 0
 buffer_load_dwordx4 v44, s[44:47], s83 offen lds
 s_mov_b32 s82, 0x7080
 s_add_u32 m0, s73, 0x1000
 s_nop 0
 buffer_load_dwordx4 v43, s[44:47], s82 offen lds
 s_mov_b32 s83, 0x7080
 s_add_u32 m0, s73, 0x1400
 s_nop 0
 buffer_load_dwordx4 v44, s[44:47], s83 offen lds
 s_mov_b32 s82, 0x80000
 s_add_u32 m0, s74, 0x8400
 s_nop 0
 buffer_load_dwordx4 v42, s[56:59], s82 offen nt lds
 s_mov_b32 s83, 0x82000
 s_add_u32 m0, s74, 0x8828
 s_nop 0
 buffer_load_dwordx4 v42, s[56:59], s83 offen nt lds
 s_mov_b32 s82, 0x84000
 s_add_u32 m0, s74, 0x8c40
 s_nop 0
 buffer_load_dwordx4 v42, s[56:59], s82 offen nt lds
 s_mov_b32 s83, 0x86000
 s_add_u32 m0, s74, 0x9068
 s_nop 0
 buffer_load_dwordx4 v42, s[56:59], s83 offen nt lds
 s_mov_b32 s82, 0x90000
 s_add_u32 m0, s74, 0x9480
 s_nop 0
 buffer_load_dwordx4 v42, s[56:59], s82 offen nt lds
 s_mov_b32 s83, 0x92000
 s_add_u32 m0, s74, 0x98a8
 s_nop 0
 buffer_load_dwordx4 v42, s[56:59], s83 offen nt lds
 s_mov_b32 s82, 0x94000
 s_add_u32 m0, s74, 0x9cc0
 s_nop 0
 buffer_load_dwordx4 v42, s[56:59], s82 offen nt lds
 s_mov_b32 s83, 0x96000
 s_add_u32 m0, s74, 0xa0e8
 s_nop 0
 buffer_load_dwordx4 v42, s[56:59], s83 offen nt lds
 v_lshrrev_b32 v16, 1, v10
 v_xor_b32 v16, v16, v11
 v_lshlrev_b32 v16, 4, v16
 v_lshl_add_u32 v16, v10, 7, v16
 v_xor_b32 v14, 64, v16
 s_add_u32 s11, s74, 0x10800
 v_add_u32 v46, s73, v16
 v_add_u32 v47, s73, v14
 v_add_u32 v48, s71, v16
 v_add_u32 v49, s71, v14
 v_add_u32 v50, s11, v16
 v_add_u32 v51, s11, v14
 v_lshrrev_b32 v12, 2, v7
 v_and_b32 v13, 3, v7
 v_mul_u32_u24 v1, 0x410, v10
 v_and_b32 v14, 1, v11
 v_lshl_add_u32 v1, v14, 8, v1
 v_lshrrev_b32 v14, 1, v11
 v_lshl_add_u32 v1, v14, 4, v1
 v_mul_u32_u24 v15, 0x420, v12
 v_lshl_add_u32 v2, v13, 3, v15
 v_add_u32 v2, 0x10800, v2
 v_and_b32 v14, 1, v13
 v_lshl_add_u32 v40, v14, 8, v15
 v_lshrrev_b32 v14, 1, v13
 v_lshl_add_u32 v40, v14, 4, v40
 v_and_b32 v14, 1, v12
 v_lshl_add_u32 v40, v14, 3, v40
 v_and_b32 v14, 1, v13
 v_lshlrev_b32 v14, 5, v14
 v_sub_u32 v58, v40, v14
 v_add_u32 v40, v40, v14
 v_add_u32 v59, 0x10800, v58
 v_add_u32 v41, 0x10800, v40
 v_lshlrev_b32 v14, 4, v7
 v_lshl_add_u32 v3, v9, 13, v14
 v_add_u32 v4, 0x1000, v3
 v_mul_u32_u24 v15, 0xa8000, v9
 v_add_u32 v5, v15, v14
 v_lshrrev_b32 v14, 3, v7
 v_lshl_add_u32 v15, v9, 6, v14
 v_mul_u32_u24 v15, 0x380, v15
 v_and_b32 v14, 6, v14
 v_and_b32 v16, 7, v7
 v_xor_b32 v14, v14, v16
 v_lshl_add_u32 v6, v14, 4, v15
 v_lshlrev_b32 v14, 7, v12
 v_lshl_add_u32 v14, v13, 3, v14
 v_bfe_u32 v15, v12, 1, 2
 v_xor_b32 v16, 0, v15
 v_lshl_add_u32 v36, v16, 5, v14
 v_xor_b32 v16, 1, v15
 v_lshl_add_u32 v37, v16, 5, v14
 v_xor_b32 v16, 2, v15
 v_lshl_add_u32 v38, v16, 5, v14
 v_xor_b32 v16, 3, v15
 v_lshl_add_u32 v39, v16, 5, v14
 s_lshl_b32 s89, s72, 13
 s_mov_b32 s78, 0x45800000
 s_mov_b32 s79, 0x3f803f80
 s_mov_b32 s80, 0x3db8aa3b
 s_mov_b32 s81, s80
 s_lshl_b32 s10, s7, 3
 s_lshr_b32 s11, s8, 1
 s_add_u32 s10, s10, s11
 s_lshl_b32 s11, s7, 4
 s_add_u32 s11, s11, s8
 s_cmp_eq_u32 s6, 1
 s_cselect_b32 s10, s11, s10
 s_lshl_b32 s10, s10, 20
 s_add_u32 s48, s48, s10
 s_addc_u32 s49, s49, 0
 s_mov_b32 s50, 0x100000
 s_mov_b32 s51, 0x20000
 s_add_u32 s52, s52, s10
 s_addc_u32 s53, s53, 0
 s_mov_b32 s54, 0x100000
 s_mov_b32 s55, 0x20000
 s_mul_i32 s12, s8, 229376
 s_add_u32 s60, s60, s12
 s_addc_u32 s61, s61, 0
 s_mov_b32 s62, 0x38000
 s_mov_b32 s63, 0x20000
 s_lshl_b32 s11, s6, 3
 s_add_u32 s11, s11, s7
 s_mul_i32 s11, s11, 2523136
 s_lshl_b32 s12, s8, 10
 s_add_u32 s11, s11, s12
 s_add_u32 s11, s11, 0x4000000
 s_add_u32 s64, s40, s11
 s_addc_u32 s65, s41, 0
 s_sub_u32 s12, 2523136, s12
 s_mov_b32 s66, s12
 s_mov_b32 s67, 0x20000
 s_mul_i32 s70, s7, 28672
 s_mul_i32 s11, s72, 7168
 s_add_u32 s70, s70, s11
 s_mov_b32 s75, 0
 s_mov_b32 s76, 0
 s_waitcnt vmcnt(22)
 ds_read_b128 a[0:3], v50 offset:0
 ds_read_b128 a[12:15], v51 offset:0
 ds_read_b128 a[4:7], v50 offset:2048
 ds_read_b128 a[16:19], v51 offset:2048
 ds_read_b128 a[8:11], v50 offset:4096
 ds_read_b128 a[20:23], v51 offset:4096
 s_waitcnt vmcnt(14) lgkmcnt(0)
 s_barrier
 s_cmp_eq_u32 s72, 3
 s_cbranch_scc1 L1_W3
 ds_read_b64_tr_b16 a[192:193], v41 offset:33792
 ds_read_b64_tr_b16 a[194:195], v41 offset:34304
 ds_read_b64_tr_b16 a[196:197], v41 offset:50688
 ds_read_b64_tr_b16 a[198:199], v41 offset:51200
 ds_read_b64_tr_b16 a[200:201], v41 offset:33800
 ds_read_b64_tr_b16 a[202:203], v41 offset:34312
 ds_read_b64_tr_b16 a[204:205], v41 offset:50696
 ds_read_b64_tr_b16 a[206:207], v41 offset:51208
 ds_read_b64_tr_b16 a[208:209], v59 offset:33824
 ds_read_b64_tr_b16 a[210:211], v59 offset:34336
 ds_read_b64_tr_b16 a[212:213], v59 offset:50720
 ds_read_b64_tr_b16 a[214:215], v59 offset:51232
 s_waitcnt lgkmcnt(8)
 v_mfma_f32_16x16x32_bf16 v[64:67], a[192:195], a[0:3], 0
 s_mov_b32 s82, 0x100
 s_add_u32 m0, s71, 0x0
 ds_read_b64_tr_b16 a[216:217], v59 offset:33832
 v_mfma_f32_16x16x32_bf16 v[64:67], a[196:199], a[12:15], v[64:67]
 buffer_load_dwordx4 v43, s[44:47], s82 offen lds
 ds_read_b64_tr_b16 a[218:219], v59 offset:34344
 v_mfma_f32_16x16x32_bf16 v[128:131], a[196:199], a[16:19], 0
 ds_read_b64_tr_b16 a[220:221], v59 offset:50728
 v_mfma_f32_16x16x32_bf16 v[128:131], a[192:195], a[4:7], v[128:131]
 ds_read_b64_tr_b16 a[222:223], v59 offset:51240
 v_mfma_f32_16x16x32_bf16 v[192:195], a[192:195], a[8:11], 0
 s_mov_b32 s83, 0x100
 s_add_u32 m0, s71, 0x400
 v_mfma_f32_16x16x32_bf16 v[192:195], a[196:199], a[20:23], v[192:195]
 s_waitcnt lgkmcnt(8)
 buffer_load_dwordx4 v44, s[44:47], s83 offen lds
 v_mfma_f32_16x16x32_bf16 v[196:199], a[204:207], a[20:23], 0
 ds_read_b64_tr_b16 a[192:193], v41 offset:33856
 v_mfma_f32_16x16x32_bf16 v[196:199], a[200:203], a[8:11], v[196:199]
 ds_read_b64_tr_b16 a[194:195], v41 offset:34368
 v_mfma_f32_16x16x32_bf16 v[132:135], a[200:203], a[4:7], 0
 s_mov_b32 s82, 0x3900
 s_add_u32 m0, s71, 0x800
 ds_read_b64_tr_b16 a[196:197], v41 offset:50752
 v_mfma_f32_16x16x32_bf16 v[132:135], a[204:207], a[16:19], v[132:135]
 buffer_load_dwordx4 v43, s[44:47], s82 offen lds
 ds_read_b64_tr_b16 a[198:199], v41 offset:51264
 v_mfma_f32_16x16x32_bf16 v[68:71], a[204:207], a[12:15], 0
 v_mfma_f32_16x16x32_bf16 v[68:71], a[200:203], a[0:3], v[68:71]
 s_waitcnt lgkmcnt(8)
 v_mfma_f32_16x16x32_bf16 v[72:75], a[208:211], a[0:3], 0
 ds_read_b64_tr_b16 a[200:201], v41 offset:33864
 s_waitcnt vmcnt(11)
 ds_read_b128 a[24:27], v46 offset:0
 v_mfma_f32_16x16x32_bf16 v[72:75], a[212:215], a[12:15], v[72:75]
 s_mov_b32 s83, 0x3900
 s_add_u32 m0, s71, 0xc00
 ds_read_b64_tr_b16 a[202:203], v41 offset:34376
 v_mfma_f32_16x16x32_bf16 v[136:139], a[212:215], a[16:19], 0
 buffer_load_dwordx4 v44, s[44:47], s83 offen lds
 ds_read_b64_tr_b16 a[204:205], v41 offset:50760
 v_mfma_f32_16x16x32_bf16 v[136:139], a[208:211], a[4:7], v[136:139]
 ds_read_b64_tr_b16 a[206:207], v41 offset:51272
 ds_read_b128 a[36:39], v47 offset:0
 v_mfma_f32_16x16x32_bf16 v[200:203], a[208:211], a[8:11], 0
 v_mfma_f32_16x16x32_bf16 v[200:203], a[212:215], a[20:23], v[200:203]
 s_waitcnt lgkmcnt(10)
 s_mov_b32 s82, 0x7100
 s_add_u32 m0, s71, 0x1000
 v_mfma_f32_16x16x32_bf16 v[204:207], a[220:223], a[20:23], 0
 buffer_load_dwordx4 v43, s[44:47], s82 offen lds
 ds_read_b64_tr_b16 a[208:209], v59 offset:33888
 ds_read_b128 a[28:31], v46 offset:2048
 v_mfma_f32_16x16x32_bf16 v[204:207], a[216:219], a[8:11], v[204:207]
 ds_read_b64_tr_b16 a[210:211], v59 offset:34400
 v_mfma_f32_16x16x32_bf16 v[140:143], a[216:219], a[4:7], 0
 ds_read_b64_tr_b16 a[212:213], v59 offset:50784
 v_mfma_f32_16x16x32_bf16 v[140:143], a[220:223], a[16:19], v[140:143]
 ds_read_b64_tr_b16 a[214:215], v59 offset:51296
 ds_read_b128 a[40:43], v47 offset:2048
 v_mfma_f32_16x16x32_bf16 v[76:79], a[220:223], a[12:15], 0
 s_mov_b32 s83, 0x7100
 s_add_u32 m0, s71, 0x1400
 v_mfma_f32_16x16x32_bf16 v[76:79], a[216:219], a[0:3], v[76:79]
 s_waitcnt lgkmcnt(12)
 buffer_load_dwordx4 v44, s[44:47], s83 offen lds
 v_mfma_f32_16x16x32_bf16 v[80:83], a[192:195], a[0:3], 0
 ds_read_b64_tr_b16 a[216:217], v59 offset:33896
 ds_read_b128 a[32:35], v46 offset:4096
 v_mfma_f32_16x16x32_bf16 v[80:83], a[196:199], a[12:15], v[80:83]
 ds_read_b64_tr_b16 a[218:219], v59 offset:34408
 v_mfma_f32_16x16x32_bf16 v[144:147], a[196:199], a[16:19], 0
 s_mov_b32 s82, 0x100000
 s_add_u32 m0, s74, 0x10800
 ds_read_b64_tr_b16 a[220:221], v59 offset:50792
 v_mfma_f32_16x16x32_bf16 v[144:147], a[192:195], a[4:7], v[144:147]
 buffer_load_dwordx4 v42, s[56:59], s82 offen nt lds
 ds_read_b64_tr_b16 a[222:223], v59 offset:51304
 ds_read_b128 a[44:47], v47 offset:4096
 v_mfma_f32_16x16x32_bf16 v[208:211], a[192:195], a[8:11], 0
 v_mfma_f32_16x16x32_bf16 v[208:211], a[196:199], a[20:23], v[208:211]
 s_waitcnt lgkmcnt(13)
 v_mfma_f32_16x16x32_bf16 v[212:215], a[204:207], a[20:23], 0
 s_mov_b32 s83, 0x102000
 s_add_u32 m0, s74, 0x10c28
 ds_read_b64_tr_b16 a[192:193], v41 offset:33920
 v_mfma_f32_16x16x32_bf16 v[212:215], a[200:203], a[8:11], v[212:215]
 buffer_load_dwordx4 v42, s[56:59], s83 offen nt lds
 ds_read_b64_tr_b16 a[194:195], v41 offset:34432
 v_mfma_f32_16x16x32_bf16 v[148:151], a[200:203], a[4:7], 0
 ds_read_b64_tr_b16 a[196:197], v41 offset:50816
 v_mfma_f32_16x16x32_bf16 v[148:151], a[204:207], a[16:19], v[148:151]
 ds_read_b64_tr_b16 a[198:199], v41 offset:51328
 v_mfma_f32_16x16x32_bf16 v[84:87], a[204:207], a[12:15], 0
 v_mfma_f32_16x16x32_bf16 v[84:87], a[200:203], a[0:3], v[84:87]
 s_waitcnt lgkmcnt(11)
 s_mov_b32 s82, 0x104000
 s_add_u32 m0, s74, 0x11040
 v_mfma_f32_16x16x32_bf16 v[88:91], a[208:211], a[0:3], 0
 buffer_load_dwordx4 v42, s[56:59], s82 offen nt lds
 ds_read_b64_tr_b16 a[200:201], v41 offset:33928
 v_mfma_f32_16x16x32_bf16 v[88:91], a[212:215], a[12:15], v[88:91]
 ds_read_b64_tr_b16 a[202:203], v41 offset:34440
 v_mfma_f32_16x16x32_bf16 v[152:155], a[212:215], a[16:19], 0
 ds_read_b64_tr_b16 a[204:205], v41 offset:50824
 v_mfma_f32_16x16x32_bf16 v[152:155], a[208:211], a[4:7], v[152:155]
 s_mov_b32 s83, 0x106000
 s_add_u32 m0, s74, 0x11468
 ds_read_b64_tr_b16 a[206:207], v41 offset:51336
 v_mfma_f32_16x16x32_bf16 v[216:219], a[208:211], a[8:11], 0
 buffer_load_dwordx4 v42, s[56:59], s83 offen nt lds
 v_mfma_f32_16x16x32_bf16 v[216:219], a[212:215], a[20:23], v[216:219]
 s_waitcnt lgkmcnt(9)
 v_mfma_f32_16x16x32_bf16 v[220:223], a[220:223], a[20:23], 0
 ds_read_b64_tr_b16 a[208:209], v59 offset:33952
 v_mfma_f32_16x16x32_bf16 v[220:223], a[216:219], a[8:11], v[220:223]
 ds_read_b64_tr_b16 a[210:211], v59 offset:34464
 v_mfma_f32_16x16x32_bf16 v[156:159], a[216:219], a[4:7], 0
 s_mov_b32 s82, 0x110000
 s_add_u32 m0, s74, 0x11880
 ds_read_b64_tr_b16 a[212:213], v59 offset:50848
 v_mfma_f32_16x16x32_bf16 v[156:159], a[220:223], a[16:19], v[156:159]
 buffer_load_dwordx4 v42, s[56:59], s82 offen nt lds
 ds_read_b64_tr_b16 a[214:215], v59 offset:51360
 v_mfma_f32_16x16x32_bf16 v[92:95], a[220:223], a[12:15], 0
 v_mfma_f32_16x16x32_bf16 v[92:95], a[216:219], a[0:3], v[92:95]
 s_waitcnt lgkmcnt(8)
 v_mfma_f32_16x16x32_bf16 v[96:99], a[192:195], a[0:3], 0
 s_mov_b32 s83, 0x112000
 s_add_u32 m0, s74, 0x11ca8
 ds_read_b64_tr_b16 a[216:217], v59 offset:33960
 v_mfma_f32_16x16x32_bf16 v[96:99], a[196:199], a[12:15], v[96:99]
 buffer_load_dwordx4 v42, s[56:59], s83 offen nt lds
 ds_read_b64_tr_b16 a[218:219], v59 offset:34472
 v_mfma_f32_16x16x32_bf16 v[160:163], a[196:199], a[16:19], 0
 ds_read_b64_tr_b16 a[220:221], v59 offset:50856
 v_mfma_f32_16x16x32_bf16 v[160:163], a[192:195], a[4:7], v[160:163]
 ds_read_b64_tr_b16 a[222:223], v59 offset:51368
 v_mfma_f32_16x16x32_bf16 v[224:227], a[192:195], a[8:11], 0
 s_mov_b32 s82, 0x114000
 s_add_u32 m0, s74, 0x120c0
 v_mfma_f32_16x16x32_bf16 v[224:227], a[196:199], a[20:23], v[224:227]
 s_waitcnt lgkmcnt(8)
 buffer_load_dwordx4 v42, s[56:59], s82 offen nt lds
 v_mfma_f32_16x16x32_bf16 v[228:231], a[204:207], a[20:23], 0
 ds_read_b64_tr_b16 a[192:193], v41 offset:33984
 v_mfma_f32_16x16x32_bf16 v[228:231], a[200:203], a[8:11], v[228:231]
 ds_read_b64_tr_b16 a[194:195], v41 offset:34496
 v_mfma_f32_16x16x32_bf16 v[164:167], a[200:203], a[4:7], 0
 ds_read_b64_tr_b16 a[196:197], v41 offset:50880
 v_mfma_f32_16x16x32_bf16 v[164:167], a[204:207], a[16:19], v[164:167]
 s_mov_b32 s83, 0x116000
 s_add_u32 m0, s74, 0x124e8
 ds_read_b64_tr_b16 a[198:199], v41 offset:51392
 v_mfma_f32_16x16x32_bf16 v[100:103], a[204:207], a[12:15], 0
 buffer_load_dwordx4 v42, s[56:59], s83 offen nt lds
 v_mfma_f32_16x16x32_bf16 v[100:103], a[200:203], a[0:3], v[100:103]
 s_waitcnt lgkmcnt(8)
 v_mfma_f32_16x16x32_bf16 v[104:107], a[208:211], a[0:3], 0
 ds_read_b64_tr_b16 a[200:201], v41 offset:33992
 v_mfma_f32_16x16x32_bf16 v[104:107], a[212:215], a[12:15], v[104:107]
 s_mov_b32 s82, 0x180
 s_add_u32 m0, s73, 0x0
 ds_read_b64_tr_b16 a[202:203], v41 offset:34504
 v_mfma_f32_16x16x32_bf16 v[168:171], a[212:215], a[16:19], 0
 buffer_load_dwordx4 v43, s[44:47], s82 offen lds
 ds_read_b64_tr_b16 a[204:205], v41 offset:50888
 v_mfma_f32_16x16x32_bf16 v[168:171], a[208:211], a[4:7], v[168:171]
 ds_read_b64_tr_b16 a[206:207], v41 offset:51400
 v_mfma_f32_16x16x32_bf16 v[232:235], a[208:211], a[8:11], 0
 v_mfma_f32_16x16x32_bf16 v[232:235], a[212:215], a[20:23], v[232:235]
 s_waitcnt lgkmcnt(8)
 v_mfma_f32_16x16x32_bf16 v[236:239], a[220:223], a[20:23], 0
 s_mov_b32 s83, 0x180
 s_add_u32 m0, s73, 0x400
 ds_read_b64_tr_b16 a[208:209], v59 offset:34016
 v_mfma_f32_16x16x32_bf16 v[236:239], a[216:219], a[8:11], v[236:239]
 buffer_load_dwordx4 v44, s[44:47], s83 offen lds
 ds_read_b64_tr_b16 a[210:211], v59 offset:34528
 v_mfma_f32_16x16x32_bf16 v[172:175], a[216:219], a[4:7], 0
 ds_read_b64_tr_b16 a[212:213], v59 offset:50912
 v_mfma_f32_16x16x32_bf16 v[172:175], a[220:223], a[16:19], v[172:175]
 ds_read_b64_tr_b16 a[214:215], v59 offset:51424
 v_mfma_f32_16x16x32_bf16 v[108:111], a[220:223], a[12:15], 0
 s_mov_b32 s82, 0x3980
 s_add_u32 m0, s73, 0x800
 v_mfma_f32_16x16x32_bf16 v[108:111], a[216:219], a[0:3], v[108:111]
 s_waitcnt lgkmcnt(8)
 buffer_load_dwordx4 v43, s[44:47], s82 offen lds
 v_mfma_f32_16x16x32_bf16 v[112:115], a[192:195], a[0:3], 0
 ds_read_b64_tr_b16 a[216:217], v59 offset:34024
 v_mfma_f32_16x16x32_bf16 v[112:115], a[196:199], a[12:15], v[112:115]
 ds_read_b64_tr_b16 a[218:219], v59 offset:34536
 v_mfma_f32_16x16x32_bf16 v[176:179], a[196:199], a[16:19], 0
 s_mov_b32 s83, 0x3980
 s_add_u32 m0, s73, 0xc00
 ds_read_b64_tr_b16 a[220:221], v59 offset:50920
 v_mfma_f32_16x16x32_bf16 v[176:179], a[192:195], a[4:7], v[176:179]
 buffer_load_dwordx4 v44, s[44:47], s83 offen lds
 ds_read_b64_tr_b16 a[222:223], v59 offset:51432
 v_mfma_f32_16x16x32_bf16 v[240:243], a[192:195], a[8:11], 0
 v_mfma_f32_16x16x32_bf16 v[240:243], a[196:199], a[20:23], v[240:243]
 s_waitcnt lgkmcnt(8)
 v_mfma_f32_16x16x32_bf16 v[244:247], a[204:207], a[20:23], 0
 v_mfma_f32_16x16x32_bf16 v[244:247], a[200:203], a[8:11], v[244:247]
 s_mov_b32 s82, 0x7180
 s_add_u32 m0, s73, 0x1000
 s_waitcnt vmcnt(18) lgkmcnt(0)
 s_barrier
 v_mfma_f32_16x16x32_bf16 v[180:183], a[200:203], a[4:7], 0
 buffer_load_dwordx4 v43, s[44:47], s82 offen lds
 ds_read_b64_tr_b16 a[192:193], v40 offset:33792
 v_mfma_f32_16x16x32_bf16 v[180:183], a[204:207], a[16:19], v[180:183]
 ds_read_b64_tr_b16 a[194:195], v40 offset:34304
 v_mfma_f32_16x16x32_bf16 v[116:119], a[204:207], a[12:15], 0
 ds_read_b64_tr_b16 a[196:197], v40 offset:50688
 v_mfma_f32_16x16x32_bf16 v[116:119], a[200:203], a[0:3], v[116:119]
 s_mov_b32 s83, 0x7180
 s_add_u32 m0, s73, 0x1400
 ds_read_b64_tr_b16 a[198:199], v40 offset:51200
 v_mfma_f32_16x16x32_bf16 v[120:123], a[208:211], a[0:3], 0
 buffer_load_dwordx4 v44, s[44:47], s83 offen lds
 ds_read_b64_tr_b16 a[200:201], v40 offset:33800
 v_mfma_f32_16x16x32_bf16 v[120:123], a[212:215], a[12:15], v[120:123]
 ds_read_b64_tr_b16 a[202:203], v40 offset:34312
 v_mfma_f32_16x16x32_bf16 v[184:187], a[212:215], a[16:19], 0
 ds_read_b64_tr_b16 a[204:205], v40 offset:50696
 v_mfma_f32_16x16x32_bf16 v[184:187], a[208:211], a[4:7], v[184:187]
 ds_read_b64_tr_b16 a[206:207], v40 offset:51208
 v_mfma_f32_16x16x32_bf16 v[248:251], a[208:211], a[8:11], 0
 v_mfma_f32_16x16x32_bf16 v[248:251], a[212:215], a[20:23], v[248:251]
 v_mfma_f32_16x16x32_bf16 v[252:255], a[220:223], a[20:23], 0
 ds_read_b64_tr_b16 a[208:209], v58 offset:33824
 v_mfma_f32_16x16x32_bf16 v[252:255], a[216:219], a[8:11], v[252:255]
 ds_read_b64_tr_b16 a[210:211], v58 offset:34336
 v_mfma_f32_16x16x32_bf16 v[188:191], a[216:219], a[4:7], 0
 ds_read_b64_tr_b16 a[212:213], v58 offset:50720
 v_mfma_f32_16x16x32_bf16 v[188:191], a[220:223], a[16:19], v[188:191]
 ds_read_b64_tr_b16 a[214:215], v58 offset:51232
 v_mfma_f32_16x16x32_bf16 v[124:127], a[220:223], a[12:15], 0
 v_mfma_f32_16x16x32_bf16 v[124:127], a[216:219], a[0:3], v[124:127]
 s_waitcnt lgkmcnt(8)
 v_mfma_f32_16x16x32_bf16 v[64:67], a[192:195], a[24:27], v[64:67]
 ds_read_b64_tr_b16 a[216:217], v58 offset:33832
 v_mfma_f32_16x16x32_bf16 v[64:67], a[196:199], a[36:39], v[64:67]
 ds_read_b64_tr_b16 a[218:219], v58 offset:34344
 v_mfma_f32_16x16x32_bf16 v[128:131], a[196:199], a[40:43], v[128:131]
 ds_read_b64_tr_b16 a[220:221], v58 offset:50728
 v_mfma_f32_16x16x32_bf16 v[128:131], a[192:195], a[28:31], v[128:131]
 s_mov_b32 s82, 0x180000
 s_add_u32 m0, s74, 0x18c00
 ds_read_b64_tr_b16 a[222:223], v58 offset:51240
 v_mfma_f32_16x16x32_bf16 v[192:195], a[192:195], a[32:35], v[192:195]
 buffer_load_dwordx4 v42, s[56:59], s82 offen nt lds
 v_mfma_f32_16x16x32_bf16 v[192:195], a[196:199], a[44:47], v[192:195]
 s_waitcnt lgkmcnt(8)
 v_mfma_f32_16x16x32_bf16 v[196:199], a[204:207], a[44:47], v[196:199]
 ds_read_b64_tr_b16 a[192:193], v40 offset:33856
 v_mfma_f32_16x16x32_bf16 v[196:199], a[200:203], a[32:35], v[196:199]
 ds_read_b64_tr_b16 a[194:195], v40 offset:34368
 v_mfma_f32_16x16x32_bf16 v[132:135], a[200:203], a[28:31], v[132:135]
 ds_read_b64_tr_b16 a[196:197], v40 offset:50752
 v_mfma_f32_16x16x32_bf16 v[132:135], a[204:207], a[40:43], v[132:135]
 s_mov_b32 s83, 0x182000
 s_add_u32 m0, s74, 0x19028
 ds_read_b64_tr_b16 a[198:199], v40 offset:51264
 v_mfma_f32_16x16x32_bf16 v[68:71], a[204:207], a[36:39], v[68:71]
 buffer_load_dwordx4 v42, s[56:59], s83 offen nt lds
 v_mfma_f32_16x16x32_bf16 v[68:71], a[200:203], a[24:27], v[68:71]
 s_waitcnt lgkmcnt(8)
 v_mfma_f32_16x16x32_bf16 v[72:75], a[208:211], a[24:27], v[72:75]
 ds_read_b64_tr_b16 a[200:201], v40 offset:33864
 s_waitcnt vmcnt(16)
 ds_read_b128 a[48:51], v48 offset:0
 v_mfma_f32_16x16x32_bf16 v[72:75], a[212:215], a[36:39], v[72:75]
 ds_read_b64_tr_b16 a[202:203], v40 offset:34376
 v_mfma_f32_16x16x32_bf16 v[136:139], a[212:215], a[40:43], v[136:139]
 ds_read_b64_tr_b16 a[204:205], v40 offset:50760
 v_mfma_f32_16x16x32_bf16 v[136:139], a[208:211], a[28:31], v[136:139]
 s_mov_b32 s82, 0x184000
 s_add_u32 m0, s74, 0x19440
 ds_read_b64_tr_b16 a[206:207], v40 offset:51272
 ds_read_b128 a[60:63], v49 offset:0
 v_mfma_f32_16x16x32_bf16 v[200:203], a[208:211], a[32:35], v[200:203]
 buffer_load_dwordx4 v42, s[56:59], s82 offen nt lds
 v_mfma_f32_16x16x32_bf16 v[200:203], a[212:215], a[44:47], v[200:203]
 s_waitcnt lgkmcnt(10)
 v_mfma_f32_16x16x32_bf16 v[204:207], a[220:223], a[44:47], v[204:207]
 ds_read_b64_tr_b16 a[208:209], v58 offset:33888
 ds_read_b128 a[52:55], v48 offset:2048
 v_mfma_f32_16x16x32_bf16 v[204:207], a[216:219], a[32:35], v[204:207]
 ds_read_b64_tr_b16 a[210:211], v58 offset:34400
 v_mfma_f32_16x16x32_bf16 v[140:143], a[216:219], a[28:31], v[140:143]
 ds_read_b64_tr_b16 a[212:213], v58 offset:50784
 v_mfma_f32_16x16x32_bf16 v[140:143], a[220:223], a[40:43], v[140:143]
 s_mov_b32 s83, 0x186000
 s_add_u32 m0, s74, 0x19868
 ds_read_b64_tr_b16 a[214:215], v58 offset:51296
 ds_read_b128 a[64:67], v49 offset:2048
 v_mfma_f32_16x16x32_bf16 v[76:79], a[220:223], a[36:39], v[76:79]
 buffer_load_dwordx4 v42, s[56:59], s83 offen nt lds
 v_mfma_f32_16x16x32_bf16 v[76:79], a[216:219], a[24:27], v[76:79]
 s_waitcnt lgkmcnt(12)
 v_mfma_f32_16x16x32_bf16 v[80:83], a[192:195], a[24:27], v[80:83]
 ds_read_b64_tr_b16 a[216:217], v58 offset:33896
 ds_read_b128 a[56:59], v48 offset:4096
 v_mfma_f32_16x16x32_bf16 v[80:83], a[196:199], a[36:39], v[80:83]
 ds_read_b64_tr_b16 a[218:219], v58 offset:34408
 v_mfma_f32_16x16x32_bf16 v[144:147], a[196:199], a[40:43], v[144:147]
 ds_read_b64_tr_b16 a[220:221], v58 offset:50792
 v_mfma_f32_16x16x32_bf16 v[144:147], a[192:195], a[28:31], v[144:147]
 s_mov_b32 s82, 0x190000
 s_add_u32 m0, s74, 0x19c80
 ds_read_b64_tr_b16 a[222:223], v58 offset:51304
 ds_read_b128 a[68:71], v49 offset:4096
 v_mfma_f32_16x16x32_bf16 v[208:211], a[192:195], a[32:35], v[208:211]
 buffer_load_dwordx4 v42, s[56:59], s82 offen nt lds
 v_mfma_f32_16x16x32_bf16 v[208:211], a[196:199], a[44:47], v[208:211]
 s_waitcnt lgkmcnt(13)
 v_mfma_f32_16x16x32_bf16 v[212:215], a[204:207], a[44:47], v[212:215]
 ds_read_b64_tr_b16 a[192:193], v40 offset:33920
 v_mfma_f32_16x16x32_bf16 v[212:215], a[200:203], a[32:35], v[212:215]
 ds_read_b64_tr_b16 a[194:195], v40 offset:34432
 v_mfma_f32_16x16x32_bf16 v[148:151], a[200:203], a[28:31], v[148:151]
 ds_read_b64_tr_b16 a[196:197], v40 offset:50816
 v_mfma_f32_16x16x32_bf16 v[148:151], a[204:207], a[40:43], v[148:151]
 s_mov_b32 s83, 0x192000
 s_add_u32 m0, s74, 0x1a0a8
 ds_read_b64_tr_b16 a[198:199], v40 offset:51328
 v_mfma_f32_16x16x32_bf16 v[84:87], a[204:207], a[36:39], v[84:87]
 buffer_load_dwordx4 v42, s[56:59], s83 offen nt lds
 v_mfma_f32_16x16x32_bf16 v[84:87], a[200:203], a[24:27], v[84:87]
 s_waitcnt lgkmcnt(11)
 v_mfma_f32_16x16x32_bf16 v[88:91], a[208:211], a[24:27], v[88:91]
 ds_read_b64_tr_b16 a[200:201], v40 offset:33928
 v_mfma_f32_16x16x32_bf16 v[88:91], a[212:215], a[36:39], v[88:91]
 ds_read_b64_tr_b16 a[202:203], v40 offset:34440
 v_mfma_f32_16x16x32_bf16 v[152:155], a[212:215], a[40:43], v[152:155]
 ds_read_b64_tr_b16 a[204:205], v40 offset:50824
 v_mfma_f32_16x16x32_bf16 v[152:155], a[208:211], a[28:31], v[152:155]
 s_mov_b32 s82, 0x194000
 s_add_u32 m0, s74, 0x1a4c0
 ds_read_b64_tr_b16 a[206:207], v40 offset:51336
 v_mfma_f32_16x16x32_bf16 v[216:219], a[208:211], a[32:35], v[216:219]
 buffer_load_dwordx4 v42, s[56:59], s82 offen nt lds
 v_mfma_f32_16x16x32_bf16 v[216:219], a[212:215], a[44:47], v[216:219]
 s_waitcnt lgkmcnt(9)
 v_mfma_f32_16x16x32_bf16 v[220:223], a[220:223], a[44:47], v[220:223]
 ds_read_b64_tr_b16 a[208:209], v58 offset:33952
 v_mfma_f32_16x16x32_bf16 v[220:223], a[216:219], a[32:35], v[220:223]
 ds_read_b64_tr_b16 a[210:211], v58 offset:34464
 v_mfma_f32_16x16x32_bf16 v[156:159], a[216:219], a[28:31], v[156:159]
 ds_read_b64_tr_b16 a[212:213], v58 offset:50848
 v_mfma_f32_16x16x32_bf16 v[156:159], a[220:223], a[40:43], v[156:159]
 s_mov_b32 s83, 0x196000
 s_add_u32 m0, s74, 0x1a8e8
 ds_read_b64_tr_b16 a[214:215], v58 offset:51360
 v_mfma_f32_16x16x32_bf16 v[92:95], a[220:223], a[36:39], v[92:95]
 buffer_load_dwordx4 v42, s[56:59], s83 offen nt lds
 v_mfma_f32_16x16x32_bf16 v[92:95], a[216:219], a[24:27], v[92:95]
 s_waitcnt lgkmcnt(8)
 v_mfma_f32_16x16x32_bf16 v[96:99], a[192:195], a[24:27], v[96:99]
 ds_read_b64_tr_b16 a[216:217], v58 offset:33960
 v_mfma_f32_16x16x32_bf16 v[96:99], a[196:199], a[36:39], v[96:99]
 ds_read_b64_tr_b16 a[218:219], v58 offset:34472
 v_mfma_f32_16x16x32_bf16 v[160:163], a[196:199], a[40:43], v[160:163]
 ds_read_b64_tr_b16 a[220:221], v58 offset:50856
 v_mfma_f32_16x16x32_bf16 v[160:163], a[192:195], a[28:31], v[160:163]
 s_mov_b32 s82, 0x200
 s_add_u32 m0, s71, 0x0
 ds_read_b64_tr_b16 a[222:223], v58 offset:51368
 v_mfma_f32_16x16x32_bf16 v[224:227], a[192:195], a[32:35], v[224:227]
 buffer_load_dwordx4 v43, s[44:47], s82 offen lds
 v_mfma_f32_16x16x32_bf16 v[224:227], a[196:199], a[44:47], v[224:227]
 s_waitcnt lgkmcnt(8)
 v_mfma_f32_16x16x32_bf16 v[228:231], a[204:207], a[44:47], v[228:231]
 ds_read_b64_tr_b16 a[192:193], v40 offset:33984
 v_mfma_f32_16x16x32_bf16 v[228:231], a[200:203], a[32:35], v[228:231]
 ds_read_b64_tr_b16 a[194:195], v40 offset:34496
 v_mfma_f32_16x16x32_bf16 v[164:167], a[200:203], a[28:31], v[164:167]
 ds_read_b64_tr_b16 a[196:197], v40 offset:50880
 v_mfma_f32_16x16x32_bf16 v[164:167], a[204:207], a[40:43], v[164:167]
 s_mov_b32 s83, 0x200
 s_add_u32 m0, s71, 0x400
 ds_read_b64_tr_b16 a[198:199], v40 offset:51392
 v_mfma_f32_16x16x32_bf16 v[100:103], a[204:207], a[36:39], v[100:103]
 buffer_load_dwordx4 v44, s[44:47], s83 offen lds
 v_mfma_f32_16x16x32_bf16 v[100:103], a[200:203], a[24:27], v[100:103]
 s_waitcnt lgkmcnt(8)
 v_mfma_f32_16x16x32_bf16 v[104:107], a[208:211], a[24:27], v[104:107]
 ds_read_b64_tr_b16 a[200:201], v40 offset:33992
 v_mfma_f32_16x16x32_bf16 v[104:107], a[212:215], a[36:39], v[104:107]
 ds_read_b64_tr_b16 a[202:203], v40 offset:34504
 v_mfma_f32_16x16x32_bf16 v[168:171], a[212:215], a[40:43], v[168:171]
 ds_read_b64_tr_b16 a[204:205], v40 offset:50888
 v_mfma_f32_16x16x32_bf16 v[168:171], a[208:211], a[28:31], v[168:171]
 s_mov_b32 s82, 0x3a00
 s_add_u32 m0, s71, 0x800
 ds_read_b64_tr_b16 a[206:207], v40 offset:51400
 v_mfma_f32_16x16x32_bf16 v[232:235], a[208:211], a[32:35], v[232:235]
 buffer_load_dwordx4 v43, s[44:47], s82 offen lds
 v_mfma_f32_16x16x32_bf16 v[232:235], a[212:215], a[44:47], v[232:235]
 s_waitcnt lgkmcnt(8)
 v_mfma_f32_16x16x32_bf16 v[236:239], a[220:223], a[44:47], v[236:239]
 ds_read_b64_tr_b16 a[208:209], v58 offset:34016
 v_mfma_f32_16x16x32_bf16 v[236:239], a[216:219], a[32:35], v[236:239]
 ds_read_b64_tr_b16 a[210:211], v58 offset:34528
 v_mfma_f32_16x16x32_bf16 v[172:175], a[216:219], a[28:31], v[172:175]
 ds_read_b64_tr_b16 a[212:213], v58 offset:50912
 v_mfma_f32_16x16x32_bf16 v[172:175], a[220:223], a[40:43], v[172:175]
 s_mov_b32 s83, 0x3a00
 s_add_u32 m0, s71, 0xc00
 ds_read_b64_tr_b16 a[214:215], v58 offset:51424
 v_mfma_f32_16x16x32_bf16 v[108:111], a[220:223], a[36:39], v[108:111]
 buffer_load_dwordx4 v44, s[44:47], s83 offen lds
 v_mfma_f32_16x16x32_bf16 v[108:111], a[216:219], a[24:27], v[108:111]
 s_waitcnt lgkmcnt(8)
 v_mfma_f32_16x16x32_bf16 v[112:115], a[192:195], a[24:27], v[112:115]
 ds_read_b64_tr_b16 a[216:217], v58 offset:34024
 v_mfma_f32_16x16x32_bf16 v[112:115], a[196:199], a[36:39], v[112:115]
 ds_read_b64_tr_b16 a[218:219], v58 offset:34536
 v_mfma_f32_16x16x32_bf16 v[176:179], a[196:199], a[40:43], v[176:179]
 ds_read_b64_tr_b16 a[220:221], v58 offset:50920
 v_mfma_f32_16x16x32_bf16 v[176:179], a[192:195], a[28:31], v[176:179]
 s_mov_b32 s82, 0x7200
 s_add_u32 m0, s71, 0x1000
 ds_read_b64_tr_b16 a[222:223], v58 offset:51432
 v_mfma_f32_16x16x32_bf16 v[240:243], a[192:195], a[32:35], v[240:243]
 buffer_load_dwordx4 v43, s[44:47], s82 offen lds
 v_mfma_f32_16x16x32_bf16 v[240:243], a[196:199], a[44:47], v[240:243]
 s_waitcnt lgkmcnt(8)
 v_mfma_f32_16x16x32_bf16 v[244:247], a[204:207], a[44:47], v[244:247]
 v_mfma_f32_16x16x32_bf16 v[244:247], a[200:203], a[32:35], v[244:247]
 s_waitcnt vmcnt(19) lgkmcnt(0)
 s_barrier
 v_mfma_f32_16x16x32_bf16 v[180:183], a[200:203], a[28:31], v[180:183]
 ds_read_b64_tr_b16 a[192:193], v41 offset:0
 v_mfma_f32_16x16x32_bf16 v[180:183], a[204:207], a[40:43], v[180:183]
 ds_read_b64_tr_b16 a[194:195], v41 offset:512
 v_mfma_f32_16x16x32_bf16 v[116:119], a[204:207], a[36:39], v[116:119]
 ds_read_b64_tr_b16 a[196:197], v41 offset:16896
 v_mfma_f32_16x16x32_bf16 v[116:119], a[200:203], a[24:27], v[116:119]
 ds_read_b64_tr_b16 a[198:199], v41 offset:17408
 v_mfma_f32_16x16x32_bf16 v[120:123], a[208:211], a[24:27], v[120:123]
 ds_read_b64_tr_b16 a[200:201], v41 offset:8
 v_mfma_f32_16x16x32_bf16 v[120:123], a[212:215], a[36:39], v[120:123]
 ds_read_b64_tr_b16 a[202:203], v41 offset:520
 v_mfma_f32_16x16x32_bf16 v[184:187], a[212:215], a[40:43], v[184:187]
 ds_read_b64_tr_b16 a[204:205], v41 offset:16904
 v_mfma_f32_16x16x32_bf16 v[184:187], a[208:211], a[28:31], v[184:187]
 s_mov_b32 s83, 0x7200
 s_add_u32 m0, s71, 0x1400
 ds_read_b64_tr_b16 a[206:207], v41 offset:17416
 v_mfma_f32_16x16x32_bf16 v[248:251], a[208:211], a[32:35], v[248:251]
 buffer_load_dwordx4 v44, s[44:47], s83 offen lds
 v_mfma_f32_16x16x32_bf16 v[248:251], a[212:215], a[44:47], v[248:251]
 v_mfma_f32_16x16x32_bf16 v[252:255], a[220:223], a[44:47], v[252:255]
 ds_read_b64_tr_b16 a[208:209], v59 offset:32
 v_mfma_f32_16x16x32_bf16 v[252:255], a[216:219], a[32:35], v[252:255]
 ds_read_b64_tr_b16 a[210:211], v59 offset:544
 v_mfma_f32_16x16x32_bf16 v[188:191], a[216:219], a[28:31], v[188:191]
 ds_read_b64_tr_b16 a[212:213], v59 offset:16928
 v_mfma_f32_16x16x32_bf16 v[188:191], a[220:223], a[40:43], v[188:191]
 ds_read_b64_tr_b16 a[214:215], v59 offset:17440
 v_mfma_f32_16x16x32_bf16 v[124:127], a[220:223], a[36:39], v[124:127]
 v_mfma_f32_16x16x32_bf16 v[124:127], a[216:219], a[24:27], v[124:127]
 s_waitcnt lgkmcnt(8)
 v_mfma_f32_16x16x32_bf16 v[64:67], a[192:195], a[48:51], v[64:67]
 ds_read_b64_tr_b16 a[216:217], v59 offset:40
 v_mfma_f32_16x16x32_bf16 v[64:67], a[196:199], a[60:63], v[64:67]
 ds_read_b64_tr_b16 a[218:219], v59 offset:552
 v_mfma_f32_16x16x32_bf16 v[128:131], a[196:199], a[64:67], v[128:131]
 ds_read_b64_tr_b16 a[220:221], v59 offset:16936
 v_mfma_f32_16x16x32_bf16 v[128:131], a[192:195], a[52:55], v[128:131]
 s_mov_b32 s82, 0x200000
 s_add_u32 m0, s74, 0x8400
 ds_read_b64_tr_b16 a[222:223], v59 offset:17448
 v_mfma_f32_16x16x32_bf16 v[192:195], a[192:195], a[56:59], v[192:195]
 buffer_load_dwordx4 v42, s[56:59], s82 offen nt lds
 v_mfma_f32_16x16x32_bf16 v[192:195], a[196:199], a[68:71], v[192:195]
 s_waitcnt lgkmcnt(8)
 v_mfma_f32_16x16x32_bf16 v[196:199], a[204:207], a[68:71], v[196:199]
 ds_read_b64_tr_b16 a[192:193], v41 offset:64
 v_mfma_f32_16x16x32_bf16 v[196:199], a[200:203], a[56:59], v[196:199]
 ds_read_b64_tr_b16 a[194:195], v41 offset:576
 v_mfma_f32_16x16x32_bf16 v[132:135], a[200:203], a[52:55], v[132:135]
 ds_read_b64_tr_b16 a[196:197], v41 offset:16960
 v_mfma_f32_16x16x32_bf16 v[132:135], a[204:207], a[64:67], v[132:135]
 s_mov_b32 s83, 0x202000
 s_add_u32 m0, s74, 0x8828
 ds_read_b64_tr_b16 a[198:199], v41 offset:17472
 v_mfma_f32_16x16x32_bf16 v[68:71], a[204:207], a[60:63], v[68:71]
 buffer_load_dwordx4 v42, s[56:59], s83 offen nt lds
 v_mfma_f32_16x16x32_bf16 v[68:71], a[200:203], a[48:51], v[68:71]
 s_waitcnt lgkmcnt(8)
 v_mfma_f32_16x16x32_bf16 v[72:75], a[208:211], a[48:51], v[72:75]
 ds_read_b64_tr_b16 a[200:201], v41 offset:72
 s_waitcnt vmcnt(16)
 ds_read_b128 a[72:75], v46 offset:0
 v_mfma_f32_16x16x32_bf16 v[72:75], a[212:215], a[60:63], v[72:75]
 ds_read_b64_tr_b16 a[202:203], v41 offset:584
 v_mfma_f32_16x16x32_bf16 v[136:139], a[212:215], a[64:67], v[136:139]
 ds_read_b64_tr_b16 a[204:205], v41 offset:16968
 v_mfma_f32_16x16x32_bf16 v[136:139], a[208:211], a[52:55], v[136:139]
 s_mov_b32 s82, 0x204000
 s_add_u32 m0, s74, 0x8c40
 ds_read_b64_tr_b16 a[206:207], v41 offset:17480
 ds_read_b128 a[84:87], v47 offset:0
 v_mfma_f32_16x16x32_bf16 v[200:203], a[208:211], a[56:59], v[200:203]
 buffer_load_dwordx4 v42, s[56:59], s82 offen nt lds
 v_mfma_f32_16x16x32_bf16 v[200:203], a[212:215], a[68:71], v[200:203]
 s_waitcnt lgkmcnt(10)
 v_mfma_f32_16x16x32_bf16 v[204:207], a[220:223], a[68:71], v[204:207]
 ds_read_b64_tr_b16 a[208:209], v59 offset:96
 ds_read_b128 a[76:79], v46 offset:2048
 v_mfma_f32_16x16x32_bf16 v[204:207], a[216:219], a[56:59], v[204:207]
 ds_read_b64_tr_b16 a[210:211], v59 offset:608
 v_mfma_f32_16x16x32_bf16 v[140:143], a[216:219], a[52:55], v[140:143]
 ds_read_b64_tr_b16 a[212:213], v59 offset:16992
 v_mfma_f32_16x16x32_bf16 v[140:143], a[220:223], a[64:67], v[140:143]
 s_mov_b32 s83, 0x206000
 s_add_u32 m0, s74, 0x9068
 ds_read_b64_tr_b16 a[214:215], v59 offset:17504
 ds_read_b128 a[88:91], v47 offset:2048
 v_mfma_f32_16x16x32_bf16 v[76:79], a[220:223], a[60:63], v[76:79]
 buffer_load_dwordx4 v42, s[56:59], s83 offen nt lds
 v_mfma_f32_16x16x32_bf16 v[76:79], a[216:219], a[48:51], v[76:79]
 s_waitcnt lgkmcnt(12)
 v_mfma_f32_16x16x32_bf16 v[80:83], a[192:195], a[48:51], v[80:83]
 ds_read_b64_tr_b16 a[216:217], v59 offset:104
 ds_read_b128 a[80:83], v46 offset:4096
 v_mfma_f32_16x16x32_bf16 v[80:83], a[196:199], a[60:63], v[80:83]
 ds_read_b64_tr_b16 a[218:219], v59 offset:616
 v_mfma_f32_16x16x32_bf16 v[144:147], a[196:199], a[64:67], v[144:147]
 ds_read_b64_tr_b16 a[220:221], v59 offset:17000
 v_mfma_f32_16x16x32_bf16 v[144:147], a[192:195], a[52:55], v[144:147]
 s_mov_b32 s82, 0x210000
 s_add_u32 m0, s74, 0x9480
 ds_read_b64_tr_b16 a[222:223], v59 offset:17512
 ds_read_b128 a[92:95], v47 offset:4096
 v_mfma_f32_16x16x32_bf16 v[208:211], a[192:195], a[56:59], v[208:211]
 buffer_load_dwordx4 v42, s[56:59], s82 offen nt lds
 v_mfma_f32_16x16x32_bf16 v[208:211], a[196:199], a[68:71], v[208:211]
 s_waitcnt lgkmcnt(13)
 v_mfma_f32_16x16x32_bf16 v[212:215], a[204:207], a[68:71], v[212:215]
 ds_read_b64_tr_b16 a[192:193], v41 offset:128
 v_mfma_f32_16x16x32_bf16 v[212:215], a[200:203], a[56:59], v[212:215]
 ds_read_b64_tr_b16 a[194:195], v41 offset:640
 v_mfma_f32_16x16x32_bf16 v[148:151], a[200:203], a[52:55], v[148:151]
 ds_read_b64_tr_b16 a[196:197], v41 offset:17024
 v_mfma_f32_16x16x32_bf16 v[148:151], a[204:207], a[64:67], v[148:151]
 s_mov_b32 s83, 0x212000
 s_add_u32 m0, s74, 0x98a8
 ds_read_b64_tr_b16 a[198:199], v41 offset:17536
 v_mfma_f32_16x16x32_bf16 v[84:87], a[204:207], a[60:63], v[84:87]
 buffer_load_dwordx4 v42, s[56:59], s83 offen nt lds
L1_PAD2:
 s_cbranch_execz L1_PRT2
 v_mfma_f32_16x16x32_bf16 v[84:87], a[200:203], a[48:51], v[84:87]
 s_waitcnt lgkmcnt(11)
 v_mfma_f32_16x16x32_bf16 v[88:91], a[208:211], a[48:51], v[88:91]
 ds_read_b64_tr_b16 a[200:201], v41 offset:136
 v_mfma_f32_16x16x32_bf16 v[88:91], a[212:215], a[60:63], v[88:91]
 ds_read_b64_tr_b16 a[202:203], v41 offset:648
 v_mfma_f32_16x16x32_bf16 v[152:155], a[212:215], a[64:67], v[152:155]
 ds_read_b64_tr_b16 a[204:205], v41 offset:17032
 v_mfma_f32_16x16x32_bf16 v[152:155], a[208:211], a[52:55], v[152:155]
 s_mov_b32 s82, 0x214000
 s_add_u32 m0, s74, 0x9cc0
 ds_read_b64_tr_b16 a[206:207], v41 offset:17544
 v_mfma_f32_16x16x32_bf16 v[216:219], a[208:211], a[56:59], v[216:219]
 buffer_load_dwordx4 v42, s[56:59], s82 offen nt lds
 v_mfma_f32_16x16x32_bf16 v[216:219], a[212:215], a[68:71], v[216:219]
 s_waitcnt lgkmcnt(9)
 v_mfma_f32_16x16x32_bf16 v[220:223], a[220:223], a[68:71], v[220:223]
 ds_read_b64_tr_b16 a[208:209], v59 offset:160
 v_mfma_f32_16x16x32_bf16 v[220:223], a[216:219], a[56:59], v[220:223]
 ds_read_b64_tr_b16 a[210:211], v59 offset:672
 v_mfma_f32_16x16x32_bf16 v[156:159], a[216:219], a[52:55], v[156:159]
 ds_read_b64_tr_b16 a[212:213], v59 offset:17056
 v_mfma_f32_16x16x32_bf16 v[156:159], a[220:223], a[64:67], v[156:159]
 s_mov_b32 s83, 0x216000
 s_add_u32 m0, s74, 0xa0e8
 ds_read_b64_tr_b16 a[214:215], v59 offset:17568
 v_mfma_f32_16x16x32_bf16 v[92:95], a[220:223], a[60:63], v[92:95]
 buffer_load_dwordx4 v42, s[56:59], s83 offen nt lds
 v_mfma_f32_16x16x32_bf16 v[92:95], a[216:219], a[48:51], v[92:95]
 s_waitcnt lgkmcnt(8)
 v_mfma_f32_16x16x32_bf16 v[96:99], a[192:195], a[48:51], v[96:99]
 ds_read_b64_tr_b16 a[216:217], v59 offset:168
 v_mfma_f32_16x16x32_bf16 v[96:99], a[196:199], a[60:63], v[96:99]
 ds_read_b64_tr_b16 a[218:219], v59 offset:680
 v_mfma_f32_16x16x32_bf16 v[160:163], a[196:199], a[64:67], v[160:163]
 ds_read_b64_tr_b16 a[220:221], v59 offset:17064
 v_mfma_f32_16x16x32_bf16 v[160:163], a[192:195], a[52:55], v[160:163]
 s_mov_b32 s82, 0x280
 s_add_u32 m0, s73, 0x0
 ds_read_b64_tr_b16 a[222:223], v59 offset:17576
 v_mfma_f32_16x16x32_bf16 v[224:227], a[192:195], a[56:59], v[224:227]
 buffer_load_dwordx4 v43, s[44:47], s82 offen lds
 v_mfma_f32_16x16x32_bf16 v[224:227], a[196:199], a[68:71], v[224:227]
 s_waitcnt lgkmcnt(8)
 v_mfma_f32_16x16x32_bf16 v[228:231], a[204:207], a[68:71], v[228:231]
 ds_read_b64_tr_b16 a[192:193], v41 offset:192
 v_mfma_f32_16x16x32_bf16 v[228:231], a[200:203], a[56:59], v[228:231]
 ds_read_b64_tr_b16 a[194:195], v41 offset:704
 v_mfma_f32_16x16x32_bf16 v[164:167], a[200:203], a[52:55], v[164:167]
 ds_read_b64_tr_b16 a[196:197], v41 offset:17088
 v_mfma_f32_16x16x32_bf16 v[164:167], a[204:207], a[64:67], v[164:167]
 s_mov_b32 s83, 0x280
 s_add_u32 m0, s73, 0x400
 ds_read_b64_tr_b16 a[198:199], v41 offset:17600
 v_mfma_f32_16x16x32_bf16 v[100:103], a[204:207], a[60:63], v[100:103]
 buffer_load_dwordx4 v44, s[44:47], s83 offen lds
 v_mfma_f32_16x16x32_bf16 v[100:103], a[200:203], a[48:51], v[100:103]
 s_waitcnt lgkmcnt(8)
 v_mfma_f32_16x16x32_bf16 v[104:107], a[208:211], a[48:51], v[104:107]
 ds_read_b64_tr_b16 a[200:201], v41 offset:200
 v_mfma_f32_16x16x32_bf16 v[104:107], a[212:215], a[60:63], v[104:107]
 ds_read_b64_tr_b16 a[202:203], v41 offset:712
 v_mfma_f32_16x16x32_bf16 v[168:171], a[212:215], a[64:67], v[168:171]
 ds_read_b64_tr_b16 a[204:205], v41 offset:17096
 v_mfma_f32_16x16x32_bf16 v[168:171], a[208:211], a[52:55], v[168:171]
 s_mov_b32 s82, 0x3a80
 s_add_u32 m0, s73, 0x800
 ds_read_b64_tr_b16 a[206:207], v41 offset:17608
 v_mfma_f32_16x16x32_bf16 v[232:235], a[208:211], a[56:59], v[232:235]
 buffer_load_dwordx4 v43, s[44:47], s82 offen lds
 v_mfma_f32_16x16x32_bf16 v[232:235], a[212:215], a[68:71], v[232:235]
 s_waitcnt lgkmcnt(8)
 v_mfma_f32_16x16x32_bf16 v[236:239], a[220:223], a[68:71], v[236:239]
 ds_read_b64_tr_b16 a[208:209], v59 offset:224
 v_mfma_f32_16x16x32_bf16 v[236:239], a[216:219], a[56:59], v[236:239]
 ds_read_b64_tr_b16 a[210:211], v59 offset:736
 v_mfma_f32_16x16x32_bf16 v[172:175], a[216:219], a[52:55], v[172:175]
 ds_read_b64_tr_b16 a[212:213], v59 offset:17120
 v_mfma_f32_16x16x32_bf16 v[172:175], a[220:223], a[64:67], v[172:175]
 s_mov_b32 s83, 0x3a80
 s_add_u32 m0, s73, 0xc00
 ds_read_b64_tr_b16 a[214:215], v59 offset:17632
 v_mfma_f32_16x16x32_bf16 v[108:111], a[220:223], a[60:63], v[108:111]
 buffer_load_dwordx4 v44, s[44:47], s83 offen lds
 v_mfma_f32_16x16x32_bf16 v[108:111], a[216:219], a[48:51], v[108:111]
 s_waitcnt lgkmcnt(8)
 v_mfma_f32_16x16x32_bf16 v[112:115], a[192:195], a[48:51], v[112:115]
 ds_read_b64_tr_b16 a[216:217], v59 offset:232
 v_mfma_f32_16x16x32_bf16 v[112:115], a[196:199], a[60:63], v[112:115]
 ds_read_b64_tr_b16 a[218:219], v59 offset:744
 v_mfma_f32_16x16x32_bf16 v[176:179], a[196:199], a[64:67], v[176:179]
 ds_read_b64_tr_b16 a[220:221], v59 offset:17128
 v_mfma_f32_16x16x32_bf16 v[176:179], a[192:195], a[52:55], v[176:179]
 s_mov_b32 s82, 0x7280
 s_add_u32 m0, s73, 0x1000
 ds_read_b64_tr_b16 a[222:223], v59 offset:17640
 v_mfma_f32_16x16x32_bf16 v[240:243], a[192:195], a[56:59], v[240:243]
 buffer_load_dwordx4 v43, s[44:47], s82 offen lds
 v_mfma_f32_16x16x32_bf16 v[240:243], a[196:199], a[68:71], v[240:243]
 s_waitcnt lgkmcnt(8)
 v_mfma_f32_16x16x32_bf16 v[244:247], a[204:207], a[68:71], v[244:247]
 v_mfma_f32_16x16x32_bf16 v[244:247], a[200:203], a[56:59], v[244:247]
 s_waitcnt vmcnt(19) lgkmcnt(0)
 s_barrier
 v_mfma_f32_16x16x32_bf16 v[180:183], a[200:203], a[52:55], v[180:183]
 ds_read_b64_tr_b16 a[192:193], v41 offset:33792
 v_mfma_f32_16x16x32_bf16 v[180:183], a[204:207], a[64:67], v[180:183]
 ds_read_b64_tr_b16 a[194:195], v41 offset:34304
 v_mfma_f32_16x16x32_bf16 v[116:119], a[204:207], a[60:63], v[116:119]
 ds_read_b64_tr_b16 a[196:197], v41 offset:50688
 v_mfma_f32_16x16x32_bf16 v[116:119], a[200:203], a[48:51], v[116:119]
 ds_read_b64_tr_b16 a[198:199], v41 offset:51200
 v_mfma_f32_16x16x32_bf16 v[120:123], a[208:211], a[48:51], v[120:123]
 ds_read_b64_tr_b16 a[200:201], v41 offset:33800
 v_mfma_f32_16x16x32_bf16 v[120:123], a[212:215], a[60:63], v[120:123]
 ds_read_b64_tr_b16 a[202:203], v41 offset:34312
 v_mfma_f32_16x16x32_bf16 v[184:187], a[212:215], a[64:67], v[184:187]
 ds_read_b64_tr_b16 a[204:205], v41 offset:50696
 v_mfma_f32_16x16x32_bf16 v[184:187], a[208:211], a[52:55], v[184:187]
 s_mov_b32 s83, 0x7280
 s_add_u32 m0, s73, 0x1400
 ds_read_b64_tr_b16 a[206:207], v41 offset:51208
 v_mfma_f32_16x16x32_bf16 v[248:251], a[208:211], a[56:59], v[248:251]
 buffer_load_dwordx4 v44, s[44:47], s83 offen lds
 v_mfma_f32_16x16x32_bf16 v[248:251], a[212:215], a[68:71], v[248:251]
 v_mfma_f32_16x16x32_bf16 v[252:255], a[220:223], a[68:71], v[252:255]
 ds_read_b64_tr_b16 a[208:209], v59 offset:33824
 v_mfma_f32_16x16x32_bf16 v[252:255], a[216:219], a[56:59], v[252:255]
 ds_read_b64_tr_b16 a[210:211], v59 offset:34336
 v_mfma_f32_16x16x32_bf16 v[188:191], a[216:219], a[52:55], v[188:191]
 ds_read_b64_tr_b16 a[212:213], v59 offset:50720
 v_mfma_f32_16x16x32_bf16 v[188:191], a[220:223], a[64:67], v[188:191]
 ds_read_b64_tr_b16 a[214:215], v59 offset:51232
 v_mfma_f32_16x16x32_bf16 v[124:127], a[220:223], a[60:63], v[124:127]
 v_mfma_f32_16x16x32_bf16 v[124:127], a[216:219], a[48:51], v[124:127]
 s_waitcnt lgkmcnt(8)
 v_mfma_f32_16x16x32_bf16 v[64:67], a[192:195], a[72:75], v[64:67]
 ds_read_b64_tr_b16 a[216:217], v59 offset:33832
 v_mfma_f32_16x16x32_bf16 v[64:67], a[196:199], a[84:87], v[64:67]
 ds_read_b64_tr_b16 a[218:219], v59 offset:34344
 v_mfma_f32_16x16x32_bf16 v[128:131], a[196:199], a[88:91], v[128:131]
 ds_read_b64_tr_b16 a[220:221], v59 offset:50728
 v_mfma_f32_16x16x32_bf16 v[128:131], a[192:195], a[76:79], v[128:131]
 s_mov_b32 s82, 0x280000
 s_add_u32 m0, s74, 0x10800
 ds_read_b64_tr_b16 a[222:223], v59 offset:51240
 v_mfma_f32_16x16x32_bf16 v[192:195], a[192:195], a[80:83], v[192:195]
 buffer_load_dwordx4 v42, s[56:59], s82 offen nt lds
 v_mfma_f32_16x16x32_bf16 v[192:195], a[196:199], a[92:95], v[192:195]
 s_waitcnt lgkmcnt(8)
 v_mfma_f32_16x16x32_bf16 v[196:199], a[204:207], a[92:95], v[196:199]
 ds_read_b64_tr_b16 a[192:193], v41 offset:33856
 v_mfma_f32_16x16x32_bf16 v[196:199], a[200:203], a[80:83], v[196:199]
 ds_read_b64_tr_b16 a[194:195], v41 offset:34368
 v_mfma_f32_16x16x32_bf16 v[132:135], a[200:203], a[76:79], v[132:135]
 ds_read_b64_tr_b16 a[196:197], v41 offset:50752
 v_mfma_f32_16x16x32_bf16 v[132:135], a[204:207], a[88:91], v[132:135]
 s_mov_b32 s83, 0x282000
 s_add_u32 m0, s74, 0x10c28
 ds_read_b64_tr_b16 a[198:199], v41 offset:51264
 v_mfma_f32_16x16x32_bf16 v[68:71], a[204:207], a[84:87], v[68:71]
 buffer_load_dwordx4 v42, s[56:59], s83 offen nt lds
 v_mfma_f32_16x16x32_bf16 v[68:71], a[200:203], a[72:75], v[68:71]
 s_waitcnt lgkmcnt(8)
 v_mfma_f32_16x16x32_bf16 v[72:75], a[208:211], a[72:75], v[72:75]
 ds_read_b64_tr_b16 a[200:201], v41 offset:33864
 s_waitcnt vmcnt(16)
 ds_read_b128 a[96:99], v48 offset:0
 v_mfma_f32_16x16x32_bf16 v[72:75], a[212:215], a[84:87], v[72:75]
 ds_read_b64_tr_b16 a[202:203], v41 offset:34376
 v_mfma_f32_16x16x32_bf16 v[136:139], a[212:215], a[88:91], v[136:139]
 ds_read_b64_tr_b16 a[204:205], v41 offset:50760
 v_mfma_f32_16x16x32_bf16 v[136:139], a[208:211], a[76:79], v[136:139]
 s_mov_b32 s82, 0x284000
 s_add_u32 m0, s74, 0x11040
 ds_read_b64_tr_b16 a[206:207], v41 offset:51272
 ds_read_b128 a[108:111], v49 offset:0
 v_mfma_f32_16x16x32_bf16 v[200:203], a[208:211], a[80:83], v[200:203]
 buffer_load_dwordx4 v42, s[56:59], s82 offen nt lds
 v_mfma_f32_16x16x32_bf16 v[200:203], a[212:215], a[92:95], v[200:203]
 s_waitcnt lgkmcnt(10)
 v_mfma_f32_16x16x32_bf16 v[204:207], a[220:223], a[92:95], v[204:207]
 ds_read_b64_tr_b16 a[208:209], v59 offset:33888
 ds_read_b128 a[100:103], v48 offset:2048
 v_mfma_f32_16x16x32_bf16 v[204:207], a[216:219], a[80:83], v[204:207]
 ds_read_b64_tr_b16 a[210:211], v59 offset:34400
 v_mfma_f32_16x16x32_bf16 v[140:143], a[216:219], a[76:79], v[140:143]
 ds_read_b64_tr_b16 a[212:213], v59 offset:50784
 v_mfma_f32_16x16x32_bf16 v[140:143], a[220:223], a[88:91], v[140:143]
 s_mov_b32 s83, 0x286000
 s_add_u32 m0, s74, 0x11468
 ds_read_b64_tr_b16 a[214:215], v59 offset:51296
 ds_read_b128 a[112:115], v49 offset:2048
 v_mfma_f32_16x16x32_bf16 v[76:79], a[220:223], a[84:87], v[76:79]
 buffer_load_dwordx4 v42, s[56:59], s83 offen nt lds
 v_mfma_f32_16x16x32_bf16 v[76:79], a[216:219], a[72:75], v[76:79]
 s_waitcnt lgkmcnt(12)
 v_mfma_f32_16x16x32_bf16 v[80:83], a[192:195], a[72:75], v[80:83]
 ds_read_b64_tr_b16 a[216:217], v59 offset:33896
 ds_read_b128 a[104:107], v48 offset:4096
 v_mfma_f32_16x16x32_bf16 v[80:83], a[196:199], a[84:87], v[80:83]
 ds_read_b64_tr_b16 a[218:219], v59 offset:34408
 v_mfma_f32_16x16x32_bf16 v[144:147], a[196:199], a[88:91], v[144:147]
 ds_read_b64_tr_b16 a[220:221], v59 offset:50792
 v_mfma_f32_16x16x32_bf16 v[144:147], a[192:195], a[76:79], v[144:147]
 s_mov_b32 s82, 0x290000
 s_add_u32 m0, s74, 0x11880
 ds_read_b64_tr_b16 a[222:223], v59 offset:51304
 ds_read_b128 a[116:119], v49 offset:4096
 v_mfma_f32_16x16x32_bf16 v[208:211], a[192:195], a[80:83], v[208:211]
 buffer_load_dwordx4 v42, s[56:59], s82 offen nt lds
 v_mfma_f32_16x16x32_bf16 v[208:211], a[196:199], a[92:95], v[208:211]
 s_waitcnt lgkmcnt(13)
 v_mfma_f32_16x16x32_bf16 v[212:215], a[204:207], a[92:95], v[212:215]
 ds_read_b64_tr_b16 a[192:193], v41 offset:33920
 v_mfma_f32_16x16x32_bf16 v[212:215], a[200:203], a[80:83], v[212:215]
 ds_read_b64_tr_b16 a[194:195], v41 offset:34432
 v_mfma_f32_16x16x32_bf16 v[148:151], a[200:203], a[76:79], v[148:151]
 ds_read_b64_tr_b16 a[196:197], v41 offset:50816
 v_mfma_f32_16x16x32_bf16 v[148:151], a[204:207], a[88:91], v[148:151]
 s_mov_b32 s83, 0x292000
 s_add_u32 m0, s74, 0x11ca8
 ds_read_b64_tr_b16 a[198:199], v41 offset:51328
 v_mfma_f32_16x16x32_bf16 v[84:87], a[204:207], a[84:87], v[84:87]
 buffer_load_dwordx4 v42, s[56:59], s83 offen nt lds
 v_mfma_f32_16x16x32_bf16 v[84:87], a[200:203], a[72:75], v[84:87]
 s_waitcnt lgkmcnt(11)
 v_mfma_f32_16x16x32_bf16 v[88:91], a[208:211], a[72:75], v[88:91]
 ds_read_b64_tr_b16 a[200:201], v41 offset:33928
 v_mfma_f32_16x16x32_bf16 v[88:91], a[212:215], a[84:87], v[88:91]
 ds_read_b64_tr_b16 a[202:203], v41 offset:34440
 v_mfma_f32_16x16x32_bf16 v[152:155], a[212:215], a[88:91], v[152:155]
 ds_read_b64_tr_b16 a[204:205], v41 offset:50824
 v_mfma_f32_16x16x32_bf16 v[152:155], a[208:211], a[76:79], v[152:155]
 s_mov_b32 s82, 0x294000
 s_add_u32 m0, s74, 0x120c0
 ds_read_b64_tr_b16 a[206:207], v41 offset:51336
 v_mfma_f32_16x16x32_bf16 v[216:219], a[208:211], a[80:83], v[216:219]
 buffer_load_dwordx4 v42, s[56:59], s82 offen nt lds
 v_mfma_f32_16x16x32_bf16 v[216:219], a[212:215], a[92:95], v[216:219]
 s_waitcnt lgkmcnt(9)
 v_mfma_f32_16x16x32_bf16 v[220:223], a[220:223], a[92:95], v[220:223]
 ds_read_b64_tr_b16 a[208:209], v59 offset:33952
 v_mfma_f32_16x16x32_bf16 v[220:223], a[216:219], a[80:83], v[220:223]
 ds_read_b64_tr_b16 a[210:211], v59 offset:34464
 v_mfma_f32_16x16x32_bf16 v[156:159], a[216:219], a[76:79], v[156:159]
 ds_read_b64_tr_b16 a[212:213], v59 offset:50848
 v_mfma_f32_16x16x32_bf16 v[156:159], a[220:223], a[88:91], v[156:159]
 s_mov_b32 s83, 0x296000
 s_add_u32 m0, s74, 0x124e8
 ds_read_b64_tr_b16 a[214:215], v59 offset:51360
 v_mfma_f32_16x16x32_bf16 v[92:95], a[220:223], a[84:87], v[92:95]
 buffer_load_dwordx4 v42, s[56:59], s83 offen nt lds
 v_mfma_f32_16x16x32_bf16 v[92:95], a[216:219], a[72:75], v[92:95]
 s_waitcnt lgkmcnt(8)
 v_mfma_f32_16x16x32_bf16 v[96:99], a[192:195], a[72:75], v[96:99]
 ds_read_b64_tr_b16 a[216:217], v59 offset:33960
 v_mfma_f32_16x16x32_bf16 v[96:99], a[196:199], a[84:87], v[96:99]
 ds_read_b64_tr_b16 a[218:219], v59 offset:34472
 v_mfma_f32_16x16x32_bf16 v[160:163], a[196:199], a[88:91], v[160:163]
 ds_read_b64_tr_b16 a[220:221], v59 offset:50856
 v_mfma_f32_16x16x32_bf16 v[160:163], a[192:195], a[76:79], v[160:163]
 s_mov_b32 s82, 0x300
 s_add_u32 m0, s71, 0x0
 ds_read_b64_tr_b16 a[222:223], v59 offset:51368
 v_mfma_f32_16x16x32_bf16 v[224:227], a[192:195], a[80:83], v[224:227]
 buffer_load_dwordx4 v43, s[44:47], s82 offen lds
 v_mfma_f32_16x16x32_bf16 v[224:227], a[196:199], a[92:95], v[224:227]
 s_waitcnt lgkmcnt(8)
 v_mfma_f32_16x16x32_bf16 v[228:231], a[204:207], a[92:95], v[228:231]
 ds_read_b64_tr_b16 a[192:193], v41 offset:33984
 v_mfma_f32_16x16x32_bf16 v[228:231], a[200:203], a[80:83], v[228:231]
 ds_read_b64_tr_b16 a[194:195], v41 offset:34496
 v_mfma_f32_16x16x32_bf16 v[164:167], a[200:203], a[76:79], v[164:167]
 ds_read_b64_tr_b16 a[196:197], v41 offset:50880
 v_mfma_f32_16x16x32_bf16 v[164:167], a[204:207], a[88:91], v[164:167]
 s_mov_b32 s83, 0x300
 s_add_u32 m0, s71, 0x400
 ds_read_b64_tr_b16 a[198:199], v41 offset:51392
 v_mfma_f32_16x16x32_bf16 v[100:103], a[204:207], a[84:87], v[100:103]
 buffer_load_dwordx4 v44, s[44:47], s83 offen lds
 v_mfma_f32_16x16x32_bf16 v[100:103], a[200:203], a[72:75], v[100:103]
 s_waitcnt lgkmcnt(8)
 v_mfma_f32_16x16x32_bf16 v[104:107], a[208:211], a[72:75], v[104:107]
 ds_read_b64_tr_b16 a[200:201], v41 offset:33992
 v_mfma_f32_16x16x32_bf16 v[104:107], a[212:215], a[84:87], v[104:107]
 ds_read_b64_tr_b16 a[202:203], v41 offset:34504
 v_mfma_f32_16x16x32_bf16 v[168:171], a[212:215], a[88:91], v[168:171]
 ds_read_b64_tr_b16 a[204:205], v41 offset:50888
 v_mfma_f32_16x16x32_bf16 v[168:171], a[208:211], a[76:79], v[168:171]
 s_mov_b32 s82, 0x3b00
 s_add_u32 m0, s71, 0x800
 ds_read_b64_tr_b16 a[206:207], v41 offset:51400
 v_mfma_f32_16x16x32_bf16 v[232:235], a[208:211], a[80:83], v[232:235]
 buffer_load_dwordx4 v43, s[44:47], s82 offen lds
 v_mfma_f32_16x16x32_bf16 v[232:235], a[212:215], a[92:95], v[232:235]
 s_waitcnt lgkmcnt(8)
 v_mfma_f32_16x16x32_bf16 v[236:239], a[220:223], a[92:95], v[236:239]
 ds_read_b64_tr_b16 a[208:209], v59 offset:34016
 v_mfma_f32_16x16x32_bf16 v[236:239], a[216:219], a[80:83], v[236:239]
 ds_read_b64_tr_b16 a[210:211], v59 offset:34528
 v_mfma_f32_16x16x32_bf16 v[172:175], a[216:219], a[76:79], v[172:175]
 ds_read_b64_tr_b16 a[212:213], v59 offset:50912
 v_mfma_f32_16x16x32_bf16 v[172:175], a[220:223], a[88:91], v[172:175]
 s_mov_b32 s83, 0x3b00
 s_add_u32 m0, s71, 0xc00
 ds_read_b64_tr_b16 a[214:215], v59 offset:51424
 v_mfma_f32_16x16x32_bf16 v[108:111], a[220:223], a[84:87], v[108:111]
 buffer_load_dwordx4 v44, s[44:47], s83 offen lds
 v_mfma_f32_16x16x32_bf16 v[108:111], a[216:219], a[72:75], v[108:111]
 s_waitcnt lgkmcnt(8)
 v_mfma_f32_16x16x32_bf16 v[112:115], a[192:195], a[72:75], v[112:115]
 ds_read_b64_tr_b16 a[216:217], v59 offset:34024
 v_mfma_f32_16x16x32_bf16 v[112:115], a[196:199], a[84:87], v[112:115]
 ds_read_b64_tr_b16 a[218:219], v59 offset:34536
 v_mfma_f32_16x16x32_bf16 v[176:179], a[196:199], a[88:91], v[176:179]
 ds_read_b64_tr_b16 a[220:221], v59 offset:50920
 v_mfma_f32_16x16x32_bf16 v[176:179], a[192:195], a[76:79], v[176:179]
 s_mov_b32 s82, 0x7300
 s_add_u32 m0, s71, 0x1000
 ds_read_b64_tr_b16 a[222:223], v59 offset:51432
 v_mfma_f32_16x16x32_bf16 v[240:243], a[192:195], a[80:83], v[240:243]
 buffer_load_dwordx4 v43, s[44:47], s82 offen lds
 v_mfma_f32_16x16x32_bf16 v[240:243], a[196:199], a[92:95], v[240:243]
 s_waitcnt lgkmcnt(8)
 v_mfma_f32_16x16x32_bf16 v[244:247], a[204:207], a[92:95], v[244:247]
 v_mfma_f32_16x16x32_bf16 v[244:247], a[200:203], a[80:83], v[244:247]
 s_waitcnt vmcnt(19) lgkmcnt(0)
 s_barrier
 v_mfma_f32_16x16x32_bf16 v[180:183], a[200:203], a[76:79], v[180:183]
 ds_read_b64_tr_b16 a[192:193], v40 offset:33792
 v_mfma_f32_16x16x32_bf16 v[180:183], a[204:207], a[88:91], v[180:183]
 ds_read_b64_tr_b16 a[194:195], v40 offset:34304
 v_mfma_f32_16x16x32_bf16 v[116:119], a[204:207], a[84:87], v[116:119]
 ds_read_b64_tr_b16 a[196:197], v40 offset:50688
 v_mfma_f32_16x16x32_bf16 v[116:119], a[200:203], a[72:75], v[116:119]
 ds_read_b64_tr_b16 a[198:199], v40 offset:51200
 v_mfma_f32_16x16x32_bf16 v[120:123], a[208:211], a[72:75], v[120:123]
 ds_read_b64_tr_b16 a[200:201], v40 offset:33800
 v_mfma_f32_16x16x32_bf16 v[120:123], a[212:215], a[84:87], v[120:123]
 ds_read_b64_tr_b16 a[202:203], v40 offset:34312
 v_mfma_f32_16x16x32_bf16 v[184:187], a[212:215], a[88:91], v[184:187]
 ds_read_b64_tr_b16 a[204:205], v40 offset:50696
 v_mfma_f32_16x16x32_bf16 v[184:187], a[208:211], a[76:79], v[184:187]
 s_mov_b32 s83, 0x7300
 s_add_u32 m0, s71, 0x1400
 ds_read_b64_tr_b16 a[206:207], v40 offset:51208
 v_mfma_f32_16x16x32_bf16 v[248:251], a[208:211], a[80:83], v[248:251]
 buffer_load_dwordx4 v44, s[44:47], s83 offen lds
 v_mfma_f32_16x16x32_bf16 v[248:251], a[212:215], a[92:95], v[248:251]
 v_mfma_f32_16x16x32_bf16 v[252:255], a[220:223], a[92:95], v[252:255]
 ds_read_b64_tr_b16 a[208:209], v58 offset:33824
 v_mfma_f32_16x16x32_bf16 v[252:255], a[216:219], a[80:83], v[252:255]
 ds_read_b64_tr_b16 a[210:211], v58 offset:34336
 v_mfma_f32_16x16x32_bf16 v[188:191], a[216:219], a[76:79], v[188:191]
 ds_read_b64_tr_b16 a[212:213], v58 offset:50720
 v_mfma_f32_16x16x32_bf16 v[188:191], a[220:223], a[88:91], v[188:191]
 ds_read_b64_tr_b16 a[214:215], v58 offset:51232
 v_mfma_f32_16x16x32_bf16 v[124:127], a[220:223], a[84:87], v[124:127]
 v_mfma_f32_16x16x32_bf16 v[124:127], a[216:219], a[72:75], v[124:127]
 s_waitcnt lgkmcnt(8)
 v_mfma_f32_16x16x32_bf16 v[64:67], a[192:195], a[96:99], v[64:67]
 ds_read_b64_tr_b16 a[216:217], v58 offset:33832
 v_mfma_f32_16x16x32_bf16 v[64:67], a[196:199], a[108:111], v[64:67]
 ds_read_b64_tr_b16 a[218:219], v58 offset:34344
 v_mfma_f32_16x16x32_bf16 v[128:131], a[196:199], a[112:115], v[128:131]
 ds_read_b64_tr_b16 a[220:221], v58 offset:50728
 v_mfma_f32_16x16x32_bf16 v[128:131], a[192:195], a[100:103], v[128:131]
 s_mov_b32 s82, 0x300000
 s_add_u32 m0, s74, 0x18c00
 ds_read_b64_tr_b16 a[222:223], v58 offset:51240
 v_mfma_f32_16x16x32_bf16 v[192:195], a[192:195], a[104:107], v[192:195]
 buffer_load_dwordx4 v42, s[56:59], s82 offen nt lds
 v_mfma_f32_16x16x32_bf16 v[192:195], a[196:199], a[116:119], v[192:195]
 s_waitcnt lgkmcnt(8)
 v_mfma_f32_16x16x32_bf16 v[196:199], a[204:207], a[116:119], v[196:199]
 ds_read_b64_tr_b16 a[192:193], v40 offset:33856
 v_mfma_f32_16x16x32_bf16 v[196:199], a[200:203], a[104:107], v[196:199]
 ds_read_b64_tr_b16 a[194:195], v40 offset:34368
 v_mfma_f32_16x16x32_bf16 v[132:135], a[200:203], a[100:103], v[132:135]
 ds_read_b64_tr_b16 a[196:197], v40 offset:50752
 v_mfma_f32_16x16x32_bf16 v[132:135], a[204:207], a[112:115], v[132:135]
 s_mov_b32 s83, 0x302000
 s_add_u32 m0, s74, 0x19028
 ds_read_b64_tr_b16 a[198:199], v40 offset:51264
 v_mfma_f32_16x16x32_bf16 v[68:71], a[204:207], a[108:111], v[68:71]
 buffer_load_dwordx4 v42, s[56:59], s83 offen nt lds
 v_mfma_f32_16x16x32_bf16 v[68:71], a[200:203], a[96:99], v[68:71]
 s_waitcnt lgkmcnt(8)
 v_mfma_f32_16x16x32_bf16 v[72:75], a[208:211], a[96:99], v[72:75]
 ds_read_b64_tr_b16 a[200:201], v40 offset:33864
 s_waitcnt vmcnt(16)
 ds_read_b128 a[120:123], v46 offset:0
 v_mfma_f32_16x16x32_bf16 v[72:75], a[212:215], a[108:111], v[72:75]
 ds_read_b64_tr_b16 a[202:203], v40 offset:34376
 v_mfma_f32_16x16x32_bf16 v[136:139], a[212:215], a[112:115], v[136:139]
 ds_read_b64_tr_b16 a[204:205], v40 offset:50760
 v_mfma_f32_16x16x32_bf16 v[136:139], a[208:211], a[100:103], v[136:139]
 s_mov_b32 s82, 0x304000
 s_add_u32 m0, s74, 0x19440
 ds_read_b64_tr_b16 a[206:207], v40 offset:51272
 ds_read_b128 a[132:135], v47 offset:0
 v_mfma_f32_16x16x32_bf16 v[200:203], a[208:211], a[104:107], v[200:203]
 buffer_load_dwordx4 v42, s[56:59], s82 offen nt lds
 s_mov_b32 s83, 0x306000
 s_add_u32 m0, s74, 0x19868
 v_mfma_f32_16x16x32_bf16 v[200:203], a[212:215], a[116:119], v[200:203]
 s_waitcnt lgkmcnt(10)
 buffer_load_dwordx4 v42, s[56:59], s83 offen nt lds
 v_mfma_f32_16x16x32_bf16 v[204:207], a[220:223], a[116:119], v[204:207]
 ds_read_b64_tr_b16 a[208:209], v58 offset:33888
 ds_read_b128 a[124:127], v46 offset:2048
 v_mfma_f32_16x16x32_bf16 v[204:207], a[216:219], a[104:107], v[204:207]
 ds_read_b64_tr_b16 a[210:211], v58 offset:34400
 v_mfma_f32_16x16x32_bf16 v[140:143], a[216:219], a[100:103], v[140:143]
 ds_read_b64_tr_b16 a[212:213], v58 offset:50784
 v_mfma_f32_16x16x32_bf16 v[140:143], a[220:223], a[112:115], v[140:143]
 ds_read_b64_tr_b16 a[214:215], v58 offset:51296
 ds_read_b128 a[136:139], v47 offset:2048
 v_mfma_f32_16x16x32_bf16 v[76:79], a[220:223], a[108:111], v[76:79]
 s_mov_b32 s82, 0x310000
 s_add_u32 m0, s74, 0x19c80
 v_mfma_f32_16x16x32_bf16 v[76:79], a[216:219], a[96:99], v[76:79]
 s_waitcnt lgkmcnt(12)
 buffer_load_dwordx4 v42, s[56:59], s82 offen nt lds
 v_mfma_f32_16x16x32_bf16 v[80:83], a[192:195], a[96:99], v[80:83]
 ds_read_b64_tr_b16 a[216:217], v58 offset:33896
 ds_read_b128 a[128:131], v46 offset:4096
 v_mfma_f32_16x16x32_bf16 v[80:83], a[196:199], a[108:111], v[80:83]
 ds_read_b64_tr_b16 a[218:219], v58 offset:34408
 v_mfma_f32_16x16x32_bf16 v[144:147], a[196:199], a[112:115], v[144:147]
 ds_read_b64_tr_b16 a[220:221], v58 offset:50792
 v_mfma_f32_16x16x32_bf16 v[144:147], a[192:195], a[100:103], v[144:147]
 s_mov_b32 s83, 0x312000
 s_add_u32 m0, s74, 0x1a0a8
 ds_read_b64_tr_b16 a[222:223], v58 offset:51304
 ds_read_b128 a[140:143], v47 offset:4096
 v_mfma_f32_16x16x32_bf16 v[208:211], a[192:195], a[104:107], v[208:211]
 buffer_load_dwordx4 v42, s[56:59], s83 offen nt lds
 v_mfma_f32_16x16x32_bf16 v[208:211], a[196:199], a[116:119], v[208:211]
 s_waitcnt lgkmcnt(13)
 v_mfma_f32_16x16x32_bf16 v[212:215], a[204:207], a[116:119], v[212:215]
 ds_read_b64_tr_b16 a[192:193], v40 offset:33920
 v_mfma_f32_16x16x32_bf16 v[212:215], a[200:203], a[104:107], v[212:215]
 ds_read_b64_tr_b16 a[194:195], v40 offset:34432
 v_mfma_f32_16x16x32_bf16 v[148:151], a[200:203], a[100:103], v[148:151]
 ds_read_b64_tr_b16 a[196:197], v40 offset:50816
 v_mfma_f32_16x16x32_bf16 v[148:151], a[204:207], a[112:115], v[148:151]
 s_mov_b32 s82, 0x314000
 s_add_u32 m0, s74, 0x1a4c0
 ds_read_b64_tr_b16 a[198:199], v40 offset:51328
 v_mfma_f32_16x16x32_bf16 v[84:87], a[204:207], a[108:111], v[84:87]
 buffer_load_dwordx4 v42, s[56:59], s82 offen nt lds
 v_mfma_f32_16x16x32_bf16 v[84:87], a[200:203], a[96:99], v[84:87]
 s_waitcnt lgkmcnt(11)
 v_mfma_f32_16x16x32_bf16 v[88:91], a[208:211], a[96:99], v[88:91]
 ds_read_b64_tr_b16 a[200:201], v40 offset:33928
 v_mfma_f32_16x16x32_bf16 v[88:91], a[212:215], a[108:111], v[88:91]
 ds_read_b64_tr_b16 a[202:203], v40 offset:34440
 v_mfma_f32_16x16x32_bf16 v[152:155], a[212:215], a[112:115], v[152:155]
 ds_read_b64_tr_b16 a[204:205], v40 offset:50824
 v_mfma_f32_16x16x32_bf16 v[152:155], a[208:211], a[100:103], v[152:155]
 s_mov_b32 s83, 0x316000
 s_add_u32 m0, s74, 0x1a8e8
 ds_read_b64_tr_b16 a[206:207], v40 offset:51336
 v_mfma_f32_16x16x32_bf16 v[216:219], a[208:211], a[104:107], v[216:219]
 buffer_load_dwordx4 v42, s[56:59], s83 offen nt lds
 v_mfma_f32_16x16x32_bf16 v[216:219], a[212:215], a[116:119], v[216:219]
 s_waitcnt lgkmcnt(9)
 v_mfma_f32_16x16x32_bf16 v[220:223], a[220:223], a[116:119], v[220:223]
 ds_read_b64_tr_b16 a[208:209], v58 offset:33952
 v_mfma_f32_16x16x32_bf16 v[220:223], a[216:219], a[104:107], v[220:223]
 ds_read_b64_tr_b16 a[210:211], v58 offset:34464
 v_mfma_f32_16x16x32_bf16 v[156:159], a[216:219], a[100:103], v[156:159]
 ds_read_b64_tr_b16 a[212:213], v58 offset:50848
 v_mfma_f32_16x16x32_bf16 v[156:159], a[220:223], a[112:115], v[156:159]
 s_add_u32 m0, s73, 0x0
 ds_read_b64_tr_b16 a[214:215], v58 offset:51360
 v_mfma_f32_16x16x32_bf16 v[92:95], a[220:223], a[108:111], v[92:95]
 s_waitcnt lgkmcnt(12)
 buffer_load_dwordx4 v3, s[48:51], s75 offen offset:0 nt lds
 v_mfma_f32_16x16x32_bf16 v[92:95], a[216:219], a[96:99], v[92:95]
 s_waitcnt lgkmcnt(8)
 v_mfma_f32_16x16x32_bf16 v[96:99], a[192:195], a[96:99], v[96:99]
 ds_read_b64_tr_b16 a[216:217], v58 offset:33960
 v_mfma_f32_16x16x32_bf16 v[96:99], a[196:199], a[108:111], v[96:99]
 ds_read_b64_tr_b16 a[218:219], v58 offset:34472
 v_mfma_f32_16x16x32_bf16 v[160:163], a[196:199], a[112:115], v[160:163]
 ds_read_b64_tr_b16 a[220:221], v58 offset:50856
 v_mfma_f32_16x16x32_bf16 v[160:163], a[192:195], a[100:103], v[160:163]
 s_add_u32 m0, s73, 0x10
 ds_read_b64_tr_b16 a[222:223], v58 offset:51368
 v_mfma_f32_16x16x32_bf16 v[224:227], a[192:195], a[104:107], v[224:227]
 buffer_load_dwordx4 v3, s[48:51], s75 offen offset:1024 nt lds
 v_mfma_f32_16x16x32_bf16 v[224:227], a[196:199], a[116:119], v[224:227]
 s_waitcnt lgkmcnt(8)
 v_mfma_f32_16x16x32_bf16 v[228:231], a[204:207], a[116:119], v[228:231]
 ds_read_b64_tr_b16 a[192:193], v40 offset:33984
 v_mfma_f32_16x16x32_bf16 v[228:231], a[200:203], a[104:107], v[228:231]
 ds_read_b64_tr_b16 a[194:195], v40 offset:34496
 v_mfma_f32_16x16x32_bf16 v[164:167], a[200:203], a[100:103], v[164:167]
 ds_read_b64_tr_b16 a[196:197], v40 offset:50880
 v_mfma_f32_16x16x32_bf16 v[164:167], a[204:207], a[112:115], v[164:167]
 s_add_u32 m0, s73, 0x20
 ds_read_b64_tr_b16 a[198:199], v40 offset:51392
 v_mfma_f32_16x16x32_bf16 v[100:103], a[204:207], a[108:111], v[100:103]
 buffer_load_dwordx4 v3, s[48:51], s75 offen offset:2048 nt lds
 v_mfma_f32_16x16x32_bf16 v[100:103], a[200:203], a[96:99], v[100:103]
 s_waitcnt lgkmcnt(8)
 v_mfma_f32_16x16x32_bf16 v[104:107], a[208:211], a[96:99], v[104:107]
 ds_read_b64_tr_b16 a[200:201], v40 offset:33992
 v_mfma_f32_16x16x32_bf16 v[104:107], a[212:215], a[108:111], v[104:107]
 ds_read_b64_tr_b16 a[202:203], v40 offset:34504
 v_mfma_f32_16x16x32_bf16 v[168:171], a[212:215], a[112:115], v[168:171]
 ds_read_b64_tr_b16 a[204:205], v40 offset:50888
 v_mfma_f32_16x16x32_bf16 v[168:171], a[208:211], a[100:103], v[168:171]
 s_add_u32 m0, s73, 0x30
 ds_read_b64_tr_b16 a[206:207], v40 offset:51400
 v_mfma_f32_16x16x32_bf16 v[232:235], a[208:211], a[104:107], v[232:235]
 buffer_load_dwordx4 v3, s[48:51], s75 offen offset:3072 nt lds
 v_mfma_f32_16x16x32_bf16 v[232:235], a[212:215], a[116:119], v[232:235]
 s_waitcnt lgkmcnt(8)
 v_mfma_f32_16x16x32_bf16 v[236:239], a[220:223], a[116:119], v[236:239]
 ds_read_b64_tr_b16 a[208:209], v58 offset:34016
 v_mfma_f32_16x16x32_bf16 v[236:239], a[216:219], a[104:107], v[236:239]
 ds_read_b64_tr_b16 a[210:211], v58 offset:34528
 v_mfma_f32_16x16x32_bf16 v[172:175], a[216:219], a[100:103], v[172:175]
 ds_read_b64_tr_b16 a[212:213], v58 offset:50912
 v_mfma_f32_16x16x32_bf16 v[172:175], a[220:223], a[112:115], v[172:175]
 s_add_u32 m0, s73, 0x1040
 ds_read_b64_tr_b16 a[214:215], v58 offset:51424
 v_mfma_f32_16x16x32_bf16 v[108:111], a[220:223], a[108:111], v[108:111]
 buffer_load_dwordx4 v4, s[48:51], s75 offen offset:0 nt lds
 v_mfma_f32_16x16x32_bf16 v[108:111], a[216:219], a[96:99], v[108:111]
 s_waitcnt lgkmcnt(8)
 v_mfma_f32_16x16x32_bf16 v[112:115], a[192:195], a[96:99], v[112:115]
L1_PAD3:
 s_cbranch_execz L1_PRT3
 ds_read_b64_tr_b16 a[216:217], v58 offset:34024
 v_mfma_f32_16x16x32_bf16 v[112:115], a[196:199], a[108:111], v[112:115]
 ds_read_b64_tr_b16 a[218:219], v58 offset:34536
 v_mfma_f32_16x16x32_bf16 v[176:179], a[196:199], a[112:115], v[176:179]
 ds_read_b64_tr_b16 a[220:221], v58 offset:50920
 v_mfma_f32_16x16x32_bf16 v[176:179], a[192:195], a[100:103], v[176:179]
 s_add_u32 m0, s73, 0x1050
 ds_read_b64_tr_b16 a[222:223], v58 offset:51432
 v_mfma_f32_16x16x32_bf16 v[240:243], a[192:195], a[104:107], v[240:243]
 buffer_load_dwordx4 v4, s[48:51], s75 offen offset:1024 nt lds
 v_mfma_f32_16x16x32_bf16 v[240:243], a[196:199], a[116:119], v[240:243]
 s_waitcnt lgkmcnt(8)
 s_add_u32 m0, s73, 0x1060
 v_mfma_f32_16x16x32_bf16 v[244:247], a[204:207], a[116:119], v[244:247]
 buffer_load_dwordx4 v4, s[48:51], s75 offen offset:2048 nt lds
 v_mfma_f32_16x16x32_bf16 v[244:247], a[200:203], a[104:107], v[244:247]
 s_waitcnt vmcnt(21) lgkmcnt(0)
 s_barrier
 v_mfma_f32_16x16x32_bf16 v[180:183], a[200:203], a[100:103], v[180:183]
 ds_read_b64_tr_b16 a[192:193], v41 offset:0
 v_mfma_f32_16x16x32_bf16 v[180:183], a[204:207], a[112:115], v[180:183]
 ds_read_b64_tr_b16 a[194:195], v41 offset:512
 v_mfma_f32_16x16x32_bf16 v[116:119], a[204:207], a[108:111], v[116:119]
 ds_read_b64_tr_b16 a[196:197], v41 offset:16896
 v_mfma_f32_16x16x32_bf16 v[116:119], a[200:203], a[96:99], v[116:119]
 ds_read_b64_tr_b16 a[198:199], v41 offset:17408
 v_mfma_f32_16x16x32_bf16 v[120:123], a[208:211], a[96:99], v[120:123]
 ds_read_b64_tr_b16 a[200:201], v41 offset:8
 v_mfma_f32_16x16x32_bf16 v[120:123], a[212:215], a[108:111], v[120:123]
 ds_read_b64_tr_b16 a[202:203], v41 offset:520
 v_mfma_f32_16x16x32_bf16 v[184:187], a[212:215], a[112:115], v[184:187]
 ds_read_b64_tr_b16 a[204:205], v41 offset:16904
 v_mfma_f32_16x16x32_bf16 v[184:187], a[208:211], a[100:103], v[184:187]
 s_add_u32 m0, s73, 0x1070
 ds_read_b64_tr_b16 a[206:207], v41 offset:17416
 v_mfma_f32_16x16x32_bf16 v[248:251], a[208:211], a[104:107], v[248:251]
 buffer_load_dwordx4 v4, s[48:51], s75 offen offset:3072 nt lds
 v_mfma_f32_16x16x32_bf16 v[248:251], a[212:215], a[116:119], v[248:251]
 v_mfma_f32_16x16x32_bf16 v[252:255], a[220:223], a[116:119], v[252:255]
 ds_read_b64_tr_b16 a[208:209], v59 offset:32
 v_mfma_f32_16x16x32_bf16 v[252:255], a[216:219], a[104:107], v[252:255]
 ds_read_b64_tr_b16 a[210:211], v59 offset:544
 v_mfma_f32_16x16x32_bf16 v[188:191], a[216:219], a[100:103], v[188:191]
 ds_read_b64_tr_b16 a[212:213], v59 offset:16928
 v_mfma_f32_16x16x32_bf16 v[188:191], a[220:223], a[112:115], v[188:191]
 ds_read_b64_tr_b16 a[214:215], v59 offset:17440
 v_mfma_f32_16x16x32_bf16 v[124:127], a[220:223], a[108:111], v[124:127]
 v_mfma_f32_16x16x32_bf16 v[124:127], a[216:219], a[96:99], v[124:127]
 s_waitcnt lgkmcnt(8)
 s_add_u32 s75, s75, 0x8000
 v_mfma_f32_16x16x32_bf16 v[64:67], a[192:195], a[120:123], v[64:67]
 ds_read_b64_tr_b16 a[216:217], v59 offset:40
 v_mfma_f32_16x16x32_bf16 v[64:67], a[196:199], a[132:135], v[64:67]
 ds_read_b64_tr_b16 a[218:219], v59 offset:552
 v_mfma_f32_16x16x32_bf16 v[128:131], a[196:199], a[136:139], v[128:131]
 ds_read_b64_tr_b16 a[220:221], v59 offset:16936
 v_mfma_f32_16x16x32_bf16 v[128:131], a[192:195], a[124:127], v[128:131]
 s_add_u32 m0, s73, 0x8400
 ds_read_b64_tr_b16 a[222:223], v59 offset:17448
 v_mfma_f32_16x16x32_bf16 v[192:195], a[192:195], a[128:131], v[192:195]
 buffer_load_dwordx4 v3, s[48:51], s75 offen offset:0 nt lds
 v_mfma_f32_16x16x32_bf16 v[192:195], a[196:199], a[140:143], v[192:195]
 s_waitcnt lgkmcnt(8)
 v_mfma_f32_16x16x32_bf16 v[196:199], a[204:207], a[140:143], v[196:199]
 ds_read_b64_tr_b16 a[192:193], v41 offset:64
 v_mfma_f32_16x16x32_bf16 v[196:199], a[200:203], a[128:131], v[196:199]
 ds_read_b64_tr_b16 a[194:195], v41 offset:576
 v_mfma_f32_16x16x32_bf16 v[132:135], a[200:203], a[124:127], v[132:135]
 ds_read_b64_tr_b16 a[196:197], v41 offset:16960
 v_mfma_f32_16x16x32_bf16 v[132:135], a[204:207], a[136:139], v[132:135]
 ds_read_b64_tr_b16 a[198:199], v41 offset:17472
 v_mfma_f32_16x16x32_bf16 v[68:71], a[204:207], a[132:135], v[68:71]
 v_mfma_f32_16x16x32_bf16 v[68:71], a[200:203], a[120:123], v[68:71]
 s_waitcnt lgkmcnt(8)
 v_mfma_f32_16x16x32_bf16 v[72:75], a[208:211], a[120:123], v[72:75]
 ds_read_b64_tr_b16 a[200:201], v41 offset:72
 s_waitcnt vmcnt(17)
 ds_read_b128 a[144:147], v48 offset:0
 v_mfma_f32_16x16x32_bf16 v[72:75], a[212:215], a[132:135], v[72:75]
 ds_read_b64_tr_b16 a[202:203], v41 offset:584
 v_mfma_f32_16x16x32_bf16 v[136:139], a[212:215], a[136:139], v[136:139]
 ds_read_b64_tr_b16 a[204:205], v41 offset:16968
 v_mfma_f32_16x16x32_bf16 v[136:139], a[208:211], a[124:127], v[136:139]
 s_add_u32 m0, s73, 0x8410
 ds_read_b64_tr_b16 a[206:207], v41 offset:17480
 ds_read_b128 a[156:159], v49 offset:0
 v_mfma_f32_16x16x32_bf16 v[200:203], a[208:211], a[128:131], v[200:203]
 buffer_load_dwordx4 v3, s[48:51], s75 offen offset:1024 nt lds
 v_mfma_f32_16x16x32_bf16 v[200:203], a[212:215], a[140:143], v[200:203]
 s_waitcnt lgkmcnt(10)
 v_mfma_f32_16x16x32_bf16 v[204:207], a[220:223], a[140:143], v[204:207]
 ds_read_b64_tr_b16 a[208:209], v59 offset:96
 ds_read_b128 a[148:151], v48 offset:2048
 v_mfma_f32_16x16x32_bf16 v[204:207], a[216:219], a[128:131], v[204:207]
 ds_read_b64_tr_b16 a[210:211], v59 offset:608
 v_mfma_f32_16x16x32_bf16 v[140:143], a[216:219], a[124:127], v[140:143]
 ds_read_b64_tr_b16 a[212:213], v59 offset:16992
 v_mfma_f32_16x16x32_bf16 v[140:143], a[220:223], a[136:139], v[140:143]
 ds_read_b64_tr_b16 a[214:215], v59 offset:17504
 ds_read_b128 a[160:163], v49 offset:2048
 v_mfma_f32_16x16x32_bf16 v[76:79], a[220:223], a[132:135], v[76:79]
 s_add_u32 m0, s73, 0x8420
 v_mfma_f32_16x16x32_bf16 v[76:79], a[216:219], a[120:123], v[76:79]
 s_waitcnt lgkmcnt(12)
 buffer_load_dwordx4 v3, s[48:51], s75 offen offset:2048 nt lds
 v_mfma_f32_16x16x32_bf16 v[80:83], a[192:195], a[120:123], v[80:83]
 ds_read_b64_tr_b16 a[216:217], v59 offset:104
 ds_read_b128 a[152:155], v48 offset:4096
 v_mfma_f32_16x16x32_bf16 v[80:83], a[196:199], a[132:135], v[80:83]
 ds_read_b64_tr_b16 a[218:219], v59 offset:616
 v_mfma_f32_16x16x32_bf16 v[144:147], a[196:199], a[136:139], v[144:147]
 ds_read_b64_tr_b16 a[220:221], v59 offset:17000
 v_mfma_f32_16x16x32_bf16 v[144:147], a[192:195], a[124:127], v[144:147]
 ds_read_b64_tr_b16 a[222:223], v59 offset:17512
 ds_read_b128 a[164:167], v49 offset:4096
 v_mfma_f32_16x16x32_bf16 v[208:211], a[192:195], a[128:131], v[208:211]
 v_mfma_f32_16x16x32_bf16 v[208:211], a[196:199], a[140:143], v[208:211]
 s_waitcnt lgkmcnt(13)
 v_mfma_f32_16x16x32_bf16 v[212:215], a[204:207], a[140:143], v[212:215]
 ds_read_b64_tr_b16 a[192:193], v41 offset:128
 v_mfma_f32_16x16x32_bf16 v[212:215], a[200:203], a[128:131], v[212:215]
 ds_read_b64_tr_b16 a[194:195], v41 offset:640
 v_mfma_f32_16x16x32_bf16 v[148:151], a[200:203], a[124:127], v[148:151]
 ds_read_b64_tr_b16 a[196:197], v41 offset:17024
 v_mfma_f32_16x16x32_bf16 v[148:151], a[204:207], a[136:139], v[148:151]
 s_add_u32 m0, s73, 0x8430
 ds_read_b64_tr_b16 a[198:199], v41 offset:17536
 v_mfma_f32_16x16x32_bf16 v[84:87], a[204:207], a[132:135], v[84:87]
 buffer_load_dwordx4 v3, s[48:51], s75 offen offset:3072 nt lds
 v_mfma_f32_16x16x32_bf16 v[84:87], a[200:203], a[120:123], v[84:87]
 s_waitcnt lgkmcnt(11)
 v_mfma_f32_16x16x32_bf16 v[88:91], a[208:211], a[120:123], v[88:91]
 ds_read_b64_tr_b16 a[200:201], v41 offset:136
 v_mfma_f32_16x16x32_bf16 v[88:91], a[212:215], a[132:135], v[88:91]
 ds_read_b64_tr_b16 a[202:203], v41 offset:648
 v_mfma_f32_16x16x32_bf16 v[152:155], a[212:215], a[136:139], v[152:155]
 ds_read_b64_tr_b16 a[204:205], v41 offset:17032
 v_mfma_f32_16x16x32_bf16 v[152:155], a[208:211], a[124:127], v[152:155]
 ds_read_b64_tr_b16 a[206:207], v41 offset:17544
 v_mfma_f32_16x16x32_bf16 v[216:219], a[208:211], a[128:131], v[216:219]
 v_mfma_f32_16x16x32_bf16 v[216:219], a[212:215], a[140:143], v[216:219]
 s_waitcnt lgkmcnt(9)
 v_mfma_f32_16x16x32_bf16 v[220:223], a[220:223], a[140:143], v[220:223]
 ds_read_b64_tr_b16 a[208:209], v59 offset:160
 v_mfma_f32_16x16x32_bf16 v[220:223], a[216:219], a[128:131], v[220:223]
 ds_read_b64_tr_b16 a[210:211], v59 offset:672
 v_mfma_f32_16x16x32_bf16 v[156:159], a[216:219], a[124:127], v[156:159]
 ds_read_b64_tr_b16 a[212:213], v59 offset:17056
 v_mfma_f32_16x16x32_bf16 v[156:159], a[220:223], a[136:139], v[156:159]
 s_add_u32 m0, s73, 0x9440
 ds_read_b64_tr_b16 a[214:215], v59 offset:17568
 v_mfma_f32_16x16x32_bf16 v[92:95], a[220:223], a[132:135], v[92:95]
 buffer_load_dwordx4 v4, s[48:51], s75 offen offset:0 nt lds
 v_mfma_f32_16x16x32_bf16 v[92:95], a[216:219], a[120:123], v[92:95]
 s_waitcnt lgkmcnt(8)
 v_mfma_f32_16x16x32_bf16 v[96:99], a[192:195], a[120:123], v[96:99]
 ds_read_b64_tr_b16 a[216:217], v59 offset:168
 v_mfma_f32_16x16x32_bf16 v[96:99], a[196:199], a[132:135], v[96:99]
 ds_read_b64_tr_b16 a[218:219], v59 offset:680
 v_mfma_f32_16x16x32_bf16 v[160:163], a[196:199], a[136:139], v[160:163]
 ds_read_b64_tr_b16 a[220:221], v59 offset:17064
 v_mfma_f32_16x16x32_bf16 v[160:163], a[192:195], a[124:127], v[160:163]
 ds_read_b64_tr_b16 a[222:223], v59 offset:17576
 v_mfma_f32_16x16x32_bf16 v[224:227], a[192:195], a[128:131], v[224:227]
 v_mfma_f32_16x16x32_bf16 v[224:227], a[196:199], a[140:143], v[224:227]
 s_waitcnt lgkmcnt(8)
 v_mfma_f32_16x16x32_bf16 v[228:231], a[204:207], a[140:143], v[228:231]
 ds_read_b64_tr_b16 a[192:193], v41 offset:192
 v_mfma_f32_16x16x32_bf16 v[228:231], a[200:203], a[128:131], v[228:231]
 ds_read_b64_tr_b16 a[194:195], v41 offset:704
 v_mfma_f32_16x16x32_bf16 v[164:167], a[200:203], a[124:127], v[164:167]
 ds_read_b64_tr_b16 a[196:197], v41 offset:17088
 v_mfma_f32_16x16x32_bf16 v[164:167], a[204:207], a[136:139], v[164:167]
 s_add_u32 m0, s73, 0x9450
 ds_read_b64_tr_b16 a[198:199], v41 offset:17600
 v_mfma_f32_16x16x32_bf16 v[100:103], a[204:207], a[132:135], v[100:103]
 buffer_load_dwordx4 v4, s[48:51], s75 offen offset:1024 nt lds
 v_mfma_f32_16x16x32_bf16 v[100:103], a[200:203], a[120:123], v[100:103]
 s_waitcnt lgkmcnt(8)
 v_mfma_f32_16x16x32_bf16 v[104:107], a[208:211], a[120:123], v[104:107]
 ds_read_b64_tr_b16 a[200:201], v41 offset:200
 v_mfma_f32_16x16x32_bf16 v[104:107], a[212:215], a[132:135], v[104:107]
 ds_read_b64_tr_b16 a[202:203], v41 offset:712
 v_mfma_f32_16x16x32_bf16 v[168:171], a[212:215], a[136:139], v[168:171]
 ds_read_b64_tr_b16 a[204:205], v41 offset:17096
 v_mfma_f32_16x16x32_bf16 v[168:171], a[208:211], a[124:127], v[168:171]
 ds_read_b64_tr_b16 a[206:207], v41 offset:17608
 v_mfma_f32_16x16x32_bf16 v[232:235], a[208:211], a[128:131], v[232:235]
 v_mfma_f32_16x16x32_bf16 v[232:235], a[212:215], a[140:143], v[232:235]
 s_waitcnt lgkmcnt(8)
 v_mfma_f32_16x16x32_bf16 v[236:239], a[220:223], a[140:143], v[236:239]
 ds_read_b64_tr_b16 a[208:209], v59 offset:224
 v_mfma_f32_16x16x32_bf16 v[236:239], a[216:219], a[128:131], v[236:239]
 ds_read_b64_tr_b16 a[210:211], v59 offset:736
 v_mfma_f32_16x16x32_bf16 v[172:175], a[216:219], a[124:127], v[172:175]
 ds_read_b64_tr_b16 a[212:213], v59 offset:17120
 v_mfma_f32_16x16x32_bf16 v[172:175], a[220:223], a[136:139], v[172:175]
 s_add_u32 m0, s73, 0x9460
 ds_read_b64_tr_b16 a[214:215], v59 offset:17632
 v_mfma_f32_16x16x32_bf16 v[108:111], a[220:223], a[132:135], v[108:111]
 buffer_load_dwordx4 v4, s[48:51], s75 offen offset:2048 nt lds
 v_mfma_f32_16x16x32_bf16 v[108:111], a[216:219], a[120:123], v[108:111]
 s_waitcnt lgkmcnt(8)
 v_mfma_f32_16x16x32_bf16 v[112:115], a[192:195], a[120:123], v[112:115]
 ds_read_b64_tr_b16 a[216:217], v59 offset:232
 v_mfma_f32_16x16x32_bf16 v[112:115], a[196:199], a[132:135], v[112:115]
 ds_read_b64_tr_b16 a[218:219], v59 offset:744
 v_mfma_f32_16x16x32_bf16 v[176:179], a[196:199], a[136:139], v[176:179]
 ds_read_b64_tr_b16 a[220:221], v59 offset:17128
 v_mfma_f32_16x16x32_bf16 v[176:179], a[192:195], a[124:127], v[176:179]
 ds_read_b64_tr_b16 a[222:223], v59 offset:17640
 v_mfma_f32_16x16x32_bf16 v[240:243], a[192:195], a[128:131], v[240:243]
 v_mfma_f32_16x16x32_bf16 v[240:243], a[196:199], a[140:143], v[240:243]
 s_waitcnt lgkmcnt(8)
 s_add_u32 m0, s73, 0x9470
 v_mfma_f32_16x16x32_bf16 v[244:247], a[204:207], a[140:143], v[244:247]
 buffer_load_dwordx4 v4, s[48:51], s75 offen offset:3072 nt lds
 v_mfma_f32_16x16x32_bf16 v[244:247], a[200:203], a[128:131], v[244:247]
 s_waitcnt vmcnt(16) lgkmcnt(0)
 s_barrier
 v_mfma_f32_16x16x32_bf16 v[180:183], a[200:203], a[124:127], v[180:183]
 ds_read_b64_tr_b16 a[192:193], v41 offset:33792
 v_mfma_f32_16x16x32_bf16 v[180:183], a[204:207], a[136:139], v[180:183]
 ds_read_b64_tr_b16 a[194:195], v41 offset:34304
 v_mfma_f32_16x16x32_bf16 v[116:119], a[204:207], a[132:135], v[116:119]
 ds_read_b64_tr_b16 a[196:197], v41 offset:50688
 v_mfma_f32_16x16x32_bf16 v[116:119], a[200:203], a[120:123], v[116:119]
 ds_read_b64_tr_b16 a[198:199], v41 offset:51200
 v_mfma_f32_16x16x32_bf16 v[120:123], a[208:211], a[120:123], v[120:123]
 ds_read_b64_tr_b16 a[200:201], v41 offset:33800
 v_mfma_f32_16x16x32_bf16 v[120:123], a[212:215], a[132:135], v[120:123]
 ds_read_b64_tr_b16 a[202:203], v41 offset:34312
 v_mfma_f32_16x16x32_bf16 v[184:187], a[212:215], a[136:139], v[184:187]
 ds_read_b64_tr_b16 a[204:205], v41 offset:50696
 v_mfma_f32_16x16x32_bf16 v[184:187], a[208:211], a[124:127], v[184:187]
 ds_read_b64_tr_b16 a[206:207], v41 offset:51208
 v_mfma_f32_16x16x32_bf16 v[248:251], a[208:211], a[128:131], v[248:251]
 v_mfma_f32_16x16x32_bf16 v[248:251], a[212:215], a[140:143], v[248:251]
 v_mfma_f32_16x16x32_bf16 v[252:255], a[220:223], a[140:143], v[252:255]
 ds_read_b64_tr_b16 a[208:209], v59 offset:33824
 v_mfma_f32_16x16x32_bf16 v[252:255], a[216:219], a[128:131], v[252:255]
 ds_read_b64_tr_b16 a[210:211], v59 offset:34336
 v_mfma_f32_16x16x32_bf16 v[188:191], a[216:219], a[124:127], v[188:191]
 ds_read_b64_tr_b16 a[212:213], v59 offset:50720
 v_mfma_f32_16x16x32_bf16 v[188:191], a[220:223], a[136:139], v[188:191]
 ds_read_b64_tr_b16 a[214:215], v59 offset:51232
 v_mfma_f32_16x16x32_bf16 v[124:127], a[220:223], a[132:135], v[124:127]
 v_mfma_f32_16x16x32_bf16 v[124:127], a[216:219], a[120:123], v[124:127]
 s_waitcnt lgkmcnt(8)
 s_add_u32 s75, s75, 0x8000
 v_mfma_f32_16x16x32_bf16 v[64:67], a[192:195], a[144:147], v[64:67]
 ds_read_b64_tr_b16 a[216:217], v59 offset:33832
 v_mfma_f32_16x16x32_bf16 v[64:67], a[196:199], a[156:159], v[64:67]
 ds_read_b64_tr_b16 a[218:219], v59 offset:34344
 v_mfma_f32_16x16x32_bf16 v[128:131], a[196:199], a[160:163], v[128:131]
 ds_read_b64_tr_b16 a[220:221], v59 offset:50728
 v_mfma_f32_16x16x32_bf16 v[128:131], a[192:195], a[148:151], v[128:131]
 s_add_u32 m0, s74, 0x10800
 ds_read_b64_tr_b16 a[222:223], v59 offset:51240
 v_mfma_f32_16x16x32_bf16 v[192:195], a[192:195], a[152:155], v[192:195]
 buffer_load_dwordx4 v3, s[52:55], s76 offen offset:0 nt lds
 v_mfma_f32_16x16x32_bf16 v[192:195], a[196:199], a[164:167], v[192:195]
 s_waitcnt lgkmcnt(8)
 v_mfma_f32_16x16x32_bf16 v[196:199], a[204:207], a[164:167], v[196:199]
 ds_read_b64_tr_b16 a[192:193], v41 offset:33856
 v_mfma_f32_16x16x32_bf16 v[196:199], a[200:203], a[152:155], v[196:199]
 ds_read_b64_tr_b16 a[194:195], v41 offset:34368
 v_mfma_f32_16x16x32_bf16 v[132:135], a[200:203], a[148:151], v[132:135]
 ds_read_b64_tr_b16 a[196:197], v41 offset:50752
 v_mfma_f32_16x16x32_bf16 v[132:135], a[204:207], a[160:163], v[132:135]
 ds_read_b64_tr_b16 a[198:199], v41 offset:51264
 v_mfma_f32_16x16x32_bf16 v[68:71], a[204:207], a[156:159], v[68:71]
 v_mul_f32 v192, s80, v192
 v_mul_f32 v193, s80, v193
 v_mfma_f32_16x16x32_bf16 v[68:71], a[200:203], a[144:147], v[68:71]
 s_waitcnt lgkmcnt(8)
 v_mul_f32 v194, s80, v194
 v_mul_f32 v195, s80, v195
 v_mfma_f32_16x16x32_bf16 v[72:75], a[208:211], a[144:147], v[72:75]
 ds_read_b64_tr_b16 a[200:201], v41 offset:33864
 v_cvt_pk_bf16_f32 v192, v192, v193
 v_mfma_f32_16x16x32_bf16 v[72:75], a[212:215], a[156:159], v[72:75]
 ds_read_b64_tr_b16 a[202:203], v41 offset:34376
 v_accvgpr_write_b32 a224, v192
 v_mfma_f32_16x16x32_bf16 v[136:139], a[212:215], a[160:163], v[136:139]
 ds_read_b64_tr_b16 a[204:205], v41 offset:50760
 v_cvt_pk_bf16_f32 v194, v194, v195
 v_mfma_f32_16x16x32_bf16 v[136:139], a[208:211], a[148:151], v[136:139]
 s_add_u32 m0, s74, 0x10820
 ds_read_b64_tr_b16 a[206:207], v41 offset:51272
 v_accvgpr_write_b32 a225, v194
 v_mul_f32 v196, s80, v196
 v_mfma_f32_16x16x32_bf16 v[200:203], a[208:211], a[152:155], v[200:203]
 buffer_load_dwordx4 v3, s[52:55], s76 offen offset:1024 nt lds
 v_mfma_f32_16x16x32_bf16 v[200:203], a[212:215], a[164:167], v[200:203]
 s_waitcnt lgkmcnt(8)
 v_mul_f32 v197, s80, v197
 v_mul_f32 v198, s80, v198
 v_mfma_f32_16x16x32_bf16 v[204:207], a[220:223], a[164:167], v[204:207]
 ds_read_b64_tr_b16 a[208:209], v59 offset:33888
 v_mul_f32 v199, s80, v199
 v_mfma_f32_16x16x32_bf16 v[204:207], a[216:219], a[152:155], v[204:207]
 ds_read_b64_tr_b16 a[210:211], v59 offset:34400
 v_cvt_pk_bf16_f32 v196, v196, v197
 v_mfma_f32_16x16x32_bf16 v[140:143], a[216:219], a[148:151], v[140:143]
 ds_read_b64_tr_b16 a[212:213], v59 offset:50784
 v_accvgpr_write_b32 a226, v196
 v_mfma_f32_16x16x32_bf16 v[140:143], a[220:223], a[160:163], v[140:143]
 ds_read_b64_tr_b16 a[214:215], v59 offset:51296
 v_cvt_pk_bf16_f32 v198, v198, v199
 v_mfma_f32_16x16x32_bf16 v[76:79], a[220:223], a[156:159], v[76:79]
 s_add_u32 m0, s74, 0x10840
 v_accvgpr_write_b32 a227, v198
 v_mul_f32 v200, s80, v200
 v_mfma_f32_16x16x32_bf16 v[76:79], a[216:219], a[144:147], v[76:79]
 s_waitcnt lgkmcnt(8)
 buffer_load_dwordx4 v3, s[52:55], s76 offen offset:2048 nt lds
 v_mfma_f32_16x16x32_bf16 v[80:83], a[192:195], a[144:147], v[80:83]
 ds_read_b64_tr_b16 a[216:217], v59 offset:33896
 v_mul_f32 v201, s80, v201
 v_mul_f32 v202, s80, v202
 v_mfma_f32_16x16x32_bf16 v[80:83], a[196:199], a[156:159], v[80:83]
 ds_read_b64_tr_b16 a[218:219], v59 offset:34408
 v_mul_f32 v203, s80, v203
 v_mfma_f32_16x16x32_bf16 v[144:147], a[196:199], a[160:163], v[144:147]
 ds_read_b64_tr_b16 a[220:221], v59 offset:50792
 v_cvt_pk_bf16_f32 v200, v200, v201
 v_mfma_f32_16x16x32_bf16 v[144:147], a[192:195], a[148:151], v[144:147]
 ds_read_b64_tr_b16 a[222:223], v59 offset:51304
 v_accvgpr_write_b32 a228, v200
 v_mfma_f32_16x16x32_bf16 v[208:211], a[192:195], a[152:155], v[208:211]
 v_cvt_pk_bf16_f32 v202, v202, v203
 v_accvgpr_write_b32 a229, v202
 v_mfma_f32_16x16x32_bf16 v[208:211], a[196:199], a[164:167], v[208:211]
 s_waitcnt lgkmcnt(8)
 v_mul_f32 v204, s80, v204
 v_mul_f32 v205, s80, v205
 v_mfma_f32_16x16x32_bf16 v[212:215], a[204:207], a[164:167], v[212:215]
 ds_read_b64_tr_b16 a[192:193], v41 offset:33920
 v_mul_f32 v206, s80, v206
 v_mfma_f32_16x16x32_bf16 v[212:215], a[200:203], a[152:155], v[212:215]
 ds_read_b64_tr_b16 a[194:195], v41 offset:34432
 v_mul_f32 v207, s80, v207
 v_mfma_f32_16x16x32_bf16 v[148:151], a[200:203], a[148:151], v[148:151]
 ds_read_b64_tr_b16 a[196:197], v41 offset:50816
 v_cvt_pk_bf16_f32 v204, v204, v205
 v_mfma_f32_16x16x32_bf16 v[148:151], a[204:207], a[160:163], v[148:151]
 s_add_u32 m0, s74, 0x10860
 ds_read_b64_tr_b16 a[198:199], v41 offset:51328
 v_accvgpr_write_b32 a230, v204
 v_mfma_f32_16x16x32_bf16 v[84:87], a[204:207], a[156:159], v[84:87]
 buffer_load_dwordx4 v3, s[52:55], s76 offen offset:3072 nt lds
 v_mfma_f32_16x16x32_bf16 v[84:87], a[200:203], a[144:147], v[84:87]
 s_waitcnt lgkmcnt(8)
 v_cvt_pk_bf16_f32 v206, v206, v207
 v_accvgpr_write_b32 a231, v206
 v_mul_f32 v208, s80, v208
 v_mfma_f32_16x16x32_bf16 v[88:91], a[208:211], a[144:147], v[88:91]
 ds_read_b64_tr_b16 a[200:201], v41 offset:33928
 v_mul_f32 v209, s80, v209
 v_mfma_f32_16x16x32_bf16 v[88:91], a[212:215], a[156:159], v[88:91]
 ds_read_b64_tr_b16 a[202:203], v41 offset:34440
 v_mul_f32 v210, s80, v210
 v_mfma_f32_16x16x32_bf16 v[152:155], a[212:215], a[160:163], v[152:155]
 ds_read_b64_tr_b16 a[204:205], v41 offset:50824
 v_mul_f32 v211, s80, v211
 v_mfma_f32_16x16x32_bf16 v[152:155], a[208:211], a[148:151], v[152:155]
 ds_read_b64_tr_b16 a[206:207], v41 offset:51336
 v_cvt_pk_bf16_f32 v208, v208, v209
 v_mfma_f32_16x16x32_bf16 v[216:219], a[208:211], a[152:155], v[216:219]
 v_accvgpr_write_b32 a232, v208
 v_cvt_pk_bf16_f32 v210, v210, v211
 v_mfma_f32_16x16x32_bf16 v[216:219], a[212:215], a[164:167], v[216:219]
 s_waitcnt lgkmcnt(8)
 v_accvgpr_write_b32 a233, v210
 v_mul_f32 v212, s80, v212
 v_mfma_f32_16x16x32_bf16 v[220:223], a[220:223], a[164:167], v[220:223]
 ds_read_b64_tr_b16 a[208:209], v59 offset:33952
 v_mul_f32 v213, s80, v213
 v_mfma_f32_16x16x32_bf16 v[220:223], a[216:219], a[152:155], v[220:223]
 ds_read_b64_tr_b16 a[210:211], v59 offset:34464
 v_mul_f32 v214, s80, v214
 v_mfma_f32_16x16x32_bf16 v[156:159], a[216:219], a[148:151], v[156:159]
 ds_read_b64_tr_b16 a[212:213], v59 offset:50848
 v_mul_f32 v215, s80, v215
 v_mfma_f32_16x16x32_bf16 v[156:159], a[220:223], a[160:163], v[156:159]
 s_add_u32 m0, s74, 0x11880
 ds_read_b64_tr_b16 a[214:215], v59 offset:51360
 v_cvt_pk_bf16_f32 v212, v212, v213
 v_accvgpr_write_b32 a234, v212
 v_mfma_f32_16x16x32_bf16 v[92:95], a[220:223], a[156:159], v[92:95]
 buffer_load_dwordx4 v4, s[52:55], s76 offen offset:0 nt lds
 v_mfma_f32_16x16x32_bf16 v[92:95], a[216:219], a[144:147], v[92:95]
 s_waitcnt lgkmcnt(8)
 v_cvt_pk_bf16_f32 v214, v214, v215
 v_accvgpr_write_b32 a235, v214
 v_mfma_f32_16x16x32_bf16 v[96:99], a[192:195], a[144:147], v[96:99]
 ds_read_b64_tr_b16 a[216:217], v59 offset:33960
 v_mul_f32 v216, s80, v216
 v_mfma_f32_16x16x32_bf16 v[96:99], a[196:199], a[156:159], v[96:99]
 ds_read_b64_tr_b16 a[218:219], v59 offset:34472
 v_mul_f32 v217, s80, v217
 v_mfma_f32_16x16x32_bf16 v[160:163], a[196:199], a[160:163], v[160:163]
 ds_read_b64_tr_b16 a[220:221], v59 offset:50856
 v_mul_f32 v218, s80, v218
 v_mfma_f32_16x16x32_bf16 v[160:163], a[192:195], a[148:151], v[160:163]
 ds_read_b64_tr_b16 a[222:223], v59 offset:51368
 v_mul_f32 v219, s80, v219
 v_mfma_f32_16x16x32_bf16 v[224:227], a[192:195], a[152:155], v[224:227]
 v_cvt_pk_bf16_f32 v216, v216, v217
 v_accvgpr_write_b32 a236, v216
 v_mfma_f32_16x16x32_bf16 v[224:227], a[196:199], a[164:167], v[224:227]
 s_waitcnt lgkmcnt(8)
 v_cvt_pk_bf16_f32 v218, v218, v219
 v_accvgpr_write_b32 a237, v218
 v_mfma_f32_16x16x32_bf16 v[228:231], a[204:207], a[164:167], v[228:231]
 ds_read_b64_tr_b16 a[192:193], v41 offset:33984
 v_mul_f32 v220, s80, v220
 v_mfma_f32_16x16x32_bf16 v[228:231], a[200:203], a[152:155], v[228:231]
 ds_read_b64_tr_b16 a[194:195], v41 offset:34496
 v_mul_f32 v221, s80, v221
 v_mfma_f32_16x16x32_bf16 v[164:167], a[200:203], a[148:151], v[164:167]
 ds_read_b64_tr_b16 a[196:197], v41 offset:50880
 v_mul_f32 v222, s80, v222
 v_mfma_f32_16x16x32_bf16 v[164:167], a[204:207], a[160:163], v[164:167]
 s_add_u32 m0, s74, 0x118a0
 ds_read_b64_tr_b16 a[198:199], v41 offset:51392
 v_mul_f32 v223, s80, v223
 v_cvt_pk_bf16_f32 v220, v220, v221
 v_mfma_f32_16x16x32_bf16 v[100:103], a[204:207], a[156:159], v[100:103]
 buffer_load_dwordx4 v4, s[52:55], s76 offen offset:1024 nt lds
 v_mfma_f32_16x16x32_bf16 v[100:103], a[200:203], a[144:147], v[100:103]
 s_waitcnt lgkmcnt(8)
 v_accvgpr_write_b32 a238, v220
 v_cvt_pk_bf16_f32 v222, v222, v223
 v_mfma_f32_16x16x32_bf16 v[104:107], a[208:211], a[144:147], v[104:107]
 ds_read_b64_tr_b16 a[200:201], v41 offset:33992
 v_accvgpr_write_b32 a239, v222
 v_mfma_f32_16x16x32_bf16 v[104:107], a[212:215], a[156:159], v[104:107]
 ds_read_b64_tr_b16 a[202:203], v41 offset:34504
 v_mul_f32 v224, s80, v224
 v_mfma_f32_16x16x32_bf16 v[168:171], a[212:215], a[160:163], v[168:171]
 ds_read_b64_tr_b16 a[204:205], v41 offset:50888
 v_mul_f32 v225, s80, v225
 v_mfma_f32_16x16x32_bf16 v[168:171], a[208:211], a[148:151], v[168:171]
 ds_read_b64_tr_b16 a[206:207], v41 offset:51400
 v_mul_f32 v226, s80, v226
 v_mfma_f32_16x16x32_bf16 v[232:235], a[208:211], a[152:155], v[232:235]
 v_mul_f32 v227, s80, v227
 v_cvt_pk_bf16_f32 v224, v224, v225
 v_mfma_f32_16x16x32_bf16 v[232:235], a[212:215], a[164:167], v[232:235]
 s_waitcnt lgkmcnt(8)
 v_accvgpr_write_b32 a240, v224
 v_cvt_pk_bf16_f32 v226, v226, v227
 v_mfma_f32_16x16x32_bf16 v[236:239], a[220:223], a[164:167], v[236:239]
 ds_read_b64_tr_b16 a[208:209], v59 offset:34016
 v_accvgpr_write_b32 a241, v226
 v_mfma_f32_16x16x32_bf16 v[236:239], a[216:219], a[152:155], v[236:239]
 ds_read_b64_tr_b16 a[210:211], v59 offset:34528
 v_mul_f32 v228, s80, v228
 v_mfma_f32_16x16x32_bf16 v[172:175], a[216:219], a[148:151], v[172:175]
 ds_read_b64_tr_b16 a[212:213], v59 offset:50912
 v_mul_f32 v229, s80, v229
 v_mfma_f32_16x16x32_bf16 v[172:175], a[220:223], a[160:163], v[172:175]
 s_add_u32 m0, s74, 0x118c0
 ds_read_b64_tr_b16 a[214:215], v59 offset:51424
 v_mul_f32 v230, s80, v230
 v_mfma_f32_16x16x32_bf16 v[108:111], a[220:223], a[156:159], v[108:111]
 buffer_load_dwordx4 v4, s[52:55], s76 offen offset:2048 nt lds
 v_mfma_f32_16x16x32_bf16 v[108:111], a[216:219], a[144:147], v[108:111]
 s_waitcnt lgkmcnt(8)
 v_mul_f32 v231, s80, v231
 v_cvt_pk_bf16_f32 v228, v228, v229
 v_accvgpr_write_b32 a242, v228
 v_mfma_f32_16x16x32_bf16 v[112:115], a[192:195], a[144:147], v[112:115]
 ds_read_b64_tr_b16 a[216:217], v59 offset:34024
 v_cvt_pk_bf16_f32 v230, v230, v231
 v_mfma_f32_16x16x32_bf16 v[112:115], a[196:199], a[156:159], v[112:115]
 ds_read_b64_tr_b16 a[218:219], v59 offset:34536
 v_accvgpr_write_b32 a243, v230
 v_mfma_f32_16x16x32_bf16 v[176:179], a[196:199], a[160:163], v[176:179]
 ds_read_b64_tr_b16 a[220:221], v59 offset:50920
 v_mul_f32 v232, s80, v232
 v_mfma_f32_16x16x32_bf16 v[176:179], a[192:195], a[148:151], v[176:179]
 ds_read_b64_tr_b16 a[222:223], v59 offset:51432
 v_mul_f32 v233, s80, v233
 v_mfma_f32_16x16x32_bf16 v[240:243], a[192:195], a[152:155], v[240:243]
 v_mul_f32 v234, s80, v234
 v_mul_f32 v235, s80, v235
 v_mfma_f32_16x16x32_bf16 v[240:243], a[196:199], a[164:167], v[240:243]
 s_waitcnt lgkmcnt(8)
 s_add_u32 m0, s74, 0x118e0
 v_cvt_pk_bf16_f32 v232, v232, v233
 v_accvgpr_write_b32 a244, v232
 v_mfma_f32_16x16x32_bf16 v[244:247], a[204:207], a[164:167], v[244:247]
 buffer_load_dwordx4 v4, s[52:55], s76 offen offset:3072 nt lds
 v_mfma_f32_16x16x32_bf16 v[244:247], a[200:203], a[152:155], v[244:247]
 s_waitcnt vmcnt(16) lgkmcnt(0)
 s_barrier
 v_mfma_f32_16x16x32_bf16 v[180:183], a[200:203], a[148:151], v[180:183]
 ds_read_b128 a[192:195], v1 offset:0
 v_cvt_pk_bf16_f32 v234, v234, v235
 v_mfma_f32_16x16x32_bf16 v[180:183], a[204:207], a[160:163], v[180:183]
 ds_read_b128 a[196:199], v1 offset:32
 v_accvgpr_write_b32 a245, v234
 v_mfma_f32_16x16x32_bf16 v[116:119], a[204:207], a[156:159], v[116:119]
 v_mul_f32 v236, s80, v236
 v_mul_f32 v237, s80, v237
 v_mfma_f32_16x16x32_bf16 v[116:119], a[200:203], a[144:147], v[116:119]
 v_mul_f32 v238, s80, v238
 v_mul_f32 v239, s80, v239
 v_mfma_f32_16x16x32_bf16 v[120:123], a[208:211], a[144:147], v[120:123]
 ds_read_b128 a[200:203], v1 offset:64
 v_cvt_pk_bf16_f32 v236, v236, v237
 v_mfma_f32_16x16x32_bf16 v[120:123], a[212:215], a[156:159], v[120:123]
 ds_read_b128 a[204:207], v1 offset:96
 v_accvgpr_write_b32 a246, v236
 v_mfma_f32_16x16x32_bf16 v[184:187], a[212:215], a[160:163], v[184:187]
 v_cvt_pk_bf16_f32 v238, v238, v239
 v_accvgpr_write_b32 a247, v238
 v_mfma_f32_16x16x32_bf16 v[184:187], a[208:211], a[148:151], v[184:187]
 v_mul_f32 v240, s80, v240
 v_mul_f32 v241, s80, v241
 v_mfma_f32_16x16x32_bf16 v[248:251], a[208:211], a[152:155], v[248:251]
 v_mul_f32 v242, s80, v242
 v_mul_f32 v243, s80, v243
 v_mfma_f32_16x16x32_bf16 v[248:251], a[212:215], a[164:167], v[248:251]
 v_cvt_pk_bf16_f32 v240, v240, v241
 v_accvgpr_write_b32 a248, v240
 v_mfma_f32_16x16x32_bf16 v[252:255], a[220:223], a[164:167], v[252:255]
 ds_read_b128 a[208:211], v1 offset:128
 v_cvt_pk_bf16_f32 v242, v242, v243
 v_mfma_f32_16x16x32_bf16 v[252:255], a[216:219], a[152:155], v[252:255]
 ds_read_b128 a[212:215], v1 offset:160
 v_accvgpr_write_b32 a249, v242
 v_mul_f32 v244, s80, v244
 v_mfma_f32_16x16x32_bf16 v[188:191], a[216:219], a[148:151], v[188:191]
 v_mul_f32 v245, s80, v245
 v_mul_f32 v246, s80, v246
 v_mfma_f32_16x16x32_bf16 v[188:191], a[220:223], a[160:163], v[188:191]
 v_mul_f32 v247, s80, v247
 v_cvt_pk_bf16_f32 v244, v244, v245
 v_mfma_f32_16x16x32_bf16 v[124:127], a[220:223], a[156:159], v[124:127]
 v_accvgpr_write_b32 a250, v244
 v_cvt_pk_bf16_f32 v246, v246, v247
 v_mfma_f32_16x16x32_bf16 v[124:127], a[216:219], a[144:147], v[124:127]
 s_waitcnt lgkmcnt(4)
 s_add_u32 s76, s76, 0x8000
 v_accvgpr_write_b32 a251, v246
.p2align 3
 v_pk_mul_f32 v[64:65], v[64:65], s[80:81]
 v_pk_mul_f32 v[66:67], v[66:67], s[80:81]
 v_pk_mul_f32 v[68:69], v[68:69], s[80:81]
 v_pk_mul_f32 v[70:71], v[70:71], s[80:81]
 v_cvt_pk_bf16_f32 v64, v64, v65
 v_cvt_pk_bf16_f32 v65, v66, v67
 v_cvt_pk_bf16_f32 v66, v68, v69
 v_cvt_pk_bf16_f32 v67, v70, v71
L1_PAD4:
 s_cbranch_execz L1_PRT4
 s_nop 0
 v_pk_mul_f32 v[72:73], v[72:73], s[80:81]
 v_pk_mul_f32 v[74:75], v[74:75], s[80:81]
 v_pk_mul_f32 v[76:77], v[76:77], s[80:81]
 v_pk_mul_f32 v[78:79], v[78:79], s[80:81]
 v_cvt_pk_bf16_f32 v68, v72, v73
 v_cvt_pk_bf16_f32 v69, v74, v75
 v_cvt_pk_bf16_f32 v70, v76, v77
 v_cvt_pk_bf16_f32 v71, v78, v79
 v_pk_mul_f32 v[80:81], v[80:81], s[80:81]
 v_pk_mul_f32 v[82:83], v[82:83], s[80:81]
 v_pk_mul_f32 v[84:85], v[84:85], s[80:81]
 v_pk_mul_f32 v[86:87], v[86:87], s[80:81]
 v_cvt_pk_bf16_f32 v72, v80, v81
 v_cvt_pk_bf16_f32 v73, v82, v83
 v_cvt_pk_bf16_f32 v74, v84, v85
 v_cvt_pk_bf16_f32 v75, v86, v87
 v_pk_mul_f32 v[88:89], v[88:89], s[80:81]
 v_pk_mul_f32 v[90:91], v[90:91], s[80:81]
 v_pk_mul_f32 v[92:93], v[92:93], s[80:81]
 v_pk_mul_f32 v[94:95], v[94:95], s[80:81]
 v_cvt_pk_bf16_f32 v76, v88, v89
 v_cvt_pk_bf16_f32 v77, v90, v91
 v_cvt_pk_bf16_f32 v78, v92, v93
 v_cvt_pk_bf16_f32 v79, v94, v95
 v_pk_mul_f32 v[96:97], v[96:97], s[80:81]
 v_pk_mul_f32 v[98:99], v[98:99], s[80:81]
 v_pk_mul_f32 v[100:101], v[100:101], s[80:81]
 v_pk_mul_f32 v[102:103], v[102:103], s[80:81]
 v_cvt_pk_bf16_f32 v80, v96, v97
 v_cvt_pk_bf16_f32 v81, v98, v99
 v_cvt_pk_bf16_f32 v82, v100, v101
 v_cvt_pk_bf16_f32 v83, v102, v103
 v_pk_mul_f32 v[104:105], v[104:105], s[80:81]
 v_pk_mul_f32 v[106:107], v[106:107], s[80:81]
 v_pk_mul_f32 v[108:109], v[108:109], s[80:81]
 v_pk_mul_f32 v[110:111], v[110:111], s[80:81]
 v_cvt_pk_bf16_f32 v84, v104, v105
 v_cvt_pk_bf16_f32 v85, v106, v107
 v_cvt_pk_bf16_f32 v86, v108, v109
 v_cvt_pk_bf16_f32 v87, v110, v111
 v_pk_mul_f32 v[112:113], v[112:113], s[80:81]
 v_pk_mul_f32 v[114:115], v[114:115], s[80:81]
 v_pk_mul_f32 v[116:117], v[116:117], s[80:81]
 v_pk_mul_f32 v[118:119], v[118:119], s[80:81]
 v_cvt_pk_bf16_f32 v88, v112, v113
 v_cvt_pk_bf16_f32 v89, v114, v115
 v_cvt_pk_bf16_f32 v90, v116, v117
 v_cvt_pk_bf16_f32 v91, v118, v119
 v_pk_mul_f32 v[120:121], v[120:121], s[80:81]
 v_pk_mul_f32 v[122:123], v[122:123], s[80:81]
 v_pk_mul_f32 v[124:125], v[124:125], s[80:81]
 v_pk_mul_f32 v[126:127], v[126:127], s[80:81]
 v_cvt_pk_bf16_f32 v92, v120, v121
 v_cvt_pk_bf16_f32 v93, v122, v123
 v_cvt_pk_bf16_f32 v94, v124, v125
 v_cvt_pk_bf16_f32 v95, v126, v127
 v_pk_mul_f32 v[128:129], v[128:129], s[80:81]
 v_pk_mul_f32 v[130:131], v[130:131], s[80:81]
 v_pk_mul_f32 v[132:133], v[132:133], s[80:81]
 v_pk_mul_f32 v[134:135], v[134:135], s[80:81]
 v_cvt_pk_bf16_f32 v96, v128, v129
 v_cvt_pk_bf16_f32 v97, v130, v131
 v_cvt_pk_bf16_f32 v98, v132, v133
 v_cvt_pk_bf16_f32 v99, v134, v135
 v_pk_mul_f32 v[136:137], v[136:137], s[80:81]
 v_pk_mul_f32 v[138:139], v[138:139], s[80:81]
 v_pk_mul_f32 v[140:141], v[140:141], s[80:81]
 v_pk_mul_f32 v[142:143], v[142:143], s[80:81]
 v_cvt_pk_bf16_f32 v100, v136, v137
 v_cvt_pk_bf16_f32 v101, v138, v139
 v_cvt_pk_bf16_f32 v102, v140, v141
 v_cvt_pk_bf16_f32 v103, v142, v143
 v_pk_mul_f32 v[144:145], v[144:145], s[80:81]
 v_pk_mul_f32 v[146:147], v[146:147], s[80:81]
 v_pk_mul_f32 v[148:149], v[148:149], s[80:81]
 v_pk_mul_f32 v[150:151], v[150:151], s[80:81]
 v_cvt_pk_bf16_f32 v104, v144, v145
 v_cvt_pk_bf16_f32 v105, v146, v147
 v_cvt_pk_bf16_f32 v106, v148, v149
 v_cvt_pk_bf16_f32 v107, v150, v151
 v_pk_mul_f32 v[152:153], v[152:153], s[80:81]
 v_pk_mul_f32 v[154:155], v[154:155], s[80:81]
 v_pk_mul_f32 v[156:157], v[156:157], s[80:81]
 v_pk_mul_f32 v[158:159], v[158:159], s[80:81]
 v_cvt_pk_bf16_f32 v108, v152, v153
 v_cvt_pk_bf16_f32 v109, v154, v155
 v_cvt_pk_bf16_f32 v110, v156, v157
 v_cvt_pk_bf16_f32 v111, v158, v159
 v_pk_mul_f32 v[160:161], v[160:161], s[80:81]
 v_pk_mul_f32 v[162:163], v[162:163], s[80:81]
 v_pk_mul_f32 v[164:165], v[164:165], s[80:81]
 v_pk_mul_f32 v[166:167], v[166:167], s[80:81]
 v_cvt_pk_bf16_f32 v112, v160, v161
 v_cvt_pk_bf16_f32 v113, v162, v163
 v_cvt_pk_bf16_f32 v114, v164, v165
 v_cvt_pk_bf16_f32 v115, v166, v167
 v_pk_mul_f32 v[168:169], v[168:169], s[80:81]
 v_pk_mul_f32 v[170:171], v[170:171], s[80:81]
 v_pk_mul_f32 v[172:173], v[172:173], s[80:81]
 v_pk_mul_f32 v[174:175], v[174:175], s[80:81]
 v_cvt_pk_bf16_f32 v116, v168, v169
 v_cvt_pk_bf16_f32 v117, v170, v171
 v_cvt_pk_bf16_f32 v118, v172, v173
 v_cvt_pk_bf16_f32 v119, v174, v175
 v_pk_mul_f32 v[176:177], v[176:177], s[80:81]
 v_pk_mul_f32 v[178:179], v[178:179], s[80:81]
 v_pk_mul_f32 v[180:181], v[180:181], s[80:81]
 v_pk_mul_f32 v[182:183], v[182:183], s[80:81]
 v_cvt_pk_bf16_f32 v120, v176, v177
 v_cvt_pk_bf16_f32 v121, v178, v179
 v_cvt_pk_bf16_f32 v122, v180, v181
 v_cvt_pk_bf16_f32 v123, v182, v183
 v_pk_mul_f32 v[184:185], v[184:185], s[80:81]
 v_pk_mul_f32 v[186:187], v[186:187], s[80:81]
 v_pk_mul_f32 v[188:189], v[188:189], s[80:81]
 v_pk_mul_f32 v[190:191], v[190:191], s[80:81]
 v_cvt_pk_bf16_f32 v124, v184, v185
 v_cvt_pk_bf16_f32 v125, v186, v187
 v_cvt_pk_bf16_f32 v126, v188, v189
 v_cvt_pk_bf16_f32 v127, v190, v191
 v_pk_mul_f32 v[248:249], v[248:249], s[80:81]
 v_pk_mul_f32 v[250:251], v[250:251], s[80:81]
 v_pk_mul_f32 v[252:253], v[252:253], s[80:81]
 v_pk_mul_f32 v[254:255], v[254:255], s[80:81]
 v_cvt_pk_bf16_f32 v248, v248, v249
 v_cvt_pk_bf16_f32 v249, v250, v251
 v_cvt_pk_bf16_f32 v250, v252, v253
 v_cvt_pk_bf16_f32 v251, v254, v255
 v_accvgpr_write_b32 a252, v248
 v_accvgpr_write_b32 a253, v249
 v_accvgpr_write_b32 a254, v250
 v_accvgpr_write_b32 a255, v251
 v_mfma_f32_16x16x32_bf16 v[128:131], a[192:195], v[64:67], 0
 s_add_u32 m0, s74, 0x18c00
 ds_read_b128 a[216:219], v1 offset:192
 v_mfma_f32_16x16x32_bf16 v[128:131], a[196:199], v[68:71], v[128:131]
 buffer_load_dwordx4 v3, s[52:55], s76 offen offset:0 nt lds
 v_mfma_f32_16x16x32_bf16 v[132:135], a[196:199], v[100:103], 0
 s_add_u32 m0, s74, 0x18c20
 ds_read_b128 a[220:223], v1 offset:224
 v_mfma_f32_16x16x32_bf16 v[132:135], a[192:195], v[96:99], v[132:135]
 buffer_load_dwordx4 v3, s[52:55], s76 offen offset:1024 nt lds
 v_mfma_f32_16x16x32_bf16 v[136:139], a[192:195], a[224:227], 0
 v_mfma_f32_16x16x32_bf16 v[136:139], a[196:199], a[228:231], v[136:139]
 s_waitcnt lgkmcnt(4)
 v_mfma_f32_16x16x32_bf16 v[136:139], a[204:207], a[236:239], v[136:139]
 s_add_u32 m0, s74, 0x18c40
 ds_read_b128 a[192:195], v1 offset:512
 v_mfma_f32_16x16x32_bf16 v[136:139], a[200:203], a[232:235], v[136:139]
 buffer_load_dwordx4 v3, s[52:55], s76 offen offset:2048 nt lds
 v_mfma_f32_16x16x32_bf16 v[132:135], a[200:203], v[104:107], v[132:135]
 s_add_u32 m0, s74, 0x18c60
 ds_read_b128 a[196:199], v1 offset:544
 v_mfma_f32_16x16x32_bf16 v[132:135], a[204:207], v[108:111], v[132:135]
 buffer_load_dwordx4 v3, s[52:55], s76 offen offset:3072 nt lds
 v_mfma_f32_16x16x32_bf16 v[128:131], a[204:207], v[76:79], v[128:131]
 v_mfma_f32_16x16x32_bf16 v[128:131], a[200:203], v[72:75], v[128:131]
 s_waitcnt lgkmcnt(4)
 v_mfma_f32_16x16x32_bf16 v[128:131], a[208:211], v[80:83], v[128:131]
 s_add_u32 m0, s74, 0x19c80
 ds_read_b128 a[200:203], v1 offset:576
 v_mfma_f32_16x16x32_bf16 v[128:131], a[212:215], v[84:87], v[128:131]
 buffer_load_dwordx4 v4, s[52:55], s76 offen offset:0 nt lds
 v_mfma_f32_16x16x32_bf16 v[132:135], a[212:215], v[116:119], v[132:135]
 s_add_u32 m0, s74, 0x19ca0
 ds_read_b128 a[204:207], v1 offset:608
 v_mfma_f32_16x16x32_bf16 v[132:135], a[208:211], v[112:115], v[132:135]
 buffer_load_dwordx4 v4, s[52:55], s76 offen offset:1024 nt lds
 v_mfma_f32_16x16x32_bf16 v[136:139], a[208:211], a[240:243], v[136:139]
 s_add_u32 m0, s74, 0x19cc0
 v_mfma_f32_16x16x32_bf16 v[136:139], a[212:215], a[244:247], v[136:139]
 s_waitcnt lgkmcnt(4)
 buffer_load_dwordx4 v4, s[52:55], s76 offen offset:2048 nt lds
 v_mfma_f32_16x16x32_bf16 v[136:139], a[220:223], a[252:255], v[136:139]
 ds_read_b128 a[208:211], v1 offset:640
 v_mfma_f32_16x16x32_bf16 v[136:139], a[216:219], a[248:251], v[136:139]
 v_mfma_f32_16x16x32_bf16 v[132:135], a[216:219], v[120:123], v[132:135]
 s_add_u32 m0, s74, 0x19ce0
 ds_read_b128 a[212:215], v1 offset:672
 v_mfma_f32_16x16x32_bf16 v[132:135], a[220:223], v[124:127], v[132:135]
 buffer_load_dwordx4 v4, s[52:55], s76 offen offset:3072 nt lds
 v_mfma_f32_16x16x32_bf16 v[128:131], a[220:223], v[92:95], v[128:131]
 v_mfma_f32_16x16x32_bf16 v[128:131], a[216:219], v[88:91], v[128:131]
 s_waitcnt lgkmcnt(4)
 v_mfma_f32_16x16x32_bf16 v[140:143], a[192:195], v[64:67], 0
 ds_read_b128 a[216:219], v1 offset:704
 v_max3_f32 v240, v136, v137, v138
 v_mfma_f32_16x16x32_bf16 v[140:143], a[196:199], v[68:71], v[140:143]
 v_max_f32 v240, v240, v139
 v_mov_b32 v241, v240
 v_mfma_f32_16x16x32_bf16 v[144:147], a[196:199], v[100:103], 0
 ds_read_b128 a[220:223], v1 offset:736
 v_max3_f32 v238, v132, v133, v134
 v_mfma_f32_16x16x32_bf16 v[144:147], a[192:195], v[96:99], v[144:147]
 v_max_f32 v238, v238, v135
 v_mov_b32 v239, v238
 v_mfma_f32_16x16x32_bf16 v[148:151], a[192:195], a[224:227], 0
 v_max3_f32 v236, v128, v129, v130
 v_max_f32 v236, v236, v131
 v_mfma_f32_16x16x32_bf16 v[148:151], a[196:199], a[228:231], v[148:151]
 s_waitcnt lgkmcnt(4)
 v_mov_b32 v237, v236
 v_permlane32_swap_b32 v238, v239
 v_max_f32 v238, v238, v239
 v_mfma_f32_16x16x32_bf16 v[148:151], a[204:207], a[236:239], v[148:151]
 ds_read_b128 a[192:195], v1 offset:16640
 v_mov_b32 v239, v238
 v_mfma_f32_16x16x32_bf16 v[148:151], a[200:203], a[232:235], v[148:151]
 v_permlane32_swap_b32 v236, v237
 v_max_f32 v236, v236, v237
 v_mfma_f32_16x16x32_bf16 v[144:147], a[200:203], v[104:107], v[144:147]
 ds_read_b128 a[196:199], v1 offset:16672
 v_mov_b32 v237, v236
 v_mfma_f32_16x16x32_bf16 v[144:147], a[204:207], v[108:111], v[144:147]
 v_permlane32_swap_b32 v240, v241
 v_max_f32 v240, v240, v241
 v_mov_b32 v241, v240
 v_mfma_f32_16x16x32_bf16 v[140:143], a[204:207], v[76:79], v[140:143]
 v_permlane16_swap_b32 v236, v237
 v_max_f32 v236, v236, v237
 v_mfma_f32_16x16x32_bf16 v[140:143], a[200:203], v[72:75], v[140:143]
 s_waitcnt lgkmcnt(4)
 v_sub_f32 v16, 0, v236
 v_sub_f32 v17, 0, v236
 v_mfma_f32_16x16x32_bf16 v[140:143], a[208:211], v[80:83], v[140:143]
 ds_read_b128 a[200:203], v1 offset:16704
 v_sub_f32 v18, 0, v236
 v_mfma_f32_16x16x32_bf16 v[140:143], a[212:215], v[84:87], v[140:143]
 v_sub_f32 v19, 0, v236
 v_permlane16_swap_b32 v238, v239
 v_max_f32 v238, v238, v239
 v_mfma_f32_16x16x32_bf16 v[144:147], a[212:215], v[116:119], v[144:147]
 ds_read_b128 a[204:207], v1 offset:16736
 v_sub_f32 v20, 0, v238
 v_mfma_f32_16x16x32_bf16 v[144:147], a[208:211], v[112:115], v[144:147]
 v_sub_f32 v21, 0, v238
 v_sub_f32 v22, 0, v238
 v_mfma_f32_16x16x32_bf16 v[148:151], a[208:211], a[240:243], v[148:151]
 v_sub_f32 v23, 0, v238
 v_permlane16_swap_b32 v240, v241
 v_mfma_f32_16x16x32_bf16 v[148:151], a[212:215], a[244:247], v[148:151]
 s_waitcnt lgkmcnt(4)
 v_max_f32 v240, v240, v241
 v_sub_f32 v24, 0, v240
 v_sub_f32 v25, 0, v240
 v_mfma_f32_16x16x32_bf16 v[148:151], a[220:223], a[252:255], v[148:151]
 ds_read_b128 a[208:211], v1 offset:16768
 v_sub_f32 v26, 0, v240
 v_mfma_f32_16x16x32_bf16 v[148:151], a[216:219], a[248:251], v[148:151]
 v_sub_f32 v27, 0, v240
 v_add_f32 v128, v128, v16
 v_mfma_f32_16x16x32_bf16 v[144:147], a[216:219], v[120:123], v[144:147]
 ds_read_b128 a[212:215], v1 offset:16800
 v_add_f32 v129, v129, v16
 v_mfma_f32_16x16x32_bf16 v[144:147], a[220:223], v[124:127], v[144:147]
 v_exp_f32 v28, v128
 v_add_f32 v132, v132, v20
 v_mfma_f32_16x16x32_bf16 v[140:143], a[220:223], v[92:95], v[140:143]
 v_exp_f32 v29, v129
 v_mfma_f32_16x16x32_bf16 v[140:143], a[216:219], v[88:91], v[140:143]
 s_waitcnt lgkmcnt(4)
 v_add_f32 v133, v133, v20
 v_cvt_pk_bf16_f32 v52, v28, v29
 v_mfma_f32_16x16x32_bf16 v[152:155], a[192:195], v[64:67], v[16:19]
 ds_read_b128 a[216:219], v1 offset:16832
 v_add_f32 v136, v136, v24
 v_mfma_f32_16x16x32_bf16 v[152:155], a[196:199], v[68:71], v[152:155]
 v_exp_f32 v28, v132
 v_add_f32 v137, v137, v24
 v_mfma_f32_16x16x32_bf16 v[156:159], a[196:199], v[100:103], v[20:23]
 ds_read_b128 a[220:223], v1 offset:16864
 v_add_f32 v130, v130, v16
 v_mfma_f32_16x16x32_bf16 v[156:159], a[192:195], v[96:99], v[156:159]
 v_exp_f32 v29, v133
 v_mfma_f32_16x16x32_bf16 v[160:163], a[192:195], a[224:227], v[24:27]
 v_exp_f32 v30, v130
 v_mfma_f32_16x16x32_bf16 v[160:163], a[196:199], a[228:231], v[160:163]
 s_waitcnt lgkmcnt(4)
 v_cvt_pk_bf16_f32 v56, v28, v29
 v_exp_f32 v28, v136
 v_mfma_f32_16x16x32_bf16 v[160:163], a[204:207], a[236:239], v[160:163]
 ds_read_b128 a[192:195], v1 offset:17152
 v_add_f32 v131, v131, v16
 v_mfma_f32_16x16x32_bf16 v[160:163], a[200:203], a[232:235], v[160:163]
 v_exp_f32 v29, v137
 v_mfma_f32_16x16x32_bf16 v[156:159], a[200:203], v[104:107], v[156:159]
 ds_read_b128 a[196:199], v1 offset:17184
 v_add_f32 v140, v140, v16
 v_mfma_f32_16x16x32_bf16 v[156:159], a[204:207], v[108:111], v[156:159]
 v_exp_f32 v31, v131
 v_mfma_f32_16x16x32_bf16 v[152:155], a[204:207], v[76:79], v[152:155]
 v_exp_f32 v32, v140
 v_add_f32 v141, v141, v16
 v_mfma_f32_16x16x32_bf16 v[152:155], a[200:203], v[72:75], v[152:155]
 s_waitcnt lgkmcnt(4)
 v_exp_f32 v33, v141
 v_mfma_f32_16x16x32_bf16 v[152:155], a[208:211], v[80:83], v[152:155]
 ds_read_b128 a[200:203], v1 offset:17216
 v_add_f32 v142, v142, v16
 v_mfma_f32_16x16x32_bf16 v[152:155], a[212:215], v[84:87], v[152:155]
 v_exp_f32 v34, v142
 v_mfma_f32_16x16x32_bf16 v[156:159], a[212:215], v[116:119], v[156:159]
 ds_read_b128 a[204:207], v1 offset:17248
 v_add_f32 v143, v143, v16
 v_dot2_f32_bf16 v11, v52, s79, 0
 v_mfma_f32_16x16x32_bf16 v[156:159], a[208:211], v[112:115], v[156:159]
 v_exp_f32 v35, v143
 v_mfma_f32_16x16x32_bf16 v[160:163], a[208:211], a[240:243], v[160:163]
 v_dot2_f32_bf16 v12, v56, s79, 0
 v_cvt_pk_bf16_f32 v60, v28, v29
 v_mfma_f32_16x16x32_bf16 v[160:163], a[212:215], a[244:247], v[160:163]
 s_waitcnt lgkmcnt(4)
 v_dot2_f32_bf16 v13, v60, s79, 0
 v_add_f32 v134, v134, v20
 v_mfma_f32_16x16x32_bf16 v[160:163], a[220:223], a[252:255], v[160:163]
 ds_read_b128 a[208:211], v1 offset:17280
 v_add_f32 v135, v135, v20
 v_mfma_f32_16x16x32_bf16 v[160:163], a[216:219], a[248:251], v[160:163]
 v_add_f32 v144, v144, v20
 v_add_f32 v145, v145, v20
 v_add_f32 v146, v146, v20
 v_mfma_f32_16x16x32_bf16 v[156:159], a[216:219], v[120:123], v[156:159]
 ds_read_b128 a[212:215], v1 offset:17312
 v_add_f32 v147, v147, v20
 v_mfma_f32_16x16x32_bf16 v[156:159], a[220:223], v[124:127], v[156:159]
 v_cvt_pk_bf16_f32 v53, v30, v31
 v_cvt_pk_bf16_f32 v54, v32, v33
 v_mfma_f32_16x16x32_bf16 v[152:155], a[220:223], v[92:95], v[152:155]
 v_exp_f32 v30, v134
 v_mfma_f32_16x16x32_bf16 v[152:155], a[216:219], v[88:91], v[152:155]
 s_waitcnt lgkmcnt(4)
 v_exp_f32 v31, v135
 v_mfma_f32_16x16x32_bf16 v[164:167], a[192:195], v[64:67], v[16:19]
 ds_read_b128 a[216:219], v1 offset:17344
 v_exp_f32 v32, v144
 v_mfma_f32_16x16x32_bf16 v[164:167], a[196:199], v[68:71], v[164:167]
 v_exp_f32 v33, v145
 v_mfma_f32_16x16x32_bf16 v[168:171], a[196:199], v[100:103], v[20:23]
 ds_read_b128 a[220:223], v1 offset:17376
 v_cvt_pk_bf16_f32 v55, v34, v35
 v_mfma_f32_16x16x32_bf16 v[168:171], a[192:195], v[96:99], v[168:171]
 v_exp_f32 v34, v146
 v_mfma_f32_16x16x32_bf16 v[172:175], a[192:195], a[224:227], v[24:27]
 v_exp_f32 v35, v147
 v_mfma_f32_16x16x32_bf16 v[172:175], a[196:199], a[228:231], v[172:175]
 s_waitcnt lgkmcnt(4)
 v_add_f32 v138, v138, v24
 v_add_f32 v139, v139, v24
 v_add_f32 v148, v148, v24
 v_mfma_f32_16x16x32_bf16 v[172:175], a[204:207], a[236:239], v[172:175]
 v_add_f32 v149, v149, v24
 v_add_f32 v150, v150, v24
 v_mfma_f32_16x16x32_bf16 v[172:175], a[200:203], a[232:235], v[172:175]
 v_add_f32 v151, v151, v24
 v_cvt_pk_bf16_f32 v57, v30, v31
 v_mfma_f32_16x16x32_bf16 v[168:171], a[200:203], v[104:107], v[168:171]
 v_exp_f32 v30, v138
 v_mfma_f32_16x16x32_bf16 v[168:171], a[204:207], v[108:111], v[168:171]
 v_exp_f32 v31, v139
 v_mfma_f32_16x16x32_bf16 v[164:167], a[204:207], v[76:79], v[164:167]
 v_cvt_pk_bf16_f32 v58, v32, v33
 v_exp_f32 v32, v148
 v_mfma_f32_16x16x32_bf16 v[164:167], a[200:203], v[72:75], v[164:167]
 s_waitcnt lgkmcnt(2)
 v_exp_f32 v33, v149
 v_mfma_f32_16x16x32_bf16 v[164:167], a[208:211], v[80:83], v[164:167]
 v_cvt_pk_bf16_f32 v59, v34, v35
 v_mov_b32 v8, 0
 v_mfma_f32_16x16x32_bf16 v[164:167], a[212:215], v[84:87], v[164:167]
 v_exp_f32 v34, v150
 v_mfma_f32_16x16x32_bf16 v[168:171], a[212:215], v[116:119], v[168:171]
 v_exp_f32 v35, v151
 v_mfma_f32_16x16x32_bf16 v[168:171], a[208:211], v[112:115], v[168:171]
 v_mov_b32 v9, 0
 v_mov_b32 v10, 0
 v_mfma_f32_16x16x32_bf16 v[172:175], a[208:211], a[240:243], v[172:175]
 v_dot2c_f32_bf16 v11, s79, v53
 v_dot2c_f32_bf16 v11, s79, v54
 v_mfma_f32_16x16x32_bf16 v[172:175], a[212:215], a[244:247], v[172:175]
 s_waitcnt lgkmcnt(0)
 v_dot2c_f32_bf16 v11, s79, v55
 v_dot2c_f32_bf16 v12, s79, v57
 v_dot2c_f32_bf16 v12, s79, v58
 v_mfma_f32_16x16x32_bf16 v[172:175], a[220:223], a[252:255], v[172:175]
 v_dot2c_f32_bf16 v12, s79, v59
 v_cvt_pk_bf16_f32 v61, v30, v31
 v_mfma_f32_16x16x32_bf16 v[172:175], a[216:219], a[248:251], v[172:175]
 v_dot2c_f32_bf16 v13, s79, v61
 v_cvt_pk_bf16_f32 v62, v32, v33
 v_mfma_f32_16x16x32_bf16 v[168:171], a[216:219], v[120:123], v[168:171]
 v_dot2c_f32_bf16 v13, s79, v62
 v_cvt_pk_bf16_f32 v63, v34, v35
 v_mfma_f32_16x16x32_bf16 v[168:171], a[220:223], v[124:127], v[168:171]
 s_waitcnt vmcnt(16)
 s_barrier
 v_mfma_f32_16x16x32_bf16 v[164:167], a[220:223], v[92:95], v[164:167]
 ds_read_b128 a[192:195], v1 offset:33792
 v_dot2c_f32_bf16 v13, s79, v63
 v_mfma_f32_16x16x32_bf16 v[164:167], a[216:219], v[88:91], v[164:167]
 s_waitcnt lgkmcnt(0)
 s_add_u32 s76, s76, 0x8000
 ds_read_b128 a[196:199], v1 offset:33824
 ds_read_b128 a[200:203], v1 offset:33856
 ds_read_b128 a[204:207], v1 offset:33888
 ds_read_b128 a[208:211], v1 offset:33920
 ds_read_b128 a[212:215], v1 offset:33952
 s_waitcnt lgkmcnt(4)
 v_mfma_f32_16x16x32_bf16 v[176:179], a[192:195], v[64:67], v[16:19]
 s_add_u32 m0, s73, 0x0
 ds_read_b128 a[216:219], v1 offset:33984
 v_mfma_f32_16x16x32_bf16 v[176:179], a[196:199], v[68:71], v[176:179]
 buffer_load_dwordx4 v3, s[48:51], s75 offen offset:0 nt lds
 v_mfma_f32_16x16x32_bf16 v[180:183], a[196:199], v[100:103], v[20:23]
 ds_read_b128 a[220:223], v1 offset:34016
 v_mfma_f32_16x16x32_bf16 v[180:183], a[192:195], v[96:99], v[180:183]
 v_exp_f32 v28, v152
 v_mfma_f32_16x16x32_bf16 v[184:187], a[192:195], a[224:227], v[24:27]
 v_exp_f32 v29, v153
 v_mfma_f32_16x16x32_bf16 v[184:187], a[196:199], a[228:231], v[184:187]
 s_waitcnt lgkmcnt(4)
 v_mfma_f32_16x16x32_bf16 v[184:187], a[204:207], a[236:239], v[184:187]
 ds_read_b128 a[192:195], v1 offset:34304
 v_cvt_pk_bf16_f32 v40, v28, v29
 v_mfma_f32_16x16x32_bf16 v[184:187], a[200:203], a[232:235], v[184:187]
 v_exp_f32 v30, v154
 v_mfma_f32_16x16x32_bf16 v[180:183], a[200:203], v[104:107], v[180:183]
 ds_read_b128 a[196:199], v1 offset:34336
 v_mfma_f32_16x16x32_bf16 v[180:183], a[204:207], v[108:111], v[180:183]
 v_mfma_f32_16x16x32_bf16 v[176:179], a[204:207], v[76:79], v[176:179]
 v_exp_f32 v31, v155
 v_mfma_f32_16x16x32_bf16 v[176:179], a[200:203], v[72:75], v[176:179]
 s_waitcnt lgkmcnt(4)
 v_mfma_f32_16x16x32_bf16 v[176:179], a[208:211], v[80:83], v[176:179]
 s_add_u32 m0, s73, 0x10
 ds_read_b128 a[200:203], v1 offset:34368
 v_cvt_pk_bf16_f32 v41, v30, v31
 v_mfma_f32_16x16x32_bf16 v[176:179], a[212:215], v[84:87], v[176:179]
 buffer_load_dwordx4 v3, s[48:51], s75 offen offset:1024 nt lds
 v_mfma_f32_16x16x32_bf16 v[180:183], a[212:215], v[116:119], v[180:183]
 ds_read_b128 a[204:207], v1 offset:34400
 v_mfma_f32_16x16x32_bf16 v[180:183], a[208:211], v[112:115], v[180:183]
 v_exp_f32 v32, v164
 v_mfma_f32_16x16x32_bf16 v[184:187], a[208:211], a[240:243], v[184:187]
 v_exp_f32 v33, v165
 v_mfma_f32_16x16x32_bf16 v[184:187], a[212:215], a[244:247], v[184:187]
 s_waitcnt lgkmcnt(4)
 v_mfma_f32_16x16x32_bf16 v[184:187], a[220:223], a[252:255], v[184:187]
 ds_read_b128 a[208:211], v1 offset:34432
 v_mfma_f32_16x16x32_bf16 v[184:187], a[216:219], a[248:251], v[184:187]
 v_exp_f32 v34, v166
 v_mfma_f32_16x16x32_bf16 v[180:183], a[216:219], v[120:123], v[180:183]
 ds_read_b128 a[212:215], v1 offset:34464
 v_mfma_f32_16x16x32_bf16 v[180:183], a[220:223], v[124:127], v[180:183]
 v_exp_f32 v35, v167
 v_mfma_f32_16x16x32_bf16 v[176:179], a[220:223], v[92:95], v[176:179]
 v_mfma_f32_16x16x32_bf16 v[176:179], a[216:219], v[88:91], v[176:179]
 s_waitcnt lgkmcnt(4)
 v_exp_f32 v28, v156
 v_mfma_f32_16x16x32_bf16 v[188:191], a[192:195], v[64:67], v[16:19]
 s_add_u32 m0, s73, 0x20
 ds_read_b128 a[216:219], v1 offset:34496
 v_mfma_f32_16x16x32_bf16 v[188:191], a[196:199], v[68:71], v[188:191]
 buffer_load_dwordx4 v3, s[48:51], s75 offen offset:2048 nt lds
 v_mfma_f32_16x16x32_bf16 v[192:195], a[196:199], v[100:103], v[20:23]
 ds_read_b128 a[220:223], v1 offset:34528
 v_mfma_f32_16x16x32_bf16 v[192:195], a[192:195], v[96:99], v[192:195]
 v_exp_f32 v29, v157
 v_mfma_f32_16x16x32_bf16 v[196:199], a[192:195], a[224:227], v[24:27]
 v_mfma_f32_16x16x32_bf16 v[196:199], a[196:199], a[228:231], v[196:199]
 s_waitcnt lgkmcnt(4)
 v_exp_f32 v30, v158
 v_mfma_f32_16x16x32_bf16 v[196:199], a[204:207], a[236:239], v[196:199]
 ds_read_b128 a[192:195], v1 offset:50432
 v_mfma_f32_16x16x32_bf16 v[196:199], a[200:203], a[232:235], v[196:199]
 v_exp_f32 v31, v159
 v_mfma_f32_16x16x32_bf16 v[192:195], a[200:203], v[104:107], v[192:195]
 ds_read_b128 a[196:199], v1 offset:50464
 v_mfma_f32_16x16x32_bf16 v[192:195], a[204:207], v[108:111], v[192:195]
 v_mfma_f32_16x16x32_bf16 v[188:191], a[204:207], v[76:79], v[188:191]
 v_cvt_pk_bf16_f32 v42, v32, v33
 v_cvt_pk_bf16_f32 v43, v34, v35
 v_mfma_f32_16x16x32_bf16 v[188:191], a[200:203], v[72:75], v[188:191]
 s_waitcnt lgkmcnt(4)
 v_exp_f32 v32, v168
 v_mfma_f32_16x16x32_bf16 v[188:191], a[208:211], v[80:83], v[188:191]
 s_add_u32 m0, s73, 0x30
 ds_read_b128 a[200:203], v1 offset:50496
 v_mfma_f32_16x16x32_bf16 v[188:191], a[212:215], v[84:87], v[188:191]
 buffer_load_dwordx4 v3, s[48:51], s75 offen offset:3072 nt lds
 v_mfma_f32_16x16x32_bf16 v[192:195], a[212:215], v[116:119], v[192:195]
 ds_read_b128 a[204:207], v1 offset:50528
 v_mfma_f32_16x16x32_bf16 v[192:195], a[208:211], v[112:115], v[192:195]
 v_exp_f32 v33, v169
 v_mfma_f32_16x16x32_bf16 v[196:199], a[208:211], a[240:243], v[196:199]
 v_mfma_f32_16x16x32_bf16 v[196:199], a[212:215], a[244:247], v[196:199]
 s_waitcnt lgkmcnt(4)
 v_exp_f32 v34, v170
 v_mfma_f32_16x16x32_bf16 v[196:199], a[220:223], a[252:255], v[196:199]
 ds_read_b128 a[208:211], v1 offset:50560
 v_mfma_f32_16x16x32_bf16 v[196:199], a[216:219], a[248:251], v[196:199]
 v_mfma_f32_16x16x32_bf16 v[192:195], a[216:219], v[120:123], v[192:195]
 ds_read_b128 a[212:215], v1 offset:50592
 v_cvt_pk_bf16_f32 v44, v28, v29
 v_mfma_f32_16x16x32_bf16 v[192:195], a[220:223], v[124:127], v[192:195]
 v_exp_f32 v35, v171
 v_mfma_f32_16x16x32_bf16 v[188:191], a[220:223], v[92:95], v[188:191]
 v_mfma_f32_16x16x32_bf16 v[188:191], a[216:219], v[88:91], v[188:191]
 s_waitcnt lgkmcnt(4)
 v_exp_f32 v28, v160
 v_mfma_f32_16x16x32_bf16 v[200:203], a[192:195], v[64:67], v[16:19]
 s_add_u32 m0, s73, 0x1040
 ds_read_b128 a[216:219], v1 offset:50624
 v_mfma_f32_16x16x32_bf16 v[200:203], a[196:199], v[68:71], v[200:203]
 buffer_load_dwordx4 v4, s[48:51], s75 offen offset:0 nt lds
 v_mfma_f32_16x16x32_bf16 v[204:207], a[196:199], v[100:103], v[20:23]
 ds_read_b128 a[220:223], v1 offset:50656
 v_mfma_f32_16x16x32_bf16 v[204:207], a[192:195], v[96:99], v[204:207]
 v_exp_f32 v29, v161
 v_mfma_f32_16x16x32_bf16 v[208:211], a[192:195], a[224:227], v[24:27]
 v_mfma_f32_16x16x32_bf16 v[208:211], a[196:199], a[228:231], v[208:211]
 s_waitcnt lgkmcnt(4)
 v_cvt_pk_bf16_f32 v45, v30, v31
 v_mfma_f32_16x16x32_bf16 v[208:211], a[204:207], a[236:239], v[208:211]
 ds_read_b128 a[192:195], v1 offset:50944
 v_cvt_pk_bf16_f32 v46, v32, v33
 v_mfma_f32_16x16x32_bf16 v[208:211], a[200:203], a[232:235], v[208:211]
 v_exp_f32 v30, v162
 v_mfma_f32_16x16x32_bf16 v[204:207], a[200:203], v[104:107], v[204:207]
 ds_read_b128 a[196:199], v1 offset:50976
 v_mfma_f32_16x16x32_bf16 v[204:207], a[204:207], v[108:111], v[204:207]
 v_mfma_f32_16x16x32_bf16 v[200:203], a[204:207], v[76:79], v[200:203]
 s_add_u32 m0, s73, 0x1050
 v_exp_f32 v31, v163
 v_mfma_f32_16x16x32_bf16 v[200:203], a[200:203], v[72:75], v[200:203]
 s_waitcnt lgkmcnt(4)
 buffer_load_dwordx4 v4, s[48:51], s75 offen offset:1024 nt lds
 v_mfma_f32_16x16x32_bf16 v[200:203], a[208:211], v[80:83], v[200:203]
 ds_read_b128 a[200:203], v1 offset:51008
 v_mfma_f32_16x16x32_bf16 v[200:203], a[212:215], v[84:87], v[200:203]
 v_exp_f32 v32, v172
 v_mfma_f32_16x16x32_bf16 v[204:207], a[212:215], v[116:119], v[204:207]
 ds_read_b128 a[204:207], v1 offset:51040
 v_mfma_f32_16x16x32_bf16 v[204:207], a[208:211], v[112:115], v[204:207]
 v_mfma_f32_16x16x32_bf16 v[208:211], a[208:211], a[240:243], v[208:211]
 v_exp_f32 v33, v173
 v_mfma_f32_16x16x32_bf16 v[208:211], a[212:215], a[244:247], v[208:211]
 s_waitcnt lgkmcnt(4)
 v_mfma_f32_16x16x32_bf16 v[208:211], a[220:223], a[252:255], v[208:211]
 ds_read_b128 a[208:211], v1 offset:51072
 v_cvt_pk_bf16_f32 v47, v34, v35
 v_mfma_f32_16x16x32_bf16 v[208:211], a[216:219], a[248:251], v[208:211]
 v_exp_f32 v34, v174
 v_mfma_f32_16x16x32_bf16 v[204:207], a[216:219], v[120:123], v[204:207]
 ds_read_b128 a[212:215], v1 offset:51104
 v_mfma_f32_16x16x32_bf16 v[204:207], a[220:223], v[124:127], v[204:207]
 v_mfma_f32_16x16x32_bf16 v[200:203], a[220:223], v[92:95], v[200:203]
 s_add_u32 m0, s73, 0x1060
 v_exp_f32 v35, v175
 v_mfma_f32_16x16x32_bf16 v[200:203], a[216:219], v[88:91], v[200:203]
 s_waitcnt lgkmcnt(4)
 buffer_load_dwordx4 v4, s[48:51], s75 offen offset:2048 nt lds
 v_mfma_f32_16x16x32_bf16 v[212:215], a[192:195], v[64:67], v[16:19]
 ds_read_b128 a[216:219], v1 offset:51136
 v_mfma_f32_16x16x32_bf16 v[212:215], a[196:199], v[68:71], v[212:215]
 v_dot2c_f32_bf16 v11, s79, v40
 v_mfma_f32_16x16x32_bf16 v[216:219], a[196:199], v[100:103], v[20:23]
 ds_read_b128 a[220:223], v1 offset:51168
 v_mfma_f32_16x16x32_bf16 v[216:219], a[192:195], v[96:99], v[216:219]
 v_dot2c_f32_bf16 v11, s79, v41
 v_mfma_f32_16x16x32_bf16 v[220:223], a[192:195], a[224:227], v[24:27]
 v_dot2c_f32_bf16 v11, s79, v42
 v_mfma_f32_16x16x32_bf16 v[220:223], a[196:199], a[228:231], v[220:223]
 s_waitcnt lgkmcnt(4)
 v_dot2c_f32_bf16 v11, s79, v43
 v_mfma_f32_16x16x32_bf16 v[220:223], a[204:207], a[236:239], v[220:223]
 v_dot2c_f32_bf16 v12, s79, v44
 v_mfma_f32_16x16x32_bf16 v[220:223], a[200:203], a[232:235], v[220:223]
 v_dot2c_f32_bf16 v12, s79, v45
 v_mfma_f32_16x16x32_bf16 v[216:219], a[200:203], v[104:107], v[216:219]
 v_dot2c_f32_bf16 v12, s79, v46
 v_mfma_f32_16x16x32_bf16 v[216:219], a[204:207], v[108:111], v[216:219]
 v_dot2c_f32_bf16 v12, s79, v47
 v_mfma_f32_16x16x32_bf16 v[212:215], a[204:207], v[76:79], v[212:215]
 s_add_u32 m0, s73, 0x1070
 v_cvt_pk_bf16_f32 v48, v28, v29
 v_mfma_f32_16x16x32_bf16 v[212:215], a[200:203], v[72:75], v[212:215]
 s_waitcnt lgkmcnt(2)
 buffer_load_dwordx4 v4, s[48:51], s75 offen offset:3072 nt lds
 v_mfma_f32_16x16x32_bf16 v[212:215], a[208:211], v[80:83], v[212:215]
 v_dot2c_f32_bf16 v13, s79, v48
 v_mfma_f32_16x16x32_bf16 v[212:215], a[212:215], v[84:87], v[212:215]
 v_cvt_pk_bf16_f32 v49, v30, v31
 v_mfma_f32_16x16x32_bf16 v[216:219], a[212:215], v[116:119], v[216:219]
L1_PAD5:
 s_cbranch_execz L1_PRT5
 v_dot2c_f32_bf16 v13, s79, v49
 v_mfma_f32_16x16x32_bf16 v[216:219], a[208:211], v[112:115], v[216:219]
 v_cvt_pk_bf16_f32 v50, v32, v33
 v_mfma_f32_16x16x32_bf16 v[220:223], a[208:211], a[240:243], v[220:223]
 v_dot2c_f32_bf16 v13, s79, v50
 v_mfma_f32_16x16x32_bf16 v[220:223], a[212:215], a[244:247], v[220:223]
 s_waitcnt lgkmcnt(0)
 v_cvt_pk_bf16_f32 v51, v34, v35
 v_mfma_f32_16x16x32_bf16 v[220:223], a[220:223], a[252:255], v[220:223]
 v_dot2c_f32_bf16 v13, s79, v51
 v_mfma_f32_16x16x32_bf16 v[220:223], a[216:219], a[248:251], v[220:223]
 v_mfma_f32_16x16x32_bf16 v[216:219], a[216:219], v[120:123], v[216:219]
 v_mfma_f32_16x16x32_bf16 v[216:219], a[220:223], v[124:127], v[216:219]
 s_waitcnt vmcnt(16)
 s_barrier
 v_mfma_f32_16x16x32_bf16 v[212:215], a[220:223], v[92:95], v[212:215]
 s_add_u32 s75, s75, 0x8000
 ds_read_b64_tr_b16 a[192:193], v2 offset:0
 v_max3_f32 v14, v11, v12, v13
 v_cmp_nge_f32 vcc, s78, v14
 v_mfma_f32_16x16x32_bf16 v[212:215], a[216:219], v[88:91], v[212:215]
 s_waitcnt lgkmcnt(0)
 s_mov_b32 s90, 0
 ds_read_b64_tr_b16 a[194:195], v2 offset:512
 ds_read_b64_tr_b16 a[196:197], v2 offset:16896
 ds_read_b64_tr_b16 a[198:199], v2 offset:17408
 ds_read_b64_tr_b16 a[200:201], v2 offset:32
 ds_read_b64_tr_b16 a[202:203], v2 offset:544
 ds_read_b64_tr_b16 a[204:205], v2 offset:16928
 ds_read_b64_tr_b16 a[206:207], v2 offset:17440
 ds_read_b64_tr_b16 a[208:209], v2 offset:64
 ds_read_b64_tr_b16 a[210:211], v2 offset:576
 ds_read_b64_tr_b16 a[212:213], v2 offset:16960
 ds_read_b64_tr_b16 a[214:215], v2 offset:17472
 s_cbranch_vccnz L1_RARE0
L1_BACK0:
 s_waitcnt lgkmcnt(8)
 v_mfma_f32_16x16x32_bf16 a[0:3], a[192:195], v[52:55], 0
 ds_read_b64_tr_b16 a[216:217], v2 offset:96
 v_mfma_f32_16x16x32_bf16 a[0:3], a[196:199], v[40:43], a[0:3]
 ds_read_b64_tr_b16 a[218:219], v2 offset:608
 v_add_f32 v8, v8, v11
 v_mfma_f32_16x16x32_bf16 a[4:7], a[196:199], v[44:47], 0
 ds_read_b64_tr_b16 a[220:221], v2 offset:16992
 v_add_f32 v9, v9, v12
 v_mfma_f32_16x16x32_bf16 a[4:7], a[192:195], v[56:59], a[4:7]
 s_add_u32 m0, s73, 0x8400
 ds_read_b64_tr_b16 a[222:223], v2 offset:17504
 v_mfma_f32_16x16x32_bf16 a[8:11], a[192:195], v[60:63], 0
 buffer_load_dwordx4 v3, s[48:51], s75 offen offset:0 nt lds
 v_mfma_f32_16x16x32_bf16 a[8:11], a[196:199], v[48:51], a[8:11]
 s_waitcnt lgkmcnt(8)
 v_exp_f32 v28, v176
 v_mfma_f32_16x16x32_bf16 a[20:23], a[204:207], v[48:51], 0
 ds_read_b64_tr_b16 a[192:193], v2 offset:128
 v_mfma_f32_16x16x32_bf16 a[20:23], a[200:203], v[60:63], a[20:23]
 ds_read_b64_tr_b16 a[194:195], v2 offset:640
 v_add_f32 v10, v10, v13
 v_mfma_f32_16x16x32_bf16 a[16:19], a[200:203], v[56:59], 0
 ds_read_b64_tr_b16 a[196:197], v2 offset:17024
 v_mfma_f32_16x16x32_bf16 a[16:19], a[204:207], v[44:47], a[16:19]
 ds_read_b64_tr_b16 a[198:199], v2 offset:17536
 v_mfma_f32_16x16x32_bf16 a[12:15], a[204:207], v[40:43], 0
 v_exp_f32 v29, v177
 v_mfma_f32_16x16x32_bf16 a[12:15], a[200:203], v[52:55], a[12:15]
 s_waitcnt lgkmcnt(8)
 v_exp_f32 v30, v178
 v_mfma_f32_16x16x32_bf16 a[24:27], a[208:211], v[52:55], 0
 ds_read_b64_tr_b16 a[200:201], v2 offset:160
 v_cvt_pk_bf16_f32 v224, v28, v29
 v_mfma_f32_16x16x32_bf16 a[24:27], a[212:215], v[40:43], a[24:27]
 ds_read_b64_tr_b16 a[202:203], v2 offset:672
 v_mfma_f32_16x16x32_bf16 a[28:31], a[212:215], v[44:47], 0
 ds_read_b64_tr_b16 a[204:205], v2 offset:17056
 v_dot2_f32_bf16 v11, v224, s79, 0
 v_mfma_f32_16x16x32_bf16 a[28:31], a[208:211], v[56:59], a[28:31]
 s_add_u32 m0, s73, 0x8410
 ds_read_b64_tr_b16 a[206:207], v2 offset:17568
 v_mfma_f32_16x16x32_bf16 a[32:35], a[208:211], v[60:63], 0
 buffer_load_dwordx4 v3, s[48:51], s75 offen offset:1024 nt lds
 v_mfma_f32_16x16x32_bf16 a[32:35], a[212:215], v[48:51], a[32:35]
 s_waitcnt lgkmcnt(8)
 v_exp_f32 v28, v180
 v_mfma_f32_16x16x32_bf16 a[44:47], a[220:223], v[48:51], 0
 ds_read_b64_tr_b16 a[208:209], v2 offset:192
 v_mfma_f32_16x16x32_bf16 a[44:47], a[216:219], v[60:63], a[44:47]
 ds_read_b64_tr_b16 a[210:211], v2 offset:704
 v_mfma_f32_16x16x32_bf16 a[40:43], a[216:219], v[56:59], 0
 ds_read_b64_tr_b16 a[212:213], v2 offset:17088
 v_mfma_f32_16x16x32_bf16 a[40:43], a[220:223], v[44:47], a[40:43]
 ds_read_b64_tr_b16 a[214:215], v2 offset:17600
 v_mfma_f32_16x16x32_bf16 a[36:39], a[220:223], v[40:43], 0
 v_exp_f32 v29, v181
 v_mfma_f32_16x16x32_bf16 a[36:39], a[216:219], v[52:55], a[36:39]
 s_waitcnt lgkmcnt(8)
 v_exp_f32 v31, v179
 v_mfma_f32_16x16x32_bf16 a[48:51], a[192:195], v[52:55], 0
 ds_read_b64_tr_b16 a[216:217], v2 offset:224
 v_cvt_pk_bf16_f32 v228, v28, v29
 v_mfma_f32_16x16x32_bf16 a[48:51], a[196:199], v[40:43], a[48:51]
 ds_read_b64_tr_b16 a[218:219], v2 offset:736
 v_mfma_f32_16x16x32_bf16 a[52:55], a[196:199], v[44:47], 0
 ds_read_b64_tr_b16 a[220:221], v2 offset:17120
 v_dot2_f32_bf16 v12, v228, s79, 0
 v_mfma_f32_16x16x32_bf16 a[52:55], a[192:195], v[56:59], a[52:55]
 s_add_u32 m0, s73, 0x8420
 ds_read_b64_tr_b16 a[222:223], v2 offset:17632
 v_cvt_pk_bf16_f32 v225, v30, v31
 v_mfma_f32_16x16x32_bf16 a[56:59], a[192:195], v[60:63], 0
 buffer_load_dwordx4 v3, s[48:51], s75 offen offset:2048 nt lds
 v_mfma_f32_16x16x32_bf16 a[56:59], a[196:199], v[48:51], a[56:59]
 s_waitcnt lgkmcnt(8)
 v_exp_f32 v28, v184
 v_mfma_f32_16x16x32_bf16 a[68:71], a[204:207], v[48:51], 0
 ds_read_b64_tr_b16 a[192:193], v2 offset:256
 v_mfma_f32_16x16x32_bf16 a[68:71], a[200:203], v[60:63], a[68:71]
 ds_read_b64_tr_b16 a[194:195], v2 offset:768
 v_mfma_f32_16x16x32_bf16 a[64:67], a[200:203], v[56:59], 0
 ds_read_b64_tr_b16 a[196:197], v2 offset:17152
 v_mfma_f32_16x16x32_bf16 a[64:67], a[204:207], v[44:47], a[64:67]
 ds_read_b64_tr_b16 a[198:199], v2 offset:17664
 v_mfma_f32_16x16x32_bf16 a[60:63], a[204:207], v[40:43], 0
 v_exp_f32 v29, v185
 v_mfma_f32_16x16x32_bf16 a[60:63], a[200:203], v[52:55], a[60:63]
 s_waitcnt lgkmcnt(8)
 v_exp_f32 v32, v188
 v_mfma_f32_16x16x32_bf16 a[72:75], a[208:211], v[52:55], 0
 ds_read_b64_tr_b16 a[200:201], v2 offset:288
 v_cvt_pk_bf16_f32 v232, v28, v29
 v_mfma_f32_16x16x32_bf16 a[72:75], a[212:215], v[40:43], a[72:75]
 ds_read_b64_tr_b16 a[202:203], v2 offset:800
 v_mfma_f32_16x16x32_bf16 a[76:79], a[212:215], v[44:47], 0
 ds_read_b64_tr_b16 a[204:205], v2 offset:17184
 v_dot2_f32_bf16 v13, v232, s79, 0
 v_mfma_f32_16x16x32_bf16 a[76:79], a[208:211], v[56:59], a[76:79]
 s_add_u32 m0, s73, 0x8430
 ds_read_b64_tr_b16 a[206:207], v2 offset:17696
 v_mfma_f32_16x16x32_bf16 a[80:83], a[208:211], v[60:63], 0
 buffer_load_dwordx4 v3, s[48:51], s75 offen offset:3072 nt lds
 v_mfma_f32_16x16x32_bf16 a[80:83], a[212:215], v[48:51], a[80:83]
 s_waitcnt lgkmcnt(8)
 v_exp_f32 v33, v189
 v_mfma_f32_16x16x32_bf16 a[92:95], a[220:223], v[48:51], 0
 ds_read_b64_tr_b16 a[208:209], v2 offset:320
 v_cvt_pk_bf16_f32 v226, v32, v33
 v_mfma_f32_16x16x32_bf16 a[92:95], a[216:219], v[60:63], a[92:95]
 ds_read_b64_tr_b16 a[210:211], v2 offset:832
 v_mfma_f32_16x16x32_bf16 a[88:91], a[216:219], v[56:59], 0
 ds_read_b64_tr_b16 a[212:213], v2 offset:17216
 v_mfma_f32_16x16x32_bf16 a[88:91], a[220:223], v[44:47], a[88:91]
 ds_read_b64_tr_b16 a[214:215], v2 offset:17728
 v_mfma_f32_16x16x32_bf16 a[84:87], a[220:223], v[40:43], 0
 v_exp_f32 v34, v190
 v_mfma_f32_16x16x32_bf16 a[84:87], a[216:219], v[52:55], a[84:87]
 s_waitcnt lgkmcnt(8)
 v_exp_f32 v35, v191
 v_mfma_f32_16x16x32_bf16 a[96:99], a[192:195], v[52:55], 0
 ds_read_b64_tr_b16 a[216:217], v2 offset:352
 v_cvt_pk_bf16_f32 v227, v34, v35
 v_mfma_f32_16x16x32_bf16 a[96:99], a[196:199], v[40:43], a[96:99]
 ds_read_b64_tr_b16 a[218:219], v2 offset:864
 v_mfma_f32_16x16x32_bf16 a[100:103], a[196:199], v[44:47], 0
 ds_read_b64_tr_b16 a[220:221], v2 offset:17248
 v_mfma_f32_16x16x32_bf16 a[100:103], a[192:195], v[56:59], a[100:103]
 s_add_u32 m0, s73, 0x9440
 ds_read_b64_tr_b16 a[222:223], v2 offset:17760
 v_mfma_f32_16x16x32_bf16 a[104:107], a[192:195], v[60:63], 0
 buffer_load_dwordx4 v4, s[48:51], s75 offen offset:0 nt lds
 v_mfma_f32_16x16x32_bf16 a[104:107], a[196:199], v[48:51], a[104:107]
 s_waitcnt lgkmcnt(8)
 v_exp_f32 v30, v182
 v_mfma_f32_16x16x32_bf16 a[116:119], a[204:207], v[48:51], 0
 ds_read_b64_tr_b16 a[192:193], v2 offset:384
 v_mfma_f32_16x16x32_bf16 a[116:119], a[200:203], v[60:63], a[116:119]
 ds_read_b64_tr_b16 a[194:195], v2 offset:896
 v_mfma_f32_16x16x32_bf16 a[112:115], a[200:203], v[56:59], 0
 ds_read_b64_tr_b16 a[196:197], v2 offset:17280
 v_mfma_f32_16x16x32_bf16 a[112:115], a[204:207], v[44:47], a[112:115]
 ds_read_b64_tr_b16 a[198:199], v2 offset:17792
 v_mfma_f32_16x16x32_bf16 a[108:111], a[204:207], v[40:43], 0
 s_add_u32 m0, s73, 0x9450
 v_exp_f32 v31, v183
 v_mfma_f32_16x16x32_bf16 a[108:111], a[200:203], v[52:55], a[108:111]
 s_waitcnt lgkmcnt(8)
 buffer_load_dwordx4 v4, s[48:51], s75 offen offset:1024 nt lds
 v_mfma_f32_16x16x32_bf16 a[120:123], a[208:211], v[52:55], 0
 ds_read_b64_tr_b16 a[200:201], v2 offset:416
 v_cvt_pk_bf16_f32 v229, v30, v31
 v_mfma_f32_16x16x32_bf16 a[120:123], a[212:215], v[40:43], a[120:123]
 ds_read_b64_tr_b16 a[202:203], v2 offset:928
 v_dot2c_f32_bf16 v11, s79, v225
 v_mfma_f32_16x16x32_bf16 a[124:127], a[212:215], v[44:47], 0
 ds_read_b64_tr_b16 a[204:205], v2 offset:17312
 v_dot2c_f32_bf16 v11, s79, v226
 v_mfma_f32_16x16x32_bf16 a[124:127], a[208:211], v[56:59], a[124:127]
 ds_read_b64_tr_b16 a[206:207], v2 offset:17824
 v_dot2c_f32_bf16 v11, s79, v227
 v_mfma_f32_16x16x32_bf16 a[128:131], a[208:211], v[60:63], 0
 v_exp_f32 v32, v192
 v_mfma_f32_16x16x32_bf16 a[128:131], a[212:215], v[48:51], a[128:131]
 s_waitcnt lgkmcnt(8)
 v_mfma_f32_16x16x32_bf16 a[140:143], a[220:223], v[48:51], 0
 ds_read_b64_tr_b16 a[208:209], v2 offset:448
 v_dot2c_f32_bf16 v12, s79, v229
 v_mfma_f32_16x16x32_bf16 a[140:143], a[216:219], v[60:63], a[140:143]
 ds_read_b64_tr_b16 a[210:211], v2 offset:960
 v_mfma_f32_16x16x32_bf16 a[136:139], a[216:219], v[56:59], 0
 ds_read_b64_tr_b16 a[212:213], v2 offset:17344
 v_mfma_f32_16x16x32_bf16 a[136:139], a[220:223], v[44:47], a[136:139]
 ds_read_b64_tr_b16 a[214:215], v2 offset:17856
 v_mfma_f32_16x16x32_bf16 a[132:135], a[220:223], v[40:43], 0
 s_add_u32 m0, s73, 0x9460
 v_exp_f32 v33, v193
 v_mfma_f32_16x16x32_bf16 a[132:135], a[216:219], v[52:55], a[132:135]
 s_waitcnt lgkmcnt(8)
 buffer_load_dwordx4 v4, s[48:51], s75 offen offset:2048 nt lds
 v_mfma_f32_16x16x32_bf16 a[144:147], a[192:195], v[52:55], 0
 ds_read_b64_tr_b16 a[216:217], v2 offset:480
 v_cvt_pk_bf16_f32 v230, v32, v33
 v_mfma_f32_16x16x32_bf16 a[144:147], a[196:199], v[40:43], a[144:147]
 ds_read_b64_tr_b16 a[218:219], v2 offset:992
 v_dot2c_f32_bf16 v12, s79, v230
 v_mfma_f32_16x16x32_bf16 a[148:151], a[196:199], v[44:47], 0
 ds_read_b64_tr_b16 a[220:221], v2 offset:17376
 v_mfma_f32_16x16x32_bf16 a[148:151], a[192:195], v[56:59], a[148:151]
 ds_read_b64_tr_b16 a[222:223], v2 offset:17888
 v_mfma_f32_16x16x32_bf16 a[152:155], a[192:195], v[60:63], 0
 v_exp_f32 v34, v194
 v_mfma_f32_16x16x32_bf16 a[152:155], a[196:199], v[48:51], a[152:155]
 s_waitcnt lgkmcnt(8)
 v_exp_f32 v35, v195
 v_mfma_f32_16x16x32_bf16 a[164:167], a[204:207], v[48:51], 0
 v_exp_f32 v30, v186
 v_mfma_f32_16x16x32_bf16 a[164:167], a[200:203], v[60:63], a[164:167]
 v_exp_f32 v31, v187
 v_mfma_f32_16x16x32_bf16 a[160:163], a[200:203], v[56:59], 0
 v_mfma_f32_16x16x32_bf16 a[160:163], a[204:207], v[44:47], a[160:163]
 v_exp_f32 v32, v196
 v_mfma_f32_16x16x32_bf16 a[156:159], a[204:207], v[40:43], 0
 s_add_u32 m0, s73, 0x9470
 v_exp_f32 v33, v197
 v_mfma_f32_16x16x32_bf16 a[156:159], a[200:203], v[52:55], a[156:159]
 s_waitcnt lgkmcnt(4)
 buffer_load_dwordx4 v4, s[48:51], s75 offen offset:3072 nt lds
 v_mfma_f32_16x16x32_bf16 a[168:171], a[208:211], v[52:55], 0
 v_cvt_pk_bf16_f32 v231, v34, v35
 v_mfma_f32_16x16x32_bf16 a[168:171], a[212:215], v[40:43], a[168:171]
 v_exp_f32 v34, v198
 v_mfma_f32_16x16x32_bf16 a[172:175], a[212:215], v[44:47], 0
 v_mfma_f32_16x16x32_bf16 a[172:175], a[208:211], v[56:59], a[172:175]
 v_exp_f32 v35, v199
 v_mfma_f32_16x16x32_bf16 a[176:179], a[208:211], v[60:63], 0
 v_dot2c_f32_bf16 v12, s79, v231
 v_mfma_f32_16x16x32_bf16 a[176:179], a[212:215], v[48:51], a[176:179]
 s_waitcnt lgkmcnt(0)
 v_cvt_pk_bf16_f32 v233, v30, v31
 v_dot2c_f32_bf16 v13, s79, v233
 v_mfma_f32_16x16x32_bf16 a[188:191], a[220:223], v[48:51], 0
 v_cvt_pk_bf16_f32 v234, v32, v33
 v_mfma_f32_16x16x32_bf16 a[188:191], a[216:219], v[60:63], a[188:191]
 v_dot2c_f32_bf16 v13, s79, v234
 v_mfma_f32_16x16x32_bf16 a[184:187], a[216:219], v[56:59], 0
 v_cvt_pk_bf16_f32 v235, v34, v35
 v_mfma_f32_16x16x32_bf16 a[184:187], a[220:223], v[44:47], a[184:187]
 s_waitcnt vmcnt(8)
 s_barrier
 v_mfma_f32_16x16x32_bf16 a[180:183], a[220:223], v[40:43], 0
 s_add_u32 s75, s75, 0x8000
 ds_read_b128 a[192:195], v1 offset:0
 v_dot2c_f32_bf16 v13, s79, v235
 v_mfma_f32_16x16x32_bf16 a[180:183], a[216:219], v[52:55], a[180:183]
 s_waitcnt lgkmcnt(0)
 s_mov_b32 s77, 14
 ds_read_b128 a[196:199], v1 offset:32
 ds_read_b128 a[200:203], v1 offset:64
 ds_read_b128 a[204:207], v1 offset:96
 ds_read_b128 a[208:211], v1 offset:128
 ds_read_b128 a[212:215], v1 offset:160
.p2align 6
L1_LOOP:
 s_waitcnt lgkmcnt(4)
 v_mfma_f32_16x16x32_bf16 v[128:131], a[192:195], v[64:67], v[16:19]
 s_add_u32 m0, s74, 0x10800
 ds_read_b128 a[216:219], v1 offset:192
 v_mfma_f32_16x16x32_bf16 v[128:131], a[196:199], v[68:71], v[128:131]
 buffer_load_dwordx4 v3, s[52:55], s76 offen offset:0 nt lds
 v_mfma_f32_16x16x32_bf16 v[132:135], a[196:199], v[100:103], v[20:23]
 ds_read_b128 a[220:223], v1 offset:224
 v_mfma_f32_16x16x32_bf16 v[132:135], a[192:195], v[96:99], v[132:135]
 v_exp_f32 v28, v200
 v_mfma_f32_16x16x32_bf16 v[136:139], a[192:195], a[224:227], v[24:27]
 v_exp_f32 v29, v201
 v_mfma_f32_16x16x32_bf16 v[136:139], a[196:199], a[228:231], v[136:139]
 s_waitcnt lgkmcnt(4)
 v_mfma_f32_16x16x32_bf16 v[136:139], a[204:207], a[236:239], v[136:139]
 ds_read_b128 a[192:195], v1 offset:512
 v_cvt_pk_bf16_f32 v40, v28, v29
 v_mfma_f32_16x16x32_bf16 v[136:139], a[200:203], a[232:235], v[136:139]
 v_exp_f32 v30, v202
 v_mfma_f32_16x16x32_bf16 v[132:135], a[200:203], v[104:107], v[132:135]
 ds_read_b128 a[196:199], v1 offset:544
 v_mfma_f32_16x16x32_bf16 v[132:135], a[204:207], v[108:111], v[132:135]
 v_mfma_f32_16x16x32_bf16 v[128:131], a[204:207], v[76:79], v[128:131]
 v_exp_f32 v31, v203
 v_mfma_f32_16x16x32_bf16 v[128:131], a[200:203], v[72:75], v[128:131]
 s_waitcnt lgkmcnt(4)
 v_mfma_f32_16x16x32_bf16 v[128:131], a[208:211], v[80:83], v[128:131]
 s_add_u32 m0, s74, 0x10820
 ds_read_b128 a[200:203], v1 offset:576
 v_cvt_pk_bf16_f32 v41, v30, v31
 v_mfma_f32_16x16x32_bf16 v[128:131], a[212:215], v[84:87], v[128:131]
 buffer_load_dwordx4 v3, s[52:55], s76 offen offset:1024 nt lds
 v_mfma_f32_16x16x32_bf16 v[132:135], a[212:215], v[116:119], v[132:135]
 ds_read_b128 a[204:207], v1 offset:608
 v_mfma_f32_16x16x32_bf16 v[132:135], a[208:211], v[112:115], v[132:135]
 v_exp_f32 v32, v212
 v_mfma_f32_16x16x32_bf16 v[136:139], a[208:211], a[240:243], v[136:139]
 v_exp_f32 v33, v213
 v_mfma_f32_16x16x32_bf16 v[136:139], a[212:215], a[244:247], v[136:139]
 s_waitcnt lgkmcnt(4)
 v_mfma_f32_16x16x32_bf16 v[136:139], a[220:223], a[252:255], v[136:139]
 ds_read_b128 a[208:211], v1 offset:640
 v_mfma_f32_16x16x32_bf16 v[136:139], a[216:219], a[248:251], v[136:139]
 v_exp_f32 v34, v214
 v_mfma_f32_16x16x32_bf16 v[132:135], a[216:219], v[120:123], v[132:135]
 ds_read_b128 a[212:215], v1 offset:672
 v_mfma_f32_16x16x32_bf16 v[132:135], a[220:223], v[124:127], v[132:135]
 v_exp_f32 v35, v215
 v_mfma_f32_16x16x32_bf16 v[128:131], a[220:223], v[92:95], v[128:131]
 v_mfma_f32_16x16x32_bf16 v[128:131], a[216:219], v[88:91], v[128:131]
 s_waitcnt lgkmcnt(4)
 v_exp_f32 v28, v204
 v_mfma_f32_16x16x32_bf16 v[140:143], a[192:195], v[64:67], v[16:19]
 s_add_u32 m0, s74, 0x10840
 ds_read_b128 a[216:219], v1 offset:704
 v_mfma_f32_16x16x32_bf16 v[140:143], a[196:199], v[68:71], v[140:143]
 buffer_load_dwordx4 v3, s[52:55], s76 offen offset:2048 nt lds
 v_mfma_f32_16x16x32_bf16 v[144:147], a[196:199], v[100:103], v[20:23]
 ds_read_b128 a[220:223], v1 offset:736
 v_mfma_f32_16x16x32_bf16 v[144:147], a[192:195], v[96:99], v[144:147]
 v_exp_f32 v29, v205
 v_mfma_f32_16x16x32_bf16 v[148:151], a[192:195], a[224:227], v[24:27]
 v_mfma_f32_16x16x32_bf16 v[148:151], a[196:199], a[228:231], v[148:151]
 s_waitcnt lgkmcnt(4)
 v_exp_f32 v30, v206
 v_mfma_f32_16x16x32_bf16 v[148:151], a[204:207], a[236:239], v[148:151]
 ds_read_b128 a[192:195], v1 offset:16640
 v_mfma_f32_16x16x32_bf16 v[148:151], a[200:203], a[232:235], v[148:151]
 v_exp_f32 v31, v207
 v_mfma_f32_16x16x32_bf16 v[144:147], a[200:203], v[104:107], v[144:147]
 ds_read_b128 a[196:199], v1 offset:16672
 v_mfma_f32_16x16x32_bf16 v[144:147], a[204:207], v[108:111], v[144:147]
 v_mfma_f32_16x16x32_bf16 v[140:143], a[204:207], v[76:79], v[140:143]
 v_cvt_pk_bf16_f32 v42, v32, v33
 v_cvt_pk_bf16_f32 v43, v34, v35
 v_mfma_f32_16x16x32_bf16 v[140:143], a[200:203], v[72:75], v[140:143]
 s_waitcnt lgkmcnt(4)
 v_exp_f32 v32, v216
 v_mfma_f32_16x16x32_bf16 v[140:143], a[208:211], v[80:83], v[140:143]
 s_add_u32 m0, s74, 0x10860
 ds_read_b128 a[200:203], v1 offset:16704
 v_mfma_f32_16x16x32_bf16 v[140:143], a[212:215], v[84:87], v[140:143]
 buffer_load_dwordx4 v3, s[52:55], s76 offen offset:3072 nt lds
 v_mfma_f32_16x16x32_bf16 v[144:147], a[212:215], v[116:119], v[144:147]
 ds_read_b128 a[204:207], v1 offset:16736
 v_mfma_f32_16x16x32_bf16 v[144:147], a[208:211], v[112:115], v[144:147]
 v_exp_f32 v33, v217
 v_mfma_f32_16x16x32_bf16 v[148:151], a[208:211], a[240:243], v[148:151]
 v_mfma_f32_16x16x32_bf16 v[148:151], a[212:215], a[244:247], v[148:151]
 s_waitcnt lgkmcnt(4)
 v_exp_f32 v34, v218
 v_mfma_f32_16x16x32_bf16 v[148:151], a[220:223], a[252:255], v[148:151]
 ds_read_b128 a[208:211], v1 offset:16768
 v_mfma_f32_16x16x32_bf16 v[148:151], a[216:219], a[248:251], v[148:151]
 v_mfma_f32_16x16x32_bf16 v[144:147], a[216:219], v[120:123], v[144:147]
 ds_read_b128 a[212:215], v1 offset:16800
 v_cvt_pk_bf16_f32 v44, v28, v29
 v_mfma_f32_16x16x32_bf16 v[144:147], a[220:223], v[124:127], v[144:147]
 v_exp_f32 v35, v219
 v_mfma_f32_16x16x32_bf16 v[140:143], a[220:223], v[92:95], v[140:143]
 v_mfma_f32_16x16x32_bf16 v[140:143], a[216:219], v[88:91], v[140:143]
 s_waitcnt lgkmcnt(4)
 v_exp_f32 v28, v208
 v_mfma_f32_16x16x32_bf16 v[152:155], a[192:195], v[64:67], v[16:19]
 s_add_u32 m0, s74, 0x11880
 ds_read_b128 a[216:219], v1 offset:16832
 v_mfma_f32_16x16x32_bf16 v[152:155], a[196:199], v[68:71], v[152:155]
 buffer_load_dwordx4 v4, s[52:55], s76 offen offset:0 nt lds
 v_mfma_f32_16x16x32_bf16 v[156:159], a[196:199], v[100:103], v[20:23]
 ds_read_b128 a[220:223], v1 offset:16864
 v_mfma_f32_16x16x32_bf16 v[156:159], a[192:195], v[96:99], v[156:159]
 v_exp_f32 v29, v209
 v_mfma_f32_16x16x32_bf16 v[160:163], a[192:195], a[224:227], v[24:27]
 v_mfma_f32_16x16x32_bf16 v[160:163], a[196:199], a[228:231], v[160:163]
 s_waitcnt lgkmcnt(4)
 v_cvt_pk_bf16_f32 v45, v30, v31
 v_mfma_f32_16x16x32_bf16 v[160:163], a[204:207], a[236:239], v[160:163]
 ds_read_b128 a[192:195], v1 offset:17152
 v_cvt_pk_bf16_f32 v46, v32, v33
 v_mfma_f32_16x16x32_bf16 v[160:163], a[200:203], a[232:235], v[160:163]
 v_exp_f32 v30, v210
 v_mfma_f32_16x16x32_bf16 v[156:159], a[200:203], v[104:107], v[156:159]
 ds_read_b128 a[196:199], v1 offset:17184
 v_mfma_f32_16x16x32_bf16 v[156:159], a[204:207], v[108:111], v[156:159]
 v_mfma_f32_16x16x32_bf16 v[152:155], a[204:207], v[76:79], v[152:155]
 s_add_u32 m0, s74, 0x118a0
 v_exp_f32 v31, v211
 v_mfma_f32_16x16x32_bf16 v[152:155], a[200:203], v[72:75], v[152:155]
 s_waitcnt lgkmcnt(4)
 buffer_load_dwordx4 v4, s[52:55], s76 offen offset:1024 nt lds
 v_mfma_f32_16x16x32_bf16 v[152:155], a[208:211], v[80:83], v[152:155]
 ds_read_b128 a[200:203], v1 offset:17216
 v_mfma_f32_16x16x32_bf16 v[152:155], a[212:215], v[84:87], v[152:155]
 v_exp_f32 v32, v220
 v_mfma_f32_16x16x32_bf16 v[156:159], a[212:215], v[116:119], v[156:159]
 ds_read_b128 a[204:207], v1 offset:17248
 v_mfma_f32_16x16x32_bf16 v[156:159], a[208:211], v[112:115], v[156:159]
 v_mfma_f32_16x16x32_bf16 v[160:163], a[208:211], a[240:243], v[160:163]
 v_exp_f32 v33, v221
 v_mfma_f32_16x16x32_bf16 v[160:163], a[212:215], a[244:247], v[160:163]
 s_waitcnt lgkmcnt(4)
 v_mfma_f32_16x16x32_bf16 v[160:163], a[220:223], a[252:255], v[160:163]
 ds_read_b128 a[208:211], v1 offset:17280
 v_cvt_pk_bf16_f32 v47, v34, v35
 v_mfma_f32_16x16x32_bf16 v[160:163], a[216:219], a[248:251], v[160:163]
 v_exp_f32 v34, v222
 v_mfma_f32_16x16x32_bf16 v[156:159], a[216:219], v[120:123], v[156:159]
 ds_read_b128 a[212:215], v1 offset:17312
 v_mfma_f32_16x16x32_bf16 v[156:159], a[220:223], v[124:127], v[156:159]
 v_mfma_f32_16x16x32_bf16 v[152:155], a[220:223], v[92:95], v[152:155]
 s_add_u32 m0, s74, 0x118c0
 v_exp_f32 v35, v223
 v_mfma_f32_16x16x32_bf16 v[152:155], a[216:219], v[88:91], v[152:155]
 s_waitcnt lgkmcnt(4)
 buffer_load_dwordx4 v4, s[52:55], s76 offen offset:2048 nt lds
 v_mfma_f32_16x16x32_bf16 v[164:167], a[192:195], v[64:67], v[16:19]
 ds_read_b128 a[216:219], v1 offset:17344
 v_mfma_f32_16x16x32_bf16 v[164:167], a[196:199], v[68:71], v[164:167]
 v_dot2c_f32_bf16 v11, s79, v40
 v_mfma_f32_16x16x32_bf16 v[168:171], a[196:199], v[100:103], v[20:23]
 ds_read_b128 a[220:223], v1 offset:17376
 v_mfma_f32_16x16x32_bf16 v[168:171], a[192:195], v[96:99], v[168:171]
 v_dot2c_f32_bf16 v11, s79, v41
 v_mfma_f32_16x16x32_bf16 v[172:175], a[192:195], a[224:227], v[24:27]
 v_dot2c_f32_bf16 v11, s79, v42
 v_mfma_f32_16x16x32_bf16 v[172:175], a[196:199], a[228:231], v[172:175]
 s_waitcnt lgkmcnt(4)
 v_dot2c_f32_bf16 v11, s79, v43
 v_mfma_f32_16x16x32_bf16 v[172:175], a[204:207], a[236:239], v[172:175]
 v_dot2c_f32_bf16 v12, s79, v44
 v_mfma_f32_16x16x32_bf16 v[172:175], a[200:203], a[232:235], v[172:175]
 v_dot2c_f32_bf16 v12, s79, v45
 v_mfma_f32_16x16x32_bf16 v[168:171], a[200:203], v[104:107], v[168:171]
 v_dot2c_f32_bf16 v12, s79, v46
 v_mfma_f32_16x16x32_bf16 v[168:171], a[204:207], v[108:111], v[168:171]
 v_dot2c_f32_bf16 v12, s79, v47
 v_mfma_f32_16x16x32_bf16 v[164:167], a[204:207], v[76:79], v[164:167]
 s_add_u32 m0, s74, 0x118e0
 v_cvt_pk_bf16_f32 v48, v28, v29
 v_mfma_f32_16x16x32_bf16 v[164:167], a[200:203], v[72:75], v[164:167]
 s_waitcnt lgkmcnt(2)
 buffer_load_dwordx4 v4, s[52:55], s76 offen offset:3072 nt lds
 v_mfma_f32_16x16x32_bf16 v[164:167], a[208:211], v[80:83], v[164:167]
 v_dot2c_f32_bf16 v13, s79, v48
 v_mfma_f32_16x16x32_bf16 v[164:167], a[212:215], v[84:87], v[164:167]
 v_cvt_pk_bf16_f32 v49, v30, v31
 v_mfma_f32_16x16x32_bf16 v[168:171], a[212:215], v[116:119], v[168:171]
 v_dot2c_f32_bf16 v13, s79, v49
 v_mfma_f32_16x16x32_bf16 v[168:171], a[208:211], v[112:115], v[168:171]
 v_cvt_pk_bf16_f32 v50, v32, v33
 v_mfma_f32_16x16x32_bf16 v[172:175], a[208:211], a[240:243], v[172:175]
 v_dot2c_f32_bf16 v13, s79, v50
 v_mfma_f32_16x16x32_bf16 v[172:175], a[212:215], a[244:247], v[172:175]
 s_waitcnt lgkmcnt(0)
 v_cvt_pk_bf16_f32 v51, v34, v35
 v_mfma_f32_16x16x32_bf16 v[172:175], a[220:223], a[252:255], v[172:175]
 v_dot2c_f32_bf16 v13, s79, v51
 v_mfma_f32_16x16x32_bf16 v[172:175], a[216:219], a[248:251], v[172:175]
 v_mfma_f32_16x16x32_bf16 v[168:171], a[216:219], v[120:123], v[168:171]
 v_mfma_f32_16x16x32_bf16 v[168:171], a[220:223], v[124:127], v[168:171]
 s_waitcnt vmcnt(16)
 s_barrier
 v_mfma_f32_16x16x32_bf16 v[164:167], a[220:223], v[92:95], v[164:167]
 s_add_u32 s76, s76, 0x8000
 ds_read_b64_tr_b16 a[192:193], v2 offset:33792
 v_max3_f32 v14, v11, v12, v13
 v_cmp_nge_f32 vcc, s78, v14
 v_mfma_f32_16x16x32_bf16 v[164:167], a[216:219], v[88:91], v[164:167]
 s_waitcnt lgkmcnt(0)
 s_mov_b32 s90, 1
 ds_read_b64_tr_b16 a[194:195], v2 offset:34304
 ds_read_b64_tr_b16 a[196:197], v2 offset:50688
 ds_read_b64_tr_b16 a[198:199], v2 offset:51200
 ds_read_b64_tr_b16 a[200:201], v2 offset:33824
 ds_read_b64_tr_b16 a[202:203], v2 offset:34336
 ds_read_b64_tr_b16 a[204:205], v2 offset:50720
 ds_read_b64_tr_b16 a[206:207], v2 offset:51232
 ds_read_b64_tr_b16 a[208:209], v2 offset:33856
 ds_read_b64_tr_b16 a[210:211], v2 offset:34368
 ds_read_b64_tr_b16 a[212:213], v2 offset:50752
 ds_read_b64_tr_b16 a[214:215], v2 offset:51264
 s_cbranch_vccnz L1_RARE1
L1_BACK1:
 s_waitcnt lgkmcnt(8)
 v_mfma_f32_16x16x32_bf16 a[0:3], a[192:195], v[224:227], a[0:3]
 ds_read_b64_tr_b16 a[216:217], v2 offset:33888
 v_mfma_f32_16x16x32_bf16 a[0:3], a[196:199], v[40:43], a[0:3]
 ds_read_b64_tr_b16 a[218:219], v2 offset:34400
 v_add_f32 v8, v8, v11
 v_mfma_f32_16x16x32_bf16 a[4:7], a[196:199], v[44:47], a[4:7]
 ds_read_b64_tr_b16 a[220:221], v2 offset:50784
 v_add_f32 v9, v9, v12
 v_mfma_f32_16x16x32_bf16 a[4:7], a[192:195], v[228:231], a[4:7]
 s_add_u32 m0, s73, 0x0
 ds_read_b64_tr_b16 a[222:223], v2 offset:51296
 v_mfma_f32_16x16x32_bf16 a[8:11], a[192:195], v[232:235], a[8:11]
 buffer_load_dwordx4 v3, s[48:51], s75 offen offset:0 nt lds
 v_mfma_f32_16x16x32_bf16 a[8:11], a[196:199], v[48:51], a[8:11]
 s_waitcnt lgkmcnt(8)
 v_exp_f32 v28, v128
 v_mfma_f32_16x16x32_bf16 a[20:23], a[204:207], v[48:51], a[20:23]
 ds_read_b64_tr_b16 a[192:193], v2 offset:33920
 v_mfma_f32_16x16x32_bf16 a[20:23], a[200:203], v[232:235], a[20:23]
 ds_read_b64_tr_b16 a[194:195], v2 offset:34432
 v_add_f32 v10, v10, v13
 v_mfma_f32_16x16x32_bf16 a[16:19], a[200:203], v[228:231], a[16:19]
 ds_read_b64_tr_b16 a[196:197], v2 offset:50816
 v_mfma_f32_16x16x32_bf16 a[16:19], a[204:207], v[44:47], a[16:19]
 ds_read_b64_tr_b16 a[198:199], v2 offset:51328
 v_mfma_f32_16x16x32_bf16 a[12:15], a[204:207], v[40:43], a[12:15]
 v_exp_f32 v29, v129
 v_mfma_f32_16x16x32_bf16 a[12:15], a[200:203], v[224:227], a[12:15]
 s_waitcnt lgkmcnt(8)
 v_exp_f32 v30, v130
 v_mfma_f32_16x16x32_bf16 a[24:27], a[208:211], v[224:227], a[24:27]
 ds_read_b64_tr_b16 a[200:201], v2 offset:33952
 v_cvt_pk_bf16_f32 v52, v28, v29
 v_mfma_f32_16x16x32_bf16 a[24:27], a[212:215], v[40:43], a[24:27]
 ds_read_b64_tr_b16 a[202:203], v2 offset:34464
 v_mfma_f32_16x16x32_bf16 a[28:31], a[212:215], v[44:47], a[28:31]
 ds_read_b64_tr_b16 a[204:205], v2 offset:50848
 v_dot2_f32_bf16 v11, v52, s79, 0
 v_mfma_f32_16x16x32_bf16 a[28:31], a[208:211], v[228:231], a[28:31]
 s_add_u32 m0, s73, 0x10
 ds_read_b64_tr_b16 a[206:207], v2 offset:51360
 v_mfma_f32_16x16x32_bf16 a[32:35], a[208:211], v[232:235], a[32:35]
 buffer_load_dwordx4 v3, s[48:51], s75 offen offset:1024 nt lds
 v_mfma_f32_16x16x32_bf16 a[32:35], a[212:215], v[48:51], a[32:35]
 s_waitcnt lgkmcnt(8)
 v_exp_f32 v28, v132
 v_mfma_f32_16x16x32_bf16 a[44:47], a[220:223], v[48:51], a[44:47]
 ds_read_b64_tr_b16 a[208:209], v2 offset:33984
 v_mfma_f32_16x16x32_bf16 a[44:47], a[216:219], v[232:235], a[44:47]
 ds_read_b64_tr_b16 a[210:211], v2 offset:34496
 v_mfma_f32_16x16x32_bf16 a[40:43], a[216:219], v[228:231], a[40:43]
 ds_read_b64_tr_b16 a[212:213], v2 offset:50880
 v_mfma_f32_16x16x32_bf16 a[40:43], a[220:223], v[44:47], a[40:43]
 ds_read_b64_tr_b16 a[214:215], v2 offset:51392
 v_mfma_f32_16x16x32_bf16 a[36:39], a[220:223], v[40:43], a[36:39]
 v_exp_f32 v29, v133
 v_mfma_f32_16x16x32_bf16 a[36:39], a[216:219], v[224:227], a[36:39]
 s_waitcnt lgkmcnt(8)
 v_exp_f32 v31, v131
 v_mfma_f32_16x16x32_bf16 a[48:51], a[192:195], v[224:227], a[48:51]
 ds_read_b64_tr_b16 a[216:217], v2 offset:34016
 v_cvt_pk_bf16_f32 v56, v28, v29
 v_mfma_f32_16x16x32_bf16 a[48:51], a[196:199], v[40:43], a[48:51]
 ds_read_b64_tr_b16 a[218:219], v2 offset:34528
 v_mfma_f32_16x16x32_bf16 a[52:55], a[196:199], v[44:47], a[52:55]
 ds_read_b64_tr_b16 a[220:221], v2 offset:50912
 v_dot2_f32_bf16 v12, v56, s79, 0
 v_mfma_f32_16x16x32_bf16 a[52:55], a[192:195], v[228:231], a[52:55]
 s_add_u32 m0, s73, 0x20
 ds_read_b64_tr_b16 a[222:223], v2 offset:51424
 v_cvt_pk_bf16_f32 v53, v30, v31
 v_mfma_f32_16x16x32_bf16 a[56:59], a[192:195], v[232:235], a[56:59]
 buffer_load_dwordx4 v3, s[48:51], s75 offen offset:2048 nt lds
 v_mfma_f32_16x16x32_bf16 a[56:59], a[196:199], v[48:51], a[56:59]
 s_waitcnt lgkmcnt(8)
 v_exp_f32 v28, v136
 v_mfma_f32_16x16x32_bf16 a[68:71], a[204:207], v[48:51], a[68:71]
 ds_read_b64_tr_b16 a[192:193], v2 offset:34048
 v_mfma_f32_16x16x32_bf16 a[68:71], a[200:203], v[232:235], a[68:71]
 ds_read_b64_tr_b16 a[194:195], v2 offset:34560
L1_PAD6:
 s_cbranch_execz L1_PRT6
 v_mfma_f32_16x16x32_bf16 a[64:67], a[200:203], v[228:231], a[64:67]
 ds_read_b64_tr_b16 a[196:197], v2 offset:50944
 v_mfma_f32_16x16x32_bf16 a[64:67], a[204:207], v[44:47], a[64:67]
 ds_read_b64_tr_b16 a[198:199], v2 offset:51456
 v_mfma_f32_16x16x32_bf16 a[60:63], a[204:207], v[40:43], a[60:63]
 v_exp_f32 v29, v137
 v_mfma_f32_16x16x32_bf16 a[60:63], a[200:203], v[224:227], a[60:63]
 s_waitcnt lgkmcnt(8)
 v_exp_f32 v32, v140
 v_mfma_f32_16x16x32_bf16 a[72:75], a[208:211], v[224:227], a[72:75]
 ds_read_b64_tr_b16 a[200:201], v2 offset:34080
 v_cvt_pk_bf16_f32 v60, v28, v29
 v_mfma_f32_16x16x32_bf16 a[72:75], a[212:215], v[40:43], a[72:75]
 ds_read_b64_tr_b16 a[202:203], v2 offset:34592
 v_mfma_f32_16x16x32_bf16 a[76:79], a[212:215], v[44:47], a[76:79]
 ds_read_b64_tr_b16 a[204:205], v2 offset:50976
 v_dot2_f32_bf16 v13, v60, s79, 0
 v_mfma_f32_16x16x32_bf16 a[76:79], a[208:211], v[228:231], a[76:79]
 s_add_u32 m0, s73, 0x30
 ds_read_b64_tr_b16 a[206:207], v2 offset:51488
 v_mfma_f32_16x16x32_bf16 a[80:83], a[208:211], v[232:235], a[80:83]
 buffer_load_dwordx4 v3, s[48:51], s75 offen offset:3072 nt lds
 v_mfma_f32_16x16x32_bf16 a[80:83], a[212:215], v[48:51], a[80:83]
 s_waitcnt lgkmcnt(8)
 v_exp_f32 v33, v141
 v_mfma_f32_16x16x32_bf16 a[92:95], a[220:223], v[48:51], a[92:95]
 ds_read_b64_tr_b16 a[208:209], v2 offset:34112
 v_cvt_pk_bf16_f32 v54, v32, v33
 v_mfma_f32_16x16x32_bf16 a[92:95], a[216:219], v[232:235], a[92:95]
 ds_read_b64_tr_b16 a[210:211], v2 offset:34624
 v_mfma_f32_16x16x32_bf16 a[88:91], a[216:219], v[228:231], a[88:91]
 ds_read_b64_tr_b16 a[212:213], v2 offset:51008
 v_mfma_f32_16x16x32_bf16 a[88:91], a[220:223], v[44:47], a[88:91]
 ds_read_b64_tr_b16 a[214:215], v2 offset:51520
 v_mfma_f32_16x16x32_bf16 a[84:87], a[220:223], v[40:43], a[84:87]
 v_exp_f32 v34, v142
 v_mfma_f32_16x16x32_bf16 a[84:87], a[216:219], v[224:227], a[84:87]
 s_waitcnt lgkmcnt(8)
 v_exp_f32 v35, v143
 v_mfma_f32_16x16x32_bf16 a[96:99], a[192:195], v[224:227], a[96:99]
 ds_read_b64_tr_b16 a[216:217], v2 offset:34144
 v_cvt_pk_bf16_f32 v55, v34, v35
 v_mfma_f32_16x16x32_bf16 a[96:99], a[196:199], v[40:43], a[96:99]
 ds_read_b64_tr_b16 a[218:219], v2 offset:34656
 v_mfma_f32_16x16x32_bf16 a[100:103], a[196:199], v[44:47], a[100:103]
 ds_read_b64_tr_b16 a[220:221], v2 offset:51040
 v_mfma_f32_16x16x32_bf16 a[100:103], a[192:195], v[228:231], a[100:103]
 s_add_u32 m0, s73, 0x1040
 ds_read_b64_tr_b16 a[222:223], v2 offset:51552
 v_mfma_f32_16x16x32_bf16 a[104:107], a[192:195], v[232:235], a[104:107]
 buffer_load_dwordx4 v4, s[48:51], s75 offen offset:0 nt lds
 v_mfma_f32_16x16x32_bf16 a[104:107], a[196:199], v[48:51], a[104:107]
 s_waitcnt lgkmcnt(8)
 v_exp_f32 v30, v134
 v_mfma_f32_16x16x32_bf16 a[116:119], a[204:207], v[48:51], a[116:119]
 ds_read_b64_tr_b16 a[192:193], v2 offset:34176
 v_mfma_f32_16x16x32_bf16 a[116:119], a[200:203], v[232:235], a[116:119]
 ds_read_b64_tr_b16 a[194:195], v2 offset:34688
 v_mfma_f32_16x16x32_bf16 a[112:115], a[200:203], v[228:231], a[112:115]
 ds_read_b64_tr_b16 a[196:197], v2 offset:51072
 v_mfma_f32_16x16x32_bf16 a[112:115], a[204:207], v[44:47], a[112:115]
 ds_read_b64_tr_b16 a[198:199], v2 offset:51584
 v_mfma_f32_16x16x32_bf16 a[108:111], a[204:207], v[40:43], a[108:111]
 s_add_u32 m0, s73, 0x1050
 v_exp_f32 v31, v135
 v_mfma_f32_16x16x32_bf16 a[108:111], a[200:203], v[224:227], a[108:111]
 s_waitcnt lgkmcnt(8)
 buffer_load_dwordx4 v4, s[48:51], s75 offen offset:1024 nt lds
 v_mfma_f32_16x16x32_bf16 a[120:123], a[208:211], v[224:227], a[120:123]
 ds_read_b64_tr_b16 a[200:201], v2 offset:34208
 v_cvt_pk_bf16_f32 v57, v30, v31
 v_mfma_f32_16x16x32_bf16 a[120:123], a[212:215], v[40:43], a[120:123]
 ds_read_b64_tr_b16 a[202:203], v2 offset:34720
 v_dot2c_f32_bf16 v11, s79, v53
 v_mfma_f32_16x16x32_bf16 a[124:127], a[212:215], v[44:47], a[124:127]
 ds_read_b64_tr_b16 a[204:205], v2 offset:51104
 v_dot2c_f32_bf16 v11, s79, v54
 v_mfma_f32_16x16x32_bf16 a[124:127], a[208:211], v[228:231], a[124:127]
 ds_read_b64_tr_b16 a[206:207], v2 offset:51616
 v_dot2c_f32_bf16 v11, s79, v55
 v_mfma_f32_16x16x32_bf16 a[128:131], a[208:211], v[232:235], a[128:131]
 v_exp_f32 v32, v144
 v_mfma_f32_16x16x32_bf16 a[128:131], a[212:215], v[48:51], a[128:131]
 s_waitcnt lgkmcnt(8)
 v_mfma_f32_16x16x32_bf16 a[140:143], a[220:223], v[48:51], a[140:143]
 ds_read_b64_tr_b16 a[208:209], v2 offset:34240
 v_dot2c_f32_bf16 v12, s79, v57
 v_mfma_f32_16x16x32_bf16 a[140:143], a[216:219], v[232:235], a[140:143]
 ds_read_b64_tr_b16 a[210:211], v2 offset:34752
 v_mfma_f32_16x16x32_bf16 a[136:139], a[216:219], v[228:231], a[136:139]
 ds_read_b64_tr_b16 a[212:213], v2 offset:51136
 v_mfma_f32_16x16x32_bf16 a[136:139], a[220:223], v[44:47], a[136:139]
 ds_read_b64_tr_b16 a[214:215], v2 offset:51648
 v_mfma_f32_16x16x32_bf16 a[132:135], a[220:223], v[40:43], a[132:135]
 s_add_u32 m0, s73, 0x1060
 v_exp_f32 v33, v145
 v_mfma_f32_16x16x32_bf16 a[132:135], a[216:219], v[224:227], a[132:135]
 s_waitcnt lgkmcnt(8)
 buffer_load_dwordx4 v4, s[48:51], s75 offen offset:2048 nt lds
 v_mfma_f32_16x16x32_bf16 a[144:147], a[192:195], v[224:227], a[144:147]
 ds_read_b64_tr_b16 a[216:217], v2 offset:34272
 v_cvt_pk_bf16_f32 v58, v32, v33
 v_mfma_f32_16x16x32_bf16 a[144:147], a[196:199], v[40:43], a[144:147]
 ds_read_b64_tr_b16 a[218:219], v2 offset:34784
 v_dot2c_f32_bf16 v12, s79, v58
 v_mfma_f32_16x16x32_bf16 a[148:151], a[196:199], v[44:47], a[148:151]
 ds_read_b64_tr_b16 a[220:221], v2 offset:51168
 v_mfma_f32_16x16x32_bf16 a[148:151], a[192:195], v[228:231], a[148:151]
 ds_read_b64_tr_b16 a[222:223], v2 offset:51680
 v_mfma_f32_16x16x32_bf16 a[152:155], a[192:195], v[232:235], a[152:155]
 v_exp_f32 v34, v146
 v_mfma_f32_16x16x32_bf16 a[152:155], a[196:199], v[48:51], a[152:155]
 s_waitcnt lgkmcnt(8)
 v_exp_f32 v35, v147
 v_mfma_f32_16x16x32_bf16 a[164:167], a[204:207], v[48:51], a[164:167]
 v_exp_f32 v30, v138
 v_mfma_f32_16x16x32_bf16 a[164:167], a[200:203], v[232:235], a[164:167]
 v_exp_f32 v31, v139
 v_mfma_f32_16x16x32_bf16 a[160:163], a[200:203], v[228:231], a[160:163]
 v_mfma_f32_16x16x32_bf16 a[160:163], a[204:207], v[44:47], a[160:163]
 v_exp_f32 v32, v148
 v_mfma_f32_16x16x32_bf16 a[156:159], a[204:207], v[40:43], a[156:159]
 s_add_u32 m0, s73, 0x1070
 v_exp_f32 v33, v149
 v_mfma_f32_16x16x32_bf16 a[156:159], a[200:203], v[224:227], a[156:159]
 s_waitcnt lgkmcnt(4)
 buffer_load_dwordx4 v4, s[48:51], s75 offen offset:3072 nt lds
 v_mfma_f32_16x16x32_bf16 a[168:171], a[208:211], v[224:227], a[168:171]
 v_cvt_pk_bf16_f32 v59, v34, v35
 v_mfma_f32_16x16x32_bf16 a[168:171], a[212:215], v[40:43], a[168:171]
 v_exp_f32 v34, v150
 v_mfma_f32_16x16x32_bf16 a[172:175], a[212:215], v[44:47], a[172:175]
 v_mfma_f32_16x16x32_bf16 a[172:175], a[208:211], v[228:231], a[172:175]
 v_exp_f32 v35, v151
 v_mfma_f32_16x16x32_bf16 a[176:179], a[208:211], v[232:235], a[176:179]
 v_dot2c_f32_bf16 v12, s79, v59
 v_mfma_f32_16x16x32_bf16 a[176:179], a[212:215], v[48:51], a[176:179]
 s_waitcnt lgkmcnt(0)
 v_cvt_pk_bf16_f32 v61, v30, v31
 v_dot2c_f32_bf16 v13, s79, v61
 v_mfma_f32_16x16x32_bf16 a[188:191], a[220:223], v[48:51], a[188:191]
 v_cvt_pk_bf16_f32 v62, v32, v33
 v_mfma_f32_16x16x32_bf16 a[188:191], a[216:219], v[232:235], a[188:191]
 v_dot2c_f32_bf16 v13, s79, v62
 v_mfma_f32_16x16x32_bf16 a[184:187], a[216:219], v[228:231], a[184:187]
 v_cvt_pk_bf16_f32 v63, v34, v35
 v_mfma_f32_16x16x32_bf16 a[184:187], a[220:223], v[44:47], a[184:187]
 s_waitcnt vmcnt(16)
 s_barrier
 v_mfma_f32_16x16x32_bf16 a[180:183], a[220:223], v[40:43], a[180:183]
 ds_read_b128 a[192:195], v1 offset:33792
 v_dot2c_f32_bf16 v13, s79, v63
 v_mfma_f32_16x16x32_bf16 a[180:183], a[216:219], v[224:227], a[180:183]
 s_waitcnt lgkmcnt(0)
 s_add_u32 s75, s75, 0x8000
 ds_read_b128 a[196:199], v1 offset:33824
 ds_read_b128 a[200:203], v1 offset:33856
 ds_read_b128 a[204:207], v1 offset:33888
 ds_read_b128 a[208:211], v1 offset:33920
 ds_read_b128 a[212:215], v1 offset:33952
 s_waitcnt lgkmcnt(4)
 v_mfma_f32_16x16x32_bf16 v[176:179], a[192:195], v[64:67], v[16:19]
 s_add_u32 m0, s74, 0x18c00
 ds_read_b128 a[216:219], v1 offset:33984
 v_mfma_f32_16x16x32_bf16 v[176:179], a[196:199], v[68:71], v[176:179]
 buffer_load_dwordx4 v3, s[52:55], s76 offen offset:0 nt lds
 v_mfma_f32_16x16x32_bf16 v[180:183], a[196:199], v[100:103], v[20:23]
 ds_read_b128 a[220:223], v1 offset:34016
 v_mfma_f32_16x16x32_bf16 v[180:183], a[192:195], v[96:99], v[180:183]
 v_exp_f32 v28, v152
 v_mfma_f32_16x16x32_bf16 v[184:187], a[192:195], a[224:227], v[24:27]
 v_exp_f32 v29, v153
 v_mfma_f32_16x16x32_bf16 v[184:187], a[196:199], a[228:231], v[184:187]
 s_waitcnt lgkmcnt(4)
 v_mfma_f32_16x16x32_bf16 v[184:187], a[204:207], a[236:239], v[184:187]
 ds_read_b128 a[192:195], v1 offset:34304
 v_cvt_pk_bf16_f32 v40, v28, v29
 v_mfma_f32_16x16x32_bf16 v[184:187], a[200:203], a[232:235], v[184:187]
 v_exp_f32 v30, v154
 v_mfma_f32_16x16x32_bf16 v[180:183], a[200:203], v[104:107], v[180:183]
 ds_read_b128 a[196:199], v1 offset:34336
 v_mfma_f32_16x16x32_bf16 v[180:183], a[204:207], v[108:111], v[180:183]
 v_mfma_f32_16x16x32_bf16 v[176:179], a[204:207], v[76:79], v[176:179]
 v_exp_f32 v31, v155
 v_mfma_f32_16x16x32_bf16 v[176:179], a[200:203], v[72:75], v[176:179]
 s_waitcnt lgkmcnt(4)
 v_mfma_f32_16x16x32_bf16 v[176:179], a[208:211], v[80:83], v[176:179]
 s_add_u32 m0, s74, 0x18c20
 ds_read_b128 a[200:203], v1 offset:34368
 v_cvt_pk_bf16_f32 v41, v30, v31
 v_mfma_f32_16x16x32_bf16 v[176:179], a[212:215], v[84:87], v[176:179]
 buffer_load_dwordx4 v3, s[52:55], s76 offen offset:1024 nt lds
 v_mfma_f32_16x16x32_bf16 v[180:183], a[212:215], v[116:119], v[180:183]
 ds_read_b128 a[204:207], v1 offset:34400
 v_mfma_f32_16x16x32_bf16 v[180:183], a[208:211], v[112:115], v[180:183]
 v_exp_f32 v32, v164
 v_mfma_f32_16x16x32_bf16 v[184:187], a[208:211], a[240:243], v[184:187]
 v_exp_f32 v33, v165
 v_mfma_f32_16x16x32_bf16 v[184:187], a[212:215], a[244:247], v[184:187]
 s_waitcnt lgkmcnt(4)
 v_mfma_f32_16x16x32_bf16 v[184:187], a[220:223], a[252:255], v[184:187]
 ds_read_b128 a[208:211], v1 offset:34432
 v_mfma_f32_16x16x32_bf16 v[184:187], a[216:219], a[248:251], v[184:187]
 v_exp_f32 v34, v166
 v_mfma_f32_16x16x32_bf16 v[180:183], a[216:219], v[120:123], v[180:183]
 ds_read_b128 a[212:215], v1 offset:34464
 v_mfma_f32_16x16x32_bf16 v[180:183], a[220:223], v[124:127], v[180:183]
 v_exp_f32 v35, v167
 v_mfma_f32_16x16x32_bf16 v[176:179], a[220:223], v[92:95], v[176:179]
 v_mfma_f32_16x16x32_bf16 v[176:179], a[216:219], v[88:91], v[176:179]
 s_waitcnt lgkmcnt(4)
 v_exp_f32 v28, v156
 v_mfma_f32_16x16x32_bf16 v[188:191], a[192:195], v[64:67], v[16:19]
 s_add_u32 m0, s74, 0x18c40
 ds_read_b128 a[216:219], v1 offset:34496
 v_mfma_f32_16x16x32_bf16 v[188:191], a[196:199], v[68:71], v[188:191]
 buffer_load_dwordx4 v3, s[52:55], s76 offen offset:2048 nt lds
 v_mfma_f32_16x16x32_bf16 v[192:195], a[196:199], v[100:103], v[20:23]
 ds_read_b128 a[220:223], v1 offset:34528
 v_mfma_f32_16x16x32_bf16 v[192:195], a[192:195], v[96:99], v[192:195]
 v_exp_f32 v29, v157
 v_mfma_f32_16x16x32_bf16 v[196:199], a[192:195], a[224:227], v[24:27]
 v_mfma_f32_16x16x32_bf16 v[196:199], a[196:199], a[228:231], v[196:199]
 s_waitcnt lgkmcnt(4)
 v_exp_f32 v30, v158
 v_mfma_f32_16x16x32_bf16 v[196:199], a[204:207], a[236:239], v[196:199]
 ds_read_b128 a[192:195], v1 offset:50432
 v_mfma_f32_16x16x32_bf16 v[196:199], a[200:203], a[232:235], v[196:199]
 v_exp_f32 v31, v159
 v_mfma_f32_16x16x32_bf16 v[192:195], a[200:203], v[104:107], v[192:195]
 ds_read_b128 a[196:199], v1 offset:50464
 v_mfma_f32_16x16x32_bf16 v[192:195], a[204:207], v[108:111], v[192:195]
 v_mfma_f32_16x16x32_bf16 v[188:191], a[204:207], v[76:79], v[188:191]
 v_cvt_pk_bf16_f32 v42, v32, v33
 v_cvt_pk_bf16_f32 v43, v34, v35
 v_mfma_f32_16x16x32_bf16 v[188:191], a[200:203], v[72:75], v[188:191]
 s_waitcnt lgkmcnt(4)
 v_exp_f32 v32, v168
 v_mfma_f32_16x16x32_bf16 v[188:191], a[208:211], v[80:83], v[188:191]
 s_add_u32 m0, s74, 0x18c60
 ds_read_b128 a[200:203], v1 offset:50496
 v_mfma_f32_16x16x32_bf16 v[188:191], a[212:215], v[84:87], v[188:191]
 buffer_load_dwordx4 v3, s[52:55], s76 offen offset:3072 nt lds
 v_mfma_f32_16x16x32_bf16 v[192:195], a[212:215], v[116:119], v[192:195]
 ds_read_b128 a[204:207], v1 offset:50528
 v_mfma_f32_16x16x32_bf16 v[192:195], a[208:211], v[112:115], v[192:195]
 v_exp_f32 v33, v169
 v_mfma_f32_16x16x32_bf16 v[196:199], a[208:211], a[240:243], v[196:199]
 v_mfma_f32_16x16x32_bf16 v[196:199], a[212:215], a[244:247], v[196:199]
 s_waitcnt lgkmcnt(4)
 v_exp_f32 v34, v170
 v_mfma_f32_16x16x32_bf16 v[196:199], a[220:223], a[252:255], v[196:199]
 ds_read_b128 a[208:211], v1 offset:50560
 v_mfma_f32_16x16x32_bf16 v[196:199], a[216:219], a[248:251], v[196:199]
 v_mfma_f32_16x16x32_bf16 v[192:195], a[216:219], v[120:123], v[192:195]
 ds_read_b128 a[212:215], v1 offset:50592
 v_cvt_pk_bf16_f32 v44, v28, v29
 v_mfma_f32_16x16x32_bf16 v[192:195], a[220:223], v[124:127], v[192:195]
 v_exp_f32 v35, v171
 v_mfma_f32_16x16x32_bf16 v[188:191], a[220:223], v[92:95], v[188:191]
 v_mfma_f32_16x16x32_bf16 v[188:191], a[216:219], v[88:91], v[188:191]
 s_waitcnt lgkmcnt(4)
 v_exp_f32 v28, v160
 v_mfma_f32_16x16x32_bf16 v[200:203], a[192:195], v[64:67], v[16:19]
 s_add_u32 m0, s74, 0x19c80
 ds_read_b128 a[216:219], v1 offset:50624
 v_mfma_f32_16x16x32_bf16 v[200:203], a[196:199], v[68:71], v[200:203]
 buffer_load_dwordx4 v4, s[52:55], s76 offen offset:0 nt lds
 v_mfma_f32_16x16x32_bf16 v[204:207], a[196:199], v[100:103], v[20:23]
 ds_read_b128 a[220:223], v1 offset:50656
 v_mfma_f32_16x16x32_bf16 v[204:207], a[192:195], v[96:99], v[204:207]
 v_exp_f32 v29, v161
 v_mfma_f32_16x16x32_bf16 v[208:211], a[192:195], a[224:227], v[24:27]
 v_mfma_f32_16x16x32_bf16 v[208:211], a[196:199], a[228:231], v[208:211]
 s_waitcnt lgkmcnt(4)
 v_cvt_pk_bf16_f32 v45, v30, v31
 v_mfma_f32_16x16x32_bf16 v[208:211], a[204:207], a[236:239], v[208:211]
 ds_read_b128 a[192:195], v1 offset:50944
 v_cvt_pk_bf16_f32 v46, v32, v33
 v_mfma_f32_16x16x32_bf16 v[208:211], a[200:203], a[232:235], v[208:211]
 v_exp_f32 v30, v162
 v_mfma_f32_16x16x32_bf16 v[204:207], a[200:203], v[104:107], v[204:207]
 ds_read_b128 a[196:199], v1 offset:50976
 v_mfma_f32_16x16x32_bf16 v[204:207], a[204:207], v[108:111], v[204:207]
 v_mfma_f32_16x16x32_bf16 v[200:203], a[204:207], v[76:79], v[200:203]
 s_add_u32 m0, s74, 0x19ca0
 v_exp_f32 v31, v163
 v_mfma_f32_16x16x32_bf16 v[200:203], a[200:203], v[72:75], v[200:203]
 s_waitcnt lgkmcnt(4)
 buffer_load_dwordx4 v4, s[52:55], s76 offen offset:1024 nt lds
 v_mfma_f32_16x16x32_bf16 v[200:203], a[208:211], v[80:83], v[200:203]
 ds_read_b128 a[200:203], v1 offset:51008
 v_mfma_f32_16x16x32_bf16 v[200:203], a[212:215], v[84:87], v[200:203]
 v_exp_f32 v32, v172
 v_mfma_f32_16x16x32_bf16 v[204:207], a[212:215], v[116:119], v[204:207]
 ds_read_b128 a[204:207], v1 offset:51040
 v_mfma_f32_16x16x32_bf16 v[204:207], a[208:211], v[112:115], v[204:207]
 v_mfma_f32_16x16x32_bf16 v[208:211], a[208:211], a[240:243], v[208:211]
 v_exp_f32 v33, v173
 v_mfma_f32_16x16x32_bf16 v[208:211], a[212:215], a[244:247], v[208:211]
 s_waitcnt lgkmcnt(4)
 v_mfma_f32_16x16x32_bf16 v[208:211], a[220:223], a[252:255], v[208:211]
 ds_read_b128 a[208:211], v1 offset:51072
 v_cvt_pk_bf16_f32 v47, v34, v35
 v_mfma_f32_16x16x32_bf16 v[208:211], a[216:219], a[248:251], v[208:211]
 v_exp_f32 v34, v174
 v_mfma_f32_16x16x32_bf16 v[204:207], a[216:219], v[120:123], v[204:207]
 ds_read_b128 a[212:215], v1 offset:51104
 v_mfma_f32_16x16x32_bf16 v[204:207], a[220:223], v[124:127], v[204:207]
 v_mfma_f32_16x16x32_bf16 v[200:203], a[220:223], v[92:95], v[200:203]
 s_add_u32 m0, s74, 0x19cc0
 v_exp_f32 v35, v175
 v_mfma_f32_16x16x32_bf16 v[200:203], a[216:219], v[88:91], v[200:203]
 s_waitcnt lgkmcnt(4)
 buffer_load_dwordx4 v4, s[52:55], s76 offen offset:2048 nt lds
 v_mfma_f32_16x16x32_bf16 v[212:215], a[192:195], v[64:67], v[16:19]
 ds_read_b128 a[216:219], v1 offset:51136
 v_mfma_f32_16x16x32_bf16 v[212:215], a[196:199], v[68:71], v[212:215]
 v_dot2c_f32_bf16 v11, s79, v40
 v_mfma_f32_16x16x32_bf16 v[216:219], a[196:199], v[100:103], v[20:23]
 ds_read_b128 a[220:223], v1 offset:51168
 v_mfma_f32_16x16x32_bf16 v[216:219], a[192:195], v[96:99], v[216:219]
 v_dot2c_f32_bf16 v11, s79, v41
 v_mfma_f32_16x16x32_bf16 v[220:223], a[192:195], a[224:227], v[24:27]
 v_dot2c_f32_bf16 v11, s79, v42
 v_mfma_f32_16x16x32_bf16 v[220:223], a[196:199], a[228:231], v[220:223]
 s_waitcnt lgkmcnt(4)
 v_dot2c_f32_bf16 v11, s79, v43
 v_mfma_f32_16x16x32_bf16 v[220:223], a[204:207], a[236:239], v[220:223]
 v_dot2c_f32_bf16 v12, s79, v44
 v_mfma_f32_16x16x32_bf16 v[220:223], a[200:203], a[232:235], v[220:223]
 v_dot2c_f32_bf16 v12, s79, v45
 v_mfma_f32_16x16x32_bf16 v[216:219], a[200:203], v[104:107], v[216:219]
 v_dot2c_f32_bf16 v12, s79, v46
 v_mfma_f32_16x16x32_bf16 v[216:219], a[204:207], v[108:111], v[216:219]
 v_dot2c_f32_bf16 v12, s79, v47
 v_mfma_f32_16x16x32_bf16 v[212:215], a[204:207], v[76:79], v[212:215]
 s_add_u32 m0, s74, 0x19ce0
 v_cvt_pk_bf16_f32 v48, v28, v29
 v_mfma_f32_16x16x32_bf16 v[212:215], a[200:203], v[72:75], v[212:215]
 s_waitcnt lgkmcnt(2)
 buffer_load_dwordx4 v4, s[52:55], s76 offen offset:3072 nt lds
 v_mfma_f32_16x16x32_bf16 v[212:215], a[208:211], v[80:83], v[212:215]
 v_dot2c_f32_bf16 v13, s79, v48
 v_mfma_f32_16x16x32_bf16 v[212:215], a[212:215], v[84:87], v[212:215]
 v_cvt_pk_bf16_f32 v49, v30, v31
 v_mfma_f32_16x16x32_bf16 v[216:219], a[212:215], v[116:119], v[216:219]
 v_dot2c_f32_bf16 v13, s79, v49
 v_mfma_f32_16x16x32_bf16 v[216:219], a[208:211], v[112:115], v[216:219]
 v_cvt_pk_bf16_f32 v50, v32, v33
 v_mfma_f32_16x16x32_bf16 v[220:223], a[208:211], a[240:243], v[220:223]
 v_dot2c_f32_bf16 v13, s79, v50
 v_mfma_f32_16x16x32_bf16 v[220:223], a[212:215], a[244:247], v[220:223]
 s_waitcnt lgkmcnt(0)
 v_cvt_pk_bf16_f32 v51, v34, v35
 v_mfma_f32_16x16x32_bf16 v[220:223], a[220:223], a[252:255], v[220:223]
 v_dot2c_f32_bf16 v13, s79, v51
 v_mfma_f32_16x16x32_bf16 v[220:223], a[216:219], a[248:251], v[220:223]
 v_mfma_f32_16x16x32_bf16 v[216:219], a[216:219], v[120:123], v[216:219]
 v_mfma_f32_16x16x32_bf16 v[216:219], a[220:223], v[124:127], v[216:219]
 s_waitcnt vmcnt(16)
 s_barrier
 v_mfma_f32_16x16x32_bf16 v[212:215], a[220:223], v[92:95], v[212:215]
 s_add_u32 s76, s76, 0x8000
 ds_read_b64_tr_b16 a[192:193], v2 offset:0
 v_max3_f32 v14, v11, v12, v13
 v_cmp_nge_f32 vcc, s78, v14
 v_mfma_f32_16x16x32_bf16 v[212:215], a[216:219], v[88:91], v[212:215]
 s_waitcnt lgkmcnt(0)
 s_mov_b32 s90, 2
 ds_read_b64_tr_b16 a[194:195], v2 offset:512
 ds_read_b64_tr_b16 a[196:197], v2 offset:16896
 ds_read_b64_tr_b16 a[198:199], v2 offset:17408
 ds_read_b64_tr_b16 a[200:201], v2 offset:32
 ds_read_b64_tr_b16 a[202:203], v2 offset:544
 ds_read_b64_tr_b16 a[204:205], v2 offset:16928
 ds_read_b64_tr_b16 a[206:207], v2 offset:17440
 ds_read_b64_tr_b16 a[208:209], v2 offset:64
 ds_read_b64_tr_b16 a[210:211], v2 offset:576
 ds_read_b64_tr_b16 a[212:213], v2 offset:16960
 ds_read_b64_tr_b16 a[214:215], v2 offset:17472
 s_cbranch_vccnz L1_RARE0
L1_BACK2:
 s_waitcnt lgkmcnt(8)
 v_mfma_f32_16x16x32_bf16 a[0:3], a[192:195], v[52:55], a[0:3]
 ds_read_b64_tr_b16 a[216:217], v2 offset:96
 v_mfma_f32_16x16x32_bf16 a[0:3], a[196:199], v[40:43], a[0:3]
 ds_read_b64_tr_b16 a[218:219], v2 offset:608
 v_add_f32 v8, v8, v11
 v_mfma_f32_16x16x32_bf16 a[4:7], a[196:199], v[44:47], a[4:7]
 ds_read_b64_tr_b16 a[220:221], v2 offset:16992
 v_add_f32 v9, v9, v12
 v_mfma_f32_16x16x32_bf16 a[4:7], a[192:195], v[56:59], a[4:7]
 s_add_u32 m0, s73, 0x8400
 ds_read_b64_tr_b16 a[222:223], v2 offset:17504
 v_mfma_f32_16x16x32_bf16 a[8:11], a[192:195], v[60:63], a[8:11]
 buffer_load_dwordx4 v3, s[48:51], s75 offen offset:0 nt lds
 v_mfma_f32_16x16x32_bf16 a[8:11], a[196:199], v[48:51], a[8:11]
 s_waitcnt lgkmcnt(8)
 v_exp_f32 v28, v176
 v_mfma_f32_16x16x32_bf16 a[20:23], a[204:207], v[48:51], a[20:23]
 ds_read_b64_tr_b16 a[192:193], v2 offset:128
 v_mfma_f32_16x16x32_bf16 a[20:23], a[200:203], v[60:63], a[20:23]
 ds_read_b64_tr_b16 a[194:195], v2 offset:640
 v_add_f32 v10, v10, v13
 v_mfma_f32_16x16x32_bf16 a[16:19], a[200:203], v[56:59], a[16:19]
 ds_read_b64_tr_b16 a[196:197], v2 offset:17024
 v_mfma_f32_16x16x32_bf16 a[16:19], a[204:207], v[44:47], a[16:19]
 ds_read_b64_tr_b16 a[198:199], v2 offset:17536
 v_mfma_f32_16x16x32_bf16 a[12:15], a[204:207], v[40:43], a[12:15]
 v_exp_f32 v29, v177
 v_mfma_f32_16x16x32_bf16 a[12:15], a[200:203], v[52:55], a[12:15]
 s_waitcnt lgkmcnt(8)
 v_exp_f32 v30, v178
 v_mfma_f32_16x16x32_bf16 a[24:27], a[208:211], v[52:55], a[24:27]
 ds_read_b64_tr_b16 a[200:201], v2 offset:160
 v_cvt_pk_bf16_f32 v224, v28, v29
 v_mfma_f32_16x16x32_bf16 a[24:27], a[212:215], v[40:43], a[24:27]
 ds_read_b64_tr_b16 a[202:203], v2 offset:672
 v_mfma_f32_16x16x32_bf16 a[28:31], a[212:215], v[44:47], a[28:31]
 ds_read_b64_tr_b16 a[204:205], v2 offset:17056
 v_dot2_f32_bf16 v11, v224, s79, 0
 v_mfma_f32_16x16x32_bf16 a[28:31], a[208:211], v[56:59], a[28:31]
 s_add_u32 m0, s73, 0x8410
 ds_read_b64_tr_b16 a[206:207], v2 offset:17568
 v_mfma_f32_16x16x32_bf16 a[32:35], a[208:211], v[60:63], a[32:35]
 buffer_load_dwordx4 v3, s[48:51], s75 offen offset:1024 nt lds
 v_mfma_f32_16x16x32_bf16 a[32:35], a[212:215], v[48:51], a[32:35]
 s_waitcnt lgkmcnt(8)
 v_exp_f32 v28, v180
 v_mfma_f32_16x16x32_bf16 a[44:47], a[220:223], v[48:51], a[44:47]
 ds_read_b64_tr_b16 a[208:209], v2 offset:192
 v_mfma_f32_16x16x32_bf16 a[44:47], a[216:219], v[60:63], a[44:47]
 ds_read_b64_tr_b16 a[210:211], v2 offset:704
 v_mfma_f32_16x16x32_bf16 a[40:43], a[216:219], v[56:59], a[40:43]
 ds_read_b64_tr_b16 a[212:213], v2 offset:17088
 v_mfma_f32_16x16x32_bf16 a[40:43], a[220:223], v[44:47], a[40:43]
 ds_read_b64_tr_b16 a[214:215], v2 offset:17600
 v_mfma_f32_16x16x32_bf16 a[36:39], a[220:223], v[40:43], a[36:39]
 v_exp_f32 v29, v181
 v_mfma_f32_16x16x32_bf16 a[36:39], a[216:219], v[52:55], a[36:39]
 s_waitcnt lgkmcnt(8)
 v_exp_f32 v31, v179
 v_mfma_f32_16x16x32_bf16 a[48:51], a[192:195], v[52:55], a[48:51]
 ds_read_b64_tr_b16 a[216:217], v2 offset:224
 v_cvt_pk_bf16_f32 v228, v28, v29
 v_mfma_f32_16x16x32_bf16 a[48:51], a[196:199], v[40:43], a[48:51]
 ds_read_b64_tr_b16 a[218:219], v2 offset:736
 v_mfma_f32_16x16x32_bf16 a[52:55], a[196:199], v[44:47], a[52:55]
 ds_read_b64_tr_b16 a[220:221], v2 offset:17120
 v_dot2_f32_bf16 v12, v228, s79, 0
 v_mfma_f32_16x16x32_bf16 a[52:55], a[192:195], v[56:59], a[52:55]
 s_add_u32 m0, s73, 0x8420
 ds_read_b64_tr_b16 a[222:223], v2 offset:17632
 v_cvt_pk_bf16_f32 v225, v30, v31
 v_mfma_f32_16x16x32_bf16 a[56:59], a[192:195], v[60:63], a[56:59]
 buffer_load_dwordx4 v3, s[48:51], s75 offen offset:2048 nt lds
 v_mfma_f32_16x16x32_bf16 a[56:59], a[196:199], v[48:51], a[56:59]
 s_waitcnt lgkmcnt(8)
 v_exp_f32 v28, v184
 v_mfma_f32_16x16x32_bf16 a[68:71], a[204:207], v[48:51], a[68:71]
 ds_read_b64_tr_b16 a[192:193], v2 offset:256
 v_mfma_f32_16x16x32_bf16 a[68:71], a[200:203], v[60:63], a[68:71]
 ds_read_b64_tr_b16 a[194:195], v2 offset:768
 v_mfma_f32_16x16x32_bf16 a[64:67], a[200:203], v[56:59], a[64:67]
 ds_read_b64_tr_b16 a[196:197], v2 offset:17152
 v_mfma_f32_16x16x32_bf16 a[64:67], a[204:207], v[44:47], a[64:67]
 ds_read_b64_tr_b16 a[198:199], v2 offset:17664
 v_mfma_f32_16x16x32_bf16 a[60:63], a[204:207], v[40:43], a[60:63]
 v_exp_f32 v29, v185
 v_mfma_f32_16x16x32_bf16 a[60:63], a[200:203], v[52:55], a[60:63]
 s_waitcnt lgkmcnt(8)
 v_exp_f32 v32, v188
 v_mfma_f32_16x16x32_bf16 a[72:75], a[208:211], v[52:55], a[72:75]
 ds_read_b64_tr_b16 a[200:201], v2 offset:288
 v_cvt_pk_bf16_f32 v232, v28, v29
 v_mfma_f32_16x16x32_bf16 a[72:75], a[212:215], v[40:43], a[72:75]
 ds_read_b64_tr_b16 a[202:203], v2 offset:800
 v_mfma_f32_16x16x32_bf16 a[76:79], a[212:215], v[44:47], a[76:79]
 ds_read_b64_tr_b16 a[204:205], v2 offset:17184
 v_dot2_f32_bf16 v13, v232, s79, 0
 v_mfma_f32_16x16x32_bf16 a[76:79], a[208:211], v[56:59], a[76:79]
 s_add_u32 m0, s73, 0x8430
 ds_read_b64_tr_b16 a[206:207], v2 offset:17696
 v_mfma_f32_16x16x32_bf16 a[80:83], a[208:211], v[60:63], a[80:83]
 buffer_load_dwordx4 v3, s[48:51], s75 offen offset:3072 nt lds
 v_mfma_f32_16x16x32_bf16 a[80:83], a[212:215], v[48:51], a[80:83]
 s_waitcnt lgkmcnt(8)
 v_exp_f32 v33, v189
 v_mfma_f32_16x16x32_bf16 a[92:95], a[220:223], v[48:51], a[92:95]
 ds_read_b64_tr_b16 a[208:209], v2 offset:320
 v_cvt_pk_bf16_f32 v226, v32, v33
 v_mfma_f32_16x16x32_bf16 a[92:95], a[216:219], v[60:63], a[92:95]
 ds_read_b64_tr_b16 a[210:211], v2 offset:832
 v_mfma_f32_16x16x32_bf16 a[88:91], a[216:219], v[56:59], a[88:91]
 ds_read_b64_tr_b16 a[212:213], v2 offset:17216
 v_mfma_f32_16x16x32_bf16 a[88:91], a[220:223], v[44:47], a[88:91]
 ds_read_b64_tr_b16 a[214:215], v2 offset:17728
 v_mfma_f32_16x16x32_bf16 a[84:87], a[220:223], v[40:43], a[84:87]
 v_exp_f32 v34, v190
 v_mfma_f32_16x16x32_bf16 a[84:87], a[216:219], v[52:55], a[84:87]
 s_waitcnt lgkmcnt(8)
 v_exp_f32 v35, v191
 v_mfma_f32_16x16x32_bf16 a[96:99], a[192:195], v[52:55], a[96:99]
 ds_read_b64_tr_b16 a[216:217], v2 offset:352
 v_cvt_pk_bf16_f32 v227, v34, v35
 v_mfma_f32_16x16x32_bf16 a[96:99], a[196:199], v[40:43], a[96:99]
 ds_read_b64_tr_b16 a[218:219], v2 offset:864
 v_mfma_f32_16x16x32_bf16 a[100:103], a[196:199], v[44:47], a[100:103]
 ds_read_b64_tr_b16 a[220:221], v2 offset:17248
 v_mfma_f32_16x16x32_bf16 a[100:103], a[192:195], v[56:59], a[100:103]
 s_add_u32 m0, s73, 0x9440
 ds_read_b64_tr_b16 a[222:223], v2 offset:17760
 v_mfma_f32_16x16x32_bf16 a[104:107], a[192:195], v[60:63], a[104:107]
 buffer_load_dwordx4 v4, s[48:51], s75 offen offset:0 nt lds
 v_mfma_f32_16x16x32_bf16 a[104:107], a[196:199], v[48:51], a[104:107]
 s_waitcnt lgkmcnt(8)
 v_exp_f32 v30, v182
 v_mfma_f32_16x16x32_bf16 a[116:119], a[204:207], v[48:51], a[116:119]
 ds_read_b64_tr_b16 a[192:193], v2 offset:384
 v_mfma_f32_16x16x32_bf16 a[116:119], a[200:203], v[60:63], a[116:119]
 ds_read_b64_tr_b16 a[194:195], v2 offset:896
 v_mfma_f32_16x16x32_bf16 a[112:115], a[200:203], v[56:59], a[112:115]
 ds_read_b64_tr_b16 a[196:197], v2 offset:17280
 v_mfma_f32_16x16x32_bf16 a[112:115], a[204:207], v[44:47], a[112:115]
 ds_read_b64_tr_b16 a[198:199], v2 offset:17792
 v_mfma_f32_16x16x32_bf16 a[108:111], a[204:207], v[40:43], a[108:111]
 s_add_u32 m0, s73, 0x9450
 v_exp_f32 v31, v183
 v_mfma_f32_16x16x32_bf16 a[108:111], a[200:203], v[52:55], a[108:111]
 s_waitcnt lgkmcnt(8)
 buffer_load_dwordx4 v4, s[48:51], s75 offen offset:1024 nt lds
 v_mfma_f32_16x16x32_bf16 a[120:123], a[208:211], v[52:55], a[120:123]
 ds_read_b64_tr_b16 a[200:201], v2 offset:416
 v_cvt_pk_bf16_f32 v229, v30, v31
 v_mfma_f32_16x16x32_bf16 a[120:123], a[212:215], v[40:43], a[120:123]
 ds_read_b64_tr_b16 a[202:203], v2 offset:928
 v_dot2c_f32_bf16 v11, s79, v225
 v_mfma_f32_16x16x32_bf16 a[124:127], a[212:215], v[44:47], a[124:127]
 ds_read_b64_tr_b16 a[204:205], v2 offset:17312
 v_dot2c_f32_bf16 v11, s79, v226
 v_mfma_f32_16x16x32_bf16 a[124:127], a[208:211], v[56:59], a[124:127]
 ds_read_b64_tr_b16 a[206:207], v2 offset:17824
 v_dot2c_f32_bf16 v11, s79, v227
 v_mfma_f32_16x16x32_bf16 a[128:131], a[208:211], v[60:63], a[128:131]
 v_exp_f32 v32, v192
 v_mfma_f32_16x16x32_bf16 a[128:131], a[212:215], v[48:51], a[128:131]
 s_waitcnt lgkmcnt(8)
 v_mfma_f32_16x16x32_bf16 a[140:143], a[220:223], v[48:51], a[140:143]
 ds_read_b64_tr_b16 a[208:209], v2 offset:448
 v_dot2c_f32_bf16 v12, s79, v229
 v_mfma_f32_16x16x32_bf16 a[140:143], a[216:219], v[60:63], a[140:143]
 ds_read_b64_tr_b16 a[210:211], v2 offset:960
 v_mfma_f32_16x16x32_bf16 a[136:139], a[216:219], v[56:59], a[136:139]
 ds_read_b64_tr_b16 a[212:213], v2 offset:17344
 v_mfma_f32_16x16x32_bf16 a[136:139], a[220:223], v[44:47], a[136:139]
 ds_read_b64_tr_b16 a[214:215], v2 offset:17856
 v_mfma_f32_16x16x32_bf16 a[132:135], a[220:223], v[40:43], a[132:135]
 s_add_u32 m0, s73, 0x9460
 v_exp_f32 v33, v193
 v_mfma_f32_16x16x32_bf16 a[132:135], a[216:219], v[52:55], a[132:135]
 s_waitcnt lgkmcnt(8)
 buffer_load_dwordx4 v4, s[48:51], s75 offen offset:2048 nt lds
 v_mfma_f32_16x16x32_bf16 a[144:147], a[192:195], v[52:55], a[144:147]
 ds_read_b64_tr_b16 a[216:217], v2 offset:480
 v_cvt_pk_bf16_f32 v230, v32, v33
 v_mfma_f32_16x16x32_bf16 a[144:147], a[196:199], v[40:43], a[144:147]
 ds_read_b64_tr_b16 a[218:219], v2 offset:992
 v_dot2c_f32_bf16 v12, s79, v230
 v_mfma_f32_16x16x32_bf16 a[148:151], a[196:199], v[44:47], a[148:151]
 ds_read_b64_tr_b16 a[220:221], v2 offset:17376
 v_mfma_f32_16x16x32_bf16 a[148:151], a[192:195], v[56:59], a[148:151]
 ds_read_b64_tr_b16 a[222:223], v2 offset:17888
 v_mfma_f32_16x16x32_bf16 a[152:155], a[192:195], v[60:63], a[152:155]
 v_exp_f32 v34, v194
 v_mfma_f32_16x16x32_bf16 a[152:155], a[196:199], v[48:51], a[152:155]
 s_waitcnt lgkmcnt(8)
 v_exp_f32 v35, v195
 v_mfma_f32_16x16x32_bf16 a[164:167], a[204:207], v[48:51], a[164:167]
 v_exp_f32 v30, v186
 v_mfma_f32_16x16x32_bf16 a[164:167], a[200:203], v[60:63], a[164:167]
 v_exp_f32 v31, v187
 v_mfma_f32_16x16x32_bf16 a[160:163], a[200:203], v[56:59], a[160:163]
L1_PAD7:
 s_cbranch_execz L1_PRT7
 v_mfma_f32_16x16x32_bf16 a[160:163], a[204:207], v[44:47], a[160:163]
 v_exp_f32 v32, v196
 v_mfma_f32_16x16x32_bf16 a[156:159], a[204:207], v[40:43], a[156:159]
 s_add_u32 m0, s73, 0x9470
 v_exp_f32 v33, v197
 v_mfma_f32_16x16x32_bf16 a[156:159], a[200:203], v[52:55], a[156:159]
 s_waitcnt lgkmcnt(4)
 buffer_load_dwordx4 v4, s[48:51], s75 offen offset:3072 nt lds
 v_mfma_f32_16x16x32_bf16 a[168:171], a[208:211], v[52:55], a[168:171]
 v_cvt_pk_bf16_f32 v231, v34, v35
 v_mfma_f32_16x16x32_bf16 a[168:171], a[212:215], v[40:43], a[168:171]
 v_exp_f32 v34, v198
 v_mfma_f32_16x16x32_bf16 a[172:175], a[212:215], v[44:47], a[172:175]
 v_mfma_f32_16x16x32_bf16 a[172:175], a[208:211], v[56:59], a[172:175]
 v_exp_f32 v35, v199
 v_mfma_f32_16x16x32_bf16 a[176:179], a[208:211], v[60:63], a[176:179]
 v_dot2c_f32_bf16 v12, s79, v231
 v_mfma_f32_16x16x32_bf16 a[176:179], a[212:215], v[48:51], a[176:179]
 s_waitcnt lgkmcnt(0)
 v_cvt_pk_bf16_f32 v233, v30, v31
 v_dot2c_f32_bf16 v13, s79, v233
 v_mfma_f32_16x16x32_bf16 a[188:191], a[220:223], v[48:51], a[188:191]
 v_cvt_pk_bf16_f32 v234, v32, v33
 v_mfma_f32_16x16x32_bf16 a[188:191], a[216:219], v[60:63], a[188:191]
 v_dot2c_f32_bf16 v13, s79, v234
 v_mfma_f32_16x16x32_bf16 a[184:187], a[216:219], v[56:59], a[184:187]
 v_cvt_pk_bf16_f32 v235, v34, v35
 v_mfma_f32_16x16x32_bf16 a[184:187], a[220:223], v[44:47], a[184:187]
 s_add_u32 s75, s75, 0x8000
 s_waitcnt vmcnt(16)
 s_barrier
 v_mfma_f32_16x16x32_bf16 a[180:183], a[220:223], v[40:43], a[180:183]
 s_sub_u32 s77, s77, 1
 ds_read_b128 a[192:195], v1 offset:0
 v_dot2c_f32_bf16 v13, s79, v235
 v_mfma_f32_16x16x32_bf16 a[180:183], a[216:219], v[52:55], a[180:183]
 s_waitcnt lgkmcnt(0)
 s_cmp_lg_u32 s77, 0
 ds_read_b128 a[196:199], v1 offset:32
 ds_read_b128 a[200:203], v1 offset:64
 ds_read_b128 a[204:207], v1 offset:96
 ds_read_b128 a[208:211], v1 offset:128
 ds_read_b128 a[212:215], v1 offset:160
 s_cbranch_scc1 L1_LOOP
 s_waitcnt lgkmcnt(4)
 v_mfma_f32_16x16x32_bf16 v[128:131], a[192:195], v[64:67], v[16:19]
 s_add_u32 m0, s74, 0x10800
 ds_read_b128 a[216:219], v1 offset:192
 v_mfma_f32_16x16x32_bf16 v[128:131], a[196:199], v[68:71], v[128:131]
 buffer_load_dwordx4 v3, s[52:55], s76 offen offset:0 nt lds
 v_mfma_f32_16x16x32_bf16 v[132:135], a[196:199], v[100:103], v[20:23]
 ds_read_b128 a[220:223], v1 offset:224
 v_mfma_f32_16x16x32_bf16 v[132:135], a[192:195], v[96:99], v[132:135]
 v_exp_f32 v28, v200
 v_mfma_f32_16x16x32_bf16 v[136:139], a[192:195], a[224:227], v[24:27]
 v_exp_f32 v29, v201
 v_mfma_f32_16x16x32_bf16 v[136:139], a[196:199], a[228:231], v[136:139]
 s_waitcnt lgkmcnt(4)
 v_exp_f32 v30, v202
 v_mfma_f32_16x16x32_bf16 v[136:139], a[204:207], a[236:239], v[136:139]
 ds_read_b128 a[192:195], v1 offset:512
 v_mfma_f32_16x16x32_bf16 v[136:139], a[200:203], a[232:235], v[136:139]
 v_exp_f32 v31, v203
 v_mfma_f32_16x16x32_bf16 v[132:135], a[200:203], v[104:107], v[132:135]
 ds_read_b128 a[196:199], v1 offset:544
 v_mfma_f32_16x16x32_bf16 v[132:135], a[204:207], v[108:111], v[132:135]
 v_exp_f32 v32, v212
 v_mfma_f32_16x16x32_bf16 v[128:131], a[204:207], v[76:79], v[128:131]
 v_mfma_f32_16x16x32_bf16 v[128:131], a[200:203], v[72:75], v[128:131]
 s_waitcnt lgkmcnt(4)
 v_exp_f32 v33, v213
 v_mfma_f32_16x16x32_bf16 v[128:131], a[208:211], v[80:83], v[128:131]
 s_add_u32 m0, s74, 0x10820
 ds_read_b128 a[200:203], v1 offset:576
 v_mfma_f32_16x16x32_bf16 v[128:131], a[212:215], v[84:87], v[128:131]
 buffer_load_dwordx4 v3, s[52:55], s76 offen offset:1024 nt lds
 v_mfma_f32_16x16x32_bf16 v[132:135], a[212:215], v[116:119], v[132:135]
 ds_read_b128 a[204:207], v1 offset:608
 v_mfma_f32_16x16x32_bf16 v[132:135], a[208:211], v[112:115], v[132:135]
 v_exp_f32 v34, v214
 v_mfma_f32_16x16x32_bf16 v[136:139], a[208:211], a[240:243], v[136:139]
 v_exp_f32 v35, v215
 v_mfma_f32_16x16x32_bf16 v[136:139], a[212:215], a[244:247], v[136:139]
 s_waitcnt lgkmcnt(4)
 v_mfma_f32_16x16x32_bf16 v[136:139], a[220:223], a[252:255], v[136:139]
 ds_read_b128 a[208:211], v1 offset:640
 v_add_f32 v11, v11, v28
 v_mfma_f32_16x16x32_bf16 v[136:139], a[216:219], a[248:251], v[136:139]
 v_add_f32 v11, v11, v29
 v_mfma_f32_16x16x32_bf16 v[132:135], a[216:219], v[120:123], v[132:135]
 ds_read_b128 a[212:215], v1 offset:672
 v_mfma_f32_16x16x32_bf16 v[132:135], a[220:223], v[124:127], v[132:135]
 v_cvt_pk_bf16_f32 v40, v28, v29
 v_add_f32 v11, v11, v30
 v_mfma_f32_16x16x32_bf16 v[128:131], a[220:223], v[92:95], v[128:131]
 v_exp_f32 v28, v204
 v_mfma_f32_16x16x32_bf16 v[128:131], a[216:219], v[88:91], v[128:131]
 s_waitcnt lgkmcnt(4)
 v_mfma_f32_16x16x32_bf16 v[140:143], a[192:195], v[64:67], v[16:19]
 s_add_u32 m0, s74, 0x10840
 ds_read_b128 a[216:219], v1 offset:704
 v_add_f32 v11, v11, v31
 v_mfma_f32_16x16x32_bf16 v[140:143], a[196:199], v[68:71], v[140:143]
 buffer_load_dwordx4 v3, s[52:55], s76 offen offset:2048 nt lds
 v_mfma_f32_16x16x32_bf16 v[144:147], a[196:199], v[100:103], v[20:23]
 ds_read_b128 a[220:223], v1 offset:736
 v_mfma_f32_16x16x32_bf16 v[144:147], a[192:195], v[96:99], v[144:147]
 v_exp_f32 v29, v205
 v_mfma_f32_16x16x32_bf16 v[148:151], a[192:195], a[224:227], v[24:27]
 v_cvt_pk_bf16_f32 v41, v30, v31
 v_mfma_f32_16x16x32_bf16 v[148:151], a[196:199], a[228:231], v[148:151]
 s_waitcnt lgkmcnt(4)
 v_exp_f32 v30, v206
 v_mfma_f32_16x16x32_bf16 v[148:151], a[204:207], a[236:239], v[148:151]
 ds_read_b128 a[192:195], v1 offset:16640
 v_mfma_f32_16x16x32_bf16 v[148:151], a[200:203], a[232:235], v[148:151]
 v_exp_f32 v31, v207
 v_mfma_f32_16x16x32_bf16 v[144:147], a[200:203], v[104:107], v[144:147]
 ds_read_b128 a[196:199], v1 offset:16672
 v_mfma_f32_16x16x32_bf16 v[144:147], a[204:207], v[108:111], v[144:147]
 v_add_f32 v11, v11, v32
 v_mfma_f32_16x16x32_bf16 v[140:143], a[204:207], v[76:79], v[140:143]
 v_add_f32 v11, v11, v33
 v_mfma_f32_16x16x32_bf16 v[140:143], a[200:203], v[72:75], v[140:143]
 s_waitcnt lgkmcnt(4)
 v_cvt_pk_bf16_f32 v42, v32, v33
 v_mfma_f32_16x16x32_bf16 v[140:143], a[208:211], v[80:83], v[140:143]
 s_add_u32 m0, s74, 0x10860
 ds_read_b128 a[200:203], v1 offset:16704
 v_add_f32 v11, v11, v34
 v_mfma_f32_16x16x32_bf16 v[140:143], a[212:215], v[84:87], v[140:143]
 buffer_load_dwordx4 v3, s[52:55], s76 offen offset:3072 nt lds
 v_mfma_f32_16x16x32_bf16 v[144:147], a[212:215], v[116:119], v[144:147]
 ds_read_b128 a[204:207], v1 offset:16736
 v_mfma_f32_16x16x32_bf16 v[144:147], a[208:211], v[112:115], v[144:147]
 v_exp_f32 v32, v216
 v_mfma_f32_16x16x32_bf16 v[148:151], a[208:211], a[240:243], v[148:151]
 v_exp_f32 v33, v217
 v_mfma_f32_16x16x32_bf16 v[148:151], a[212:215], a[244:247], v[148:151]
 s_waitcnt lgkmcnt(4)
 v_mfma_f32_16x16x32_bf16 v[148:151], a[220:223], a[252:255], v[148:151]
 ds_read_b128 a[208:211], v1 offset:16768
 v_add_f32 v11, v11, v35
 v_mfma_f32_16x16x32_bf16 v[148:151], a[216:219], a[248:251], v[148:151]
 v_cvt_pk_bf16_f32 v43, v34, v35
 v_mfma_f32_16x16x32_bf16 v[144:147], a[216:219], v[120:123], v[144:147]
 ds_read_b128 a[212:215], v1 offset:16800
 v_add_f32 v12, v12, v28
 v_mfma_f32_16x16x32_bf16 v[144:147], a[220:223], v[124:127], v[144:147]
 v_exp_f32 v34, v218
 v_mfma_f32_16x16x32_bf16 v[140:143], a[220:223], v[92:95], v[140:143]
 v_mfma_f32_16x16x32_bf16 v[140:143], a[216:219], v[88:91], v[140:143]
 s_waitcnt lgkmcnt(4)
 v_exp_f32 v35, v219
 v_mfma_f32_16x16x32_bf16 v[152:155], a[192:195], v[64:67], v[16:19]
 s_add_u32 m0, s74, 0x11880
 ds_read_b128 a[216:219], v1 offset:16832
 v_mfma_f32_16x16x32_bf16 v[152:155], a[196:199], v[68:71], v[152:155]
 buffer_load_dwordx4 v4, s[52:55], s76 offen offset:0 nt lds
 v_mfma_f32_16x16x32_bf16 v[156:159], a[196:199], v[100:103], v[20:23]
 ds_read_b128 a[220:223], v1 offset:16864
 v_mfma_f32_16x16x32_bf16 v[156:159], a[192:195], v[96:99], v[156:159]
 v_add_f32 v12, v12, v29
 v_cvt_pk_bf16_f32 v44, v28, v29
 v_mfma_f32_16x16x32_bf16 v[160:163], a[192:195], a[224:227], v[24:27]
 v_exp_f32 v28, v208
 v_mfma_f32_16x16x32_bf16 v[160:163], a[196:199], a[228:231], v[160:163]
 s_waitcnt lgkmcnt(4)
 v_mfma_f32_16x16x32_bf16 v[160:163], a[204:207], a[236:239], v[160:163]
 ds_read_b128 a[192:195], v1 offset:17152
 v_add_f32 v12, v12, v30
 v_mfma_f32_16x16x32_bf16 v[160:163], a[200:203], a[232:235], v[160:163]
 v_exp_f32 v29, v209
 v_mfma_f32_16x16x32_bf16 v[156:159], a[200:203], v[104:107], v[156:159]
 ds_read_b128 a[196:199], v1 offset:17184
 v_mfma_f32_16x16x32_bf16 v[156:159], a[204:207], v[108:111], v[156:159]
 v_add_f32 v12, v12, v31
 v_mfma_f32_16x16x32_bf16 v[152:155], a[204:207], v[76:79], v[152:155]
 s_add_u32 m0, s74, 0x118a0
 v_cvt_pk_bf16_f32 v45, v30, v31
 v_mfma_f32_16x16x32_bf16 v[152:155], a[200:203], v[72:75], v[152:155]
 s_waitcnt lgkmcnt(4)
 buffer_load_dwordx4 v4, s[52:55], s76 offen offset:1024 nt lds
 v_mfma_f32_16x16x32_bf16 v[152:155], a[208:211], v[80:83], v[152:155]
 ds_read_b128 a[200:203], v1 offset:17216
 v_mfma_f32_16x16x32_bf16 v[152:155], a[212:215], v[84:87], v[152:155]
 v_exp_f32 v30, v210
 v_mfma_f32_16x16x32_bf16 v[156:159], a[212:215], v[116:119], v[156:159]
 ds_read_b128 a[204:207], v1 offset:17248
 v_mfma_f32_16x16x32_bf16 v[156:159], a[208:211], v[112:115], v[156:159]
 v_exp_f32 v31, v211
 v_mfma_f32_16x16x32_bf16 v[160:163], a[208:211], a[240:243], v[160:163]
 v_mfma_f32_16x16x32_bf16 v[160:163], a[212:215], a[244:247], v[160:163]
 s_waitcnt lgkmcnt(4)
 v_add_f32 v12, v12, v32
 v_add_f32 v12, v12, v33
 v_mfma_f32_16x16x32_bf16 v[160:163], a[220:223], a[252:255], v[160:163]
 ds_read_b128 a[208:211], v1 offset:17280
 v_mfma_f32_16x16x32_bf16 v[160:163], a[216:219], a[248:251], v[160:163]
 v_cvt_pk_bf16_f32 v46, v32, v33
 v_mfma_f32_16x16x32_bf16 v[156:159], a[216:219], v[120:123], v[156:159]
 ds_read_b128 a[212:215], v1 offset:17312
 v_add_f32 v12, v12, v34
 v_mfma_f32_16x16x32_bf16 v[156:159], a[220:223], v[124:127], v[156:159]
 v_exp_f32 v32, v220
 v_mfma_f32_16x16x32_bf16 v[152:155], a[220:223], v[92:95], v[152:155]
 s_add_u32 m0, s74, 0x118c0
 v_mfma_f32_16x16x32_bf16 v[152:155], a[216:219], v[88:91], v[152:155]
 s_waitcnt lgkmcnt(4)
 buffer_load_dwordx4 v4, s[52:55], s76 offen offset:2048 nt lds
 v_mfma_f32_16x16x32_bf16 v[164:167], a[192:195], v[64:67], v[16:19]
 ds_read_b128 a[216:219], v1 offset:17344
 v_add_f32 v12, v12, v35
 v_mfma_f32_16x16x32_bf16 v[164:167], a[196:199], v[68:71], v[164:167]
 v_exp_f32 v33, v221
 v_mfma_f32_16x16x32_bf16 v[168:171], a[196:199], v[100:103], v[20:23]
 ds_read_b128 a[220:223], v1 offset:17376
 v_mfma_f32_16x16x32_bf16 v[168:171], a[192:195], v[96:99], v[168:171]
 v_cvt_pk_bf16_f32 v47, v34, v35
 v_mfma_f32_16x16x32_bf16 v[172:175], a[192:195], a[224:227], v[24:27]
 v_exp_f32 v34, v222
 v_mfma_f32_16x16x32_bf16 v[172:175], a[196:199], a[228:231], v[172:175]
 s_waitcnt lgkmcnt(4)
 v_mfma_f32_16x16x32_bf16 v[172:175], a[204:207], a[236:239], v[172:175]
 v_exp_f32 v35, v223
 v_mfma_f32_16x16x32_bf16 v[172:175], a[200:203], a[232:235], v[172:175]
 v_mfma_f32_16x16x32_bf16 v[168:171], a[200:203], v[104:107], v[168:171]
 v_add_f32 v13, v13, v28
 v_add_f32 v13, v13, v29
 v_mfma_f32_16x16x32_bf16 v[168:171], a[204:207], v[108:111], v[168:171]
 v_add_f32 v13, v13, v30
 v_mfma_f32_16x16x32_bf16 v[164:167], a[204:207], v[76:79], v[164:167]
 s_add_u32 m0, s74, 0x118e0
 v_add_f32 v13, v13, v31
 v_mfma_f32_16x16x32_bf16 v[164:167], a[200:203], v[72:75], v[164:167]
 s_waitcnt lgkmcnt(2)
 buffer_load_dwordx4 v4, s[52:55], s76 offen offset:3072 nt lds
 v_mfma_f32_16x16x32_bf16 v[164:167], a[208:211], v[80:83], v[164:167]
 v_add_f32 v13, v13, v32
 v_mfma_f32_16x16x32_bf16 v[164:167], a[212:215], v[84:87], v[164:167]
 v_add_f32 v13, v13, v33
 v_mfma_f32_16x16x32_bf16 v[168:171], a[212:215], v[116:119], v[168:171]
 v_add_f32 v13, v13, v34
 v_mfma_f32_16x16x32_bf16 v[168:171], a[208:211], v[112:115], v[168:171]
 v_add_f32 v13, v13, v35
 v_mfma_f32_16x16x32_bf16 v[172:175], a[208:211], a[240:243], v[172:175]
 v_max3_f32 v14, v11, v12, v13
 v_mfma_f32_16x16x32_bf16 v[172:175], a[212:215], a[244:247], v[172:175]
 s_waitcnt lgkmcnt(0)
 v_cmp_nge_f32 vcc, s78, v14
 v_cvt_pk_bf16_f32 v48, v28, v29
 v_mfma_f32_16x16x32_bf16 v[172:175], a[220:223], a[252:255], v[172:175]
 v_cvt_pk_bf16_f32 v49, v30, v31
 v_mfma_f32_16x16x32_bf16 v[172:175], a[216:219], a[248:251], v[172:175]
 v_mfma_f32_16x16x32_bf16 v[168:171], a[216:219], v[120:123], v[168:171]
 v_cvt_pk_bf16_f32 v50, v32, v33
 v_cvt_pk_bf16_f32 v51, v34, v35
 v_mfma_f32_16x16x32_bf16 v[168:171], a[220:223], v[124:127], v[168:171]
 s_waitcnt vmcnt(16)
 s_barrier
 v_mfma_f32_16x16x32_bf16 v[164:167], a[220:223], v[92:95], v[164:167]
 s_add_u32 s76, s76, 0x8000
 ds_read_b64_tr_b16 a[192:193], v2 offset:33792
 v_mfma_f32_16x16x32_bf16 v[164:167], a[216:219], v[88:91], v[164:167]
 s_waitcnt lgkmcnt(0)
 s_mov_b32 s90, 3
 ds_read_b64_tr_b16 a[194:195], v2 offset:34304
 ds_read_b64_tr_b16 a[196:197], v2 offset:50688
 ds_read_b64_tr_b16 a[198:199], v2 offset:51200
 ds_read_b64_tr_b16 a[200:201], v2 offset:33824
 ds_read_b64_tr_b16 a[202:203], v2 offset:34336
 ds_read_b64_tr_b16 a[204:205], v2 offset:50720
 ds_read_b64_tr_b16 a[206:207], v2 offset:51232
 ds_read_b64_tr_b16 a[208:209], v2 offset:33856
 ds_read_b64_tr_b16 a[210:211], v2 offset:34368
 ds_read_b64_tr_b16 a[212:213], v2 offset:50752
 ds_read_b64_tr_b16 a[214:215], v2 offset:51264
 s_cbranch_vccnz L1_RARE1
L1_BACK3:
 s_waitcnt lgkmcnt(8)
 v_mfma_f32_16x16x32_bf16 a[0:3], a[192:195], v[224:227], a[0:3]
 ds_read_b64_tr_b16 a[216:217], v2 offset:33888
 v_add_f32 v8, v8, v11
 v_mfma_f32_16x16x32_bf16 a[0:3], a[196:199], v[40:43], a[0:3]
 ds_read_b64_tr_b16 a[218:219], v2 offset:34400
 v_mfma_f32_16x16x32_bf16 a[4:7], a[196:199], v[44:47], a[4:7]
 ds_read_b64_tr_b16 a[220:221], v2 offset:50784
 v_mfma_f32_16x16x32_bf16 a[4:7], a[192:195], v[228:231], a[4:7]
 s_add_u32 m0, s74, 0x0
 ds_read_b64_tr_b16 a[222:223], v2 offset:51296
 v_mfma_f32_16x16x32_bf16 a[8:11], a[192:195], v[232:235], a[8:11]
 buffer_load_dwordx4 v3, s[52:55], s76 offen offset:0 nt lds
 v_mfma_f32_16x16x32_bf16 a[8:11], a[196:199], v[48:51], a[8:11]
 s_waitcnt lgkmcnt(8)
 v_exp_f32 v28, v128
 v_mfma_f32_16x16x32_bf16 a[20:23], a[204:207], v[48:51], a[20:23]
 ds_read_b64_tr_b16 a[192:193], v2 offset:33920
 v_mfma_f32_16x16x32_bf16 a[20:23], a[200:203], v[232:235], a[20:23]
 ds_read_b64_tr_b16 a[194:195], v2 offset:34432
 v_mfma_f32_16x16x32_bf16 a[16:19], a[200:203], v[228:231], a[16:19]
 ds_read_b64_tr_b16 a[196:197], v2 offset:50816
 v_mfma_f32_16x16x32_bf16 a[16:19], a[204:207], v[44:47], a[16:19]
 ds_read_b64_tr_b16 a[198:199], v2 offset:51328
 v_mfma_f32_16x16x32_bf16 a[12:15], a[204:207], v[40:43], a[12:15]
 s_add_u32 m0, s74, 0x20
 v_exp_f32 v29, v129
 v_mfma_f32_16x16x32_bf16 a[12:15], a[200:203], v[224:227], a[12:15]
 s_waitcnt lgkmcnt(8)
 buffer_load_dwordx4 v3, s[52:55], s76 offen offset:1024 nt lds
 v_mfma_f32_16x16x32_bf16 a[24:27], a[208:211], v[224:227], a[24:27]
 ds_read_b64_tr_b16 a[200:201], v2 offset:33952
 v_add_f32 v11, v28, v29
 v_mfma_f32_16x16x32_bf16 a[24:27], a[212:215], v[40:43], a[24:27]
 ds_read_b64_tr_b16 a[202:203], v2 offset:34464
 v_cvt_pk_bf16_f32 v52, v28, v29
 v_mfma_f32_16x16x32_bf16 a[28:31], a[212:215], v[44:47], a[28:31]
 ds_read_b64_tr_b16 a[204:205], v2 offset:50848
 v_mfma_f32_16x16x32_bf16 a[28:31], a[208:211], v[228:231], a[28:31]
 ds_read_b64_tr_b16 a[206:207], v2 offset:51360
 v_mfma_f32_16x16x32_bf16 a[32:35], a[208:211], v[232:235], a[32:35]
 v_exp_f32 v30, v130
 v_mfma_f32_16x16x32_bf16 a[32:35], a[212:215], v[48:51], a[32:35]
 s_waitcnt lgkmcnt(8)
 v_exp_f32 v31, v131
 v_mfma_f32_16x16x32_bf16 a[44:47], a[220:223], v[48:51], a[44:47]
 ds_read_b64_tr_b16 a[208:209], v2 offset:33984
 v_add_f32 v11, v11, v30
 v_mfma_f32_16x16x32_bf16 a[44:47], a[216:219], v[232:235], a[44:47]
 ds_read_b64_tr_b16 a[210:211], v2 offset:34496
 v_add_f32 v11, v11, v31
 v_mfma_f32_16x16x32_bf16 a[40:43], a[216:219], v[228:231], a[40:43]
 ds_read_b64_tr_b16 a[212:213], v2 offset:50880
 v_cvt_pk_bf16_f32 v53, v30, v31
 v_mfma_f32_16x16x32_bf16 a[40:43], a[220:223], v[44:47], a[40:43]
 s_add_u32 m0, s74, 0x40
 ds_read_b64_tr_b16 a[214:215], v2 offset:51392
 v_mfma_f32_16x16x32_bf16 a[36:39], a[220:223], v[40:43], a[36:39]
 buffer_load_dwordx4 v3, s[52:55], s76 offen offset:2048 nt lds
 v_mfma_f32_16x16x32_bf16 a[36:39], a[216:219], v[224:227], a[36:39]
 s_waitcnt lgkmcnt(8)
 v_exp_f32 v32, v140
 v_mfma_f32_16x16x32_bf16 a[48:51], a[192:195], v[224:227], a[48:51]
 ds_read_b64_tr_b16 a[216:217], v2 offset:34016
 v_add_f32 v11, v11, v32
 v_mfma_f32_16x16x32_bf16 a[48:51], a[196:199], v[40:43], a[48:51]
 ds_read_b64_tr_b16 a[218:219], v2 offset:34528
 v_mfma_f32_16x16x32_bf16 a[52:55], a[196:199], v[44:47], a[52:55]
 ds_read_b64_tr_b16 a[220:221], v2 offset:50912
 v_mfma_f32_16x16x32_bf16 a[52:55], a[192:195], v[228:231], a[52:55]
 ds_read_b64_tr_b16 a[222:223], v2 offset:51424
 v_mfma_f32_16x16x32_bf16 a[56:59], a[192:195], v[232:235], a[56:59]
 v_exp_f32 v33, v141
 v_mfma_f32_16x16x32_bf16 a[56:59], a[196:199], v[48:51], a[56:59]
 s_waitcnt lgkmcnt(8)
 v_exp_f32 v34, v142
 v_mfma_f32_16x16x32_bf16 a[68:71], a[204:207], v[48:51], a[68:71]
 ds_read_b64_tr_b16 a[192:193], v2 offset:34048
 v_add_f32 v11, v11, v33
 v_mfma_f32_16x16x32_bf16 a[68:71], a[200:203], v[232:235], a[68:71]
 ds_read_b64_tr_b16 a[194:195], v2 offset:34560
 v_cvt_pk_bf16_f32 v54, v32, v33
 v_mfma_f32_16x16x32_bf16 a[64:67], a[200:203], v[228:231], a[64:67]
 ds_read_b64_tr_b16 a[196:197], v2 offset:50944
 v_add_f32 v11, v11, v34
 v_mfma_f32_16x16x32_bf16 a[64:67], a[204:207], v[44:47], a[64:67]
 s_add_u32 m0, s74, 0x60
 ds_read_b64_tr_b16 a[198:199], v2 offset:51456
 v_add_f32 v9, v9, v12
 v_mfma_f32_16x16x32_bf16 a[60:63], a[204:207], v[40:43], a[60:63]
 buffer_load_dwordx4 v3, s[52:55], s76 offen offset:3072 nt lds
 v_mfma_f32_16x16x32_bf16 a[60:63], a[200:203], v[224:227], a[60:63]
 s_waitcnt lgkmcnt(8)
 v_exp_f32 v35, v143
 v_mfma_f32_16x16x32_bf16 a[72:75], a[208:211], v[224:227], a[72:75]
 ds_read_b64_tr_b16 a[200:201], v2 offset:34080
 v_mfma_f32_16x16x32_bf16 a[72:75], a[212:215], v[40:43], a[72:75]
 ds_read_b64_tr_b16 a[202:203], v2 offset:34592
 v_add_f32 v11, v11, v35
 v_mfma_f32_16x16x32_bf16 a[76:79], a[212:215], v[44:47], a[76:79]
 ds_read_b64_tr_b16 a[204:205], v2 offset:50976
 v_cvt_pk_bf16_f32 v55, v34, v35
 v_mfma_f32_16x16x32_bf16 a[76:79], a[208:211], v[228:231], a[76:79]
 ds_read_b64_tr_b16 a[206:207], v2 offset:51488
 v_mfma_f32_16x16x32_bf16 a[80:83], a[208:211], v[232:235], a[80:83]
 v_exp_f32 v28, v132
 v_mfma_f32_16x16x32_bf16 a[80:83], a[212:215], v[48:51], a[80:83]
 s_waitcnt lgkmcnt(8)
 v_exp_f32 v29, v133
 v_mfma_f32_16x16x32_bf16 a[92:95], a[220:223], v[48:51], a[92:95]
 ds_read_b64_tr_b16 a[208:209], v2 offset:34112
 v_add_f32 v12, v28, v29
 v_mfma_f32_16x16x32_bf16 a[92:95], a[216:219], v[232:235], a[92:95]
 ds_read_b64_tr_b16 a[210:211], v2 offset:34624
 v_mfma_f32_16x16x32_bf16 a[88:91], a[216:219], v[228:231], a[88:91]
 ds_read_b64_tr_b16 a[212:213], v2 offset:51008
 v_cvt_pk_bf16_f32 v56, v28, v29
 v_mfma_f32_16x16x32_bf16 a[88:91], a[220:223], v[44:47], a[88:91]
 s_add_u32 m0, s74, 0x1080
 ds_read_b64_tr_b16 a[214:215], v2 offset:51520
 v_mfma_f32_16x16x32_bf16 a[84:87], a[220:223], v[40:43], a[84:87]
 buffer_load_dwordx4 v4, s[52:55], s76 offen offset:0 nt lds
 v_mfma_f32_16x16x32_bf16 a[84:87], a[216:219], v[224:227], a[84:87]
 s_waitcnt lgkmcnt(8)
 v_exp_f32 v30, v134
 v_mfma_f32_16x16x32_bf16 a[96:99], a[192:195], v[224:227], a[96:99]
 ds_read_b64_tr_b16 a[216:217], v2 offset:34144
 v_add_f32 v12, v12, v30
 v_mfma_f32_16x16x32_bf16 a[96:99], a[196:199], v[40:43], a[96:99]
 ds_read_b64_tr_b16 a[218:219], v2 offset:34656
 v_mfma_f32_16x16x32_bf16 a[100:103], a[196:199], v[44:47], a[100:103]
 ds_read_b64_tr_b16 a[220:221], v2 offset:51040
 v_mfma_f32_16x16x32_bf16 a[100:103], a[192:195], v[228:231], a[100:103]
 ds_read_b64_tr_b16 a[222:223], v2 offset:51552
 v_mfma_f32_16x16x32_bf16 a[104:107], a[192:195], v[232:235], a[104:107]
 s_add_u32 m0, s74, 0x10a0
 v_exp_f32 v31, v135
 v_mfma_f32_16x16x32_bf16 a[104:107], a[196:199], v[48:51], a[104:107]
 s_waitcnt lgkmcnt(8)
 buffer_load_dwordx4 v4, s[52:55], s76 offen offset:1024 nt lds
 v_mfma_f32_16x16x32_bf16 a[116:119], a[204:207], v[48:51], a[116:119]
 ds_read_b64_tr_b16 a[192:193], v2 offset:34176
 v_add_f32 v12, v12, v31
 v_mfma_f32_16x16x32_bf16 a[116:119], a[200:203], v[232:235], a[116:119]
 ds_read_b64_tr_b16 a[194:195], v2 offset:34688
 v_cvt_pk_bf16_f32 v57, v30, v31
 v_mfma_f32_16x16x32_bf16 a[112:115], a[200:203], v[228:231], a[112:115]
 ds_read_b64_tr_b16 a[196:197], v2 offset:51072
 v_mfma_f32_16x16x32_bf16 a[112:115], a[204:207], v[44:47], a[112:115]
 ds_read_b64_tr_b16 a[198:199], v2 offset:51584
 v_mfma_f32_16x16x32_bf16 a[108:111], a[204:207], v[40:43], a[108:111]
 v_exp_f32 v32, v144
 v_mfma_f32_16x16x32_bf16 a[108:111], a[200:203], v[224:227], a[108:111]
 s_waitcnt lgkmcnt(8)
 v_exp_f32 v33, v145
 v_mfma_f32_16x16x32_bf16 a[120:123], a[208:211], v[224:227], a[120:123]
 ds_read_b64_tr_b16 a[200:201], v2 offset:34208
 v_add_f32 v12, v12, v32
 v_mfma_f32_16x16x32_bf16 a[120:123], a[212:215], v[40:43], a[120:123]
 ds_read_b64_tr_b16 a[202:203], v2 offset:34720
 v_add_f32 v12, v12, v33
 v_mfma_f32_16x16x32_bf16 a[124:127], a[212:215], v[44:47], a[124:127]
 ds_read_b64_tr_b16 a[204:205], v2 offset:51104
 v_cvt_pk_bf16_f32 v58, v32, v33
 v_mfma_f32_16x16x32_bf16 a[124:127], a[208:211], v[228:231], a[124:127]
 s_add_u32 m0, s74, 0x10c0
 ds_read_b64_tr_b16 a[206:207], v2 offset:51616
 v_add_f32 v10, v10, v13
 v_mfma_f32_16x16x32_bf16 a[128:131], a[208:211], v[232:235], a[128:131]
 buffer_load_dwordx4 v4, s[52:55], s76 offen offset:2048 nt lds
 v_mfma_f32_16x16x32_bf16 a[128:131], a[212:215], v[48:51], a[128:131]
 s_waitcnt lgkmcnt(8)
 v_exp_f32 v34, v146
 v_mfma_f32_16x16x32_bf16 a[140:143], a[220:223], v[48:51], a[140:143]
 ds_read_b64_tr_b16 a[208:209], v2 offset:34240
 v_mfma_f32_16x16x32_bf16 a[140:143], a[216:219], v[232:235], a[140:143]
 ds_read_b64_tr_b16 a[210:211], v2 offset:34752
 v_add_f32 v12, v12, v34
 v_mfma_f32_16x16x32_bf16 a[136:139], a[216:219], v[228:231], a[136:139]
 ds_read_b64_tr_b16 a[212:213], v2 offset:51136
 v_mfma_f32_16x16x32_bf16 a[136:139], a[220:223], v[44:47], a[136:139]
 ds_read_b64_tr_b16 a[214:215], v2 offset:51648
 v_mfma_f32_16x16x32_bf16 a[132:135], a[220:223], v[40:43], a[132:135]
 v_exp_f32 v35, v147
 v_mfma_f32_16x16x32_bf16 a[132:135], a[216:219], v[224:227], a[132:135]
 s_waitcnt lgkmcnt(8)
 v_exp_f32 v28, v136
 v_mfma_f32_16x16x32_bf16 a[144:147], a[192:195], v[224:227], a[144:147]
 ds_read_b64_tr_b16 a[216:217], v2 offset:34272
 v_add_f32 v12, v12, v35
 v_mfma_f32_16x16x32_bf16 a[144:147], a[196:199], v[40:43], a[144:147]
 ds_read_b64_tr_b16 a[218:219], v2 offset:34784
 v_cvt_pk_bf16_f32 v59, v34, v35
 v_mfma_f32_16x16x32_bf16 a[148:151], a[196:199], v[44:47], a[148:151]
 ds_read_b64_tr_b16 a[220:221], v2 offset:51168
 v_mfma_f32_16x16x32_bf16 a[148:151], a[192:195], v[228:231], a[148:151]
 s_add_u32 m0, s74, 0x10e0
 ds_read_b64_tr_b16 a[222:223], v2 offset:51680
 v_mfma_f32_16x16x32_bf16 a[152:155], a[192:195], v[232:235], a[152:155]
 buffer_load_dwordx4 v4, s[52:55], s76 offen offset:3072 nt lds
 v_mfma_f32_16x16x32_bf16 a[152:155], a[196:199], v[48:51], a[152:155]
 s_waitcnt lgkmcnt(8)
 v_exp_f32 v29, v137
 v_mfma_f32_16x16x32_bf16 a[164:167], a[204:207], v[48:51], a[164:167]
 v_exp_f32 v30, v138
 v_mfma_f32_16x16x32_bf16 a[164:167], a[200:203], v[232:235], a[164:167]
 v_exp_f32 v31, v139
 v_mfma_f32_16x16x32_bf16 a[160:163], a[200:203], v[228:231], a[160:163]
 v_exp_f32 v32, v148
 v_mfma_f32_16x16x32_bf16 a[160:163], a[204:207], v[44:47], a[160:163]
 v_exp_f32 v33, v149
 v_mfma_f32_16x16x32_bf16 a[156:159], a[204:207], v[40:43], a[156:159]
 v_exp_f32 v34, v150
 v_mfma_f32_16x16x32_bf16 a[156:159], a[200:203], v[224:227], a[156:159]
 s_waitcnt lgkmcnt(4)
 v_lshlrev_b32 v254, 7, v7
 v_exp_f32 v35, v151
 v_mfma_f32_16x16x32_bf16 a[168:171], a[208:211], v[224:227], a[168:171]
 buffer_load_dword v255, v254, s[60:63], s70 offen offset:0
 v_mfma_f32_16x16x32_bf16 a[168:171], a[212:215], v[40:43], a[168:171]
 v_mfma_f32_16x16x32_bf16 a[172:175], a[212:215], v[44:47], a[172:175]
 v_add_f32 v13, v28, v29
 v_cvt_pk_bf16_f32 v60, v28, v29
 v_mfma_f32_16x16x32_bf16 a[172:175], a[208:211], v[228:231], a[172:175]
 v_add_f32 v13, v13, v30
 v_add_f32 v13, v13, v31
 v_mfma_f32_16x16x32_bf16 a[176:179], a[208:211], v[232:235], a[176:179]
 v_cvt_pk_bf16_f32 v61, v30, v31
 v_mfma_f32_16x16x32_bf16 a[176:179], a[212:215], v[48:51], a[176:179]
 s_waitcnt lgkmcnt(0)
 v_add_f32 v13, v13, v32
 v_add_f32 v13, v13, v33
 v_mfma_f32_16x16x32_bf16 a[188:191], a[220:223], v[48:51], a[188:191]
 v_cvt_pk_bf16_f32 v62, v32, v33
 v_mfma_f32_16x16x32_bf16 a[188:191], a[216:219], v[232:235], a[188:191]
 v_add_f32 v13, v13, v34
 v_add_f32 v13, v13, v35
 v_mfma_f32_16x16x32_bf16 a[184:187], a[216:219], v[228:231], a[184:187]
 v_cvt_pk_bf16_f32 v63, v34, v35
 v_mfma_f32_16x16x32_bf16 a[184:187], a[220:223], v[44:47], a[184:187]
 s_waitcnt vmcnt(17)
 s_barrier
 v_mfma_f32_16x16x32_bf16 a[180:183], a[220:223], v[40:43], a[180:183]
 ds_read_b128 a[192:195], v1 offset:33792
 v_add_u32 v253, 0xfffef800, v2
 v_mfma_f32_16x16x32_bf16 a[180:183], a[216:219], v[224:227], a[180:183]
 s_waitcnt lgkmcnt(0)
 ds_read_b128 a[196:199], v1 offset:33824
 ds_read_b128 a[200:203], v1 offset:33856
 ds_read_b128 a[204:207], v1 offset:33888
 ds_read_b128 a[208:211], v1 offset:33920
 ds_read_b128 a[212:215], v1 offset:33952
 s_waitcnt lgkmcnt(4)
 v_mfma_f32_16x16x32_bf16 v[176:179], a[192:195], v[64:67], v[16:19]
 ds_read_b128 a[216:219], v1 offset:33984
 v_mfma_f32_16x16x32_bf16 v[176:179], a[196:199], v[68:71], v[176:179]
 v_exp_f32 v28, v152
 v_mfma_f32_16x16x32_bf16 v[180:183], a[196:199], v[100:103], v[20:23]
 ds_read_b128 a[220:223], v1 offset:34016
 v_add_f32 v11, v11, v28
 v_mfma_f32_16x16x32_bf16 v[180:183], a[192:195], v[96:99], v[180:183]
 v_exp_f32 v29, v153
 v_mfma_f32_16x16x32_bf16 v[184:187], a[192:195], a[224:227], v[24:27]
 v_exp_f32 v30, v154
 v_mfma_f32_16x16x32_bf16 v[184:187], a[196:199], a[228:231], v[184:187]
 s_waitcnt lgkmcnt(4)
 v_exp_f32 v31, v155
 v_mfma_f32_16x16x32_bf16 v[184:187], a[204:207], a[236:239], v[184:187]
 ds_read_b128 a[192:195], v1 offset:34304
 v_add_f32 v11, v11, v29
 v_mfma_f32_16x16x32_bf16 v[184:187], a[200:203], a[232:235], v[184:187]
 v_exp_f32 v32, v164
 v_mfma_f32_16x16x32_bf16 v[180:183], a[200:203], v[104:107], v[180:183]
 ds_read_b128 a[196:199], v1 offset:34336
 v_cvt_pk_bf16_f32 v40, v28, v29
 v_mfma_f32_16x16x32_bf16 v[180:183], a[204:207], v[108:111], v[180:183]
 v_exp_f32 v33, v165
 v_mfma_f32_16x16x32_bf16 v[176:179], a[204:207], v[76:79], v[176:179]
 v_exp_f32 v34, v166
 v_mfma_f32_16x16x32_bf16 v[176:179], a[200:203], v[72:75], v[176:179]
 s_waitcnt lgkmcnt(4)
 v_exp_f32 v35, v167
 v_mfma_f32_16x16x32_bf16 v[176:179], a[208:211], v[80:83], v[176:179]
 ds_read_b128 a[200:203], v1 offset:34368
 v_add_f32 v11, v11, v30
 v_mfma_f32_16x16x32_bf16 v[176:179], a[212:215], v[84:87], v[176:179]
 v_exp_f32 v28, v156
 v_mfma_f32_16x16x32_bf16 v[180:183], a[212:215], v[116:119], v[180:183]
 ds_read_b128 a[204:207], v1 offset:34400
 v_add_f32 v11, v11, v31
 v_mfma_f32_16x16x32_bf16 v[180:183], a[208:211], v[112:115], v[180:183]
 v_exp_f32 v29, v157
 v_mfma_f32_16x16x32_bf16 v[184:187], a[208:211], a[240:243], v[184:187]
 v_cvt_pk_bf16_f32 v41, v30, v31
 v_add_f32 v11, v11, v32
 v_mfma_f32_16x16x32_bf16 v[184:187], a[212:215], a[244:247], v[184:187]
 s_waitcnt lgkmcnt(4)
 v_exp_f32 v30, v158
 v_mfma_f32_16x16x32_bf16 v[184:187], a[220:223], a[252:255], v[184:187]
 ds_read_b128 a[208:211], v1 offset:34432
 v_add_f32 v11, v11, v33
 v_mfma_f32_16x16x32_bf16 v[184:187], a[216:219], a[248:251], v[184:187]
 v_exp_f32 v31, v159
 v_mfma_f32_16x16x32_bf16 v[180:183], a[216:219], v[120:123], v[180:183]
 ds_read_b128 a[212:215], v1 offset:34464
 v_cvt_pk_bf16_f32 v42, v32, v33
 v_mfma_f32_16x16x32_bf16 v[180:183], a[220:223], v[124:127], v[180:183]
 v_exp_f32 v32, v168
 v_mfma_f32_16x16x32_bf16 v[176:179], a[220:223], v[92:95], v[176:179]
 v_exp_f32 v33, v169
 v_mfma_f32_16x16x32_bf16 v[176:179], a[216:219], v[88:91], v[176:179]
 s_waitcnt lgkmcnt(4)
 v_add_f32 v11, v11, v34
 v_add_f32 v11, v11, v35
 v_mfma_f32_16x16x32_bf16 v[188:191], a[192:195], v[64:67], v[16:19]
 ds_read_b128 a[216:219], v1 offset:34496
 v_cvt_pk_bf16_f32 v43, v34, v35
 v_mfma_f32_16x16x32_bf16 v[188:191], a[196:199], v[68:71], v[188:191]
 v_exp_f32 v34, v170
 v_mfma_f32_16x16x32_bf16 v[192:195], a[196:199], v[100:103], v[20:23]
 ds_read_b128 a[220:223], v1 offset:34528
 v_add_f32 v12, v12, v28
 v_mfma_f32_16x16x32_bf16 v[192:195], a[192:195], v[96:99], v[192:195]
 v_exp_f32 v35, v171
 v_mfma_f32_16x16x32_bf16 v[196:199], a[192:195], a[224:227], v[24:27]
 v_add_f32 v12, v12, v29
 v_cvt_pk_bf16_f32 v44, v28, v29
 v_mfma_f32_16x16x32_bf16 v[196:199], a[196:199], a[228:231], v[196:199]
 s_waitcnt lgkmcnt(4)
 v_exp_f32 v28, v160
 v_mfma_f32_16x16x32_bf16 v[196:199], a[204:207], a[236:239], v[196:199]
 ds_read_b128 a[192:195], v1 offset:50432
 v_add_f32 v12, v12, v30
 v_mfma_f32_16x16x32_bf16 v[196:199], a[200:203], a[232:235], v[196:199]
L1_PAD8:
 s_cbranch_execz L1_PRL0
 v_exp_f32 v29, v161
 v_mfma_f32_16x16x32_bf16 v[192:195], a[200:203], v[104:107], v[192:195]
 ds_read_b128 a[196:199], v1 offset:50464
 v_add_f32 v12, v12, v31
 v_mfma_f32_16x16x32_bf16 v[192:195], a[204:207], v[108:111], v[192:195]
 v_cvt_pk_bf16_f32 v45, v30, v31
 v_add_f32 v12, v12, v32
 v_mfma_f32_16x16x32_bf16 v[188:191], a[204:207], v[76:79], v[188:191]
 v_exp_f32 v30, v162
 v_mfma_f32_16x16x32_bf16 v[188:191], a[200:203], v[72:75], v[188:191]
 s_waitcnt lgkmcnt(4)
 v_exp_f32 v31, v163
 v_mfma_f32_16x16x32_bf16 v[188:191], a[208:211], v[80:83], v[188:191]
 ds_read_b128 a[200:203], v1 offset:50496
 v_add_f32 v12, v12, v33
 v_mfma_f32_16x16x32_bf16 v[188:191], a[212:215], v[84:87], v[188:191]
 v_cvt_pk_bf16_f32 v46, v32, v33
 v_add_f32 v12, v12, v34
 v_mfma_f32_16x16x32_bf16 v[192:195], a[212:215], v[116:119], v[192:195]
 ds_read_b128 a[204:207], v1 offset:50528
 v_add_f32 v12, v12, v35
 v_mfma_f32_16x16x32_bf16 v[192:195], a[208:211], v[112:115], v[192:195]
 v_exp_f32 v32, v172
 v_mfma_f32_16x16x32_bf16 v[196:199], a[208:211], a[240:243], v[196:199]
 v_exp_f32 v33, v173
 v_mfma_f32_16x16x32_bf16 v[196:199], a[212:215], a[244:247], v[196:199]
 s_waitcnt lgkmcnt(4)
 v_cvt_pk_bf16_f32 v47, v34, v35
 v_add_f32 v13, v13, v28
 v_mfma_f32_16x16x32_bf16 v[196:199], a[220:223], a[252:255], v[196:199]
 ds_read_b128 a[208:211], v1 offset:50560
 v_add_f32 v13, v13, v29
 v_mfma_f32_16x16x32_bf16 v[196:199], a[216:219], a[248:251], v[196:199]
 v_exp_f32 v34, v174
 v_mfma_f32_16x16x32_bf16 v[192:195], a[216:219], v[120:123], v[192:195]
 ds_read_b128 a[212:215], v1 offset:50592
 v_cvt_pk_bf16_f32 v48, v28, v29
 v_mfma_f32_16x16x32_bf16 v[192:195], a[220:223], v[124:127], v[192:195]
 v_exp_f32 v35, v175
 v_mfma_f32_16x16x32_bf16 v[188:191], a[220:223], v[92:95], v[188:191]
 v_add_f32 v13, v13, v30
 v_add_f32 v13, v13, v31
 v_mfma_f32_16x16x32_bf16 v[188:191], a[216:219], v[88:91], v[188:191]
 s_waitcnt lgkmcnt(4)
 v_cvt_pk_bf16_f32 v49, v30, v31
 v_add_f32 v13, v13, v32
 v_mfma_f32_16x16x32_bf16 v[200:203], a[192:195], v[64:67], v[16:19]
 ds_read_b128 a[216:219], v1 offset:50624
 v_add_f32 v13, v13, v33
 v_mfma_f32_16x16x32_bf16 v[200:203], a[196:199], v[68:71], v[200:203]
 v_exp_f32 v28, v184
 v_mfma_f32_16x16x32_bf16 v[204:207], a[196:199], v[100:103], v[20:23]
 ds_read_b128 a[220:223], v1 offset:50656
 v_cvt_pk_bf16_f32 v50, v32, v33
 v_mfma_f32_16x16x32_bf16 v[204:207], a[192:195], v[96:99], v[204:207]
 v_exp_f32 v29, v185
 v_mfma_f32_16x16x32_bf16 v[208:211], a[192:195], a[224:227], v[24:27]
 v_exp_f32 v30, v186
 v_mfma_f32_16x16x32_bf16 v[208:211], a[196:199], a[228:231], v[208:211]
 s_waitcnt lgkmcnt(4)
 v_exp_f32 v31, v187
 v_mfma_f32_16x16x32_bf16 v[208:211], a[204:207], a[236:239], v[208:211]
 ds_read_b128 a[192:195], v1 offset:50944
 v_mfma_f32_16x16x32_bf16 v[208:211], a[200:203], a[232:235], v[208:211]
 v_exp_f32 v32, v196
 v_mfma_f32_16x16x32_bf16 v[204:207], a[200:203], v[104:107], v[204:207]
 ds_read_b128 a[196:199], v1 offset:50976
 v_add_f32 v13, v13, v34
 v_mfma_f32_16x16x32_bf16 v[204:207], a[204:207], v[108:111], v[204:207]
 v_exp_f32 v33, v197
 v_mfma_f32_16x16x32_bf16 v[200:203], a[204:207], v[76:79], v[200:203]
 v_add_f32 v13, v13, v35
 v_cvt_pk_bf16_f32 v51, v34, v35
 v_mfma_f32_16x16x32_bf16 v[200:203], a[200:203], v[72:75], v[200:203]
 s_waitcnt lgkmcnt(4)
 v_exp_f32 v34, v198
 v_mfma_f32_16x16x32_bf16 v[200:203], a[208:211], v[80:83], v[200:203]
 ds_read_b128 a[200:203], v1 offset:51008
 v_add_f32 v250, v28, v29
 v_mfma_f32_16x16x32_bf16 v[200:203], a[212:215], v[84:87], v[200:203]
 v_exp_f32 v35, v199
 v_mfma_f32_16x16x32_bf16 v[204:207], a[212:215], v[116:119], v[204:207]
 ds_read_b128 a[204:207], v1 offset:51040
 v_mfma_f32_16x16x32_bf16 v[204:207], a[208:211], v[112:115], v[204:207]
 v_cvt_pk_bf16_f32 v232, v28, v29
 v_max3_f32 v14, v11, v12, v13
 v_mfma_f32_16x16x32_bf16 v[208:211], a[208:211], a[240:243], v[208:211]
 v_exp_f32 v28, v180
 v_mfma_f32_16x16x32_bf16 v[208:211], a[212:215], a[244:247], v[208:211]
 s_waitcnt lgkmcnt(4)
 v_exp_f32 v29, v181
 v_mfma_f32_16x16x32_bf16 v[208:211], a[220:223], a[252:255], v[208:211]
 ds_read_b128 a[208:211], v1 offset:51072
 v_cmp_nge_f32 vcc, s78, v14
 v_mfma_f32_16x16x32_bf16 v[208:211], a[216:219], a[248:251], v[208:211]
 v_add_f32 v250, v250, v30
 v_add_f32 v250, v250, v31
 v_mfma_f32_16x16x32_bf16 v[204:207], a[216:219], v[120:123], v[204:207]
 ds_read_b128 a[212:215], v1 offset:51104
 v_cvt_pk_bf16_f32 v233, v30, v31
 v_mfma_f32_16x16x32_bf16 v[204:207], a[220:223], v[124:127], v[204:207]
 v_exp_f32 v30, v182
 v_mfma_f32_16x16x32_bf16 v[200:203], a[220:223], v[92:95], v[200:203]
 v_exp_f32 v31, v183
 v_mfma_f32_16x16x32_bf16 v[200:203], a[216:219], v[88:91], v[200:203]
 s_waitcnt lgkmcnt(4)
 v_add_f32 v250, v250, v32
 v_mfma_f32_16x16x32_bf16 v[212:215], a[192:195], v[64:67], v[16:19]
 ds_read_b128 a[216:219], v1 offset:51136
 v_add_f32 v250, v250, v33
 v_mfma_f32_16x16x32_bf16 v[212:215], a[196:199], v[68:71], v[212:215]
 v_cvt_pk_bf16_f32 v234, v32, v33
 v_add_f32 v250, v250, v34
 v_mfma_f32_16x16x32_bf16 v[216:219], a[196:199], v[100:103], v[20:23]
 ds_read_b128 a[220:223], v1 offset:51168
 v_add_f32 v250, v250, v35
 v_mfma_f32_16x16x32_bf16 v[216:219], a[192:195], v[96:99], v[216:219]
 v_exp_f32 v32, v192
 v_mfma_f32_16x16x32_bf16 v[220:223], a[192:195], a[224:227], v[24:27]
 v_exp_f32 v33, v193
 v_mfma_f32_16x16x32_bf16 v[220:223], a[196:199], a[228:231], v[220:223]
 s_waitcnt lgkmcnt(4)
 v_cvt_pk_bf16_f32 v235, v34, v35
 v_mfma_f32_16x16x32_bf16 v[220:223], a[204:207], a[236:239], v[220:223]
 v_exp_f32 v34, v194
 v_mfma_f32_16x16x32_bf16 v[220:223], a[200:203], a[232:235], v[220:223]
 v_exp_f32 v35, v195
 v_mfma_f32_16x16x32_bf16 v[216:219], a[200:203], v[104:107], v[216:219]
 v_add_f32 v249, v28, v29
 v_cvt_pk_bf16_f32 v228, v28, v29
 v_mfma_f32_16x16x32_bf16 v[216:219], a[204:207], v[108:111], v[216:219]
 v_exp_f32 v28, v176
 v_mfma_f32_16x16x32_bf16 v[212:215], a[204:207], v[76:79], v[212:215]
 v_exp_f32 v29, v177
 v_mfma_f32_16x16x32_bf16 v[212:215], a[200:203], v[72:75], v[212:215]
 s_waitcnt lgkmcnt(2)
 v_add_f32 v249, v249, v30
 v_mfma_f32_16x16x32_bf16 v[212:215], a[208:211], v[80:83], v[212:215]
 v_add_f32 v249, v249, v31
 v_cvt_pk_bf16_f32 v229, v30, v31
 v_mfma_f32_16x16x32_bf16 v[212:215], a[212:215], v[84:87], v[212:215]
 v_exp_f32 v30, v178
 v_mfma_f32_16x16x32_bf16 v[216:219], a[212:215], v[116:119], v[216:219]
 v_exp_f32 v31, v179
 v_mfma_f32_16x16x32_bf16 v[216:219], a[208:211], v[112:115], v[216:219]
 v_add_f32 v249, v249, v32
 v_mfma_f32_16x16x32_bf16 v[220:223], a[208:211], a[240:243], v[220:223]
 v_add_f32 v249, v249, v33
 v_cvt_pk_bf16_f32 v230, v32, v33
 v_mfma_f32_16x16x32_bf16 v[220:223], a[212:215], a[244:247], v[220:223]
 s_waitcnt lgkmcnt(0)
 v_exp_f32 v32, v188
 v_mfma_f32_16x16x32_bf16 v[220:223], a[220:223], a[252:255], v[220:223]
 v_add_f32 v249, v249, v34
 v_mfma_f32_16x16x32_bf16 v[220:223], a[216:219], a[248:251], v[220:223]
 v_add_f32 v249, v249, v35
 v_cvt_pk_bf16_f32 v231, v34, v35
 v_mfma_f32_16x16x32_bf16 v[216:219], a[216:219], v[120:123], v[216:219]
 v_add_f32 v248, v28, v29
 v_mfma_f32_16x16x32_bf16 v[216:219], a[220:223], v[124:127], v[216:219]
 s_waitcnt vmcnt(9)
 s_barrier
 v_mfma_f32_16x16x32_bf16 v[212:215], a[220:223], v[92:95], v[212:215]
 ds_read_b64_tr_b16 a[192:193], v2 offset:0
 v_cvt_pk_bf16_f32 v224, v28, v29
 v_mfma_f32_16x16x32_bf16 v[212:215], a[216:219], v[88:91], v[212:215]
 s_waitcnt lgkmcnt(0)
 s_mov_b32 s90, 4
 ds_read_b64_tr_b16 a[194:195], v2 offset:512
 ds_read_b64_tr_b16 a[196:197], v2 offset:16896
 ds_read_b64_tr_b16 a[198:199], v2 offset:17408
 ds_read_b64_tr_b16 a[200:201], v2 offset:32
 ds_read_b64_tr_b16 a[202:203], v2 offset:544
 ds_read_b64_tr_b16 a[204:205], v2 offset:16928
 ds_read_b64_tr_b16 a[206:207], v2 offset:17440
 ds_read_b64_tr_b16 a[208:209], v2 offset:64
 ds_read_b64_tr_b16 a[210:211], v2 offset:576
 ds_read_b64_tr_b16 a[212:213], v2 offset:16960
 ds_read_b64_tr_b16 a[214:215], v2 offset:17472
 s_cbranch_vccnz L1_RARE0
L1_BACK4:
 s_waitcnt lgkmcnt(8)
 v_mfma_f32_16x16x32_bf16 a[0:3], a[192:195], v[52:55], a[0:3]
 ds_read_b64_tr_b16 a[216:217], v2 offset:96
 v_add_f32 v248, v248, v30
 v_mfma_f32_16x16x32_bf16 a[0:3], a[196:199], v[40:43], a[0:3]
 ds_read_b64_tr_b16 a[218:219], v2 offset:608
 v_add_f32 v248, v248, v31
 v_mfma_f32_16x16x32_bf16 a[4:7], a[196:199], v[44:47], a[4:7]
 ds_read_b64_tr_b16 a[220:221], v2 offset:16992
 v_cvt_pk_bf16_f32 v225, v30, v31
 v_mfma_f32_16x16x32_bf16 a[4:7], a[192:195], v[56:59], a[4:7]
 s_mov_b32 s82, 0x0
 s_add_u32 m0, s89, 0x20000
 ds_read_b64_tr_b16 a[222:223], v2 offset:17504
 v_mfma_f32_16x16x32_bf16 a[8:11], a[192:195], v[60:63], a[8:11]
 buffer_load_dwordx4 v6, s[60:63], s82 offen lds
 v_mfma_f32_16x16x32_bf16 a[8:11], a[196:199], v[48:51], a[8:11]
 s_waitcnt lgkmcnt(8)
 v_exp_f32 v33, v189
 v_mfma_f32_16x16x32_bf16 a[20:23], a[204:207], v[48:51], a[20:23]
 ds_read_b64_tr_b16 a[192:193], v2 offset:128
 v_add_f32 v248, v248, v32
 v_mfma_f32_16x16x32_bf16 a[20:23], a[200:203], v[60:63], a[20:23]
 ds_read_b64_tr_b16 a[194:195], v2 offset:640
 v_add_f32 v248, v248, v33
 v_mfma_f32_16x16x32_bf16 a[16:19], a[200:203], v[56:59], a[16:19]
 ds_read_b64_tr_b16 a[196:197], v2 offset:17024
 v_cvt_pk_bf16_f32 v226, v32, v33
 v_mfma_f32_16x16x32_bf16 a[16:19], a[204:207], v[44:47], a[16:19]
 ds_read_b64_tr_b16 a[198:199], v2 offset:17536
 v_mfma_f32_16x16x32_bf16 a[12:15], a[204:207], v[40:43], a[12:15]
 v_exp_f32 v34, v190
 v_mfma_f32_16x16x32_bf16 a[12:15], a[200:203], v[52:55], a[12:15]
 s_waitcnt lgkmcnt(8)
 v_exp_f32 v35, v191
 v_mfma_f32_16x16x32_bf16 a[24:27], a[208:211], v[52:55], a[24:27]
 ds_read_b64_tr_b16 a[200:201], v2 offset:160
 v_add_f32 v248, v248, v34
 v_mfma_f32_16x16x32_bf16 a[24:27], a[212:215], v[40:43], a[24:27]
 ds_read_b64_tr_b16 a[202:203], v2 offset:672
 v_add_f32 v248, v248, v35
 v_mfma_f32_16x16x32_bf16 a[28:31], a[212:215], v[44:47], a[28:31]
 ds_read_b64_tr_b16 a[204:205], v2 offset:17056
 v_cvt_pk_bf16_f32 v227, v34, v35
 v_mfma_f32_16x16x32_bf16 a[28:31], a[208:211], v[56:59], a[28:31]
 s_mov_b32 s83, 0x1c00
 s_add_u32 m0, s89, 0x20400
 ds_read_b64_tr_b16 a[206:207], v2 offset:17568
 v_mfma_f32_16x16x32_bf16 a[32:35], a[208:211], v[60:63], a[32:35]
 buffer_load_dwordx4 v6, s[60:63], s83 offen lds
 v_mfma_f32_16x16x32_bf16 a[32:35], a[212:215], v[48:51], a[32:35]
 s_waitcnt lgkmcnt(8)
 v_exp_f32 v28, v200
 v_mfma_f32_16x16x32_bf16 a[44:47], a[220:223], v[48:51], a[44:47]
 ds_read_b64_tr_b16 a[208:209], v2 offset:192
 v_add_f32 v248, v248, v28
 v_mfma_f32_16x16x32_bf16 a[44:47], a[216:219], v[60:63], a[44:47]
 ds_read_b64_tr_b16 a[210:211], v2 offset:704
 v_mfma_f32_16x16x32_bf16 a[40:43], a[216:219], v[56:59], a[40:43]
 ds_read_b64_tr_b16 a[212:213], v2 offset:17088
 v_mfma_f32_16x16x32_bf16 a[40:43], a[220:223], v[44:47], a[40:43]
 ds_read_b64_tr_b16 a[214:215], v2 offset:17600
 v_mfma_f32_16x16x32_bf16 a[36:39], a[220:223], v[40:43], a[36:39]
 s_mov_b32 s82, 0x3800
 s_add_u32 m0, s89, 0x20800
 v_exp_f32 v29, v201
 v_mfma_f32_16x16x32_bf16 a[36:39], a[216:219], v[52:55], a[36:39]
 s_waitcnt lgkmcnt(8)
 buffer_load_dwordx4 v6, s[60:63], s82 offen lds
 v_mfma_f32_16x16x32_bf16 a[48:51], a[192:195], v[52:55], a[48:51]
 ds_read_b64_tr_b16 a[216:217], v2 offset:224
 v_add_f32 v248, v248, v29
 v_mfma_f32_16x16x32_bf16 a[48:51], a[196:199], v[40:43], a[48:51]
 ds_read_b64_tr_b16 a[218:219], v2 offset:736
 v_cvt_pk_bf16_f32 v160, v28, v29
 v_mfma_f32_16x16x32_bf16 a[52:55], a[196:199], v[44:47], a[52:55]
 ds_read_b64_tr_b16 a[220:221], v2 offset:17120
 v_mfma_f32_16x16x32_bf16 a[52:55], a[192:195], v[56:59], a[52:55]
 ds_read_b64_tr_b16 a[222:223], v2 offset:17632
 v_mfma_f32_16x16x32_bf16 a[56:59], a[192:195], v[60:63], a[56:59]
 v_exp_f32 v30, v202
 v_mfma_f32_16x16x32_bf16 a[56:59], a[196:199], v[48:51], a[56:59]
 s_waitcnt lgkmcnt(8)
 v_exp_f32 v31, v203
 v_mfma_f32_16x16x32_bf16 a[68:71], a[204:207], v[48:51], a[68:71]
 ds_read_b64_tr_b16 a[192:193], v2 offset:256
 v_add_f32 v248, v248, v30
 v_mfma_f32_16x16x32_bf16 a[68:71], a[200:203], v[60:63], a[68:71]
 ds_read_b64_tr_b16 a[194:195], v2 offset:768
 v_add_f32 v248, v248, v31
 v_mfma_f32_16x16x32_bf16 a[64:67], a[200:203], v[56:59], a[64:67]
 ds_read_b64_tr_b16 a[196:197], v2 offset:17152
 v_cvt_pk_bf16_f32 v161, v30, v31
 v_mfma_f32_16x16x32_bf16 a[64:67], a[204:207], v[44:47], a[64:67]
 s_mov_b32 s83, 0x5400
 s_add_u32 m0, s89, 0x20c00
 ds_read_b64_tr_b16 a[198:199], v2 offset:17664
 v_mfma_f32_16x16x32_bf16 a[60:63], a[204:207], v[40:43], a[60:63]
 buffer_load_dwordx4 v6, s[60:63], s83 offen lds
 v_mfma_f32_16x16x32_bf16 a[60:63], a[200:203], v[52:55], a[60:63]
 s_waitcnt lgkmcnt(8)
 v_exp_f32 v32, v212
 v_mfma_f32_16x16x32_bf16 a[72:75], a[208:211], v[52:55], a[72:75]
 ds_read_b64_tr_b16 a[200:201], v2 offset:288
 v_add_f32 v248, v248, v32
 v_mfma_f32_16x16x32_bf16 a[72:75], a[212:215], v[40:43], a[72:75]
 ds_read_b64_tr_b16 a[202:203], v2 offset:800
 v_mfma_f32_16x16x32_bf16 a[76:79], a[212:215], v[44:47], a[76:79]
 ds_read_b64_tr_b16 a[204:205], v2 offset:17184
 v_mfma_f32_16x16x32_bf16 a[76:79], a[208:211], v[56:59], a[76:79]
 ds_read_b64_tr_b16 a[206:207], v2 offset:17696
 v_mfma_f32_16x16x32_bf16 a[80:83], a[208:211], v[60:63], a[80:83]
 v_exp_f32 v33, v213
 v_mfma_f32_16x16x32_bf16 a[80:83], a[212:215], v[48:51], a[80:83]
 s_waitcnt lgkmcnt(8)
 v_exp_f32 v34, v214
 v_mfma_f32_16x16x32_bf16 a[92:95], a[220:223], v[48:51], a[92:95]
 ds_read_b64_tr_b16 a[208:209], v2 offset:320
 v_add_f32 v248, v248, v33
 v_mfma_f32_16x16x32_bf16 a[92:95], a[216:219], v[60:63], a[92:95]
 ds_read_b64_tr_b16 a[210:211], v2 offset:832
 v_cvt_pk_bf16_f32 v162, v32, v33
 v_mfma_f32_16x16x32_bf16 a[88:91], a[216:219], v[56:59], a[88:91]
 ds_read_b64_tr_b16 a[212:213], v2 offset:17216
 v_add_f32 v248, v248, v34
 v_mfma_f32_16x16x32_bf16 a[88:91], a[220:223], v[44:47], a[88:91]
 s_mov_b32 s82, 0x7000
 s_add_u32 m0, s89, 0x21000
 ds_read_b64_tr_b16 a[214:215], v2 offset:17728
 v_mfma_f32_16x16x32_bf16 a[84:87], a[220:223], v[40:43], a[84:87]
 buffer_load_dwordx4 v6, s[60:63], s82 offen lds
 v_mfma_f32_16x16x32_bf16 a[84:87], a[216:219], v[52:55], a[84:87]
 s_waitcnt lgkmcnt(8)
 v_exp_f32 v35, v215
 v_mfma_f32_16x16x32_bf16 a[96:99], a[192:195], v[52:55], a[96:99]
 ds_read_b64_tr_b16 a[216:217], v2 offset:352
 v_add_f32 v248, v248, v35
 v_mfma_f32_16x16x32_bf16 a[96:99], a[196:199], v[40:43], a[96:99]
 ds_read_b64_tr_b16 a[218:219], v2 offset:864
 v_cvt_pk_bf16_f32 v163, v34, v35
 v_mfma_f32_16x16x32_bf16 a[100:103], a[196:199], v[44:47], a[100:103]
 ds_read_b64_tr_b16 a[220:221], v2 offset:17248
 v_mfma_f32_16x16x32_bf16 a[100:103], a[192:195], v[56:59], a[100:103]
 ds_read_b64_tr_b16 a[222:223], v2 offset:17760
 v_mfma_f32_16x16x32_bf16 a[104:107], a[192:195], v[60:63], a[104:107]
 v_exp_f32 v28, v204
 v_mfma_f32_16x16x32_bf16 a[104:107], a[196:199], v[48:51], a[104:107]
 s_waitcnt lgkmcnt(8)
 v_exp_f32 v29, v205
 v_mfma_f32_16x16x32_bf16 a[116:119], a[204:207], v[48:51], a[116:119]
 ds_read_b64_tr_b16 a[192:193], v2 offset:384
 v_add_f32 v249, v249, v28
 v_mfma_f32_16x16x32_bf16 a[116:119], a[200:203], v[60:63], a[116:119]
 ds_read_b64_tr_b16 a[194:195], v2 offset:896
 v_add_f32 v249, v249, v29
 v_mfma_f32_16x16x32_bf16 a[112:115], a[200:203], v[56:59], a[112:115]
 ds_read_b64_tr_b16 a[196:197], v2 offset:17280
 v_cvt_pk_bf16_f32 v164, v28, v29
 v_mfma_f32_16x16x32_bf16 a[112:115], a[204:207], v[44:47], a[112:115]
 s_mov_b32 s83, 0x8c00
 s_add_u32 m0, s89, 0x21400
 ds_read_b64_tr_b16 a[198:199], v2 offset:17792
 v_mfma_f32_16x16x32_bf16 a[108:111], a[204:207], v[40:43], a[108:111]
 buffer_load_dwordx4 v6, s[60:63], s83 offen lds
 v_mfma_f32_16x16x32_bf16 a[108:111], a[200:203], v[52:55], a[108:111]
 s_waitcnt lgkmcnt(8)
 v_exp_f32 v30, v206
 v_mfma_f32_16x16x32_bf16 a[120:123], a[208:211], v[52:55], a[120:123]
 ds_read_b64_tr_b16 a[200:201], v2 offset:416
 v_add_f32 v249, v249, v30
 v_mfma_f32_16x16x32_bf16 a[120:123], a[212:215], v[40:43], a[120:123]
 ds_read_b64_tr_b16 a[202:203], v2 offset:928
 v_mfma_f32_16x16x32_bf16 a[124:127], a[212:215], v[44:47], a[124:127]
 ds_read_b64_tr_b16 a[204:205], v2 offset:17312
 v_mfma_f32_16x16x32_bf16 a[124:127], a[208:211], v[56:59], a[124:127]
 ds_read_b64_tr_b16 a[206:207], v2 offset:17824
 v_mfma_f32_16x16x32_bf16 a[128:131], a[208:211], v[60:63], a[128:131]
 v_exp_f32 v31, v207
 v_mfma_f32_16x16x32_bf16 a[128:131], a[212:215], v[48:51], a[128:131]
 s_waitcnt lgkmcnt(8)
 v_exp_f32 v32, v216
 v_add_f32 v249, v249, v31
 v_mfma_f32_16x16x32_bf16 a[140:143], a[220:223], v[48:51], a[140:143]
 ds_read_b64_tr_b16 a[208:209], v2 offset:448
 v_cvt_pk_bf16_f32 v165, v30, v31
 v_mfma_f32_16x16x32_bf16 a[140:143], a[216:219], v[60:63], a[140:143]
 ds_read_b64_tr_b16 a[210:211], v2 offset:960
 v_add_f32 v249, v249, v32
 v_mfma_f32_16x16x32_bf16 a[136:139], a[216:219], v[56:59], a[136:139]
 ds_read_b64_tr_b16 a[212:213], v2 offset:17344
 v_mfma_f32_16x16x32_bf16 a[136:139], a[220:223], v[44:47], a[136:139]
 s_mov_b32 s82, 0xa800
 s_add_u32 m0, s89, 0x21800
 ds_read_b64_tr_b16 a[214:215], v2 offset:17856
 v_mfma_f32_16x16x32_bf16 a[132:135], a[220:223], v[40:43], a[132:135]
 buffer_load_dwordx4 v6, s[60:63], s82 offen lds
 v_mfma_f32_16x16x32_bf16 a[132:135], a[216:219], v[52:55], a[132:135]
 s_waitcnt lgkmcnt(8)
 v_exp_f32 v33, v217
 v_mfma_f32_16x16x32_bf16 a[144:147], a[192:195], v[52:55], a[144:147]
 ds_read_b64_tr_b16 a[216:217], v2 offset:480
 v_add_f32 v249, v249, v33
 v_mfma_f32_16x16x32_bf16 a[144:147], a[196:199], v[40:43], a[144:147]
 ds_read_b64_tr_b16 a[218:219], v2 offset:992
 v_cvt_pk_bf16_f32 v166, v32, v33
 v_mfma_f32_16x16x32_bf16 a[148:151], a[196:199], v[44:47], a[148:151]
 ds_read_b64_tr_b16 a[220:221], v2 offset:17376
 v_exp_f32 v34, v218
 v_mfma_f32_16x16x32_bf16 a[148:151], a[192:195], v[56:59], a[148:151]
 ds_read_b64_tr_b16 a[222:223], v2 offset:17888
 v_add_f32 v249, v249, v34
 v_mfma_f32_16x16x32_bf16 a[152:155], a[192:195], v[60:63], a[152:155]
 v_exp_f32 v35, v219
 v_mfma_f32_16x16x32_bf16 a[152:155], a[196:199], v[48:51], a[152:155]
 s_waitcnt lgkmcnt(8)
 s_mov_b32 s83, 0xc400
 s_add_u32 m0, s89, 0x21c00
 v_exp_f32 v28, v208
 v_mfma_f32_16x16x32_bf16 a[164:167], a[204:207], v[48:51], a[164:167]
 buffer_load_dwordx4 v6, s[60:63], s83 offen lds
 v_add_f32 v249, v249, v35
 v_mfma_f32_16x16x32_bf16 a[164:167], a[200:203], v[60:63], a[164:167]
 v_exp_f32 v29, v209
 v_mfma_f32_16x16x32_bf16 a[160:163], a[200:203], v[56:59], a[160:163]
 v_exp_f32 v30, v210
 v_mfma_f32_16x16x32_bf16 a[160:163], a[204:207], v[44:47], a[160:163]
 v_exp_f32 v31, v211
 v_mfma_f32_16x16x32_bf16 a[156:159], a[204:207], v[40:43], a[156:159]
 v_exp_f32 v32, v220
 v_cvt_pk_bf16_f32 v167, v34, v35
 v_mfma_f32_16x16x32_bf16 a[156:159], a[200:203], v[52:55], a[156:159]
 s_waitcnt lgkmcnt(4)
 v_exp_f32 v33, v221
 v_mfma_f32_16x16x32_bf16 a[168:171], a[208:211], v[52:55], a[168:171]
 v_exp_f32 v34, v222
 v_mfma_f32_16x16x32_bf16 a[168:171], a[212:215], v[40:43], a[168:171]
 v_exp_f32 v35, v223
 v_mfma_f32_16x16x32_bf16 a[172:175], a[212:215], v[44:47], a[172:175]
 v_add_f32 v250, v250, v28
 v_add_f32 v250, v250, v29
 v_mfma_f32_16x16x32_bf16 a[172:175], a[208:211], v[56:59], a[172:175]
 v_add_f32 v250, v250, v30
 v_add_f32 v250, v250, v31
 v_add_f32 v250, v250, v32
 v_mfma_f32_16x16x32_bf16 a[176:179], a[208:211], v[60:63], a[176:179]
 v_add_f32 v250, v250, v33
 v_add_f32 v250, v250, v34
 v_mfma_f32_16x16x32_bf16 a[176:179], a[212:215], v[48:51], a[176:179]
 s_waitcnt lgkmcnt(0)
 v_add_f32 v250, v250, v35
 v_max3_f32 v14, v248, v249, v250
 v_mfma_f32_16x16x32_bf16 a[188:191], a[220:223], v[48:51], a[188:191]
 v_cmp_nge_f32 vcc, s78, v14
 v_add_f32 v8, v8, v11
 v_mfma_f32_16x16x32_bf16 a[188:191], a[216:219], v[60:63], a[188:191]
 v_add_f32 v9, v9, v12
 v_add_f32 v10, v10, v13
 v_mfma_f32_16x16x32_bf16 a[184:187], a[216:219], v[56:59], a[184:187]
 v_cvt_pk_bf16_f32 v168, v28, v29
 v_cvt_pk_bf16_f32 v169, v30, v31
 v_cvt_pk_bf16_f32 v170, v32, v33
 v_mfma_f32_16x16x32_bf16 a[184:187], a[220:223], v[44:47], a[184:187]
 s_waitcnt vmcnt(9)
 s_barrier
 v_mfma_f32_16x16x32_bf16 a[180:183], a[220:223], v[40:43], a[180:183]
 ds_read_b64_tr_b16 a[192:193], v253 offset:0
 v_cvt_pk_bf16_f32 v171, v34, v35
 v_mfma_f32_16x16x32_bf16 a[180:183], a[216:219], v[52:55], a[180:183]
 s_waitcnt lgkmcnt(0)
 s_mov_b32 s90, 5
 ds_read_b64_tr_b16 a[194:195], v253 offset:512
 ds_read_b64_tr_b16 a[196:197], v253 offset:16896
 ds_read_b64_tr_b16 a[198:199], v253 offset:17408
 ds_read_b64_tr_b16 a[200:201], v253 offset:32
 ds_read_b64_tr_b16 a[202:203], v253 offset:544
 ds_read_b64_tr_b16 a[204:205], v253 offset:16928
 ds_read_b64_tr_b16 a[206:207], v253 offset:17440
 ds_read_b64_tr_b16 a[208:209], v253 offset:64
 ds_read_b64_tr_b16 a[210:211], v253 offset:576
 ds_read_b64_tr_b16 a[212:213], v253 offset:16960
 ds_read_b64_tr_b16 a[214:215], v253 offset:17472
 s_cbranch_vccnz L1_RARE1
L1_BACK5:
 s_waitcnt lgkmcnt(8)
 v_mfma_f32_16x16x32_bf16 a[0:3], a[192:195], v[224:227], a[0:3]
 ds_read_b64_tr_b16 a[216:217], v253 offset:96
 v_add_u32 v24, 0x20000, v36
 v_mfma_f32_16x16x32_bf16 a[0:3], a[196:199], v[160:163], a[0:3]
 ds_read_b64_tr_b16 a[218:219], v253 offset:608
 v_add_u32 v25, 0x20000, v37
 v_add_u32 v26, 0x20000, v38
 v_mfma_f32_16x16x32_bf16 a[4:7], a[196:199], v[164:167], a[4:7]
 ds_read_b64_tr_b16 a[220:221], v253 offset:16992
 v_add_u32 v27, 0x20000, v39
 v_mfma_f32_16x16x32_bf16 a[4:7], a[192:195], v[228:231], a[4:7]
 s_mov_b32 s82, 0x80
 s_add_u32 m0, s89, 0x10000
 ds_read_b64_tr_b16 a[222:223], v253 offset:17504
 v_add_u32 v236, 0x10000, v36
 v_add_u32 v237, 0x10000, v37
 v_mfma_f32_16x16x32_bf16 a[8:11], a[192:195], v[232:235], a[8:11]
 buffer_load_dwordx4 v6, s[60:63], s82 offen lds
 v_mfma_f32_16x16x32_bf16 a[8:11], a[196:199], v[168:171], a[8:11]
 s_waitcnt lgkmcnt(8)
 v_add_u32 v238, 0x10000, v38
 v_add_u32 v239, 0x10000, v39
 v_add_u32 v240, 0x38000, v5
 v_mfma_f32_16x16x32_bf16 a[20:23], a[204:207], v[168:171], a[20:23]
 ds_read_b64_tr_b16 a[192:193], v253 offset:128
 v_add_u32 v241, 0x70000, v5
 v_add_f32 v8, v8, v248
 v_mfma_f32_16x16x32_bf16 a[20:23], a[200:203], v[232:235], a[20:23]
 ds_read_b64_tr_b16 a[194:195], v253 offset:640
 v_add_f32 v9, v9, v249
 v_mfma_f32_16x16x32_bf16 a[16:19], a[200:203], v[228:231], a[16:19]
 ds_read_b64_tr_b16 a[196:197], v253 offset:17024
 v_add_f32 v10, v10, v250
 v_mfma_f32_16x16x32_bf16 a[16:19], a[204:207], v[164:167], a[16:19]
 s_mov_b32 s83, 0x1c80
 s_add_u32 m0, s89, 0x10400
 ds_read_b64_tr_b16 a[198:199], v253 offset:17536
 v_mfma_f32_16x16x32_bf16 a[12:15], a[204:207], v[160:163], a[12:15]
 buffer_load_dwordx4 v6, s[60:63], s83 offen lds
 v_mfma_f32_16x16x32_bf16 a[12:15], a[200:203], v[224:227], a[12:15]
 s_waitcnt lgkmcnt(8)
 v_mfma_f32_16x16x32_bf16 a[24:27], a[208:211], v[224:227], a[24:27]
 ds_read_b64_tr_b16 a[200:201], v253 offset:160
 v_accvgpr_read_b32 v28, a8
 v_mfma_f32_16x16x32_bf16 a[24:27], a[212:215], v[160:163], a[24:27]
 ds_read_b64_tr_b16 a[202:203], v253 offset:672
 v_accvgpr_read_b32 v29, a9
 v_accvgpr_read_b32 v30, a10
 v_mfma_f32_16x16x32_bf16 a[28:31], a[212:215], v[164:167], a[28:31]
 ds_read_b64_tr_b16 a[204:205], v253 offset:17056
 v_accvgpr_read_b32 v31, a11
 v_cvt_pk_bf16_f32 v72, v28, v29
 v_mfma_f32_16x16x32_bf16 a[28:31], a[208:211], v[228:231], a[28:31]
 s_mov_b32 s82, 0x3880
 s_add_u32 m0, s89, 0x10800
 ds_read_b64_tr_b16 a[206:207], v253 offset:17568
 v_cvt_pk_bf16_f32 v73, v30, v31
 v_mfma_f32_16x16x32_bf16 a[32:35], a[208:211], v[232:235], a[32:35]
 buffer_load_dwordx4 v6, s[60:63], s82 offen lds
 s_mov_b32 s83, 0x5480
 s_add_u32 m0, s89, 0x10c00
 v_accvgpr_read_b32 v32, a20
 v_mfma_f32_16x16x32_bf16 a[32:35], a[212:215], v[168:171], a[32:35]
 s_waitcnt lgkmcnt(8)
 buffer_load_dwordx4 v6, s[60:63], s83 offen lds
 v_accvgpr_read_b32 v33, a21
 v_mfma_f32_16x16x32_bf16 a[44:47], a[220:223], v[168:171], a[44:47]
 ds_read_b64_tr_b16 a[208:209], v253 offset:192
 v_accvgpr_read_b32 v34, a22
 v_mfma_f32_16x16x32_bf16 a[44:47], a[216:219], v[232:235], a[44:47]
 ds_read_b64_tr_b16 a[210:211], v253 offset:704
 v_accvgpr_read_b32 v35, a23
 v_cvt_pk_bf16_f32 v74, v32, v33
 v_mfma_f32_16x16x32_bf16 a[40:43], a[216:219], v[228:231], a[40:43]
 ds_read_b64_tr_b16 a[212:213], v253 offset:17088
 v_cvt_pk_bf16_f32 v75, v34, v35
 v_accvgpr_read_b32 v28, a4
 v_mfma_f32_16x16x32_bf16 a[40:43], a[220:223], v[164:167], a[40:43]
 ds_read_b64_tr_b16 a[214:215], v253 offset:17600
 v_accvgpr_read_b32 v29, a5
 v_mfma_f32_16x16x32_bf16 a[36:39], a[220:223], v[160:163], a[36:39]
 s_mov_b32 s82, 0x7080
 s_add_u32 m0, s89, 0x11000
 v_accvgpr_read_b32 v30, a6
 v_accvgpr_read_b32 v31, a7
 v_cvt_pk_bf16_f32 v68, v28, v29
 v_mfma_f32_16x16x32_bf16 a[36:39], a[216:219], v[224:227], a[36:39]
 s_waitcnt lgkmcnt(8)
 buffer_load_dwordx4 v6, s[60:63], s82 offen lds
 v_cvt_pk_bf16_f32 v69, v30, v31
 v_mfma_f32_16x16x32_bf16 a[48:51], a[192:195], v[224:227], a[48:51]
 ds_read_b64_tr_b16 a[216:217], v253 offset:224
 v_accvgpr_read_b32 v32, a16
 v_mfma_f32_16x16x32_bf16 a[48:51], a[196:199], v[160:163], a[48:51]
 ds_read_b64_tr_b16 a[218:219], v253 offset:736
 v_accvgpr_read_b32 v33, a17
 v_accvgpr_read_b32 v34, a18
 v_mfma_f32_16x16x32_bf16 a[52:55], a[196:199], v[164:167], a[52:55]
 ds_read_b64_tr_b16 a[220:221], v253 offset:17120
 v_accvgpr_read_b32 v35, a19
 v_cvt_pk_bf16_f32 v70, v32, v33
 v_mfma_f32_16x16x32_bf16 a[52:55], a[192:195], v[228:231], a[52:55]
 s_mov_b32 s83, 0x8c80
 s_add_u32 m0, s89, 0x11400
 ds_read_b64_tr_b16 a[222:223], v253 offset:17632
 v_cvt_pk_bf16_f32 v71, v34, v35
 v_mfma_f32_16x16x32_bf16 a[56:59], a[192:195], v[232:235], a[56:59]
 buffer_load_dwordx4 v6, s[60:63], s83 offen lds
 v_accvgpr_read_b32 v28, a0
 v_mfma_f32_16x16x32_bf16 a[56:59], a[196:199], v[168:171], a[56:59]
 s_waitcnt lgkmcnt(8)
 v_accvgpr_read_b32 v29, a1
 v_accvgpr_read_b32 v30, a2
 v_accvgpr_read_b32 v31, a3
 v_mfma_f32_16x16x32_bf16 a[68:71], a[204:207], v[168:171], a[68:71]
 ds_read_b64_tr_b16 a[192:193], v253 offset:256
 v_cvt_pk_bf16_f32 v64, v28, v29
 v_mfma_f32_16x16x32_bf16 a[68:71], a[200:203], v[232:235], a[68:71]
 ds_read_b64_tr_b16 a[194:195], v253 offset:768
 v_cvt_pk_bf16_f32 v65, v30, v31
 v_accvgpr_read_b32 v32, a12
 v_mfma_f32_16x16x32_bf16 a[64:67], a[200:203], v[228:231], a[64:67]
 ds_read_b64_tr_b16 a[196:197], v253 offset:17152
 v_accvgpr_read_b32 v33, a13
 v_accvgpr_read_b32 v34, a14
 v_mfma_f32_16x16x32_bf16 a[64:67], a[204:207], v[164:167], a[64:67]
 s_mov_b32 s82, 0xa880
 s_add_u32 m0, s89, 0x11800
 ds_read_b64_tr_b16 a[198:199], v253 offset:17664
 v_accvgpr_read_b32 v35, a15
 v_mfma_f32_16x16x32_bf16 a[60:63], a[204:207], v[160:163], a[60:63]
L1_PAD9:
 s_cbranch_execz L1_PRL0
 buffer_load_dwordx4 v6, s[60:63], s82 offen lds
 v_cvt_pk_bf16_f32 v66, v32, v33
 v_mfma_f32_16x16x32_bf16 a[60:63], a[200:203], v[224:227], a[60:63]
 s_waitcnt lgkmcnt(8)
 v_cvt_pk_bf16_f32 v67, v34, v35
 v_accvgpr_read_b32 v28, a32
 v_accvgpr_read_b32 v29, a33
 v_mfma_f32_16x16x32_bf16 a[72:75], a[208:211], v[224:227], a[72:75]
 ds_read_b64_tr_b16 a[200:201], v253 offset:288
 v_accvgpr_read_b32 v30, a34
 v_mfma_f32_16x16x32_bf16 a[72:75], a[212:215], v[160:163], a[72:75]
 ds_read_b64_tr_b16 a[202:203], v253 offset:800
 v_accvgpr_read_b32 v31, a35
 v_cvt_pk_bf16_f32 v84, v28, v29
 v_mfma_f32_16x16x32_bf16 a[76:79], a[212:215], v[164:167], a[76:79]
 ds_read_b64_tr_b16 a[204:205], v253 offset:17184
 v_cvt_pk_bf16_f32 v85, v30, v31
 v_accvgpr_read_b32 v32, a44
 v_mfma_f32_16x16x32_bf16 a[76:79], a[208:211], v[228:231], a[76:79]
 s_mov_b32 s83, 0xc480
 s_add_u32 m0, s89, 0x11c00
 ds_read_b64_tr_b16 a[206:207], v253 offset:17696
 v_accvgpr_read_b32 v33, a45
 v_mfma_f32_16x16x32_bf16 a[80:83], a[208:211], v[232:235], a[80:83]
 buffer_load_dwordx4 v6, s[60:63], s83 offen lds
 v_accvgpr_read_b32 v34, a46
 v_mfma_f32_16x16x32_bf16 a[80:83], a[212:215], v[168:171], a[80:83]
 s_waitcnt lgkmcnt(8)
 v_accvgpr_read_b32 v35, a47
 v_cvt_pk_bf16_f32 v86, v32, v33
 v_cvt_pk_bf16_f32 v87, v34, v35
 v_mfma_f32_16x16x32_bf16 a[92:95], a[220:223], v[168:171], a[92:95]
 ds_read_b64_tr_b16 a[208:209], v253 offset:320
 v_accvgpr_read_b32 v28, a28
 v_mfma_f32_16x16x32_bf16 a[92:95], a[216:219], v[232:235], a[92:95]
 ds_read_b64_tr_b16 a[210:211], v253 offset:832
 v_accvgpr_read_b32 v29, a29
 v_accvgpr_read_b32 v30, a30
 v_mfma_f32_16x16x32_bf16 a[88:91], a[216:219], v[228:231], a[88:91]
 ds_read_b64_tr_b16 a[212:213], v253 offset:17216
 v_accvgpr_read_b32 v31, a31
 v_cvt_pk_bf16_f32 v80, v28, v29
 v_mfma_f32_16x16x32_bf16 a[88:91], a[220:223], v[164:167], a[88:91]
 s_mov_b32 s82, 0x100
 s_add_u32 m0, s89, 0x18000
 ds_read_b64_tr_b16 a[214:215], v253 offset:17728
 v_cvt_pk_bf16_f32 v81, v30, v31
 v_mfma_f32_16x16x32_bf16 a[84:87], a[220:223], v[160:163], a[84:87]
 buffer_load_dwordx4 v6, s[60:63], s82 offen lds
 v_accvgpr_read_b32 v32, a40
 v_mfma_f32_16x16x32_bf16 a[84:87], a[216:219], v[224:227], a[84:87]
 s_waitcnt lgkmcnt(8)
 v_accvgpr_read_b32 v33, a41
 v_accvgpr_read_b32 v34, a42
 v_accvgpr_read_b32 v35, a43
 v_mfma_f32_16x16x32_bf16 a[96:99], a[192:195], v[224:227], a[96:99]
 ds_read_b64_tr_b16 a[216:217], v253 offset:352
 v_cvt_pk_bf16_f32 v82, v32, v33
 v_mfma_f32_16x16x32_bf16 a[96:99], a[196:199], v[160:163], a[96:99]
 ds_read_b64_tr_b16 a[218:219], v253 offset:864
 v_cvt_pk_bf16_f32 v83, v34, v35
 v_accvgpr_read_b32 v28, a24
 v_mfma_f32_16x16x32_bf16 a[100:103], a[196:199], v[164:167], a[100:103]
 ds_read_b64_tr_b16 a[220:221], v253 offset:17248
 v_accvgpr_read_b32 v29, a25
 v_mfma_f32_16x16x32_bf16 a[100:103], a[192:195], v[228:231], a[100:103]
 s_mov_b32 s83, 0x1d00
 s_add_u32 m0, s89, 0x18400
 ds_read_b64_tr_b16 a[222:223], v253 offset:17760
 v_accvgpr_read_b32 v30, a26
 v_accvgpr_read_b32 v31, a27
 v_mfma_f32_16x16x32_bf16 a[104:107], a[192:195], v[232:235], a[104:107]
 buffer_load_dwordx4 v6, s[60:63], s83 offen lds
 v_cvt_pk_bf16_f32 v76, v28, v29
 v_mfma_f32_16x16x32_bf16 a[104:107], a[196:199], v[168:171], a[104:107]
 s_waitcnt lgkmcnt(8)
 v_cvt_pk_bf16_f32 v77, v30, v31
 v_accvgpr_read_b32 v32, a36
 v_mfma_f32_16x16x32_bf16 a[116:119], a[204:207], v[168:171], a[116:119]
 ds_read_b64_tr_b16 a[192:193], v253 offset:384
 v_accvgpr_read_b32 v33, a37
 v_accvgpr_read_b32 v34, a38
 v_mfma_f32_16x16x32_bf16 a[116:119], a[200:203], v[232:235], a[116:119]
 ds_read_b64_tr_b16 a[194:195], v253 offset:896
 v_accvgpr_read_b32 v35, a39
 v_cvt_pk_bf16_f32 v78, v32, v33
 v_mfma_f32_16x16x32_bf16 a[112:115], a[200:203], v[228:231], a[112:115]
 ds_read_b64_tr_b16 a[196:197], v253 offset:17280
 v_cvt_pk_bf16_f32 v79, v34, v35
 v_mfma_f32_16x16x32_bf16 a[112:115], a[204:207], v[164:167], a[112:115]
 s_mov_b32 s82, 0x3900
 s_add_u32 m0, s89, 0x18800
 ds_read_b64_tr_b16 a[198:199], v253 offset:17792
 v_accvgpr_read_b32 v28, a56
 v_accvgpr_read_b32 v29, a57
 v_mfma_f32_16x16x32_bf16 a[108:111], a[204:207], v[160:163], a[108:111]
 buffer_load_dwordx4 v6, s[60:63], s82 offen lds
 v_accvgpr_read_b32 v30, a58
 v_mfma_f32_16x16x32_bf16 a[108:111], a[200:203], v[224:227], a[108:111]
 s_waitcnt lgkmcnt(8)
 v_accvgpr_read_b32 v31, a59
 v_cvt_pk_bf16_f32 v96, v28, v29
 v_mfma_f32_16x16x32_bf16 a[120:123], a[208:211], v[224:227], a[120:123]
 ds_read_b64_tr_b16 a[200:201], v253 offset:416
 v_cvt_pk_bf16_f32 v97, v30, v31
 v_accvgpr_read_b32 v32, a68
 v_mfma_f32_16x16x32_bf16 a[120:123], a[212:215], v[160:163], a[120:123]
 ds_read_b64_tr_b16 a[202:203], v253 offset:928
 v_accvgpr_read_b32 v33, a69
 v_accvgpr_read_b32 v34, a70
 v_mfma_f32_16x16x32_bf16 a[124:127], a[212:215], v[164:167], a[124:127]
 ds_read_b64_tr_b16 a[204:205], v253 offset:17312
 v_accvgpr_read_b32 v35, a71
 v_mfma_f32_16x16x32_bf16 a[124:127], a[208:211], v[228:231], a[124:127]
 s_mov_b32 s83, 0x5500
 s_add_u32 m0, s89, 0x18c00
 ds_read_b64_tr_b16 a[206:207], v253 offset:17824
 v_cvt_pk_bf16_f32 v98, v32, v33
 v_cvt_pk_bf16_f32 v99, v34, v35
 v_mfma_f32_16x16x32_bf16 a[128:131], a[208:211], v[232:235], a[128:131]
 buffer_load_dwordx4 v6, s[60:63], s83 offen lds
 v_mfma_f32_16x16x32_bf16 a[128:131], a[212:215], v[168:171], a[128:131]
 s_waitcnt lgkmcnt(8)
 v_accvgpr_read_b32 v28, a52
 v_accvgpr_read_b32 v29, a53
 v_accvgpr_read_b32 v30, a54
 v_mfma_f32_16x16x32_bf16 a[140:143], a[220:223], v[168:171], a[140:143]
 ds_read_b64_tr_b16 a[208:209], v253 offset:448
 v_accvgpr_read_b32 v31, a55
 v_cvt_pk_bf16_f32 v92, v28, v29
 v_mfma_f32_16x16x32_bf16 a[140:143], a[216:219], v[232:235], a[140:143]
 ds_read_b64_tr_b16 a[210:211], v253 offset:960
 v_cvt_pk_bf16_f32 v93, v30, v31
 v_mfma_f32_16x16x32_bf16 a[136:139], a[216:219], v[228:231], a[136:139]
 ds_read_b64_tr_b16 a[212:213], v253 offset:17344
 v_accvgpr_read_b32 v32, a64
 v_accvgpr_read_b32 v33, a65
 v_mfma_f32_16x16x32_bf16 a[136:139], a[220:223], v[164:167], a[136:139]
 s_mov_b32 s82, 0x7100
 s_add_u32 m0, s89, 0x19000
 ds_read_b64_tr_b16 a[214:215], v253 offset:17856
 v_accvgpr_read_b32 v34, a66
 v_accvgpr_read_b32 v35, a67
 v_mfma_f32_16x16x32_bf16 a[132:135], a[220:223], v[160:163], a[132:135]
 buffer_load_dwordx4 v6, s[60:63], s82 offen lds
 v_mfma_f32_16x16x32_bf16 a[132:135], a[216:219], v[224:227], a[132:135]
 s_waitcnt lgkmcnt(8)
 v_cvt_pk_bf16_f32 v94, v32, v33
 v_cvt_pk_bf16_f32 v95, v34, v35
 v_accvgpr_read_b32 v28, a48
 v_mfma_f32_16x16x32_bf16 a[144:147], a[192:195], v[224:227], a[144:147]
 ds_read_b64_tr_b16 a[216:217], v253 offset:480
 v_accvgpr_read_b32 v29, a49
 v_accvgpr_read_b32 v30, a50
 v_mfma_f32_16x16x32_bf16 a[144:147], a[196:199], v[160:163], a[144:147]
 ds_read_b64_tr_b16 a[218:219], v253 offset:992
 v_accvgpr_read_b32 v31, a51
 v_mfma_f32_16x16x32_bf16 a[148:151], a[196:199], v[164:167], a[148:151]
 ds_read_b64_tr_b16 a[220:221], v253 offset:17376
 v_cvt_pk_bf16_f32 v88, v28, v29
 v_cvt_pk_bf16_f32 v89, v30, v31
 v_mfma_f32_16x16x32_bf16 a[148:151], a[192:195], v[228:231], a[148:151]
 s_mov_b32 s83, 0x8d00
 s_add_u32 m0, s89, 0x19400
 ds_read_b64_tr_b16 a[222:223], v253 offset:17888
 v_accvgpr_read_b32 v32, a60
 v_mfma_f32_16x16x32_bf16 a[152:155], a[192:195], v[232:235], a[152:155]
 buffer_load_dwordx4 v6, s[60:63], s83 offen lds
 v_accvgpr_read_b32 v33, a61
 v_mfma_f32_16x16x32_bf16 a[152:155], a[196:199], v[168:171], a[152:155]
 s_waitcnt lgkmcnt(8)
 s_mov_b32 s82, 0xa900
 s_add_u32 m0, s89, 0x19800
 v_accvgpr_read_b32 v34, a62
 v_accvgpr_read_b32 v35, a63
 v_cvt_pk_bf16_f32 v90, v32, v33
 v_mfma_f32_16x16x32_bf16 a[164:167], a[204:207], v[168:171], a[164:167]
 buffer_load_dwordx4 v6, s[60:63], s82 offen lds
 v_mfma_f32_16x16x32_bf16 a[164:167], a[200:203], v[232:235], a[164:167]
 v_cvt_pk_bf16_f32 v91, v34, v35
 v_accvgpr_read_b32 v28, a80
 v_accvgpr_read_b32 v29, a81
 v_mfma_f32_16x16x32_bf16 a[160:163], a[200:203], v[228:231], a[160:163]
 v_accvgpr_read_b32 v30, a82
 v_accvgpr_read_b32 v31, a83
 v_mfma_f32_16x16x32_bf16 a[160:163], a[204:207], v[164:167], a[160:163]
 v_cvt_pk_bf16_f32 v108, v28, v29
 v_cvt_pk_bf16_f32 v109, v30, v31
 v_accvgpr_read_b32 v32, a92
 v_mfma_f32_16x16x32_bf16 a[156:159], a[204:207], v[160:163], a[156:159]
 s_mov_b32 s83, 0xc500
 s_add_u32 m0, s89, 0x19c00
 v_accvgpr_read_b32 v33, a93
 v_accvgpr_read_b32 v34, a94
 v_accvgpr_read_b32 v35, a95
 v_mfma_f32_16x16x32_bf16 a[156:159], a[200:203], v[224:227], a[156:159]
 s_waitcnt lgkmcnt(4)
 buffer_load_dwordx4 v6, s[60:63], s83 offen lds
 v_mfma_f32_16x16x32_bf16 a[168:171], a[208:211], v[224:227], a[168:171]
 v_cvt_pk_bf16_f32 v110, v32, v33
 v_cvt_pk_bf16_f32 v111, v34, v35
 v_accvgpr_read_b32 v28, a76
 v_mfma_f32_16x16x32_bf16 a[168:171], a[212:215], v[160:163], a[168:171]
 v_accvgpr_read_b32 v29, a77
 v_accvgpr_read_b32 v30, a78
 v_accvgpr_read_b32 v31, a79
 v_mfma_f32_16x16x32_bf16 a[172:175], a[212:215], v[164:167], a[172:175]
 v_cvt_pk_bf16_f32 v104, v28, v29
 v_cvt_pk_bf16_f32 v105, v30, v31
 v_mfma_f32_16x16x32_bf16 a[172:175], a[208:211], v[228:231], a[172:175]
 v_accvgpr_read_b32 v32, a88
 v_accvgpr_read_b32 v33, a89
 v_accvgpr_read_b32 v34, a90
 v_mfma_f32_16x16x32_bf16 a[176:179], a[208:211], v[232:235], a[176:179]
 v_accvgpr_read_b32 v35, a91
 v_cvt_pk_bf16_f32 v106, v32, v33
 v_mfma_f32_16x16x32_bf16 a[176:179], a[212:215], v[168:171], a[176:179]
 s_waitcnt lgkmcnt(0)
 v_cvt_pk_bf16_f32 v107, v34, v35
 v_accvgpr_read_b32 v28, a72
 v_accvgpr_read_b32 v29, a73
 v_mfma_f32_16x16x32_bf16 a[188:191], a[220:223], v[168:171], a[188:191]
 v_accvgpr_read_b32 v30, a74
 v_accvgpr_read_b32 v31, a75
 v_mfma_f32_16x16x32_bf16 a[188:191], a[216:219], v[232:235], a[188:191]
 v_cvt_pk_bf16_f32 v100, v28, v29
 v_cvt_pk_bf16_f32 v101, v30, v31
 v_accvgpr_read_b32 v32, a84
 v_mfma_f32_16x16x32_bf16 a[184:187], a[216:219], v[228:231], a[184:187]
 v_accvgpr_read_b32 v33, a85
 v_accvgpr_read_b32 v34, a86
 v_accvgpr_read_b32 v35, a87
 v_mfma_f32_16x16x32_bf16 a[184:187], a[220:223], v[164:167], a[184:187]
 s_waitcnt vmcnt(16)
 s_barrier
 v_mfma_f32_16x16x32_bf16 a[180:183], a[220:223], v[160:163], a[180:183]
 ds_read_b64_tr_b16 a[192:193], v24 offset:0
 v_cvt_pk_bf16_f32 v102, v32, v33
 v_mfma_f32_16x16x32_bf16 a[180:183], a[216:219], v[224:227], a[180:183]
 s_waitcnt lgkmcnt(0)
 ds_read_b64_tr_b16 a[194:195], v24 offset:2048
 ds_read_b64_tr_b16 a[196:197], v24 offset:4096
 ds_read_b64_tr_b16 a[198:199], v24 offset:6144
 ds_read_b64_tr_b16 a[200:201], v25 offset:0
 ds_read_b64_tr_b16 a[202:203], v25 offset:2048
 ds_read_b64_tr_b16 a[204:205], v25 offset:4096
 ds_read_b64_tr_b16 a[206:207], v25 offset:6144
 ds_read_b64_tr_b16 a[208:209], v26 offset:0
 ds_read_b64_tr_b16 a[210:211], v26 offset:2048
 ds_read_b64_tr_b16 a[212:213], v26 offset:4096
 ds_read_b64_tr_b16 a[214:215], v26 offset:6144
 v_cvt_pk_bf16_f32 v103, v34, v35
 s_waitcnt lgkmcnt(8)
 v_mfma_f32_16x16x32_bf16 v[176:179], a[192:195], v[64:67], 0
 ds_read_b64_tr_b16 a[216:217], v27 offset:0
 v_accvgpr_read_b32 v28, a96
 v_accvgpr_read_b32 v29, a97
 v_mfma_f32_16x16x32_bf16 v[176:179], a[196:199], v[76:79], v[176:179]
 ds_read_b64_tr_b16 a[218:219], v27 offset:2048
 v_accvgpr_read_b32 v30, a98
 v_accvgpr_read_b32 v31, a99
 v_mfma_f32_16x16x32_bf16 v[180:183], a[196:199], v[80:83], 0
 ds_read_b64_tr_b16 a[220:221], v27 offset:4096
 v_cvt_pk_bf16_f32 v112, v28, v29
 v_cvt_pk_bf16_f32 v113, v30, v31
 v_mfma_f32_16x16x32_bf16 v[180:183], a[192:195], v[68:71], v[180:183]
 s_mov_b32 s82, 0x180
 s_add_u32 m0, s89, 0x0
 ds_read_b64_tr_b16 a[222:223], v27 offset:6144
 v_accvgpr_read_b32 v32, a108
 v_accvgpr_read_b32 v33, a109
 v_mfma_f32_16x16x32_bf16 v[184:187], a[192:195], v[72:75], 0
 buffer_load_dwordx4 v6, s[60:63], s82 offen lds
 v_accvgpr_read_b32 v34, a110
 v_mfma_f32_16x16x32_bf16 v[184:187], a[196:199], v[84:87], v[184:187]
 s_waitcnt lgkmcnt(8)
 v_accvgpr_read_b32 v35, a111
 v_cvt_pk_bf16_f32 v114, v32, v33
 v_cvt_pk_bf16_f32 v115, v34, v35
 v_mfma_f32_16x16x32_bf16 v[196:199], a[204:207], v[84:87], 0
 ds_read_b64_tr_b16 a[192:193], v24 offset:8192
 v_accvgpr_read_b32 v28, a100
 v_accvgpr_read_b32 v29, a101
 v_mfma_f32_16x16x32_bf16 v[196:199], a[200:203], v[72:75], v[196:199]
 ds_read_b64_tr_b16 a[194:195], v24 offset:10240
 v_accvgpr_read_b32 v30, a102
 v_accvgpr_read_b32 v31, a103
 v_mfma_f32_16x16x32_bf16 v[192:195], a[200:203], v[68:71], 0
 ds_read_b64_tr_b16 a[196:197], v24 offset:12288
 v_cvt_pk_bf16_f32 v116, v28, v29
 v_cvt_pk_bf16_f32 v117, v30, v31
 v_mfma_f32_16x16x32_bf16 v[192:195], a[204:207], v[80:83], v[192:195]
 s_mov_b32 s83, 0x1d80
 s_add_u32 m0, s89, 0x400
 ds_read_b64_tr_b16 a[198:199], v24 offset:14336
 v_accvgpr_read_b32 v32, a112
 v_accvgpr_read_b32 v33, a113
 v_mfma_f32_16x16x32_bf16 v[188:191], a[204:207], v[76:79], 0
 buffer_load_dwordx4 v6, s[60:63], s83 offen lds
 v_accvgpr_read_b32 v34, a114
 v_mfma_f32_16x16x32_bf16 v[188:191], a[200:203], v[64:67], v[188:191]
 s_waitcnt lgkmcnt(8)
 v_accvgpr_read_b32 v35, a115
 v_cvt_pk_bf16_f32 v118, v32, v33
 v_mfma_f32_16x16x32_bf16 v[200:203], a[208:211], v[64:67], 0
 ds_read_b64_tr_b16 a[200:201], v25 offset:8192
 v_cvt_pk_bf16_f32 v119, v34, v35
 v_accvgpr_read_b32 v28, a104
 v_accvgpr_read_b32 v29, a105
 v_mfma_f32_16x16x32_bf16 v[200:203], a[212:215], v[76:79], v[200:203]
 ds_read_b64_tr_b16 a[202:203], v25 offset:10240
 v_accvgpr_read_b32 v30, a106
 v_accvgpr_read_b32 v31, a107
 v_mfma_f32_16x16x32_bf16 v[204:207], a[212:215], v[80:83], 0
 ds_read_b64_tr_b16 a[204:205], v25 offset:12288
 v_cvt_pk_bf16_f32 v120, v28, v29
 v_cvt_pk_bf16_f32 v121, v30, v31
 v_mfma_f32_16x16x32_bf16 v[204:207], a[208:211], v[68:71], v[204:207]
 s_mov_b32 s82, 0x3980
 s_add_u32 m0, s89, 0x800
 ds_read_b64_tr_b16 a[206:207], v25 offset:14336
 v_accvgpr_read_b32 v32, a116
 v_mfma_f32_16x16x32_bf16 v[208:211], a[208:211], v[72:75], 0
 buffer_load_dwordx4 v6, s[60:63], s82 offen lds
 s_mov_b32 s83, 0x5580
 s_add_u32 m0, s89, 0xc00
 v_accvgpr_read_b32 v33, a117
 v_accvgpr_read_b32 v34, a118
 v_mfma_f32_16x16x32_bf16 v[208:211], a[212:215], v[84:87], v[208:211]
 s_waitcnt lgkmcnt(8)
 buffer_load_dwordx4 v6, s[60:63], s83 offen lds
 v_accvgpr_read_b32 v35, a119
 v_mfma_f32_16x16x32_bf16 v[220:223], a[220:223], v[84:87], 0
 ds_read_b64_tr_b16 a[208:209], v26 offset:8192
 v_cvt_pk_bf16_f32 v122, v32, v33
 v_mfma_f32_16x16x32_bf16 v[220:223], a[216:219], v[72:75], v[220:223]
 ds_read_b64_tr_b16 a[210:211], v26 offset:10240
 v_cvt_pk_bf16_f32 v123, v34, v35
 v_accvgpr_read_b32 v28, a120
 v_accvgpr_read_b32 v29, a121
 v_mfma_f32_16x16x32_bf16 v[216:219], a[216:219], v[68:71], 0
 ds_read_b64_tr_b16 a[212:213], v26 offset:12288
 v_accvgpr_read_b32 v30, a122
 v_accvgpr_read_b32 v31, a123
 v_mfma_f32_16x16x32_bf16 v[216:219], a[220:223], v[80:83], v[216:219]
 ds_read_b64_tr_b16 a[214:215], v26 offset:14336
 v_cvt_pk_bf16_f32 v124, v28, v29
 v_mfma_f32_16x16x32_bf16 v[212:215], a[220:223], v[76:79], 0
 s_mov_b32 s82, 0x7180
 s_add_u32 m0, s89, 0x1000
 v_cvt_pk_bf16_f32 v125, v30, v31
 v_accvgpr_read_b32 v32, a132
 v_accvgpr_read_b32 v33, a133
 v_mfma_f32_16x16x32_bf16 v[212:215], a[216:219], v[64:67], v[212:215]
 s_waitcnt lgkmcnt(8)
 buffer_load_dwordx4 v6, s[60:63], s82 offen lds
 v_accvgpr_read_b32 v34, a134
 v_mfma_f32_16x16x32_bf16 v[176:179], a[192:195], v[88:91], v[176:179]
 ds_read_b64_tr_b16 a[216:217], v27 offset:8192
 v_accvgpr_read_b32 v35, a135
 v_cvt_pk_bf16_f32 v126, v32, v33
 v_mfma_f32_16x16x32_bf16 v[176:179], a[196:199], v[100:103], v[176:179]
 ds_read_b64_tr_b16 a[218:219], v27 offset:10240
 v_cvt_pk_bf16_f32 v127, v34, v35
 v_accvgpr_read_b32 v28, a124
 v_mfma_f32_16x16x32_bf16 v[180:183], a[196:199], v[104:107], v[180:183]
 ds_read_b64_tr_b16 a[220:221], v27 offset:12288
 v_accvgpr_read_b32 v29, a125
 v_accvgpr_read_b32 v30, a126
 v_mfma_f32_16x16x32_bf16 v[180:183], a[192:195], v[92:95], v[180:183]
 s_mov_b32 s83, 0x8d80
 s_add_u32 m0, s89, 0x1400
 ds_read_b64_tr_b16 a[222:223], v27 offset:14336
 v_accvgpr_read_b32 v31, a127
 v_cvt_pk_bf16_f32 v128, v28, v29
 v_mfma_f32_16x16x32_bf16 v[184:187], a[192:195], v[96:99], v[184:187]
 buffer_load_dwordx4 v6, s[60:63], s83 offen lds
 v_cvt_pk_bf16_f32 v129, v30, v31
 v_mfma_f32_16x16x32_bf16 v[184:187], a[196:199], v[108:111], v[184:187]
 s_waitcnt lgkmcnt(8)
 v_accvgpr_read_b32 v32, a136
 v_accvgpr_read_b32 v33, a137
 v_accvgpr_read_b32 v34, a138
 v_mfma_f32_16x16x32_bf16 v[196:199], a[204:207], v[108:111], v[196:199]
 ds_read_b64_tr_b16 a[192:193], v24 offset:16384
 v_accvgpr_read_b32 v35, a139
 v_cvt_pk_bf16_f32 v130, v32, v33
 v_mfma_f32_16x16x32_bf16 v[196:199], a[200:203], v[96:99], v[196:199]
 ds_read_b64_tr_b16 a[194:195], v24 offset:18432
 v_cvt_pk_bf16_f32 v131, v34, v35
 v_accvgpr_read_b32 v28, a128
 v_mfma_f32_16x16x32_bf16 v[192:195], a[200:203], v[92:95], v[192:195]
 ds_read_b64_tr_b16 a[196:197], v24 offset:20480
 v_accvgpr_read_b32 v29, a129
 v_accvgpr_read_b32 v30, a130
 v_mfma_f32_16x16x32_bf16 v[192:195], a[204:207], v[104:107], v[192:195]
 s_mov_b32 s82, 0xa980
 s_add_u32 m0, s89, 0x1800
 ds_read_b64_tr_b16 a[198:199], v24 offset:22528
 v_accvgpr_read_b32 v31, a131
 v_cvt_pk_bf16_f32 v132, v28, v29
 v_mfma_f32_16x16x32_bf16 v[188:191], a[204:207], v[100:103], v[188:191]
 buffer_load_dwordx4 v6, s[60:63], s82 offen lds
 v_cvt_pk_bf16_f32 v133, v30, v31
 v_mfma_f32_16x16x32_bf16 v[188:191], a[200:203], v[88:91], v[188:191]
 s_waitcnt lgkmcnt(8)
 v_accvgpr_read_b32 v32, a140
 v_accvgpr_read_b32 v33, a141
 v_accvgpr_read_b32 v34, a142
 v_mfma_f32_16x16x32_bf16 v[200:203], a[208:211], v[88:91], v[200:203]
 ds_read_b64_tr_b16 a[200:201], v25 offset:16384
 v_accvgpr_read_b32 v35, a143
 v_cvt_pk_bf16_f32 v134, v32, v33
 v_mfma_f32_16x16x32_bf16 v[200:203], a[212:215], v[100:103], v[200:203]
 ds_read_b64_tr_b16 a[202:203], v25 offset:18432
 v_cvt_pk_bf16_f32 v135, v34, v35
 v_accvgpr_read_b32 v28, a144
 v_mfma_f32_16x16x32_bf16 v[204:207], a[212:215], v[104:107], v[204:207]
 ds_read_b64_tr_b16 a[204:205], v25 offset:20480
 v_accvgpr_read_b32 v29, a145
 v_accvgpr_read_b32 v30, a146
 v_mfma_f32_16x16x32_bf16 v[204:207], a[208:211], v[92:95], v[204:207]
 s_mov_b32 s83, 0xc580
 s_add_u32 m0, s89, 0x1c00
 ds_read_b64_tr_b16 a[206:207], v25 offset:22528
 v_accvgpr_read_b32 v31, a147
 v_cvt_pk_bf16_f32 v136, v28, v29
 v_mfma_f32_16x16x32_bf16 v[208:211], a[208:211], v[96:99], v[208:211]
 buffer_load_dwordx4 v6, s[60:63], s83 offen lds
 v_cvt_pk_bf16_f32 v137, v30, v31
 v_mfma_f32_16x16x32_bf16 v[208:211], a[212:215], v[108:111], v[208:211]
 s_waitcnt lgkmcnt(8)
 v_accvgpr_read_b32 v32, a156
 v_accvgpr_read_b32 v33, a157
 v_accvgpr_read_b32 v34, a158
 v_mfma_f32_16x16x32_bf16 v[220:223], a[220:223], v[108:111], v[220:223]
 ds_read_b64_tr_b16 a[208:209], v26 offset:16384
 v_accvgpr_read_b32 v35, a159
 v_cvt_pk_bf16_f32 v138, v32, v33
 v_mfma_f32_16x16x32_bf16 v[220:223], a[216:219], v[96:99], v[220:223]
 ds_read_b64_tr_b16 a[210:211], v26 offset:18432
 v_cvt_pk_bf16_f32 v139, v34, v35
 v_accvgpr_read_b32 v28, a148
 v_mfma_f32_16x16x32_bf16 v[216:219], a[216:219], v[92:95], v[216:219]
 ds_read_b64_tr_b16 a[212:213], v26 offset:20480
 v_accvgpr_read_b32 v29, a149
 v_accvgpr_read_b32 v30, a150
 v_mfma_f32_16x16x32_bf16 v[216:219], a[220:223], v[104:107], v[216:219]
 s_mov_b32 s82, 0x200
 s_add_u32 m0, s89, 0x8000
 ds_read_b64_tr_b16 a[214:215], v26 offset:22528
 v_accvgpr_read_b32 v31, a151
 v_cvt_pk_bf16_f32 v140, v28, v29
 v_mfma_f32_16x16x32_bf16 v[212:215], a[220:223], v[100:103], v[212:215]
 buffer_load_dwordx4 v6, s[60:63], s82 offen lds
 v_cvt_pk_bf16_f32 v141, v30, v31
 v_mfma_f32_16x16x32_bf16 v[212:215], a[216:219], v[88:91], v[212:215]
 s_waitcnt lgkmcnt(8)
 v_accvgpr_read_b32 v32, a160
 v_accvgpr_read_b32 v33, a161
 v_accvgpr_read_b32 v34, a162
 v_mfma_f32_16x16x32_bf16 v[176:179], a[192:195], v[112:115], v[176:179]
 ds_read_b64_tr_b16 a[216:217], v27 offset:16384
 v_accvgpr_read_b32 v35, a163
 v_cvt_pk_bf16_f32 v142, v32, v33
 v_mfma_f32_16x16x32_bf16 v[176:179], a[196:199], v[124:127], v[176:179]
 ds_read_b64_tr_b16 a[218:219], v27 offset:18432
 v_cvt_pk_bf16_f32 v143, v34, v35
 v_accvgpr_read_b32 v28, a152
 v_mfma_f32_16x16x32_bf16 v[180:183], a[196:199], v[128:131], v[180:183]
 ds_read_b64_tr_b16 a[220:221], v27 offset:20480
 v_accvgpr_read_b32 v29, a153
 v_accvgpr_read_b32 v30, a154
 v_mfma_f32_16x16x32_bf16 v[180:183], a[192:195], v[116:119], v[180:183]
 s_mov_b32 s83, 0x1e00
 s_add_u32 m0, s89, 0x8400
 ds_read_b64_tr_b16 a[222:223], v27 offset:22528
 v_accvgpr_read_b32 v31, a155
 v_cvt_pk_bf16_f32 v144, v28, v29
 v_mfma_f32_16x16x32_bf16 v[184:187], a[192:195], v[120:123], v[184:187]
 buffer_load_dwordx4 v6, s[60:63], s83 offen lds
 v_cvt_pk_bf16_f32 v145, v30, v31
 v_mfma_f32_16x16x32_bf16 v[184:187], a[196:199], v[132:135], v[184:187]
 s_waitcnt lgkmcnt(8)
 v_accvgpr_read_b32 v32, a164
 v_accvgpr_read_b32 v33, a165
 v_accvgpr_read_b32 v34, a166
 v_mfma_f32_16x16x32_bf16 v[196:199], a[204:207], v[132:135], v[196:199]
 ds_read_b64_tr_b16 a[192:193], v24 offset:24576
 v_accvgpr_read_b32 v35, a167
 v_cvt_pk_bf16_f32 v146, v32, v33
 v_mfma_f32_16x16x32_bf16 v[196:199], a[200:203], v[120:123], v[196:199]
 ds_read_b64_tr_b16 a[194:195], v24 offset:26624
 v_cvt_pk_bf16_f32 v147, v34, v35
 v_mfma_f32_16x16x32_bf16 v[192:195], a[200:203], v[116:119], v[192:195]
 ds_read_b64_tr_b16 a[196:197], v24 offset:28672
 v_accvgpr_read_b32 v28, a168
 v_accvgpr_read_b32 v29, a169
 v_accvgpr_read_b32 v30, a170
 v_mfma_f32_16x16x32_bf16 v[192:195], a[204:207], v[128:131], v[192:195]
 s_mov_b32 s82, 0x3a00
 s_add_u32 m0, s89, 0x8800
 ds_read_b64_tr_b16 a[198:199], v24 offset:30720
 v_accvgpr_read_b32 v31, a171
 v_mfma_f32_16x16x32_bf16 v[188:191], a[204:207], v[124:127], v[188:191]
 buffer_load_dwordx4 v6, s[60:63], s82 offen lds
 v_cvt_pk_bf16_f32 v148, v28, v29
 v_cvt_pk_bf16_f32 v149, v30, v31
 v_mfma_f32_16x16x32_bf16 v[188:191], a[200:203], v[112:115], v[188:191]
 s_waitcnt lgkmcnt(8)
 v_accvgpr_read_b32 v32, a180
 v_accvgpr_read_b32 v33, a181
 v_mfma_f32_16x16x32_bf16 v[200:203], a[208:211], v[112:115], v[200:203]
 ds_read_b64_tr_b16 a[200:201], v25 offset:24576
 v_accvgpr_read_b32 v34, a182
 v_accvgpr_read_b32 v35, a183
 v_cvt_pk_bf16_f32 v150, v32, v33
 v_mfma_f32_16x16x32_bf16 v[200:203], a[212:215], v[124:127], v[200:203]
L1_PAD10:
 s_cbranch_execz L1_PRL0
 ds_read_b64_tr_b16 a[202:203], v25 offset:26624
 v_cvt_pk_bf16_f32 v151, v34, v35
 v_mfma_f32_16x16x32_bf16 v[204:207], a[212:215], v[128:131], v[204:207]
 ds_read_b64_tr_b16 a[204:205], v25 offset:28672
 v_accvgpr_read_b32 v28, a172
 v_accvgpr_read_b32 v29, a173
 v_mfma_f32_16x16x32_bf16 v[204:207], a[208:211], v[116:119], v[204:207]
 s_mov_b32 s83, 0x5600
 s_add_u32 m0, s89, 0x8c00
 ds_read_b64_tr_b16 a[206:207], v25 offset:30720
 v_accvgpr_read_b32 v30, a174
 v_accvgpr_read_b32 v31, a175
 v_cvt_pk_bf16_f32 v152, v28, v29
 v_mfma_f32_16x16x32_bf16 v[208:211], a[208:211], v[120:123], v[208:211]
 buffer_load_dwordx4 v6, s[60:63], s83 offen lds
 v_mfma_f32_16x16x32_bf16 v[208:211], a[212:215], v[132:135], v[208:211]
 s_waitcnt lgkmcnt(8)
 v_cvt_pk_bf16_f32 v153, v30, v31
 v_accvgpr_read_b32 v32, a184
 v_accvgpr_read_b32 v33, a185
 v_mfma_f32_16x16x32_bf16 v[220:223], a[220:223], v[132:135], v[220:223]
 ds_read_b64_tr_b16 a[208:209], v26 offset:24576
 v_accvgpr_read_b32 v34, a186
 v_accvgpr_read_b32 v35, a187
 v_cvt_pk_bf16_f32 v154, v32, v33
 v_mfma_f32_16x16x32_bf16 v[220:223], a[216:219], v[120:123], v[220:223]
 ds_read_b64_tr_b16 a[210:211], v26 offset:26624
 v_cvt_pk_bf16_f32 v155, v34, v35
 v_mfma_f32_16x16x32_bf16 v[216:219], a[216:219], v[116:119], v[216:219]
 ds_read_b64_tr_b16 a[212:213], v26 offset:28672
 v_accvgpr_read_b32 v28, a176
 v_accvgpr_read_b32 v29, a177
 v_mfma_f32_16x16x32_bf16 v[216:219], a[220:223], v[128:131], v[216:219]
 s_mov_b32 s82, 0x7200
 s_add_u32 m0, s89, 0x9000
 ds_read_b64_tr_b16 a[214:215], v26 offset:30720
 v_accvgpr_read_b32 v30, a178
 v_accvgpr_read_b32 v31, a179
 v_mfma_f32_16x16x32_bf16 v[212:215], a[220:223], v[124:127], v[212:215]
 buffer_load_dwordx4 v6, s[60:63], s82 offen lds
 v_cvt_pk_bf16_f32 v156, v28, v29
 v_mfma_f32_16x16x32_bf16 v[212:215], a[216:219], v[112:115], v[212:215]
 s_waitcnt lgkmcnt(8)
 v_cvt_pk_bf16_f32 v157, v30, v31
 v_accvgpr_read_b32 v32, a188
 v_accvgpr_read_b32 v33, a189
 v_mfma_f32_16x16x32_bf16 v[176:179], a[192:195], v[136:139], v[176:179]
 ds_read_b64_tr_b16 a[216:217], v27 offset:24576
 v_accvgpr_read_b32 v34, a190
 v_accvgpr_read_b32 v35, a191
 v_mfma_f32_16x16x32_bf16 v[176:179], a[196:199], v[148:151], v[176:179]
 ds_read_b64_tr_b16 a[218:219], v27 offset:26624
 v_cvt_pk_bf16_f32 v158, v32, v33
 v_cvt_pk_bf16_f32 v159, v34, v35
 v_mfma_f32_16x16x32_bf16 v[180:183], a[196:199], v[152:155], v[180:183]
 ds_read_b64_tr_b16 a[220:221], v27 offset:28672
 v_mfma_f32_16x16x32_bf16 v[180:183], a[192:195], v[140:143], v[180:183]
 s_mov_b32 s83, 0x8e00
 s_add_u32 m0, s89, 0x9400
 ds_read_b64_tr_b16 a[222:223], v27 offset:30720
 v_mfma_f32_16x16x32_bf16 v[184:187], a[192:195], v[144:147], v[184:187]
 buffer_load_dwordx4 v6, s[60:63], s83 offen lds
 v_mfma_f32_16x16x32_bf16 v[184:187], a[196:199], v[156:159], v[184:187]
 s_waitcnt lgkmcnt(8)
 s_mov_b32 s82, 0xaa00
 s_add_u32 m0, s89, 0x9800
 v_mfma_f32_16x16x32_bf16 v[196:199], a[204:207], v[156:159], v[196:199]
 buffer_load_dwordx4 v6, s[60:63], s82 offen lds
 v_mfma_f32_16x16x32_bf16 v[196:199], a[200:203], v[144:147], v[196:199]
 s_waitcnt vmcnt(23) lgkmcnt(0)
 s_barrier
 v_mfma_f32_16x16x32_bf16 v[192:195], a[200:203], v[140:143], v[192:195]
 ds_read_b64_tr_b16 a[192:193], v236 offset:0
 v_mfma_f32_16x16x32_bf16 v[192:195], a[204:207], v[152:155], v[192:195]
 ds_read_b64_tr_b16 a[194:195], v236 offset:2048
 v_mfma_f32_16x16x32_bf16 v[188:191], a[204:207], v[148:151], v[188:191]
 ds_read_b64_tr_b16 a[196:197], v236 offset:4096
 v_mfma_f32_16x16x32_bf16 v[188:191], a[200:203], v[136:139], v[188:191]
 ds_read_b64_tr_b16 a[198:199], v236 offset:6144
 v_mfma_f32_16x16x32_bf16 v[200:203], a[208:211], v[136:139], v[200:203]
 ds_read_b64_tr_b16 a[200:201], v236 offset:8192
 v_mfma_f32_16x16x32_bf16 v[200:203], a[212:215], v[148:151], v[200:203]
 ds_read_b64_tr_b16 a[202:203], v236 offset:10240
 v_mfma_f32_16x16x32_bf16 v[204:207], a[212:215], v[152:155], v[204:207]
 ds_read_b64_tr_b16 a[204:205], v236 offset:12288
 v_mfma_f32_16x16x32_bf16 v[204:207], a[208:211], v[140:143], v[204:207]
 s_mov_b32 s83, 0xc600
 s_add_u32 m0, s89, 0x9c00
 ds_read_b64_tr_b16 a[206:207], v236 offset:14336
 v_mfma_f32_16x16x32_bf16 v[208:211], a[208:211], v[144:147], v[208:211]
 buffer_load_dwordx4 v6, s[60:63], s83 offen lds
 v_mfma_f32_16x16x32_bf16 v[208:211], a[212:215], v[156:159], v[208:211]
 v_mfma_f32_16x16x32_bf16 v[220:223], a[220:223], v[156:159], v[220:223]
 ds_read_b64_tr_b16 a[208:209], v236 offset:16384
 v_mfma_f32_16x16x32_bf16 v[220:223], a[216:219], v[144:147], v[220:223]
 ds_read_b64_tr_b16 a[210:211], v236 offset:18432
 v_mfma_f32_16x16x32_bf16 v[216:219], a[216:219], v[140:143], v[216:219]
 ds_read_b64_tr_b16 a[212:213], v236 offset:20480
 v_mfma_f32_16x16x32_bf16 v[216:219], a[220:223], v[152:155], v[216:219]
 ds_read_b64_tr_b16 a[214:215], v236 offset:22528
 v_mfma_f32_16x16x32_bf16 v[212:215], a[220:223], v[148:151], v[212:215]
 v_mfma_f32_16x16x32_bf16 v[212:215], a[216:219], v[136:139], v[212:215]
 s_waitcnt lgkmcnt(8)
 v_mfma_f32_16x16x32_bf16 v[160:163], a[192:195], v[64:67], 0
 ds_read_b64_tr_b16 a[216:217], v236 offset:24576
 v_mov_b32 v11, v8
 v_mfma_f32_16x16x32_bf16 v[160:163], a[196:199], v[76:79], v[160:163]
 ds_read_b64_tr_b16 a[218:219], v236 offset:26624
 v_mov_b32 v12, v9
 v_mfma_f32_16x16x32_bf16 v[164:167], a[196:199], v[80:83], 0
 ds_read_b64_tr_b16 a[220:221], v236 offset:28672
 v_mov_b32 v13, v10
 v_mfma_f32_16x16x32_bf16 v[164:167], a[192:195], v[68:71], v[164:167]
 s_mov_b32 s82, 0x280
 s_add_u32 m0, s89, 0x20000
 ds_read_b64_tr_b16 a[222:223], v236 offset:30720
 v_permlane32_swap_b32 v8, v11
 v_mfma_f32_16x16x32_bf16 v[168:171], a[192:195], v[72:75], 0
 buffer_load_dwordx4 v6, s[60:63], s82 offen lds
 v_mfma_f32_16x16x32_bf16 v[168:171], a[196:199], v[84:87], v[168:171]
 s_waitcnt lgkmcnt(8)
 v_permlane32_swap_b32 v9, v12
 v_permlane32_swap_b32 v10, v13
 v_mfma_f32_16x16x32_bf16 v[168:171], a[204:207], v[108:111], v[168:171]
 ds_read_b64_tr_b16 a[192:193], v237 offset:0
 v_add_f32 v8, v8, v11
 v_mfma_f32_16x16x32_bf16 v[168:171], a[200:203], v[96:99], v[168:171]
 ds_read_b64_tr_b16 a[194:195], v237 offset:2048
 v_add_f32 v9, v9, v12
 s_mov_b32 s87, 0x0
 v_mfma_f32_16x16x32_bf16 v[164:167], a[200:203], v[92:95], v[164:167]
 ds_read_b64_tr_b16 a[196:197], v237 offset:4096
 v_add_f32 v10, v10, v13
 v_mfma_f32_16x16x32_bf16 v[164:167], a[204:207], v[104:107], v[164:167]
 ds_read_b64_tr_b16 a[198:199], v237 offset:6144
 v_mov_b32 v11, v8
 v_mfma_f32_16x16x32_bf16 v[160:163], a[204:207], v[100:103], v[160:163]
 v_mov_b32 v12, v9
 v_mov_b32 v13, v10
 v_mfma_f32_16x16x32_bf16 v[160:163], a[200:203], v[88:91], v[160:163]
 s_waitcnt lgkmcnt(8)
 v_permlane16_swap_b32 v8, v11
 v_add_f32 v8, v8, v11
 v_mfma_f32_16x16x32_bf16 v[160:163], a[208:211], v[112:115], v[160:163]
 ds_read_b64_tr_b16 a[200:201], v237 offset:8192
 v_permlane16_swap_b32 v9, v12
 v_mfma_f32_16x16x32_bf16 v[160:163], a[212:215], v[124:127], v[160:163]
 ds_read_b64_tr_b16 a[202:203], v237 offset:10240
 v_permlane16_swap_b32 v10, v13
 v_mfma_f32_16x16x32_bf16 v[164:167], a[212:215], v[128:131], v[164:167]
 ds_read_b64_tr_b16 a[204:205], v237 offset:12288
 v_add_f32 v9, v9, v12
 v_mfma_f32_16x16x32_bf16 v[164:167], a[208:211], v[116:119], v[164:167]
 s_mov_b32 s83, 0x1e80
 s_add_u32 m0, s89, 0x20400
 ds_read_b64_tr_b16 a[206:207], v237 offset:14336
 v_add_f32 v10, v10, v13
 v_mfma_f32_16x16x32_bf16 v[168:171], a[208:211], v[120:123], v[168:171]
 buffer_load_dwordx4 v6, s[60:63], s83 offen lds
 v_mfma_f32_16x16x32_bf16 v[168:171], a[212:215], v[132:135], v[168:171]
 s_waitcnt lgkmcnt(8)
 v_rcp_f32 v8, v8
 v_mfma_f32_16x16x32_bf16 v[168:171], a[220:223], v[156:159], v[168:171]
 ds_read_b64_tr_b16 a[208:209], v237 offset:16384
 v_mfma_f32_16x16x32_bf16 v[168:171], a[216:219], v[144:147], v[168:171]
 ds_read_b64_tr_b16 a[210:211], v237 offset:18432
 v_mfma_f32_16x16x32_bf16 v[164:167], a[216:219], v[140:143], v[164:167]
 ds_read_b64_tr_b16 a[212:213], v237 offset:20480
 v_mfma_f32_16x16x32_bf16 v[164:167], a[220:223], v[152:155], v[164:167]
 ds_read_b64_tr_b16 a[214:215], v237 offset:22528
 v_mfma_f32_16x16x32_bf16 v[160:163], a[220:223], v[148:151], v[160:163]
 s_mov_b32 s82, 0x3a80
 s_add_u32 m0, s89, 0x20800
 v_rcp_f32 v9, v9
 v_mfma_f32_16x16x32_bf16 v[160:163], a[216:219], v[136:139], v[160:163]
 s_waitcnt lgkmcnt(8)
 buffer_load_dwordx4 v6, s[60:63], s82 offen lds
 v_mfma_f32_16x16x32_bf16 v[172:175], a[192:195], v[64:67], 0
 ds_read_b64_tr_b16 a[216:217], v237 offset:24576
 v_rcp_f32 v10, v10
 v_mfma_f32_16x16x32_bf16 v[172:175], a[196:199], v[76:79], v[172:175]
 ds_read_b64_tr_b16 a[218:219], v237 offset:26624
 v_mul_f32 v184, v184, v10
 v_mfma_f32_16x16x32_bf16 v[224:227], a[196:199], v[80:83], 0
 ds_read_b64_tr_b16 a[220:221], v237 offset:28672
 v_mul_f32 v185, v185, v10
 v_mfma_f32_16x16x32_bf16 v[224:227], a[192:195], v[68:71], v[224:227]
 ds_read_b64_tr_b16 a[222:223], v237 offset:30720
 v_mul_f32 v186, v186, v10
 v_mfma_f32_16x16x32_bf16 v[228:231], a[192:195], v[72:75], 0
 v_mul_f32 v187, v187, v10
 v_mul_f32 v196, v196, v10
 v_mfma_f32_16x16x32_bf16 v[228:231], a[196:199], v[84:87], v[228:231]
 s_waitcnt lgkmcnt(8)
 v_mul_f32 v197, v197, v10
 v_mul_f32 v198, v198, v10
 v_mfma_f32_16x16x32_bf16 v[228:231], a[204:207], v[108:111], v[228:231]
 ds_read_b64_tr_b16 a[192:193], v238 offset:0
 v_mul_f32 v199, v199, v10
 v_mfma_f32_16x16x32_bf16 v[228:231], a[200:203], v[96:99], v[228:231]
 ds_read_b64_tr_b16 a[194:195], v238 offset:2048
 v_cvt_pk_bf16_f32 v184, v184, v185
 v_mfma_f32_16x16x32_bf16 v[224:227], a[200:203], v[92:95], v[224:227]
 ds_read_b64_tr_b16 a[196:197], v238 offset:4096
 v_cvt_pk_bf16_f32 v185, v186, v187
 v_mfma_f32_16x16x32_bf16 v[224:227], a[204:207], v[104:107], v[224:227]
 s_mov_b32 s83, 0x5680
 s_add_u32 m0, s89, 0x20c00
 ds_read_b64_tr_b16 a[198:199], v238 offset:6144
 v_cvt_pk_bf16_f32 v186, v196, v197
 v_mfma_f32_16x16x32_bf16 v[172:175], a[204:207], v[100:103], v[172:175]
 buffer_load_dwordx4 v6, s[60:63], s83 offen lds
 v_mfma_f32_16x16x32_bf16 v[172:175], a[200:203], v[88:91], v[172:175]
 s_waitcnt lgkmcnt(8)
 v_cvt_pk_bf16_f32 v187, v198, v199
 v_mul_f32 v180, v180, v9
 v_mfma_f32_16x16x32_bf16 v[172:175], a[208:211], v[112:115], v[172:175]
 ds_read_b64_tr_b16 a[200:201], v238 offset:8192
 v_mul_f32 v181, v181, v9
 v_mfma_f32_16x16x32_bf16 v[172:175], a[212:215], v[124:127], v[172:175]
 ds_read_b64_tr_b16 a[202:203], v238 offset:10240
 v_mul_f32 v182, v182, v9
 v_mfma_f32_16x16x32_bf16 v[224:227], a[212:215], v[128:131], v[224:227]
 ds_read_b64_tr_b16 a[204:205], v238 offset:12288
 v_mul_f32 v183, v183, v9
 v_mfma_f32_16x16x32_bf16 v[224:227], a[208:211], v[116:119], v[224:227]
 ds_read_b64_tr_b16 a[206:207], v238 offset:14336
 v_mul_f32 v192, v192, v9
 v_mfma_f32_16x16x32_bf16 v[228:231], a[208:211], v[120:123], v[228:231]
 buffer_store_dwordx4 v[184:187], v241, s[64:67], s87 offen sc0 sc1
 v_mul_f32 v193, v193, v9
 v_mfma_f32_16x16x32_bf16 v[228:231], a[212:215], v[132:135], v[228:231]
 s_waitcnt lgkmcnt(8)
 v_mul_f32 v194, v194, v9
 v_mul_f32 v195, v195, v9
 v_mfma_f32_16x16x32_bf16 v[228:231], a[220:223], v[156:159], v[228:231]
 ds_read_b64_tr_b16 a[208:209], v238 offset:16384
 v_cvt_pk_bf16_f32 v180, v180, v181
 v_mfma_f32_16x16x32_bf16 v[228:231], a[216:219], v[144:147], v[228:231]
 ds_read_b64_tr_b16 a[210:211], v238 offset:18432
 v_cvt_pk_bf16_f32 v181, v182, v183
 v_mfma_f32_16x16x32_bf16 v[224:227], a[216:219], v[140:143], v[224:227]
 ds_read_b64_tr_b16 a[212:213], v238 offset:20480
 v_cvt_pk_bf16_f32 v182, v192, v193
 v_mfma_f32_16x16x32_bf16 v[224:227], a[220:223], v[152:155], v[224:227]
 s_mov_b32 s82, 0x7280
 s_add_u32 m0, s89, 0x21000
 ds_read_b64_tr_b16 a[214:215], v238 offset:22528
 v_cvt_pk_bf16_f32 v183, v194, v195
 v_mfma_f32_16x16x32_bf16 v[172:175], a[220:223], v[148:151], v[172:175]
 buffer_load_dwordx4 v6, s[60:63], s82 offen lds
 v_mfma_f32_16x16x32_bf16 v[172:175], a[216:219], v[136:139], v[172:175]
 s_waitcnt lgkmcnt(8)
 buffer_store_dwordx4 v[180:183], v240, s[64:67], s87 offen sc0 sc1
 s_mov_b32 s88, 0x4000
 v_mfma_f32_16x16x32_bf16 v[232:235], a[192:195], v[64:67], 0
 ds_read_b64_tr_b16 a[216:217], v238 offset:24576
 v_mul_f32 v176, v176, v8
 v_mfma_f32_16x16x32_bf16 v[232:235], a[196:199], v[76:79], v[232:235]
 ds_read_b64_tr_b16 a[218:219], v238 offset:26624
 v_mul_f32 v177, v177, v8
 v_mfma_f32_16x16x32_bf16 v[244:247], a[196:199], v[80:83], 0
 ds_read_b64_tr_b16 a[220:221], v238 offset:28672
 v_mul_f32 v178, v178, v8
 v_mfma_f32_16x16x32_bf16 v[244:247], a[192:195], v[68:71], v[244:247]
 ds_read_b64_tr_b16 a[222:223], v238 offset:30720
 v_mul_f32 v179, v179, v8
 v_mfma_f32_16x16x32_bf16 v[248:251], a[192:195], v[72:75], 0
 v_mul_f32 v188, v188, v8
 v_mul_f32 v189, v189, v8
 v_mfma_f32_16x16x32_bf16 v[248:251], a[196:199], v[84:87], v[248:251]
 s_waitcnt lgkmcnt(8)
 v_mul_f32 v190, v190, v8
 v_mul_f32 v191, v191, v8
 v_mfma_f32_16x16x32_bf16 v[248:251], a[204:207], v[108:111], v[248:251]
 ds_read_b64_tr_b16 a[192:193], v239 offset:0
 v_cvt_pk_bf16_f32 v176, v176, v177
 v_mfma_f32_16x16x32_bf16 v[248:251], a[200:203], v[96:99], v[248:251]
 ds_read_b64_tr_b16 a[194:195], v239 offset:2048
 v_cvt_pk_bf16_f32 v177, v178, v179
 v_mfma_f32_16x16x32_bf16 v[244:247], a[200:203], v[92:95], v[244:247]
 ds_read_b64_tr_b16 a[196:197], v239 offset:4096
 v_cvt_pk_bf16_f32 v178, v188, v189
 v_mfma_f32_16x16x32_bf16 v[244:247], a[204:207], v[104:107], v[244:247]
 s_mov_b32 s83, 0x8e80
 s_add_u32 m0, s89, 0x21400
 ds_read_b64_tr_b16 a[198:199], v239 offset:6144
 v_cvt_pk_bf16_f32 v179, v190, v191
 v_mfma_f32_16x16x32_bf16 v[232:235], a[204:207], v[100:103], v[232:235]
 buffer_load_dwordx4 v6, s[60:63], s83 offen lds
 v_mfma_f32_16x16x32_bf16 v[232:235], a[200:203], v[88:91], v[232:235]
 s_waitcnt lgkmcnt(8)
 buffer_store_dwordx4 v[176:179], v5, s[64:67], s87 offen sc0 sc1
 v_mfma_f32_16x16x32_bf16 v[232:235], a[208:211], v[112:115], v[232:235]
 ds_read_b64_tr_b16 a[200:201], v239 offset:8192
 v_mul_f32 v208, v208, v10
 v_mfma_f32_16x16x32_bf16 v[232:235], a[212:215], v[124:127], v[232:235]
 ds_read_b64_tr_b16 a[202:203], v239 offset:10240
 v_mul_f32 v209, v209, v10
 v_mfma_f32_16x16x32_bf16 v[244:247], a[212:215], v[128:131], v[244:247]
 ds_read_b64_tr_b16 a[204:205], v239 offset:12288
 v_mul_f32 v210, v210, v10
 v_mfma_f32_16x16x32_bf16 v[244:247], a[208:211], v[116:119], v[244:247]
 ds_read_b64_tr_b16 a[206:207], v239 offset:14336
 v_mul_f32 v211, v211, v10
 v_mfma_f32_16x16x32_bf16 v[248:251], a[208:211], v[120:123], v[248:251]
 v_mul_f32 v220, v220, v10
 v_mul_f32 v221, v221, v10
 v_mfma_f32_16x16x32_bf16 v[248:251], a[212:215], v[132:135], v[248:251]
 s_waitcnt lgkmcnt(8)
 v_mul_f32 v222, v222, v10
 v_mul_f32 v223, v223, v10
 v_mfma_f32_16x16x32_bf16 v[248:251], a[220:223], v[156:159], v[248:251]
 ds_read_b64_tr_b16 a[208:209], v239 offset:16384
 v_cvt_pk_bf16_f32 v208, v208, v209
 v_mfma_f32_16x16x32_bf16 v[248:251], a[216:219], v[144:147], v[248:251]
 ds_read_b64_tr_b16 a[210:211], v239 offset:18432
 v_cvt_pk_bf16_f32 v209, v210, v211
 v_mfma_f32_16x16x32_bf16 v[244:247], a[216:219], v[140:143], v[244:247]
 ds_read_b64_tr_b16 a[212:213], v239 offset:20480
 v_cvt_pk_bf16_f32 v210, v220, v221
 v_cvt_pk_bf16_f32 v211, v222, v223
 v_mfma_f32_16x16x32_bf16 v[244:247], a[220:223], v[152:155], v[244:247]
 s_mov_b32 s82, 0xaa80
 s_add_u32 m0, s89, 0x21800
 ds_read_b64_tr_b16 a[214:215], v239 offset:22528
 v_mul_f32 v204, v204, v9
 v_mfma_f32_16x16x32_bf16 v[232:235], a[220:223], v[148:151], v[232:235]
 buffer_load_dwordx4 v6, s[60:63], s82 offen lds
 v_mfma_f32_16x16x32_bf16 v[232:235], a[216:219], v[136:139], v[232:235]
 s_waitcnt lgkmcnt(8)
 buffer_store_dwordx4 v[208:211], v241, s[64:67], s88 offen sc0 sc1
 v_mfma_f32_16x16x32_bf16 v[252:255], a[192:195], v[64:67], 0
 ds_read_b64_tr_b16 a[216:217], v239 offset:24576
 v_mul_f32 v205, v205, v9
 v_mfma_f32_16x16x32_bf16 v[252:255], a[196:199], v[76:79], v[252:255]
 ds_read_b64_tr_b16 a[218:219], v239 offset:26624
 v_mul_f32 v206, v206, v9
 v_mfma_f32_16x16x32_bf16 v[16:19], a[196:199], v[80:83], 0
 ds_read_b64_tr_b16 a[220:221], v239 offset:28672
 v_mul_f32 v207, v207, v9
 v_mfma_f32_16x16x32_bf16 v[16:19], a[192:195], v[68:71], v[16:19]
 ds_read_b64_tr_b16 a[222:223], v239 offset:30720
 v_mul_f32 v216, v216, v9
 v_mfma_f32_16x16x32_bf16 v[20:23], a[192:195], v[72:75], 0
 v_mul_f32 v217, v217, v9
 v_mul_f32 v218, v218, v9
 v_mfma_f32_16x16x32_bf16 v[20:23], a[196:199], v[84:87], v[20:23]
 s_waitcnt lgkmcnt(8)
 s_mov_b32 s83, 0xc680
 s_add_u32 m0, s89, 0x21c00
 v_mul_f32 v219, v219, v9
 v_cvt_pk_bf16_f32 v204, v204, v205
 v_mfma_f32_16x16x32_bf16 v[20:23], a[204:207], v[108:111], v[20:23]
 buffer_load_dwordx4 v6, s[60:63], s83 offen lds
 v_mfma_f32_16x16x32_bf16 v[20:23], a[200:203], v[96:99], v[20:23]
 s_waitcnt vmcnt(28) lgkmcnt(0)
 s_barrier
 v_mfma_f32_16x16x32_bf16 v[16:19], a[200:203], v[92:95], v[16:19]
 ds_read_b64_tr_b16 a[192:193], v236 offset:32768
 v_cvt_pk_bf16_f32 v205, v206, v207
 v_mfma_f32_16x16x32_bf16 v[16:19], a[204:207], v[104:107], v[16:19]
 ds_read_b64_tr_b16 a[194:195], v236 offset:34816
 v_cvt_pk_bf16_f32 v206, v216, v217
 v_mfma_f32_16x16x32_bf16 v[252:255], a[204:207], v[100:103], v[252:255]
 ds_read_b64_tr_b16 a[196:197], v236 offset:36864
 v_cvt_pk_bf16_f32 v207, v218, v219
 v_mfma_f32_16x16x32_bf16 v[252:255], a[200:203], v[88:91], v[252:255]
 ds_read_b64_tr_b16 a[198:199], v236 offset:38912
 v_mul_f32 v200, v200, v8
 v_mfma_f32_16x16x32_bf16 v[252:255], a[208:211], v[112:115], v[252:255]
 ds_read_b64_tr_b16 a[200:201], v236 offset:40960
 v_mul_f32 v201, v201, v8
 v_mfma_f32_16x16x32_bf16 v[252:255], a[212:215], v[124:127], v[252:255]
 ds_read_b64_tr_b16 a[202:203], v236 offset:43008
 v_mul_f32 v202, v202, v8
 v_mfma_f32_16x16x32_bf16 v[16:19], a[212:215], v[128:131], v[16:19]
 ds_read_b64_tr_b16 a[204:205], v236 offset:45056
 v_mul_f32 v203, v203, v8
 v_mfma_f32_16x16x32_bf16 v[16:19], a[208:211], v[116:119], v[16:19]
 ds_read_b64_tr_b16 a[206:207], v236 offset:47104
 v_mul_f32 v212, v212, v8
 v_mfma_f32_16x16x32_bf16 v[20:23], a[208:211], v[120:123], v[20:23]
 buffer_store_dwordx4 v[204:207], v240, s[64:67], s88 offen sc0 sc1
 v_mfma_f32_16x16x32_bf16 v[20:23], a[212:215], v[132:135], v[20:23]
 v_mul_f32 v213, v213, v8
 v_mul_f32 v214, v214, v8
 v_mfma_f32_16x16x32_bf16 v[20:23], a[220:223], v[156:159], v[20:23]
 ds_read_b64_tr_b16 a[208:209], v236 offset:49152
 v_mfma_f32_16x16x32_bf16 v[20:23], a[216:219], v[144:147], v[20:23]
 ds_read_b64_tr_b16 a[210:211], v236 offset:51200
 v_mul_f32 v215, v215, v8
 v_mfma_f32_16x16x32_bf16 v[16:19], a[216:219], v[140:143], v[16:19]
 ds_read_b64_tr_b16 a[212:213], v236 offset:53248
 v_cvt_pk_bf16_f32 v200, v200, v201
 v_mfma_f32_16x16x32_bf16 v[16:19], a[220:223], v[152:155], v[16:19]
 ds_read_b64_tr_b16 a[214:215], v236 offset:55296
 v_cvt_pk_bf16_f32 v201, v202, v203
 v_mfma_f32_16x16x32_bf16 v[252:255], a[220:223], v[148:151], v[252:255]
 v_cvt_pk_bf16_f32 v202, v212, v213
 v_cvt_pk_bf16_f32 v203, v214, v215
 v_mfma_f32_16x16x32_bf16 v[252:255], a[216:219], v[136:139], v[252:255]
 s_waitcnt lgkmcnt(8)
 buffer_store_dwordx4 v[200:203], v5, s[64:67], s88 offen sc0 sc1
 v_mfma_f32_16x16x32_bf16 v[176:179], a[192:195], v[64:67], 0
 s_mov_b32 s82, 0x300
 s_add_u32 m0, s89, 0x10000
 ds_read_b64_tr_b16 a[216:217], v236 offset:57344
 s_mov_b32 s84, 0x8000
 v_mfma_f32_16x16x32_bf16 v[176:179], a[196:199], v[76:79], v[176:179]
 buffer_load_dwordx4 v6, s[60:63], s82 offen lds
 ds_read_b64_tr_b16 a[218:219], v236 offset:59392
 v_mfma_f32_16x16x32_bf16 v[180:183], a[196:199], v[80:83], 0
 s_mov_b32 s83, 0x1f00
 s_add_u32 m0, s89, 0x10400
 ds_read_b64_tr_b16 a[220:221], v236 offset:61440
 v_mfma_f32_16x16x32_bf16 v[180:183], a[192:195], v[68:71], v[180:183]
 buffer_load_dwordx4 v6, s[60:63], s83 offen lds
 ds_read_b64_tr_b16 a[222:223], v236 offset:63488
 v_mfma_f32_16x16x32_bf16 v[184:187], a[192:195], v[72:75], 0
 s_mov_b32 s82, 0x3b00
 s_add_u32 m0, s89, 0x10800
 v_mul_f32 v168, v168, v10
 v_mul_f32 v169, v169, v10
 v_mfma_f32_16x16x32_bf16 v[184:187], a[196:199], v[84:87], v[184:187]
 s_waitcnt lgkmcnt(8)
 buffer_load_dwordx4 v6, s[60:63], s82 offen lds
 v_mfma_f32_16x16x32_bf16 v[184:187], a[204:207], v[108:111], v[184:187]
 s_mov_b32 s83, 0x5700
 s_add_u32 m0, s89, 0x10c00
 ds_read_b64_tr_b16 a[192:193], v237 offset:32768
 v_mul_f32 v170, v170, v10
 v_mfma_f32_16x16x32_bf16 v[184:187], a[200:203], v[96:99], v[184:187]
 buffer_load_dwordx4 v6, s[60:63], s83 offen lds
 ds_read_b64_tr_b16 a[194:195], v237 offset:34816
 v_mfma_f32_16x16x32_bf16 v[180:183], a[200:203], v[92:95], v[180:183]
 s_mov_b32 s82, 0x7300
 s_add_u32 m0, s89, 0x11000
 ds_read_b64_tr_b16 a[196:197], v237 offset:36864
 v_mul_f32 v171, v171, v10
 v_mfma_f32_16x16x32_bf16 v[180:183], a[204:207], v[104:107], v[180:183]
 buffer_load_dwordx4 v6, s[60:63], s82 offen lds
 ds_read_b64_tr_b16 a[198:199], v237 offset:38912
 v_mfma_f32_16x16x32_bf16 v[176:179], a[204:207], v[100:103], v[176:179]
 s_mov_b32 s83, 0x8f00
 s_add_u32 m0, s89, 0x11400
 v_mul_f32 v228, v228, v10
 v_mul_f32 v229, v229, v10
 v_mfma_f32_16x16x32_bf16 v[176:179], a[200:203], v[88:91], v[176:179]
 s_waitcnt lgkmcnt(8)
 buffer_load_dwordx4 v6, s[60:63], s83 offen lds
 v_mfma_f32_16x16x32_bf16 v[176:179], a[208:211], v[112:115], v[176:179]
 s_mov_b32 s82, 0xab00
 s_add_u32 m0, s89, 0x11800
 ds_read_b64_tr_b16 a[200:201], v237 offset:40960
 v_mul_f32 v230, v230, v10
 v_mfma_f32_16x16x32_bf16 v[176:179], a[212:215], v[124:127], v[176:179]
 buffer_load_dwordx4 v6, s[60:63], s82 offen lds
 ds_read_b64_tr_b16 a[202:203], v237 offset:43008
 v_mfma_f32_16x16x32_bf16 v[180:183], a[212:215], v[128:131], v[180:183]
 s_mov_b32 s83, 0xc700
 s_add_u32 m0, s89, 0x11c00
 ds_read_b64_tr_b16 a[204:205], v237 offset:45056
 v_mfma_f32_16x16x32_bf16 v[180:183], a[208:211], v[116:119], v[180:183]
 buffer_load_dwordx4 v6, s[60:63], s83 offen lds
 ds_read_b64_tr_b16 a[206:207], v237 offset:47104
 v_mfma_f32_16x16x32_bf16 v[184:187], a[208:211], v[120:123], v[184:187]
 v_mul_f32 v231, v231, v10
 v_cvt_pk_bf16_f32 v168, v168, v169
 v_mfma_f32_16x16x32_bf16 v[184:187], a[212:215], v[132:135], v[184:187]
 s_waitcnt lgkmcnt(8)
 v_cvt_pk_bf16_f32 v169, v170, v171
 v_mfma_f32_16x16x32_bf16 v[184:187], a[220:223], v[156:159], v[184:187]
 ds_read_b64_tr_b16 a[208:209], v237 offset:49152
 v_cvt_pk_bf16_f32 v170, v228, v229
 v_mfma_f32_16x16x32_bf16 v[184:187], a[216:219], v[144:147], v[184:187]
 ds_read_b64_tr_b16 a[210:211], v237 offset:51200
 v_cvt_pk_bf16_f32 v171, v230, v231
 v_mfma_f32_16x16x32_bf16 v[180:183], a[216:219], v[140:143], v[180:183]
 ds_read_b64_tr_b16 a[212:213], v237 offset:53248
 v_mul_f32 v164, v164, v9
 v_mfma_f32_16x16x32_bf16 v[180:183], a[220:223], v[152:155], v[180:183]
 ds_read_b64_tr_b16 a[214:215], v237 offset:55296
 v_mfma_f32_16x16x32_bf16 v[176:179], a[220:223], v[148:151], v[176:179]
 buffer_store_dwordx4 v[168:171], v241, s[64:67], s84 offen sc0 sc1
 v_mfma_f32_16x16x32_bf16 v[176:179], a[216:219], v[136:139], v[176:179]
 s_waitcnt lgkmcnt(8)
 v_mul_f32 v165, v165, v9
 v_mul_f32 v166, v166, v9
 v_mfma_f32_16x16x32_bf16 v[188:191], a[192:195], v[64:67], 0
 ds_read_b64_tr_b16 a[216:217], v237 offset:57344
 v_mfma_f32_16x16x32_bf16 v[188:191], a[196:199], v[76:79], v[188:191]
 ds_read_b64_tr_b16 a[218:219], v237 offset:59392
 v_mul_f32 v167, v167, v9
 v_mfma_f32_16x16x32_bf16 v[192:195], a[196:199], v[80:83], 0
 ds_read_b64_tr_b16 a[220:221], v237 offset:61440
 v_mul_f32 v224, v224, v9
 v_mfma_f32_16x16x32_bf16 v[192:195], a[192:195], v[68:71], v[192:195]
 ds_read_b64_tr_b16 a[222:223], v237 offset:63488
 v_mul_f32 v225, v225, v9
 v_mfma_f32_16x16x32_bf16 v[196:199], a[192:195], v[72:75], 0
 v_mul_f32 v226, v226, v9
 v_mfma_f32_16x16x32_bf16 v[196:199], a[196:199], v[84:87], v[196:199]
 s_waitcnt lgkmcnt(8)
 v_mul_f32 v227, v227, v9
 v_cvt_pk_bf16_f32 v164, v164, v165
 v_mfma_f32_16x16x32_bf16 v[196:199], a[204:207], v[108:111], v[196:199]
 ds_read_b64_tr_b16 a[192:193], v238 offset:32768
 v_mfma_f32_16x16x32_bf16 v[196:199], a[200:203], v[96:99], v[196:199]
 ds_read_b64_tr_b16 a[194:195], v238 offset:34816
 v_cvt_pk_bf16_f32 v165, v166, v167
 v_mfma_f32_16x16x32_bf16 v[192:195], a[200:203], v[92:95], v[192:195]
 ds_read_b64_tr_b16 a[196:197], v238 offset:36864
 v_cvt_pk_bf16_f32 v166, v224, v225
 v_mfma_f32_16x16x32_bf16 v[192:195], a[204:207], v[104:107], v[192:195]
 ds_read_b64_tr_b16 a[198:199], v238 offset:38912
 v_cvt_pk_bf16_f32 v167, v226, v227
 v_mfma_f32_16x16x32_bf16 v[188:191], a[204:207], v[100:103], v[188:191]
 buffer_store_dwordx4 v[164:167], v240, s[64:67], s84 offen sc0 sc1
 s_mov_b32 s85, 0xc000
 v_mfma_f32_16x16x32_bf16 v[188:191], a[200:203], v[88:91], v[188:191]
 s_waitcnt lgkmcnt(8)
 v_mul_f32 v160, v160, v8
 v_mfma_f32_16x16x32_bf16 v[188:191], a[208:211], v[112:115], v[188:191]
 ds_read_b64_tr_b16 a[200:201], v238 offset:40960
 v_mfma_f32_16x16x32_bf16 v[188:191], a[212:215], v[124:127], v[188:191]
 ds_read_b64_tr_b16 a[202:203], v238 offset:43008
 v_mul_f32 v161, v161, v8
 v_mfma_f32_16x16x32_bf16 v[192:195], a[212:215], v[128:131], v[192:195]
 ds_read_b64_tr_b16 a[204:205], v238 offset:45056
 v_mul_f32 v162, v162, v8
 v_mfma_f32_16x16x32_bf16 v[192:195], a[208:211], v[116:119], v[192:195]
 ds_read_b64_tr_b16 a[206:207], v238 offset:47104
 v_mul_f32 v163, v163, v8
 v_mfma_f32_16x16x32_bf16 v[196:199], a[208:211], v[120:123], v[196:199]
 v_mul_f32 v172, v172, v8
 v_mfma_f32_16x16x32_bf16 v[196:199], a[212:215], v[132:135], v[196:199]
 s_waitcnt lgkmcnt(8)
 v_mul_f32 v173, v173, v8
 v_mul_f32 v174, v174, v8
 v_mfma_f32_16x16x32_bf16 v[196:199], a[220:223], v[156:159], v[196:199]
 ds_read_b64_tr_b16 a[208:209], v238 offset:49152
 v_mfma_f32_16x16x32_bf16 v[196:199], a[216:219], v[144:147], v[196:199]
 ds_read_b64_tr_b16 a[210:211], v238 offset:51200
 v_mul_f32 v175, v175, v8
 v_mfma_f32_16x16x32_bf16 v[192:195], a[216:219], v[140:143], v[192:195]
 ds_read_b64_tr_b16 a[212:213], v238 offset:53248
 v_cvt_pk_bf16_f32 v160, v160, v161
 v_mfma_f32_16x16x32_bf16 v[192:195], a[220:223], v[152:155], v[192:195]
 ds_read_b64_tr_b16 a[214:215], v238 offset:55296
 v_cvt_pk_bf16_f32 v161, v162, v163
 v_mfma_f32_16x16x32_bf16 v[188:191], a[220:223], v[148:151], v[188:191]
 v_cvt_pk_bf16_f32 v162, v172, v173
 v_mfma_f32_16x16x32_bf16 v[188:191], a[216:219], v[136:139], v[188:191]
 s_waitcnt lgkmcnt(8)
 v_cvt_pk_bf16_f32 v163, v174, v175
 v_mul_f32 v248, v248, v10
 v_mfma_f32_16x16x32_bf16 v[200:203], a[192:195], v[64:67], 0
 ds_read_b64_tr_b16 a[216:217], v238 offset:57344
 v_mfma_f32_16x16x32_bf16 v[200:203], a[196:199], v[76:79], v[200:203]
 ds_read_b64_tr_b16 a[218:219], v238 offset:59392
 v_mul_f32 v249, v249, v10
 v_mfma_f32_16x16x32_bf16 v[204:207], a[196:199], v[80:83], 0
 ds_read_b64_tr_b16 a[220:221], v238 offset:61440
 v_mul_f32 v250, v250, v10
 v_mfma_f32_16x16x32_bf16 v[204:207], a[192:195], v[68:71], v[204:207]
 ds_read_b64_tr_b16 a[222:223], v238 offset:63488
 v_mul_f32 v251, v251, v10
 v_mfma_f32_16x16x32_bf16 v[208:211], a[192:195], v[72:75], 0
 buffer_store_dwordx4 v[160:163], v5, s[64:67], s84 offen sc0 sc1
 v_mfma_f32_16x16x32_bf16 v[208:211], a[196:199], v[84:87], v[208:211]
 s_waitcnt lgkmcnt(8)
 v_mfma_f32_16x16x32_bf16 v[208:211], a[204:207], v[108:111], v[208:211]
 ds_read_b64_tr_b16 a[192:193], v239 offset:32768
 v_mul_f32 v20, v20, v10
 v_mfma_f32_16x16x32_bf16 v[208:211], a[200:203], v[96:99], v[208:211]
 ds_read_b64_tr_b16 a[194:195], v239 offset:34816
 v_mul_f32 v21, v21, v10
 v_mfma_f32_16x16x32_bf16 v[204:207], a[200:203], v[92:95], v[204:207]
 ds_read_b64_tr_b16 a[196:197], v239 offset:36864
 v_mul_f32 v22, v22, v10
 v_mfma_f32_16x16x32_bf16 v[204:207], a[204:207], v[104:107], v[204:207]
L1_PAD11:
 s_cbranch_execz L1_PRL0
 ds_read_b64_tr_b16 a[198:199], v239 offset:38912
 v_mfma_f32_16x16x32_bf16 v[200:203], a[204:207], v[100:103], v[200:203]
 v_mul_f32 v23, v23, v10
 v_cvt_pk_bf16_f32 v248, v248, v249
 v_mfma_f32_16x16x32_bf16 v[200:203], a[200:203], v[88:91], v[200:203]
 s_waitcnt lgkmcnt(8)
 v_cvt_pk_bf16_f32 v249, v250, v251
 v_mfma_f32_16x16x32_bf16 v[200:203], a[208:211], v[112:115], v[200:203]
 ds_read_b64_tr_b16 a[200:201], v239 offset:40960
 v_cvt_pk_bf16_f32 v250, v20, v21
 v_mfma_f32_16x16x32_bf16 v[200:203], a[212:215], v[124:127], v[200:203]
 ds_read_b64_tr_b16 a[202:203], v239 offset:43008
 v_cvt_pk_bf16_f32 v251, v22, v23
 v_mfma_f32_16x16x32_bf16 v[204:207], a[212:215], v[128:131], v[204:207]
 ds_read_b64_tr_b16 a[204:205], v239 offset:45056
 v_mul_f32 v244, v244, v9
 v_mfma_f32_16x16x32_bf16 v[204:207], a[208:211], v[116:119], v[204:207]
 ds_read_b64_tr_b16 a[206:207], v239 offset:47104
 v_mfma_f32_16x16x32_bf16 v[208:211], a[208:211], v[120:123], v[208:211]
 buffer_store_dwordx4 v[248:251], v241, s[64:67], s85 offen sc0 sc1
 v_mfma_f32_16x16x32_bf16 v[208:211], a[212:215], v[132:135], v[208:211]
 s_waitcnt lgkmcnt(8)
 v_mul_f32 v245, v245, v9
 v_mfma_f32_16x16x32_bf16 v[208:211], a[220:223], v[156:159], v[208:211]
 ds_read_b64_tr_b16 a[208:209], v239 offset:49152
 v_mul_f32 v246, v246, v9
 v_mfma_f32_16x16x32_bf16 v[208:211], a[216:219], v[144:147], v[208:211]
 ds_read_b64_tr_b16 a[210:211], v239 offset:51200
 v_mul_f32 v247, v247, v9
 v_mfma_f32_16x16x32_bf16 v[204:207], a[216:219], v[140:143], v[204:207]
 ds_read_b64_tr_b16 a[212:213], v239 offset:53248
 v_mfma_f32_16x16x32_bf16 v[204:207], a[220:223], v[152:155], v[204:207]
 ds_read_b64_tr_b16 a[214:215], v239 offset:55296
 v_mul_f32 v16, v16, v9
 v_mfma_f32_16x16x32_bf16 v[200:203], a[220:223], v[148:151], v[200:203]
 v_mul_f32 v17, v17, v9
 v_mfma_f32_16x16x32_bf16 v[200:203], a[216:219], v[136:139], v[200:203]
 s_waitcnt lgkmcnt(8)
 v_mul_f32 v18, v18, v9
 v_mul_f32 v19, v19, v9
 v_mfma_f32_16x16x32_bf16 v[212:215], a[192:195], v[64:67], 0
 ds_read_b64_tr_b16 a[216:217], v239 offset:57344
 v_cvt_pk_bf16_f32 v244, v244, v245
 v_mfma_f32_16x16x32_bf16 v[212:215], a[196:199], v[76:79], v[212:215]
 ds_read_b64_tr_b16 a[218:219], v239 offset:59392
 v_mfma_f32_16x16x32_bf16 v[216:219], a[196:199], v[80:83], 0
 ds_read_b64_tr_b16 a[220:221], v239 offset:61440
 v_cvt_pk_bf16_f32 v245, v246, v247
 v_mfma_f32_16x16x32_bf16 v[216:219], a[192:195], v[68:71], v[216:219]
 ds_read_b64_tr_b16 a[222:223], v239 offset:63488
 v_cvt_pk_bf16_f32 v246, v16, v17
 v_mfma_f32_16x16x32_bf16 v[220:223], a[192:195], v[72:75], 0
 v_cvt_pk_bf16_f32 v247, v18, v19
 v_mfma_f32_16x16x32_bf16 v[220:223], a[196:199], v[84:87], v[220:223]
 s_waitcnt lgkmcnt(8)
 buffer_store_dwordx4 v[244:247], v240, s[64:67], s85 offen sc0 sc1
 v_mfma_f32_16x16x32_bf16 v[220:223], a[204:207], v[108:111], v[220:223]
 v_mul_f32 v232, v232, v8
 v_mfma_f32_16x16x32_bf16 v[220:223], a[200:203], v[96:99], v[220:223]
 s_waitcnt vmcnt(35) lgkmcnt(0)
 s_barrier
 v_mfma_f32_16x16x32_bf16 v[216:219], a[200:203], v[92:95], v[216:219]
 ds_read_b64_tr_b16 a[192:193], v36 offset:0
 v_mul_f32 v233, v233, v8
 v_mfma_f32_16x16x32_bf16 v[216:219], a[204:207], v[104:107], v[216:219]
 ds_read_b64_tr_b16 a[194:195], v36 offset:2048
 v_mfma_f32_16x16x32_bf16 v[212:215], a[204:207], v[100:103], v[212:215]
 ds_read_b64_tr_b16 a[196:197], v36 offset:4096
 v_mul_f32 v234, v234, v8
 v_mfma_f32_16x16x32_bf16 v[212:215], a[200:203], v[88:91], v[212:215]
 ds_read_b64_tr_b16 a[198:199], v36 offset:6144
 v_mul_f32 v235, v235, v8
 v_mfma_f32_16x16x32_bf16 v[212:215], a[208:211], v[112:115], v[212:215]
 ds_read_b64_tr_b16 a[200:201], v36 offset:8192
 v_mfma_f32_16x16x32_bf16 v[212:215], a[212:215], v[124:127], v[212:215]
 ds_read_b64_tr_b16 a[202:203], v36 offset:10240
 v_mul_f32 v252, v252, v8
 v_mfma_f32_16x16x32_bf16 v[216:219], a[212:215], v[128:131], v[216:219]
 ds_read_b64_tr_b16 a[204:205], v36 offset:12288
 v_mul_f32 v253, v253, v8
 v_mfma_f32_16x16x32_bf16 v[216:219], a[208:211], v[116:119], v[216:219]
 ds_read_b64_tr_b16 a[206:207], v36 offset:14336
 v_mfma_f32_16x16x32_bf16 v[220:223], a[208:211], v[120:123], v[220:223]
 v_mul_f32 v254, v254, v8
 v_mul_f32 v255, v255, v8
 v_mfma_f32_16x16x32_bf16 v[220:223], a[212:215], v[132:135], v[220:223]
 v_cvt_pk_bf16_f32 v232, v232, v233
 v_mfma_f32_16x16x32_bf16 v[220:223], a[220:223], v[156:159], v[220:223]
 ds_read_b64_tr_b16 a[208:209], v36 offset:16384
 v_cvt_pk_bf16_f32 v233, v234, v235
 v_mfma_f32_16x16x32_bf16 v[220:223], a[216:219], v[144:147], v[220:223]
 ds_read_b64_tr_b16 a[210:211], v36 offset:18432
 v_mfma_f32_16x16x32_bf16 v[216:219], a[216:219], v[140:143], v[216:219]
 ds_read_b64_tr_b16 a[212:213], v36 offset:20480
 v_cvt_pk_bf16_f32 v234, v252, v253
 v_mfma_f32_16x16x32_bf16 v[216:219], a[220:223], v[152:155], v[216:219]
 ds_read_b64_tr_b16 a[214:215], v36 offset:22528
 v_cvt_pk_bf16_f32 v235, v254, v255
 v_mfma_f32_16x16x32_bf16 v[212:215], a[220:223], v[148:151], v[212:215]
 buffer_store_dwordx4 v[232:235], v5, s[64:67], s85 offen sc0 sc1
 v_mfma_f32_16x16x32_bf16 v[212:215], a[216:219], v[136:139], v[212:215]
 s_waitcnt lgkmcnt(8)
 v_mfma_f32_16x16x32_bf16 v[160:163], a[192:195], v[64:67], 0
 ds_read_b64_tr_b16 a[216:217], v36 offset:24576
 s_mov_b32 s84, 0x10000
 v_mfma_f32_16x16x32_bf16 v[160:163], a[196:199], v[76:79], v[160:163]
 ds_read_b64_tr_b16 a[218:219], v36 offset:26624
 v_mfma_f32_16x16x32_bf16 v[164:167], a[196:199], v[80:83], 0
 ds_read_b64_tr_b16 a[220:221], v36 offset:28672
 v_mfma_f32_16x16x32_bf16 v[164:167], a[192:195], v[68:71], v[164:167]
 ds_read_b64_tr_b16 a[222:223], v36 offset:30720
 v_mul_f32 v184, v184, v10
 v_mfma_f32_16x16x32_bf16 v[168:171], a[192:195], v[72:75], 0
 v_mul_f32 v185, v185, v10
 v_mul_f32 v186, v186, v10
 v_mfma_f32_16x16x32_bf16 v[168:171], a[196:199], v[84:87], v[168:171]
 s_waitcnt lgkmcnt(8)
 v_mul_f32 v187, v187, v10
 v_mul_f32 v196, v196, v10
 v_mfma_f32_16x16x32_bf16 v[168:171], a[204:207], v[108:111], v[168:171]
 ds_read_b64_tr_b16 a[192:193], v37 offset:0
 v_mul_f32 v197, v197, v10
 v_mfma_f32_16x16x32_bf16 v[168:171], a[200:203], v[96:99], v[168:171]
 ds_read_b64_tr_b16 a[194:195], v37 offset:2048
 v_mul_f32 v198, v198, v10
 v_mul_f32 v199, v199, v10
 v_mfma_f32_16x16x32_bf16 v[164:167], a[200:203], v[92:95], v[164:167]
 ds_read_b64_tr_b16 a[196:197], v37 offset:4096
 v_cvt_pk_bf16_f32 v184, v184, v185
 v_mfma_f32_16x16x32_bf16 v[164:167], a[204:207], v[104:107], v[164:167]
 ds_read_b64_tr_b16 a[198:199], v37 offset:6144
 v_cvt_pk_bf16_f32 v185, v186, v187
 v_mfma_f32_16x16x32_bf16 v[160:163], a[204:207], v[100:103], v[160:163]
 v_cvt_pk_bf16_f32 v186, v196, v197
 v_cvt_pk_bf16_f32 v187, v198, v199
 v_mfma_f32_16x16x32_bf16 v[160:163], a[200:203], v[88:91], v[160:163]
 s_waitcnt lgkmcnt(8)
 buffer_store_dwordx4 v[184:187], v241, s[64:67], s84 offen sc0 sc1
 v_mfma_f32_16x16x32_bf16 v[160:163], a[208:211], v[112:115], v[160:163]
 ds_read_b64_tr_b16 a[200:201], v37 offset:8192
 v_mul_f32 v180, v180, v9
 v_mfma_f32_16x16x32_bf16 v[160:163], a[212:215], v[124:127], v[160:163]
 ds_read_b64_tr_b16 a[202:203], v37 offset:10240
 v_mul_f32 v181, v181, v9
 v_mfma_f32_16x16x32_bf16 v[164:167], a[212:215], v[128:131], v[164:167]
 ds_read_b64_tr_b16 a[204:205], v37 offset:12288
 v_mul_f32 v182, v182, v9
 v_mul_f32 v183, v183, v9
 v_mfma_f32_16x16x32_bf16 v[164:167], a[208:211], v[116:119], v[164:167]
 ds_read_b64_tr_b16 a[206:207], v37 offset:14336
 v_mul_f32 v192, v192, v9
 v_mfma_f32_16x16x32_bf16 v[168:171], a[208:211], v[120:123], v[168:171]
 v_mul_f32 v193, v193, v9
 v_mul_f32 v194, v194, v9
 v_mfma_f32_16x16x32_bf16 v[168:171], a[212:215], v[132:135], v[168:171]
 s_waitcnt lgkmcnt(8)
 v_mul_f32 v195, v195, v9
 v_cvt_pk_bf16_f32 v180, v180, v181
 v_mfma_f32_16x16x32_bf16 v[168:171], a[220:223], v[156:159], v[168:171]
 ds_read_b64_tr_b16 a[208:209], v37 offset:16384
 v_cvt_pk_bf16_f32 v181, v182, v183
 v_mfma_f32_16x16x32_bf16 v[168:171], a[216:219], v[144:147], v[168:171]
 ds_read_b64_tr_b16 a[210:211], v37 offset:18432
 v_cvt_pk_bf16_f32 v182, v192, v193
 v_mfma_f32_16x16x32_bf16 v[164:167], a[216:219], v[140:143], v[164:167]
 ds_read_b64_tr_b16 a[212:213], v37 offset:20480
 v_cvt_pk_bf16_f32 v183, v194, v195
 v_mfma_f32_16x16x32_bf16 v[164:167], a[220:223], v[152:155], v[164:167]
 ds_read_b64_tr_b16 a[214:215], v37 offset:22528
 v_mul_f32 v176, v176, v8
 s_mov_b32 s85, 0x14000
 v_mfma_f32_16x16x32_bf16 v[160:163], a[220:223], v[148:151], v[160:163]
 buffer_store_dwordx4 v[180:183], v240, s[64:67], s84 offen sc0 sc1
 v_mul_f32 v177, v177, v8
 v_mfma_f32_16x16x32_bf16 v[160:163], a[216:219], v[136:139], v[160:163]
 s_waitcnt lgkmcnt(8)
 v_mul_f32 v178, v178, v8
 v_mul_f32 v179, v179, v8
 v_mfma_f32_16x16x32_bf16 v[172:175], a[192:195], v[64:67], 0
 ds_read_b64_tr_b16 a[216:217], v37 offset:24576
 v_mul_f32 v188, v188, v8
 v_mfma_f32_16x16x32_bf16 v[172:175], a[196:199], v[76:79], v[172:175]
 ds_read_b64_tr_b16 a[218:219], v37 offset:26624
 v_mul_f32 v189, v189, v8
 v_mfma_f32_16x16x32_bf16 v[224:227], a[196:199], v[80:83], 0
 ds_read_b64_tr_b16 a[220:221], v37 offset:28672
 v_mul_f32 v190, v190, v8
 v_mfma_f32_16x16x32_bf16 v[224:227], a[192:195], v[68:71], v[224:227]
 ds_read_b64_tr_b16 a[222:223], v37 offset:30720
 v_mul_f32 v191, v191, v8
 v_mfma_f32_16x16x32_bf16 v[228:231], a[192:195], v[72:75], 0
 v_cvt_pk_bf16_f32 v176, v176, v177
 v_cvt_pk_bf16_f32 v177, v178, v179
 v_mfma_f32_16x16x32_bf16 v[228:231], a[196:199], v[84:87], v[228:231]
 s_waitcnt lgkmcnt(8)
 v_cvt_pk_bf16_f32 v178, v188, v189
 v_cvt_pk_bf16_f32 v179, v190, v191
 v_mul_f32 v208, v208, v10
 v_mfma_f32_16x16x32_bf16 v[228:231], a[204:207], v[108:111], v[228:231]
 ds_read_b64_tr_b16 a[192:193], v38 offset:0
 v_mul_f32 v209, v209, v10
 v_mfma_f32_16x16x32_bf16 v[228:231], a[200:203], v[96:99], v[228:231]
 ds_read_b64_tr_b16 a[194:195], v38 offset:2048
 v_mul_f32 v210, v210, v10
 v_mfma_f32_16x16x32_bf16 v[224:227], a[200:203], v[92:95], v[224:227]
 ds_read_b64_tr_b16 a[196:197], v38 offset:4096
 v_mul_f32 v211, v211, v10
 v_mfma_f32_16x16x32_bf16 v[224:227], a[204:207], v[104:107], v[224:227]
 ds_read_b64_tr_b16 a[198:199], v38 offset:6144
 v_mul_f32 v220, v220, v10
 v_mfma_f32_16x16x32_bf16 v[172:175], a[204:207], v[100:103], v[172:175]
 buffer_store_dwordx4 v[176:179], v5, s[64:67], s84 offen sc0 sc1
 v_mfma_f32_16x16x32_bf16 v[172:175], a[200:203], v[88:91], v[172:175]
 s_waitcnt lgkmcnt(8)
 v_mul_f32 v221, v221, v10
 v_mul_f32 v222, v222, v10
 v_mfma_f32_16x16x32_bf16 v[172:175], a[208:211], v[112:115], v[172:175]
 ds_read_b64_tr_b16 a[200:201], v38 offset:8192
 v_mul_f32 v223, v223, v10
 v_mfma_f32_16x16x32_bf16 v[172:175], a[212:215], v[124:127], v[172:175]
 ds_read_b64_tr_b16 a[202:203], v38 offset:10240
 v_cvt_pk_bf16_f32 v208, v208, v209
 v_mfma_f32_16x16x32_bf16 v[224:227], a[212:215], v[128:131], v[224:227]
 ds_read_b64_tr_b16 a[204:205], v38 offset:12288
 v_cvt_pk_bf16_f32 v209, v210, v211
 v_cvt_pk_bf16_f32 v210, v220, v221
 v_mfma_f32_16x16x32_bf16 v[224:227], a[208:211], v[116:119], v[224:227]
 ds_read_b64_tr_b16 a[206:207], v38 offset:14336
 v_cvt_pk_bf16_f32 v211, v222, v223
 v_mfma_f32_16x16x32_bf16 v[228:231], a[208:211], v[120:123], v[228:231]
 buffer_store_dwordx4 v[208:211], v241, s[64:67], s85 offen sc0 sc1
 v_mfma_f32_16x16x32_bf16 v[228:231], a[212:215], v[132:135], v[228:231]
 s_waitcnt lgkmcnt(8)
 v_mul_f32 v204, v204, v9
 v_mul_f32 v205, v205, v9
 v_mfma_f32_16x16x32_bf16 v[228:231], a[220:223], v[156:159], v[228:231]
 ds_read_b64_tr_b16 a[208:209], v38 offset:16384
 v_mul_f32 v206, v206, v9
 v_mfma_f32_16x16x32_bf16 v[228:231], a[216:219], v[144:147], v[228:231]
 ds_read_b64_tr_b16 a[210:211], v38 offset:18432
 v_mul_f32 v207, v207, v9
 v_mfma_f32_16x16x32_bf16 v[224:227], a[216:219], v[140:143], v[224:227]
 ds_read_b64_tr_b16 a[212:213], v38 offset:20480
 v_mul_f32 v216, v216, v9
 v_mfma_f32_16x16x32_bf16 v[224:227], a[220:223], v[152:155], v[224:227]
 ds_read_b64_tr_b16 a[214:215], v38 offset:22528
 v_mul_f32 v217, v217, v9
 v_mfma_f32_16x16x32_bf16 v[172:175], a[220:223], v[148:151], v[172:175]
 v_mul_f32 v218, v218, v9
 v_mul_f32 v219, v219, v9
 v_mfma_f32_16x16x32_bf16 v[172:175], a[216:219], v[136:139], v[172:175]
 s_waitcnt lgkmcnt(8)
 v_cvt_pk_bf16_f32 v204, v204, v205
 v_cvt_pk_bf16_f32 v205, v206, v207
 v_mfma_f32_16x16x32_bf16 v[232:235], a[192:195], v[64:67], 0
 ds_read_b64_tr_b16 a[216:217], v38 offset:24576
 v_cvt_pk_bf16_f32 v206, v216, v217
 v_cvt_pk_bf16_f32 v207, v218, v219
 v_mfma_f32_16x16x32_bf16 v[232:235], a[196:199], v[76:79], v[232:235]
 ds_read_b64_tr_b16 a[218:219], v38 offset:26624
 v_mul_f32 v200, v200, v8
 s_mov_b32 s84, 0x18000
 v_mfma_f32_16x16x32_bf16 v[244:247], a[196:199], v[80:83], 0
 ds_read_b64_tr_b16 a[220:221], v38 offset:28672
 v_mul_f32 v201, v201, v8
 v_mfma_f32_16x16x32_bf16 v[244:247], a[192:195], v[68:71], v[244:247]
 ds_read_b64_tr_b16 a[222:223], v38 offset:30720
 v_mul_f32 v202, v202, v8
 v_mfma_f32_16x16x32_bf16 v[248:251], a[192:195], v[72:75], 0
 buffer_store_dwordx4 v[204:207], v240, s[64:67], s85 offen sc0 sc1
 v_mfma_f32_16x16x32_bf16 v[248:251], a[196:199], v[84:87], v[248:251]
 s_waitcnt lgkmcnt(8)
 v_mul_f32 v203, v203, v8
 v_mul_f32 v212, v212, v8
 v_mfma_f32_16x16x32_bf16 v[248:251], a[204:207], v[108:111], v[248:251]
 ds_read_b64_tr_b16 a[192:193], v39 offset:0
 v_mul_f32 v213, v213, v8
 v_mfma_f32_16x16x32_bf16 v[248:251], a[200:203], v[96:99], v[248:251]
 ds_read_b64_tr_b16 a[194:195], v39 offset:2048
 v_mul_f32 v214, v214, v8
 v_mfma_f32_16x16x32_bf16 v[244:247], a[200:203], v[92:95], v[244:247]
 ds_read_b64_tr_b16 a[196:197], v39 offset:4096
 v_mul_f32 v215, v215, v8
 v_mfma_f32_16x16x32_bf16 v[244:247], a[204:207], v[104:107], v[244:247]
 ds_read_b64_tr_b16 a[198:199], v39 offset:6144
 v_cvt_pk_bf16_f32 v200, v200, v201
 v_mfma_f32_16x16x32_bf16 v[232:235], a[204:207], v[100:103], v[232:235]
 v_cvt_pk_bf16_f32 v201, v202, v203
 v_cvt_pk_bf16_f32 v202, v212, v213
 v_mfma_f32_16x16x32_bf16 v[232:235], a[200:203], v[88:91], v[232:235]
 s_waitcnt lgkmcnt(8)
 v_cvt_pk_bf16_f32 v203, v214, v215
 v_mul_f32 v168, v168, v10
 v_mfma_f32_16x16x32_bf16 v[232:235], a[208:211], v[112:115], v[232:235]
 ds_read_b64_tr_b16 a[200:201], v39 offset:8192
 buffer_store_dwordx4 v[200:203], v5, s[64:67], s85 offen sc0 sc1
 v_mfma_f32_16x16x32_bf16 v[232:235], a[212:215], v[124:127], v[232:235]
 ds_read_b64_tr_b16 a[202:203], v39 offset:10240
 v_mul_f32 v169, v169, v10
 v_mfma_f32_16x16x32_bf16 v[244:247], a[212:215], v[128:131], v[244:247]
 ds_read_b64_tr_b16 a[204:205], v39 offset:12288
 v_mul_f32 v170, v170, v10
 v_mfma_f32_16x16x32_bf16 v[244:247], a[208:211], v[116:119], v[244:247]
 ds_read_b64_tr_b16 a[206:207], v39 offset:14336
 v_mul_f32 v171, v171, v10
 v_mfma_f32_16x16x32_bf16 v[248:251], a[208:211], v[120:123], v[248:251]
 v_mul_f32 v228, v228, v10
 v_mul_f32 v229, v229, v10
 v_mfma_f32_16x16x32_bf16 v[248:251], a[212:215], v[132:135], v[248:251]
 s_waitcnt lgkmcnt(8)
 v_mul_f32 v230, v230, v10
 v_mfma_f32_16x16x32_bf16 v[248:251], a[220:223], v[156:159], v[248:251]
 ds_read_b64_tr_b16 a[208:209], v39 offset:16384
 v_mul_f32 v231, v231, v10
 v_mfma_f32_16x16x32_bf16 v[248:251], a[216:219], v[144:147], v[248:251]
 ds_read_b64_tr_b16 a[210:211], v39 offset:18432
 v_cvt_pk_bf16_f32 v168, v168, v169
 v_mfma_f32_16x16x32_bf16 v[244:247], a[216:219], v[140:143], v[244:247]
 ds_read_b64_tr_b16 a[212:213], v39 offset:20480
 v_cvt_pk_bf16_f32 v169, v170, v171
 v_mfma_f32_16x16x32_bf16 v[244:247], a[220:223], v[152:155], v[244:247]
 ds_read_b64_tr_b16 a[214:215], v39 offset:22528
 v_cvt_pk_bf16_f32 v170, v228, v229
 v_mfma_f32_16x16x32_bf16 v[232:235], a[220:223], v[148:151], v[232:235]
 v_cvt_pk_bf16_f32 v171, v230, v231
 v_mul_f32 v164, v164, v9
 v_mfma_f32_16x16x32_bf16 v[232:235], a[216:219], v[136:139], v[232:235]
 s_waitcnt lgkmcnt(8)
 buffer_store_dwordx4 v[168:171], v241, s[64:67], s84 offen sc0 sc1
 v_mfma_f32_16x16x32_bf16 v[252:255], a[192:195], v[64:67], 0
 ds_read_b64_tr_b16 a[216:217], v39 offset:24576
 v_mul_f32 v165, v165, v9
 v_mfma_f32_16x16x32_bf16 v[252:255], a[196:199], v[76:79], v[252:255]
 ds_read_b64_tr_b16 a[218:219], v39 offset:26624
 v_mul_f32 v166, v166, v9
 v_mfma_f32_16x16x32_bf16 v[16:19], a[196:199], v[80:83], 0
 ds_read_b64_tr_b16 a[220:221], v39 offset:28672
 v_mul_f32 v167, v167, v9
 v_mfma_f32_16x16x32_bf16 v[16:19], a[192:195], v[68:71], v[16:19]
 ds_read_b64_tr_b16 a[222:223], v39 offset:30720
 v_mul_f32 v224, v224, v9
 v_mfma_f32_16x16x32_bf16 v[20:23], a[192:195], v[72:75], 0
 v_mul_f32 v225, v225, v9
 v_mul_f32 v226, v226, v9
 v_mfma_f32_16x16x32_bf16 v[20:23], a[196:199], v[84:87], v[20:23]
 s_waitcnt lgkmcnt(8)
 v_mul_f32 v227, v227, v9
 v_cvt_pk_bf16_f32 v164, v164, v165
 v_mfma_f32_16x16x32_bf16 v[20:23], a[204:207], v[108:111], v[20:23]
 v_cvt_pk_bf16_f32 v165, v166, v167
 v_cvt_pk_bf16_f32 v166, v224, v225
 v_mfma_f32_16x16x32_bf16 v[20:23], a[200:203], v[96:99], v[20:23]
 s_waitcnt vmcnt(35) lgkmcnt(0)
 s_barrier
 v_mfma_f32_16x16x32_bf16 v[16:19], a[200:203], v[92:95], v[16:19]
 ds_read_b64_tr_b16 a[192:193], v36 offset:32768
 v_mfma_f32_16x16x32_bf16 v[16:19], a[204:207], v[104:107], v[16:19]
 ds_read_b64_tr_b16 a[194:195], v36 offset:34816
 v_cvt_pk_bf16_f32 v167, v226, v227
 v_mfma_f32_16x16x32_bf16 v[252:255], a[204:207], v[100:103], v[252:255]
 ds_read_b64_tr_b16 a[196:197], v36 offset:36864
 v_mul_f32 v160, v160, v8
 v_mfma_f32_16x16x32_bf16 v[252:255], a[200:203], v[88:91], v[252:255]
 ds_read_b64_tr_b16 a[198:199], v36 offset:38912
 v_mul_f32 v161, v161, v8
 v_mfma_f32_16x16x32_bf16 v[252:255], a[208:211], v[112:115], v[252:255]
 ds_read_b64_tr_b16 a[200:201], v36 offset:40960
 v_mul_f32 v162, v162, v8
 v_mfma_f32_16x16x32_bf16 v[252:255], a[212:215], v[124:127], v[252:255]
 ds_read_b64_tr_b16 a[202:203], v36 offset:43008
 v_mul_f32 v163, v163, v8
 v_mfma_f32_16x16x32_bf16 v[16:19], a[212:215], v[128:131], v[16:19]
 ds_read_b64_tr_b16 a[204:205], v36 offset:45056
 v_mul_f32 v172, v172, v8
 v_mfma_f32_16x16x32_bf16 v[16:19], a[208:211], v[116:119], v[16:19]
 ds_read_b64_tr_b16 a[206:207], v36 offset:47104
 v_mul_f32 v173, v173, v8
 v_mfma_f32_16x16x32_bf16 v[20:23], a[208:211], v[120:123], v[20:23]
 buffer_store_dwordx4 v[164:167], v240, s[64:67], s84 offen sc0 sc1
 v_mfma_f32_16x16x32_bf16 v[20:23], a[212:215], v[132:135], v[20:23]
 v_mul_f32 v174, v174, v8
 v_mfma_f32_16x16x32_bf16 v[20:23], a[220:223], v[156:159], v[20:23]
 ds_read_b64_tr_b16 a[208:209], v36 offset:49152
 v_mul_f32 v175, v175, v8
 v_mfma_f32_16x16x32_bf16 v[20:23], a[216:219], v[144:147], v[20:23]
 ds_read_b64_tr_b16 a[210:211], v36 offset:51200
 v_cvt_pk_bf16_f32 v160, v160, v161
 v_mfma_f32_16x16x32_bf16 v[16:19], a[216:219], v[140:143], v[16:19]
 ds_read_b64_tr_b16 a[212:213], v36 offset:53248
 v_cvt_pk_bf16_f32 v161, v162, v163
 v_mfma_f32_16x16x32_bf16 v[16:19], a[220:223], v[152:155], v[16:19]
 ds_read_b64_tr_b16 a[214:215], v36 offset:55296
 v_cvt_pk_bf16_f32 v162, v172, v173
 v_mfma_f32_16x16x32_bf16 v[252:255], a[220:223], v[148:151], v[252:255]
 v_cvt_pk_bf16_f32 v163, v174, v175
 v_mfma_f32_16x16x32_bf16 v[252:255], a[216:219], v[136:139], v[252:255]
 s_waitcnt lgkmcnt(8)
 buffer_store_dwordx4 v[160:163], v5, s[64:67], s84 offen sc0 sc1
 v_mfma_f32_16x16x32_bf16 v[176:179], a[192:195], v[64:67], 0
 ds_read_b64_tr_b16 a[216:217], v36 offset:57344
 s_mov_b32 s85, 0x1c000
 v_mfma_f32_16x16x32_bf16 v[176:179], a[196:199], v[76:79], v[176:179]
 ds_read_b64_tr_b16 a[218:219], v36 offset:59392
 v_mfma_f32_16x16x32_bf16 v[180:183], a[196:199], v[80:83], 0
 ds_read_b64_tr_b16 a[220:221], v36 offset:61440
 v_mfma_f32_16x16x32_bf16 v[180:183], a[192:195], v[68:71], v[180:183]
 ds_read_b64_tr_b16 a[222:223], v36 offset:63488
 v_mul_f32 v248, v248, v10
 v_mfma_f32_16x16x32_bf16 v[184:187], a[192:195], v[72:75], 0
 v_mul_f32 v249, v249, v10
 v_mul_f32 v250, v250, v10
 v_mfma_f32_16x16x32_bf16 v[184:187], a[196:199], v[84:87], v[184:187]
 s_waitcnt lgkmcnt(8)
 v_mul_f32 v251, v251, v10
 v_mul_f32 v20, v20, v10
 v_mfma_f32_16x16x32_bf16 v[184:187], a[204:207], v[108:111], v[184:187]
 ds_read_b64_tr_b16 a[192:193], v37 offset:32768
 v_mul_f32 v21, v21, v10
 v_mfma_f32_16x16x32_bf16 v[184:187], a[200:203], v[96:99], v[184:187]
 ds_read_b64_tr_b16 a[194:195], v37 offset:34816
 v_mul_f32 v22, v22, v10
 v_mfma_f32_16x16x32_bf16 v[180:183], a[200:203], v[92:95], v[180:183]
 ds_read_b64_tr_b16 a[196:197], v37 offset:36864
 v_mul_f32 v23, v23, v10
 v_mfma_f32_16x16x32_bf16 v[180:183], a[204:207], v[104:107], v[180:183]
 ds_read_b64_tr_b16 a[198:199], v37 offset:38912
 v_cvt_pk_bf16_f32 v248, v248, v249
 v_mfma_f32_16x16x32_bf16 v[176:179], a[204:207], v[100:103], v[176:179]
 v_cvt_pk_bf16_f32 v249, v250, v251
 v_cvt_pk_bf16_f32 v250, v20, v21
 v_mfma_f32_16x16x32_bf16 v[176:179], a[200:203], v[88:91], v[176:179]
 s_waitcnt lgkmcnt(8)
 v_cvt_pk_bf16_f32 v251, v22, v23
 v_mfma_f32_16x16x32_bf16 v[176:179], a[208:211], v[112:115], v[176:179]
 ds_read_b64_tr_b16 a[200:201], v37 offset:40960
 v_mul_f32 v244, v244, v9
 v_mfma_f32_16x16x32_bf16 v[176:179], a[212:215], v[124:127], v[176:179]
 ds_read_b64_tr_b16 a[202:203], v37 offset:43008
 v_mul_f32 v245, v245, v9
 v_mfma_f32_16x16x32_bf16 v[180:183], a[212:215], v[128:131], v[180:183]
 ds_read_b64_tr_b16 a[204:205], v37 offset:45056
 v_mul_f32 v246, v246, v9
 v_mfma_f32_16x16x32_bf16 v[180:183], a[208:211], v[116:119], v[180:183]
 ds_read_b64_tr_b16 a[206:207], v37 offset:47104
 v_mul_f32 v247, v247, v9
 v_mfma_f32_16x16x32_bf16 v[184:187], a[208:211], v[120:123], v[184:187]
 buffer_store_dwordx4 v[248:251], v241, s[64:67], s85 offen sc0 sc1
 v_mfma_f32_16x16x32_bf16 v[184:187], a[212:215], v[132:135], v[184:187]
 s_waitcnt lgkmcnt(8)
 v_mul_f32 v16, v16, v9
 v_mfma_f32_16x16x32_bf16 v[184:187], a[220:223], v[156:159], v[184:187]
 ds_read_b64_tr_b16 a[208:209], v37 offset:49152
 v_mul_f32 v17, v17, v9
 v_mfma_f32_16x16x32_bf16 v[184:187], a[216:219], v[144:147], v[184:187]
 ds_read_b64_tr_b16 a[210:211], v37 offset:51200
 v_mul_f32 v18, v18, v9
 v_mfma_f32_16x16x32_bf16 v[180:183], a[216:219], v[140:143], v[180:183]
 ds_read_b64_tr_b16 a[212:213], v37 offset:53248
 v_mul_f32 v19, v19, v9
 v_mfma_f32_16x16x32_bf16 v[180:183], a[220:223], v[152:155], v[180:183]
 ds_read_b64_tr_b16 a[214:215], v37 offset:55296
 v_cvt_pk_bf16_f32 v244, v244, v245
 v_mfma_f32_16x16x32_bf16 v[176:179], a[220:223], v[148:151], v[176:179]
 v_cvt_pk_bf16_f32 v245, v246, v247
 v_mfma_f32_16x16x32_bf16 v[176:179], a[216:219], v[136:139], v[176:179]
 s_waitcnt lgkmcnt(8)
 v_cvt_pk_bf16_f32 v246, v16, v17
 v_cvt_pk_bf16_f32 v247, v18, v19
 v_mfma_f32_16x16x32_bf16 v[188:191], a[192:195], v[64:67], 0
 ds_read_b64_tr_b16 a[216:217], v37 offset:57344
 v_mul_f32 v232, v232, v8
 s_mov_b32 s84, 0x20000
 v_mfma_f32_16x16x32_bf16 v[188:191], a[196:199], v[76:79], v[188:191]
 ds_read_b64_tr_b16 a[218:219], v37 offset:59392
 v_mul_f32 v233, v233, v8
 v_mfma_f32_16x16x32_bf16 v[192:195], a[196:199], v[80:83], 0
 ds_read_b64_tr_b16 a[220:221], v37 offset:61440
 v_mfma_f32_16x16x32_bf16 v[192:195], a[192:195], v[68:71], v[192:195]
 ds_read_b64_tr_b16 a[222:223], v37 offset:63488
 v_mul_f32 v234, v234, v8
 v_mfma_f32_16x16x32_bf16 v[196:199], a[192:195], v[72:75], 0
 buffer_store_dwordx4 v[244:247], v240, s[64:67], s85 offen sc0 sc1
 v_mfma_f32_16x16x32_bf16 v[196:199], a[196:199], v[84:87], v[196:199]
 s_waitcnt lgkmcnt(8)
 v_mul_f32 v235, v235, v8
 v_mul_f32 v252, v252, v8
 v_mfma_f32_16x16x32_bf16 v[196:199], a[204:207], v[108:111], v[196:199]
 ds_read_b64_tr_b16 a[192:193], v38 offset:32768
 v_mul_f32 v253, v253, v8
 v_mfma_f32_16x16x32_bf16 v[196:199], a[200:203], v[96:99], v[196:199]
 ds_read_b64_tr_b16 a[194:195], v38 offset:34816
 v_mfma_f32_16x16x32_bf16 v[192:195], a[200:203], v[92:95], v[192:195]
 ds_read_b64_tr_b16 a[196:197], v38 offset:36864
 v_mul_f32 v254, v254, v8
 v_mfma_f32_16x16x32_bf16 v[192:195], a[204:207], v[104:107], v[192:195]
 ds_read_b64_tr_b16 a[198:199], v38 offset:38912
 v_mul_f32 v255, v255, v8
 v_mfma_f32_16x16x32_bf16 v[188:191], a[204:207], v[100:103], v[188:191]
 v_cvt_pk_bf16_f32 v232, v232, v233
 v_cvt_pk_bf16_f32 v233, v234, v235
 v_mfma_f32_16x16x32_bf16 v[188:191], a[200:203], v[88:91], v[188:191]
 s_waitcnt lgkmcnt(8)
 v_cvt_pk_bf16_f32 v234, v252, v253
 v_mfma_f32_16x16x32_bf16 v[188:191], a[208:211], v[112:115], v[188:191]
 ds_read_b64_tr_b16 a[200:201], v38 offset:40960
 v_cvt_pk_bf16_f32 v235, v254, v255
 v_mfma_f32_16x16x32_bf16 v[188:191], a[212:215], v[124:127], v[188:191]
 ds_read_b64_tr_b16 a[202:203], v38 offset:43008
 v_mfma_f32_16x16x32_bf16 v[192:195], a[212:215], v[128:131], v[192:195]
 ds_read_b64_tr_b16 a[204:205], v38 offset:45056
 v_mfma_f32_16x16x32_bf16 v[192:195], a[208:211], v[116:119], v[192:195]
 ds_read_b64_tr_b16 a[206:207], v38 offset:47104
 v_mfma_f32_16x16x32_bf16 v[196:199], a[208:211], v[120:123], v[196:199]
 buffer_store_dwordx4 v[232:235], v5, s[64:67], s85 offen sc0 sc1
 v_mfma_f32_16x16x32_bf16 v[196:199], a[212:215], v[132:135], v[196:199]
 s_waitcnt lgkmcnt(8)
 v_mfma_f32_16x16x32_bf16 v[196:199], a[220:223], v[156:159], v[196:199]
 ds_read_b64_tr_b16 a[208:209], v38 offset:49152
 v_mfma_f32_16x16x32_bf16 v[196:199], a[216:219], v[144:147], v[196:199]
 ds_read_b64_tr_b16 a[210:211], v38 offset:51200
 v_mfma_f32_16x16x32_bf16 v[192:195], a[216:219], v[140:143], v[192:195]
 ds_read_b64_tr_b16 a[212:213], v38 offset:53248
 v_mfma_f32_16x16x32_bf16 v[192:195], a[220:223], v[152:155], v[192:195]
 ds_read_b64_tr_b16 a[214:215], v38 offset:55296
 v_mfma_f32_16x16x32_bf16 v[188:191], a[220:223], v[148:151], v[188:191]
 v_mfma_f32_16x16x32_bf16 v[188:191], a[216:219], v[136:139], v[188:191]
 s_waitcnt lgkmcnt(8)
 v_mfma_f32_16x16x32_bf16 v[200:203], a[192:195], v[64:67], 0
 ds_read_b64_tr_b16 a[216:217], v38 offset:57344
 v_mul_f32 v184, v184, v10
 v_mfma_f32_16x16x32_bf16 v[200:203], a[196:199], v[76:79], v[200:203]
 ds_read_b64_tr_b16 a[218:219], v38 offset:59392
 v_mul_f32 v185, v185, v10
 v_mfma_f32_16x16x32_bf16 v[204:207], a[196:199], v[80:83], 0
 ds_read_b64_tr_b16 a[220:221], v38 offset:61440
 v_mul_f32 v186, v186, v10
 v_mfma_f32_16x16x32_bf16 v[204:207], a[192:195], v[68:71], v[204:207]
 ds_read_b64_tr_b16 a[222:223], v38 offset:63488
 v_mul_f32 v187, v187, v10
 v_mfma_f32_16x16x32_bf16 v[208:211], a[192:195], v[72:75], 0
 v_mul_f32 v196, v196, v10
 v_mul_f32 v197, v197, v10
 v_mfma_f32_16x16x32_bf16 v[208:211], a[196:199], v[84:87], v[208:211]
 s_waitcnt lgkmcnt(8)
 v_mul_f32 v198, v198, v10
 v_mul_f32 v199, v199, v10
 v_mfma_f32_16x16x32_bf16 v[208:211], a[204:207], v[108:111], v[208:211]
 ds_read_b64_tr_b16 a[192:193], v39 offset:32768
 v_cvt_pk_bf16_f32 v184, v184, v185
 v_mfma_f32_16x16x32_bf16 v[208:211], a[200:203], v[96:99], v[208:211]
 ds_read_b64_tr_b16 a[194:195], v39 offset:34816
 v_cvt_pk_bf16_f32 v185, v186, v187
 v_mfma_f32_16x16x32_bf16 v[204:207], a[200:203], v[92:95], v[204:207]
 ds_read_b64_tr_b16 a[196:197], v39 offset:36864
 v_cvt_pk_bf16_f32 v186, v196, v197
 v_mfma_f32_16x16x32_bf16 v[204:207], a[204:207], v[104:107], v[204:207]
 ds_read_b64_tr_b16 a[198:199], v39 offset:38912
 v_cvt_pk_bf16_f32 v187, v198, v199
 v_mfma_f32_16x16x32_bf16 v[200:203], a[204:207], v[100:103], v[200:203]
 buffer_store_dwordx4 v[184:187], v241, s[64:67], s84 offen sc0 sc1
 v_mfma_f32_16x16x32_bf16 v[200:203], a[200:203], v[88:91], v[200:203]
 s_waitcnt lgkmcnt(8)
 v_mul_f32 v180, v180, v9
 v_mul_f32 v181, v181, v9
 v_mfma_f32_16x16x32_bf16 v[200:203], a[208:211], v[112:115], v[200:203]
 ds_read_b64_tr_b16 a[200:201], v39 offset:40960
 v_mul_f32 v182, v182, v9
 v_mfma_f32_16x16x32_bf16 v[200:203], a[212:215], v[124:127], v[200:203]
 ds_read_b64_tr_b16 a[202:203], v39 offset:43008
 v_mul_f32 v183, v183, v9
 v_mfma_f32_16x16x32_bf16 v[204:207], a[212:215], v[128:131], v[204:207]
 ds_read_b64_tr_b16 a[204:205], v39 offset:45056
 v_mul_f32 v192, v192, v9
 v_mfma_f32_16x16x32_bf16 v[204:207], a[208:211], v[116:119], v[204:207]
 ds_read_b64_tr_b16 a[206:207], v39 offset:47104
 v_mul_f32 v193, v193, v9
 v_mfma_f32_16x16x32_bf16 v[208:211], a[208:211], v[120:123], v[208:211]
 v_mul_f32 v194, v194, v9
 v_mul_f32 v195, v195, v9
 v_mfma_f32_16x16x32_bf16 v[208:211], a[212:215], v[132:135], v[208:211]
 s_waitcnt lgkmcnt(8)
 v_cvt_pk_bf16_f32 v180, v180, v181
 v_cvt_pk_bf16_f32 v181, v182, v183
 v_mfma_f32_16x16x32_bf16 v[208:211], a[220:223], v[156:159], v[208:211]
 ds_read_b64_tr_b16 a[208:209], v39 offset:49152
 v_cvt_pk_bf16_f32 v182, v192, v193
 v_mfma_f32_16x16x32_bf16 v[208:211], a[216:219], v[144:147], v[208:211]
 ds_read_b64_tr_b16 a[210:211], v39 offset:51200
 v_cvt_pk_bf16_f32 v183, v194, v195
 v_mfma_f32_16x16x32_bf16 v[204:207], a[216:219], v[140:143], v[204:207]
 ds_read_b64_tr_b16 a[212:213], v39 offset:53248
 v_mul_f32 v176, v176, v8
 v_mfma_f32_16x16x32_bf16 v[204:207], a[220:223], v[152:155], v[204:207]
 ds_read_b64_tr_b16 a[214:215], v39 offset:55296
 v_mul_f32 v177, v177, v8
 v_mfma_f32_16x16x32_bf16 v[200:203], a[220:223], v[148:151], v[200:203]
L1_PAD12:
 s_cbranch_execz L1_PRL0
 buffer_store_dwordx4 v[180:183], v240, s[64:67], s84 offen sc0 sc1
 v_mfma_f32_16x16x32_bf16 v[200:203], a[216:219], v[136:139], v[200:203]
 s_waitcnt lgkmcnt(8)
 v_mul_f32 v178, v178, v8
 v_mul_f32 v179, v179, v8
 v_mfma_f32_16x16x32_bf16 v[212:215], a[192:195], v[64:67], 0
 ds_read_b64_tr_b16 a[216:217], v39 offset:57344
 v_mul_f32 v188, v188, v8
 v_mfma_f32_16x16x32_bf16 v[212:215], a[196:199], v[76:79], v[212:215]
 ds_read_b64_tr_b16 a[218:219], v39 offset:59392
 v_mul_f32 v189, v189, v8
 v_mfma_f32_16x16x32_bf16 v[216:219], a[196:199], v[80:83], 0
 ds_read_b64_tr_b16 a[220:221], v39 offset:61440
 v_mul_f32 v190, v190, v8
 v_mfma_f32_16x16x32_bf16 v[216:219], a[192:195], v[68:71], v[216:219]
 ds_read_b64_tr_b16 a[222:223], v39 offset:63488
 v_mul_f32 v191, v191, v8
 v_mfma_f32_16x16x32_bf16 v[220:223], a[192:195], v[72:75], 0
 v_cvt_pk_bf16_f32 v176, v176, v177
 v_cvt_pk_bf16_f32 v177, v178, v179
 v_mfma_f32_16x16x32_bf16 v[220:223], a[196:199], v[84:87], v[220:223]
 s_waitcnt lgkmcnt(8)
 v_cvt_pk_bf16_f32 v178, v188, v189
 v_cvt_pk_bf16_f32 v179, v190, v191
 v_mfma_f32_16x16x32_bf16 v[220:223], a[204:207], v[108:111], v[220:223]
 buffer_store_dwordx4 v[176:179], v5, s[64:67], s84 offen sc0 sc1
 v_mfma_f32_16x16x32_bf16 v[220:223], a[200:203], v[96:99], v[220:223]
 s_waitcnt vmcnt(31) lgkmcnt(0)
 s_barrier
 v_mfma_f32_16x16x32_bf16 v[216:219], a[200:203], v[92:95], v[216:219]
 ds_read_b64_tr_b16 a[192:193], v24 offset:0
 v_mov_b32 v31, 0x18000
 v_mfma_f32_16x16x32_bf16 v[216:219], a[204:207], v[104:107], v[216:219]
 ds_read_b64_tr_b16 a[194:195], v24 offset:2048
 s_lshl_b32 s10, s6, 3
 v_mfma_f32_16x16x32_bf16 v[212:215], a[204:207], v[100:103], v[212:215]
 ds_read_b64_tr_b16 a[196:197], v24 offset:4096
 v_mfma_f32_16x16x32_bf16 v[212:215], a[200:203], v[88:91], v[212:215]
 ds_read_b64_tr_b16 a[198:199], v24 offset:6144
 s_add_u32 s10, s10, s7
 v_mfma_f32_16x16x32_bf16 v[212:215], a[208:211], v[112:115], v[212:215]
 ds_read_b64_tr_b16 a[200:201], v24 offset:8192
 s_mul_i32 s10, s10, 2523136
 v_mfma_f32_16x16x32_bf16 v[212:215], a[212:215], v[124:127], v[212:215]
 ds_read_b64_tr_b16 a[202:203], v24 offset:10240
 s_add_u32 s10, s10, 0x4000000
 v_mfma_f32_16x16x32_bf16 v[216:219], a[212:215], v[128:131], v[216:219]
 ds_read_b64_tr_b16 a[204:205], v24 offset:12288
 s_add_u32 s56, s40, s10
 s_addc_u32 s57, s41, 0
 v_mfma_f32_16x16x32_bf16 v[216:219], a[208:211], v[116:119], v[216:219]
 ds_read_b64_tr_b16 a[206:207], v24 offset:14336
 s_mov_b32 s58, 0x268000
 v_mfma_f32_16x16x32_bf16 v[220:223], a[208:211], v[120:123], v[220:223]
 s_mov_b32 s59, 0x20000
 s_mul_i32 s10, s7, 315392
 v_mfma_f32_16x16x32_bf16 v[220:223], a[212:215], v[132:135], v[220:223]
 s_mul_i32 s11, s6, 896
 v_mfma_f32_16x16x32_bf16 v[220:223], a[220:223], v[156:159], v[220:223]
 ds_read_b64_tr_b16 a[208:209], v24 offset:16384
 s_add_u32 s10, s10, s11
 v_mfma_f32_16x16x32_bf16 v[220:223], a[216:219], v[144:147], v[220:223]
 ds_read_b64_tr_b16 a[210:211], v24 offset:18432
 s_add_u32 s48, s36, s10
 s_addc_u32 s49, s37, 0
 v_mfma_f32_16x16x32_bf16 v[216:219], a[216:219], v[140:143], v[216:219]
 ds_read_b64_tr_b16 a[212:213], v24 offset:20480
 s_mov_b32 s50, 0x4cc80
 v_mfma_f32_16x16x32_bf16 v[216:219], a[220:223], v[152:155], v[216:219]
 ds_read_b64_tr_b16 a[214:215], v24 offset:22528
 s_mov_b32 s51, 0x20000
 v_mfma_f32_16x16x32_bf16 v[212:215], a[220:223], v[148:151], v[212:215]
 s_mov_b32 s14, 0x1000
 s_mov_b32 s15, 0x2000
 v_mfma_f32_16x16x32_bf16 v[212:215], a[216:219], v[136:139], v[212:215]
 s_waitcnt lgkmcnt(8)
 s_mov_b32 s42, 0x3000
 v_mfma_f32_16x16x32_bf16 v[160:163], a[192:195], v[64:67], 0
 ds_read_b64_tr_b16 a[216:217], v24 offset:24576
 s_mov_b32 s85, 0x24000
 v_mfma_f32_16x16x32_bf16 v[160:163], a[196:199], v[76:79], v[160:163]
 ds_read_b64_tr_b16 a[218:219], v24 offset:26624
 v_mfma_f32_16x16x32_bf16 v[164:167], a[196:199], v[80:83], 0
 ds_read_b64_tr_b16 a[220:221], v24 offset:28672
 v_mfma_f32_16x16x32_bf16 v[164:167], a[192:195], v[68:71], v[164:167]
 ds_read_b64_tr_b16 a[222:223], v24 offset:30720
 v_mul_f32 v208, v208, v10
 v_mfma_f32_16x16x32_bf16 v[168:171], a[192:195], v[72:75], 0
 v_mul_f32 v209, v209, v10
 v_mul_f32 v210, v210, v10
 v_mfma_f32_16x16x32_bf16 v[168:171], a[196:199], v[84:87], v[168:171]
 s_waitcnt lgkmcnt(8)
 v_mul_f32 v211, v211, v10
 v_mul_f32 v220, v220, v10
 v_mfma_f32_16x16x32_bf16 v[168:171], a[204:207], v[108:111], v[168:171]
 ds_read_b64_tr_b16 a[192:193], v25 offset:0
 v_mul_f32 v221, v221, v10
 v_mfma_f32_16x16x32_bf16 v[168:171], a[200:203], v[96:99], v[168:171]
 ds_read_b64_tr_b16 a[194:195], v25 offset:2048
 v_mul_f32 v222, v222, v10
 v_mfma_f32_16x16x32_bf16 v[164:167], a[200:203], v[92:95], v[164:167]
 ds_read_b64_tr_b16 a[196:197], v25 offset:4096
 v_mul_f32 v223, v223, v10
 v_mfma_f32_16x16x32_bf16 v[164:167], a[204:207], v[104:107], v[164:167]
 ds_read_b64_tr_b16 a[198:199], v25 offset:6144
 v_cvt_pk_bf16_f32 v208, v208, v209
 v_mfma_f32_16x16x32_bf16 v[160:163], a[204:207], v[100:103], v[160:163]
 v_cvt_pk_bf16_f32 v209, v210, v211
 v_cvt_pk_bf16_f32 v210, v220, v221
 v_mfma_f32_16x16x32_bf16 v[160:163], a[200:203], v[88:91], v[160:163]
 s_waitcnt lgkmcnt(8)
 v_cvt_pk_bf16_f32 v211, v222, v223
 v_mul_f32 v204, v204, v9
 v_mfma_f32_16x16x32_bf16 v[160:163], a[208:211], v[112:115], v[160:163]
 ds_read_b64_tr_b16 a[200:201], v25 offset:8192
 v_mul_f32 v205, v205, v9
 v_mfma_f32_16x16x32_bf16 v[160:163], a[212:215], v[124:127], v[160:163]
 ds_read_b64_tr_b16 a[202:203], v25 offset:10240
 v_mul_f32 v206, v206, v9
 v_mfma_f32_16x16x32_bf16 v[164:167], a[212:215], v[128:131], v[164:167]
 ds_read_b64_tr_b16 a[204:205], v25 offset:12288
 v_mfma_f32_16x16x32_bf16 v[164:167], a[208:211], v[116:119], v[164:167]
 ds_read_b64_tr_b16 a[206:207], v25 offset:14336
 v_mul_f32 v207, v207, v9
 v_mfma_f32_16x16x32_bf16 v[168:171], a[208:211], v[120:123], v[168:171]
 buffer_store_dwordx4 v[208:211], v241, s[64:67], s85 offen sc0 sc1
 v_mfma_f32_16x16x32_bf16 v[168:171], a[212:215], v[132:135], v[168:171]
 s_waitcnt lgkmcnt(8)
 v_mul_f32 v216, v216, v9
 v_mul_f32 v217, v217, v9
 v_mfma_f32_16x16x32_bf16 v[168:171], a[220:223], v[156:159], v[168:171]
 ds_read_b64_tr_b16 a[208:209], v25 offset:16384
 v_mul_f32 v218, v218, v9
 v_mfma_f32_16x16x32_bf16 v[168:171], a[216:219], v[144:147], v[168:171]
 ds_read_b64_tr_b16 a[210:211], v25 offset:18432
 v_mul_f32 v219, v219, v9
 v_mfma_f32_16x16x32_bf16 v[164:167], a[216:219], v[140:143], v[164:167]
 ds_read_b64_tr_b16 a[212:213], v25 offset:20480
 v_cvt_pk_bf16_f32 v204, v204, v205
 v_mfma_f32_16x16x32_bf16 v[164:167], a[220:223], v[152:155], v[164:167]
 ds_read_b64_tr_b16 a[214:215], v25 offset:22528
 v_cvt_pk_bf16_f32 v205, v206, v207
 v_mfma_f32_16x16x32_bf16 v[160:163], a[220:223], v[148:151], v[160:163]
 v_cvt_pk_bf16_f32 v206, v216, v217
 v_mfma_f32_16x16x32_bf16 v[160:163], a[216:219], v[136:139], v[160:163]
 s_waitcnt lgkmcnt(8)
 v_cvt_pk_bf16_f32 v207, v218, v219
 v_mul_f32 v200, v200, v8
 v_mfma_f32_16x16x32_bf16 v[172:175], a[192:195], v[64:67], 0
 ds_read_b64_tr_b16 a[216:217], v25 offset:24576
 v_mul_f32 v201, v201, v8
 v_mfma_f32_16x16x32_bf16 v[172:175], a[196:199], v[76:79], v[172:175]
 ds_read_b64_tr_b16 a[218:219], v25 offset:26624
 v_mul_f32 v202, v202, v8
 v_mfma_f32_16x16x32_bf16 v[224:227], a[196:199], v[80:83], 0
 ds_read_b64_tr_b16 a[220:221], v25 offset:28672
 v_mul_f32 v203, v203, v8
 v_mfma_f32_16x16x32_bf16 v[224:227], a[192:195], v[68:71], v[224:227]
 ds_read_b64_tr_b16 a[222:223], v25 offset:30720
 v_mul_f32 v212, v212, v8
 v_mfma_f32_16x16x32_bf16 v[228:231], a[192:195], v[72:75], 0
 buffer_store_dwordx4 v[204:207], v240, s[64:67], s85 offen sc0 sc1
 v_mfma_f32_16x16x32_bf16 v[228:231], a[196:199], v[84:87], v[228:231]
 s_waitcnt lgkmcnt(8)
 v_mul_f32 v213, v213, v8
 v_mfma_f32_16x16x32_bf16 v[228:231], a[204:207], v[108:111], v[228:231]
 ds_read_b64_tr_b16 a[192:193], v26 offset:0
 v_mul_f32 v214, v214, v8
 v_mfma_f32_16x16x32_bf16 v[228:231], a[200:203], v[96:99], v[228:231]
 ds_read_b64_tr_b16 a[194:195], v26 offset:2048
 v_mul_f32 v215, v215, v8
 v_mfma_f32_16x16x32_bf16 v[224:227], a[200:203], v[92:95], v[224:227]
 ds_read_b64_tr_b16 a[196:197], v26 offset:4096
 v_cvt_pk_bf16_f32 v200, v200, v201
 v_mfma_f32_16x16x32_bf16 v[224:227], a[204:207], v[104:107], v[224:227]
 ds_read_b64_tr_b16 a[198:199], v26 offset:6144
 v_cvt_pk_bf16_f32 v201, v202, v203
 v_mfma_f32_16x16x32_bf16 v[172:175], a[204:207], v[100:103], v[172:175]
 v_cvt_pk_bf16_f32 v202, v212, v213
 v_mfma_f32_16x16x32_bf16 v[172:175], a[200:203], v[88:91], v[172:175]
 s_waitcnt lgkmcnt(8)
 v_cvt_pk_bf16_f32 v203, v214, v215
 v_and_b32 v32, 15, v7
 v_mfma_f32_16x16x32_bf16 v[172:175], a[208:211], v[112:115], v[172:175]
 ds_read_b64_tr_b16 a[200:201], v26 offset:8192
 v_lshrrev_b32 v33, 4, v7
 v_mfma_f32_16x16x32_bf16 v[172:175], a[212:215], v[124:127], v[172:175]
 ds_read_b64_tr_b16 a[202:203], v26 offset:10240
 v_lshlrev_b32 v46, 4, v32
 v_mfma_f32_16x16x32_bf16 v[224:227], a[212:215], v[128:131], v[224:227]
 ds_read_b64_tr_b16 a[204:205], v26 offset:12288
 v_lshl_add_u32 v46, v33, 9, v46
 v_mfma_f32_16x16x32_bf16 v[224:227], a[208:211], v[116:119], v[224:227]
 ds_read_b64_tr_b16 a[206:207], v26 offset:14336
 v_mul_u32_u24 v45, 0x700, v32
 v_mfma_f32_16x16x32_bf16 v[228:231], a[208:211], v[120:123], v[228:231]
 buffer_store_dwordx4 v[200:203], v5, s[64:67], s85 offen sc0 sc1
 v_mfma_f32_16x16x32_bf16 v[228:231], a[212:215], v[132:135], v[228:231]
 s_waitcnt lgkmcnt(8)
 v_and_b32 v32, 1, v33
 v_mfma_f32_16x16x32_bf16 v[228:231], a[220:223], v[156:159], v[228:231]
 ds_read_b64_tr_b16 a[208:209], v26 offset:16384
 v_lshl_add_u32 v45, v32, 5, v45
 v_mfma_f32_16x16x32_bf16 v[228:231], a[216:219], v[144:147], v[228:231]
 ds_read_b64_tr_b16 a[210:211], v26 offset:18432
 v_lshrrev_b32 v32, 1, v33
 s_mov_b32 s84, 0x28000
 v_mfma_f32_16x16x32_bf16 v[224:227], a[216:219], v[140:143], v[224:227]
 ds_read_b64_tr_b16 a[212:213], v26 offset:20480
 v_lshl_add_u32 v45, v32, 4, v45
 v_mfma_f32_16x16x32_bf16 v[224:227], a[220:223], v[152:155], v[224:227]
 ds_read_b64_tr_b16 a[214:215], v26 offset:22528
 v_lshrrev_b32 v32, 3, v7
 v_mfma_f32_16x16x32_bf16 v[172:175], a[220:223], v[148:151], v[172:175]
 v_xor_b32 v32, v32, v33
 v_mfma_f32_16x16x32_bf16 v[172:175], a[216:219], v[136:139], v[172:175]
 s_waitcnt lgkmcnt(8)
 v_and_b32 v32, 1, v32
 v_bfe_u32 v33, v7, 1, 2
 v_mfma_f32_16x16x32_bf16 v[232:235], a[192:195], v[64:67], 0
 ds_read_b64_tr_b16 a[216:217], v26 offset:24576
 v_lshl_add_u32 v32, v32, 2, v33
 v_mfma_f32_16x16x32_bf16 v[232:235], a[196:199], v[76:79], v[232:235]
 ds_read_b64_tr_b16 a[218:219], v26 offset:26624
 v_and_b32 v33, 1, v7
 v_mfma_f32_16x16x32_bf16 v[244:247], a[196:199], v[80:83], 0
 ds_read_b64_tr_b16 a[220:221], v26 offset:28672
 v_lshlrev_b32 v33, 4, v33
 v_mfma_f32_16x16x32_bf16 v[244:247], a[192:195], v[68:71], v[244:247]
 ds_read_b64_tr_b16 a[222:223], v26 offset:30720
 v_mov_b32 v48, 0x3f80
 v_mfma_f32_16x16x32_bf16 v[248:251], a[192:195], v[72:75], 0
 v_lshlrev_b32 v33, v33, v48
 v_mfma_f32_16x16x32_bf16 v[248:251], a[196:199], v[84:87], v[248:251]
 s_waitcnt lgkmcnt(8)
 v_cmp_eq_u32 vcc, 0, v32
 s_nop 1
 v_cndmask_b32 v48, 0, v33, vcc
 v_mul_f32 v168, v168, v10
 v_mfma_f32_16x16x32_bf16 v[248:251], a[204:207], v[108:111], v[248:251]
 ds_read_b64_tr_b16 a[192:193], v27 offset:0
 v_mul_f32 v169, v169, v10
 v_mfma_f32_16x16x32_bf16 v[248:251], a[200:203], v[96:99], v[248:251]
 ds_read_b64_tr_b16 a[194:195], v27 offset:2048
 v_cmp_eq_u32 vcc, 1, v32
 s_nop 1
 v_cndmask_b32 v49, 0, v33, vcc
 v_mfma_f32_16x16x32_bf16 v[244:247], a[200:203], v[92:95], v[244:247]
 ds_read_b64_tr_b16 a[196:197], v27 offset:4096
 v_mul_f32 v170, v170, v10
 v_mfma_f32_16x16x32_bf16 v[244:247], a[204:207], v[104:107], v[244:247]
 ds_read_b64_tr_b16 a[198:199], v27 offset:6144
 v_cmp_eq_u32 vcc, 2, v32
 s_nop 1
 v_cndmask_b32 v50, 0, v33, vcc
 v_mfma_f32_16x16x32_bf16 v[232:235], a[204:207], v[100:103], v[232:235]
 v_mul_f32 v171, v171, v10
 v_mfma_f32_16x16x32_bf16 v[232:235], a[200:203], v[88:91], v[232:235]
 s_waitcnt lgkmcnt(8)
 v_mul_f32 v228, v228, v10
 v_mul_f32 v229, v229, v10
 v_mfma_f32_16x16x32_bf16 v[232:235], a[208:211], v[112:115], v[232:235]
 ds_read_b64_tr_b16 a[200:201], v27 offset:8192
 v_mul_f32 v230, v230, v10
 v_mfma_f32_16x16x32_bf16 v[232:235], a[212:215], v[124:127], v[232:235]
 ds_read_b64_tr_b16 a[202:203], v27 offset:10240
 v_mul_f32 v231, v231, v10
 v_mfma_f32_16x16x32_bf16 v[244:247], a[212:215], v[128:131], v[244:247]
 ds_read_b64_tr_b16 a[204:205], v27 offset:12288
 v_cvt_pk_bf16_f32 v168, v168, v169
 v_mfma_f32_16x16x32_bf16 v[244:247], a[208:211], v[116:119], v[244:247]
 ds_read_b64_tr_b16 a[206:207], v27 offset:14336
 v_mfma_f32_16x16x32_bf16 v[248:251], a[208:211], v[120:123], v[248:251]
 v_cvt_pk_bf16_f32 v169, v170, v171
 v_cvt_pk_bf16_f32 v170, v228, v229
 v_mfma_f32_16x16x32_bf16 v[248:251], a[212:215], v[132:135], v[248:251]
 s_waitcnt lgkmcnt(8)
 v_cvt_pk_bf16_f32 v171, v230, v231
 v_mul_f32 v164, v164, v9
 v_mfma_f32_16x16x32_bf16 v[248:251], a[220:223], v[156:159], v[248:251]
 ds_read_b64_tr_b16 a[208:209], v27 offset:16384
 v_mul_f32 v165, v165, v9
 v_mfma_f32_16x16x32_bf16 v[248:251], a[216:219], v[144:147], v[248:251]
 ds_read_b64_tr_b16 a[210:211], v27 offset:18432
 v_mfma_f32_16x16x32_bf16 v[244:247], a[216:219], v[140:143], v[244:247]
 ds_read_b64_tr_b16 a[212:213], v27 offset:20480
 v_mul_f32 v166, v166, v9
 v_mfma_f32_16x16x32_bf16 v[244:247], a[220:223], v[152:155], v[244:247]
 ds_read_b64_tr_b16 a[214:215], v27 offset:22528
 v_mul_f32 v167, v167, v9
 v_mfma_f32_16x16x32_bf16 v[232:235], a[220:223], v[148:151], v[232:235]
 buffer_store_dwordx4 v[168:171], v241, s[64:67], s84 offen sc0 sc1
 v_mfma_f32_16x16x32_bf16 v[232:235], a[216:219], v[136:139], v[232:235]
 s_waitcnt lgkmcnt(8)
 v_mul_f32 v224, v224, v9
 v_mul_f32 v225, v225, v9
 v_mfma_f32_16x16x32_bf16 v[252:255], a[192:195], v[64:67], 0
 ds_read_b64_tr_b16 a[216:217], v27 offset:24576
 v_mfma_f32_16x16x32_bf16 v[252:255], a[196:199], v[76:79], v[252:255]
 ds_read_b64_tr_b16 a[218:219], v27 offset:26624
 v_mul_f32 v226, v226, v9
 v_mfma_f32_16x16x32_bf16 v[16:19], a[196:199], v[80:83], 0
 ds_read_b64_tr_b16 a[220:221], v27 offset:28672
 v_mul_f32 v227, v227, v9
 v_mfma_f32_16x16x32_bf16 v[16:19], a[192:195], v[68:71], v[16:19]
 ds_read_b64_tr_b16 a[222:223], v27 offset:30720
 v_cvt_pk_bf16_f32 v164, v164, v165
 v_mfma_f32_16x16x32_bf16 v[20:23], a[192:195], v[72:75], 0
 v_cvt_pk_bf16_f32 v165, v166, v167
 v_mfma_f32_16x16x32_bf16 v[20:23], a[196:199], v[84:87], v[20:23]
 s_waitcnt lgkmcnt(8)
 v_cvt_pk_bf16_f32 v166, v224, v225
 v_cvt_pk_bf16_f32 v167, v226, v227
 v_mfma_f32_16x16x32_bf16 v[20:23], a[204:207], v[108:111], v[20:23]
 buffer_store_dwordx4 v[164:167], v240, s[64:67], s84 offen sc0 sc1
 v_mfma_f32_16x16x32_bf16 v[20:23], a[200:203], v[96:99], v[20:23]
 s_waitcnt vmcnt(26) lgkmcnt(0)
 s_barrier
 ds_read_b32 v28, v31 offset:4
 v_mfma_f32_16x16x32_bf16 v[16:19], a[200:203], v[92:95], v[16:19]
 ds_read_b64_tr_b16 a[192:193], v236 offset:0
 v_mul_f32 v160, v160, v8
 v_mfma_f32_16x16x32_bf16 v[16:19], a[204:207], v[104:107], v[16:19]
 ds_read_b64_tr_b16 a[194:195], v236 offset:2048
 v_mfma_f32_16x16x32_bf16 v[252:255], a[204:207], v[100:103], v[252:255]
 ds_read_b64_tr_b16 a[196:197], v236 offset:4096
 v_mul_f32 v161, v161, v8
 v_mfma_f32_16x16x32_bf16 v[252:255], a[200:203], v[88:91], v[252:255]
 ds_read_b64_tr_b16 a[198:199], v236 offset:6144
 v_mul_f32 v162, v162, v8
 v_mfma_f32_16x16x32_bf16 v[252:255], a[208:211], v[112:115], v[252:255]
 ds_read_b64_tr_b16 a[200:201], v236 offset:8192
 v_mul_f32 v163, v163, v8
 v_mfma_f32_16x16x32_bf16 v[252:255], a[212:215], v[124:127], v[252:255]
 ds_read_b64_tr_b16 a[202:203], v236 offset:10240
 v_mul_f32 v172, v172, v8
 v_mfma_f32_16x16x32_bf16 v[16:19], a[212:215], v[128:131], v[16:19]
 ds_read_b64_tr_b16 a[204:205], v236 offset:12288
 v_mfma_f32_16x16x32_bf16 v[16:19], a[208:211], v[116:119], v[16:19]
 ds_read_b64_tr_b16 a[206:207], v236 offset:14336
 v_mul_f32 v173, v173, v8
 v_mfma_f32_16x16x32_bf16 v[20:23], a[208:211], v[120:123], v[20:23]
 v_mul_f32 v174, v174, v8
 v_mul_f32 v175, v175, v8
 v_mfma_f32_16x16x32_bf16 v[20:23], a[212:215], v[132:135], v[20:23]
 v_cvt_pk_bf16_f32 v160, v160, v161
 v_mfma_f32_16x16x32_bf16 v[20:23], a[220:223], v[156:159], v[20:23]
 ds_read_b64_tr_b16 a[208:209], v236 offset:16384
 v_cvt_pk_bf16_f32 v161, v162, v163
 v_mfma_f32_16x16x32_bf16 v[20:23], a[216:219], v[144:147], v[20:23]
 ds_read_b64_tr_b16 a[210:211], v236 offset:18432
 v_cvt_pk_bf16_f32 v162, v172, v173
 v_mfma_f32_16x16x32_bf16 v[16:19], a[216:219], v[140:143], v[16:19]
 ds_read_b64_tr_b16 a[212:213], v236 offset:20480
 v_mfma_f32_16x16x32_bf16 v[16:19], a[220:223], v[152:155], v[16:19]
 ds_read_b64_tr_b16 a[214:215], v236 offset:22528
 v_cvt_pk_bf16_f32 v163, v174, v175
 v_mfma_f32_16x16x32_bf16 v[252:255], a[220:223], v[148:151], v[252:255]
 buffer_store_dwordx4 v[160:163], v5, s[64:67], s84 offen sc0 sc1
 v_mfma_f32_16x16x32_bf16 v[252:255], a[216:219], v[136:139], v[252:255]
 s_waitcnt lgkmcnt(8)
 v_cmp_eq_u32 vcc, 3, v32
 s_nop 1
 v_cndmask_b32 v51, 0, v33, vcc
 v_mfma_f32_16x16x32_bf16 v[176:179], a[192:195], v[64:67], 0
 ds_read_b64_tr_b16 a[216:217], v236 offset:24576
 s_mov_b32 s85, 0x2c000
 v_mfma_f32_16x16x32_bf16 v[176:179], a[196:199], v[76:79], v[176:179]
 ds_read_b64_tr_b16 a[218:219], v236 offset:26624
 v_readfirstlane_b32 s22, v28
 v_mfma_f32_16x16x32_bf16 v[180:183], a[196:199], v[80:83], 0
 ds_read_b64_tr_b16 a[220:221], v236 offset:28672
 v_mfma_f32_16x16x32_bf16 v[180:183], a[192:195], v[68:71], v[180:183]
 ds_read_b64_tr_b16 a[222:223], v236 offset:30720
 v_mul_f32 v248, v248, v10
 v_mfma_f32_16x16x32_bf16 v[184:187], a[192:195], v[72:75], 0
 v_mul_f32 v249, v249, v10
 v_mul_f32 v250, v250, v10
 v_mfma_f32_16x16x32_bf16 v[184:187], a[196:199], v[84:87], v[184:187]
 s_waitcnt lgkmcnt(8)
 v_mul_f32 v251, v251, v10
 v_mul_f32 v20, v20, v10
 v_mfma_f32_16x16x32_bf16 v[184:187], a[204:207], v[108:111], v[184:187]
 ds_read_b64_tr_b16 a[192:193], v237 offset:0
 v_mul_f32 v21, v21, v10
 v_mfma_f32_16x16x32_bf16 v[184:187], a[200:203], v[96:99], v[184:187]
 ds_read_b64_tr_b16 a[194:195], v237 offset:2048
 v_mul_f32 v22, v22, v10
 v_mfma_f32_16x16x32_bf16 v[180:183], a[200:203], v[92:95], v[180:183]
 ds_read_b64_tr_b16 a[196:197], v237 offset:4096
 v_mul_f32 v23, v23, v10
 v_mfma_f32_16x16x32_bf16 v[180:183], a[204:207], v[104:107], v[180:183]
 ds_read_b64_tr_b16 a[198:199], v237 offset:6144
 v_cvt_pk_bf16_f32 v248, v248, v249
 v_mfma_f32_16x16x32_bf16 v[176:179], a[204:207], v[100:103], v[176:179]
 v_cvt_pk_bf16_f32 v249, v250, v251
 v_mfma_f32_16x16x32_bf16 v[176:179], a[200:203], v[88:91], v[176:179]
 s_waitcnt lgkmcnt(8)
 v_cvt_pk_bf16_f32 v250, v20, v21
 v_cvt_pk_bf16_f32 v251, v22, v23
 v_mfma_f32_16x16x32_bf16 v[176:179], a[208:211], v[112:115], v[176:179]
 ds_read_b64_tr_b16 a[200:201], v237 offset:8192
 v_mfma_f32_16x16x32_bf16 v[176:179], a[212:215], v[124:127], v[176:179]
 ds_read_b64_tr_b16 a[202:203], v237 offset:10240
 v_mul_f32 v244, v244, v9
 v_mfma_f32_16x16x32_bf16 v[180:183], a[212:215], v[128:131], v[180:183]
 ds_read_b64_tr_b16 a[204:205], v237 offset:12288
 v_mul_f32 v245, v245, v9
 v_mfma_f32_16x16x32_bf16 v[180:183], a[208:211], v[116:119], v[180:183]
 ds_read_b64_tr_b16 a[206:207], v237 offset:14336
 v_mul_f32 v246, v246, v9
 v_mfma_f32_16x16x32_bf16 v[184:187], a[208:211], v[120:123], v[184:187]
 buffer_store_dwordx4 v[248:251], v241, s[64:67], s85 offen sc0 sc1
 v_mfma_f32_16x16x32_bf16 v[184:187], a[212:215], v[132:135], v[184:187]
 s_waitcnt lgkmcnt(8)
 v_mul_f32 v247, v247, v9
 v_mfma_f32_16x16x32_bf16 v[184:187], a[220:223], v[156:159], v[184:187]
 ds_read_b64_tr_b16 a[208:209], v237 offset:16384
 v_mul_f32 v16, v16, v9
 v_mfma_f32_16x16x32_bf16 v[184:187], a[216:219], v[144:147], v[184:187]
 ds_read_b64_tr_b16 a[210:211], v237 offset:18432
 v_mul_f32 v17, v17, v9
 v_mfma_f32_16x16x32_bf16 v[180:183], a[216:219], v[140:143], v[180:183]
 ds_read_b64_tr_b16 a[212:213], v237 offset:20480
 v_mfma_f32_16x16x32_bf16 v[180:183], a[220:223], v[152:155], v[180:183]
 ds_read_b64_tr_b16 a[214:215], v237 offset:22528
 v_mul_f32 v18, v18, v9
 v_mfma_f32_16x16x32_bf16 v[176:179], a[220:223], v[148:151], v[176:179]
 v_mul_f32 v19, v19, v9
 v_cvt_pk_bf16_f32 v244, v244, v245
 v_mfma_f32_16x16x32_bf16 v[176:179], a[216:219], v[136:139], v[176:179]
 s_waitcnt lgkmcnt(8)
 v_cvt_pk_bf16_f32 v245, v246, v247
 v_mfma_f32_16x16x32_bf16 v[188:191], a[192:195], v[64:67], 0
 ds_read_b64_tr_b16 a[216:217], v237 offset:24576
 v_cvt_pk_bf16_f32 v246, v16, v17
 v_mfma_f32_16x16x32_bf16 v[188:191], a[196:199], v[76:79], v[188:191]
 ds_read_b64_tr_b16 a[218:219], v237 offset:26624
 v_cvt_pk_bf16_f32 v247, v18, v19
 v_mfma_f32_16x16x32_bf16 v[192:195], a[196:199], v[80:83], 0
 ds_read_b64_tr_b16 a[220:221], v237 offset:28672
 v_mul_f32 v232, v232, v8
 v_mfma_f32_16x16x32_bf16 v[192:195], a[192:195], v[68:71], v[192:195]
 ds_read_b64_tr_b16 a[222:223], v237 offset:30720
 v_mfma_f32_16x16x32_bf16 v[196:199], a[192:195], v[72:75], 0
 buffer_store_dwordx4 v[244:247], v240, s[64:67], s85 offen sc0 sc1
 s_mov_b32 s25, 0x54483c30
 s_mov_b32 s26, 0x7f766b60
 v_mfma_f32_16x16x32_bf16 v[196:199], a[196:199], v[84:87], v[196:199]
 s_waitcnt lgkmcnt(8)
 v_mul_f32 v233, v233, v8
 v_mfma_f32_16x16x32_bf16 v[196:199], a[204:207], v[108:111], v[196:199]
 ds_read_b64_tr_b16 a[192:193], v238 offset:0
 v_mul_f32 v234, v234, v8
 s_lshl_b32 s10, s22, 3
 v_mfma_f32_16x16x32_bf16 v[196:199], a[200:203], v[96:99], v[196:199]
 ds_read_b64_tr_b16 a[194:195], v238 offset:2048
 v_mul_f32 v235, v235, v8
 v_mfma_f32_16x16x32_bf16 v[192:195], a[200:203], v[92:95], v[192:195]
 ds_read_b64_tr_b16 a[196:197], v238 offset:4096
 v_mul_f32 v252, v252, v8
 v_mfma_f32_16x16x32_bf16 v[192:195], a[204:207], v[104:107], v[192:195]
 ds_read_b64_tr_b16 a[198:199], v238 offset:6144
 v_mul_f32 v253, v253, v8
 v_mfma_f32_16x16x32_bf16 v[188:191], a[204:207], v[100:103], v[188:191]
 v_mul_f32 v254, v254, v8
 v_mfma_f32_16x16x32_bf16 v[188:191], a[200:203], v[88:91], v[188:191]
 s_waitcnt lgkmcnt(8)
 v_mul_f32 v255, v255, v8
 s_lshl_b32 s11, s22, 2
 v_cvt_pk_bf16_f32 v232, v232, v233
 v_mfma_f32_16x16x32_bf16 v[188:191], a[208:211], v[112:115], v[188:191]
 ds_read_b64_tr_b16 a[200:201], v238 offset:8192
 v_mfma_f32_16x16x32_bf16 v[188:191], a[212:215], v[124:127], v[188:191]
 ds_read_b64_tr_b16 a[202:203], v238 offset:10240
 v_cvt_pk_bf16_f32 v233, v234, v235
 v_mfma_f32_16x16x32_bf16 v[192:195], a[212:215], v[128:131], v[192:195]
 ds_read_b64_tr_b16 a[204:205], v238 offset:12288
 v_cvt_pk_bf16_f32 v234, v252, v253
 v_mfma_f32_16x16x32_bf16 v[192:195], a[208:211], v[116:119], v[192:195]
 ds_read_b64_tr_b16 a[206:207], v238 offset:14336
 v_cvt_pk_bf16_f32 v235, v254, v255
 v_mfma_f32_16x16x32_bf16 v[196:199], a[208:211], v[120:123], v[196:199]
 buffer_store_dwordx4 v[232:235], v5, s[64:67], s85 offen sc0 sc1
 v_mfma_f32_16x16x32_bf16 v[196:199], a[212:215], v[132:135], v[196:199]
 s_waitcnt lgkmcnt(8)
 s_mov_b32 s24, 0x24180c00
 v_mfma_f32_16x16x32_bf16 v[196:199], a[220:223], v[156:159], v[196:199]
 ds_read_b64_tr_b16 a[208:209], v238 offset:16384
 s_mov_b32 s27, 0x97948e88
 s_cmp_lt_u32 s22, 8
 s_cselect_b64 s[24:25], s[24:25], s[26:27]
 s_mov_b32 s27, 0x336699bb
 v_mfma_f32_16x16x32_bf16 v[196:199], a[216:219], v[144:147], v[196:199]
 ds_read_b64_tr_b16 a[210:211], v238 offset:18432
 v_mfma_f32_16x16x32_bf16 v[192:195], a[216:219], v[140:143], v[192:195]
 ds_read_b64_tr_b16 a[212:213], v238 offset:20480
 s_lshr_b64 s[24:25], s[24:25], s10
 s_and_b32 s10, s24, 0xff
 s_add_u32 s10, s10, s72
 s_lshl_b32 s12, s10, 6
 v_mfma_f32_16x16x32_bf16 v[192:195], a[220:223], v[152:155], v[192:195]
 ds_read_b64_tr_b16 a[214:215], v238 offset:22528
 s_mov_b32 s26, 0xcccccccc
 v_mfma_f32_16x16x32_bf16 v[188:191], a[220:223], v[148:151], v[188:191]
 s_lshr_b64 s[26:27], s[26:27], s11
 s_and_b32 s11, s26, 15
 s_sub_u32 s11, s11, s72
 s_add_u32 s11, s11, 2
 s_mul_i32 s11, s11, 43
 s_lshr_b32 s21, s11, 7
 v_mfma_f32_16x16x32_bf16 v[188:191], a[216:219], v[136:139], v[188:191]
 s_waitcnt lgkmcnt(8)
 s_lshl_b32 s11, s10, 14
 v_mfma_f32_16x16x32_bf16 v[200:203], a[192:195], v[64:67], 0
 ds_read_b64_tr_b16 a[216:217], v238 offset:24576
 v_add_u32 v40, s11, v46
 s_mul_i32 s11, s10, 4682
 s_add_u32 s10, s10, 3
 v_mfma_f32_16x16x32_bf16 v[200:203], a[196:199], v[76:79], v[200:203]
 ds_read_b64_tr_b16 a[218:219], v238 offset:26624
 s_lshr_b32 s11, s11, 16
 s_mul_i32 s11, s11, 27776
 v_mfma_f32_16x16x32_bf16 v[204:207], a[196:199], v[80:83], 0
 ds_read_b64_tr_b16 a[220:221], v238 offset:28672
 v_mfma_f32_16x16x32_bf16 v[204:207], a[192:195], v[68:71], v[204:207]
 ds_read_b64_tr_b16 a[222:223], v238 offset:30720
 s_add_u32 s16, s11, s12
 s_lshl_b32 s11, s10, 14
 s_lshl_b32 s12, s10, 6
 v_mfma_f32_16x16x32_bf16 v[208:211], a[192:195], v[72:75], 0
 v_add_u32 v41, s11, v46
 s_mul_i32 s11, s10, 4682
 s_lshr_b32 s11, s11, 16
 s_mul_i32 s11, s11, 27776
 s_add_u32 s17, s11, s12
 v_mfma_f32_16x16x32_bf16 v[208:211], a[196:199], v[84:87], v[208:211]
 s_waitcnt lgkmcnt(8)
 s_add_u32 s10, s10, 3
 s_lshl_b32 s11, s10, 14
 v_mfma_f32_16x16x32_bf16 v[208:211], a[204:207], v[108:111], v[208:211]
 ds_read_b64_tr_b16 a[192:193], v239 offset:0
 v_add_u32 v42, s11, v46
 v_mfma_f32_16x16x32_bf16 v[208:211], a[200:203], v[96:99], v[208:211]
 ds_read_b64_tr_b16 a[194:195], v239 offset:2048
 s_mul_i32 s11, s10, 4682
 s_lshr_b32 s11, s11, 16
 s_mul_i32 s11, s11, 27776
 s_mov_b32 s84, 0x30000
 v_mfma_f32_16x16x32_bf16 v[204:207], a[200:203], v[92:95], v[204:207]
 ds_read_b64_tr_b16 a[196:197], v239 offset:4096
 v_mfma_f32_16x16x32_bf16 v[204:207], a[204:207], v[104:107], v[204:207]
 ds_read_b64_tr_b16 a[198:199], v239 offset:6144
 s_lshl_b32 s12, s10, 6
 s_add_u32 s18, s11, s12
 s_add_u32 s10, s10, 3
 s_lshl_b32 s12, s10, 6
 v_mfma_f32_16x16x32_bf16 v[200:203], a[204:207], v[100:103], v[200:203]
 s_lshl_b32 s11, s10, 14
 v_add_u32 v43, s11, v46
 s_mul_i32 s11, s10, 4682
 s_add_u32 s10, s10, 3
 v_mfma_f32_16x16x32_bf16 v[200:203], a[200:203], v[88:91], v[200:203]
 s_waitcnt lgkmcnt(8)
 s_lshr_b32 s11, s11, 16
 s_mul_i32 s11, s11, 27776
 v_mfma_f32_16x16x32_bf16 v[200:203], a[208:211], v[112:115], v[200:203]
 ds_read_b64_tr_b16 a[200:201], v239 offset:8192
 s_add_u32 s19, s11, s12
 v_mfma_f32_16x16x32_bf16 v[200:203], a[212:215], v[124:127], v[200:203]
 ds_read_b64_tr_b16 a[202:203], v239 offset:10240
 v_mul_f32 v184, v184, v10
 v_mfma_f32_16x16x32_bf16 v[204:207], a[212:215], v[128:131], v[204:207]
 ds_read_b64_tr_b16 a[204:205], v239 offset:12288
 v_mfma_f32_16x16x32_bf16 v[204:207], a[208:211], v[116:119], v[204:207]
 ds_read_b64_tr_b16 a[206:207], v239 offset:14336
 v_mul_f32 v185, v185, v10
 v_mfma_f32_16x16x32_bf16 v[208:211], a[208:211], v[120:123], v[208:211]
 v_mul_f32 v186, v186, v10
 v_mul_f32 v187, v187, v10
 v_mfma_f32_16x16x32_bf16 v[208:211], a[212:215], v[132:135], v[208:211]
 s_waitcnt lgkmcnt(8)
 v_mul_f32 v196, v196, v10
 v_mfma_f32_16x16x32_bf16 v[208:211], a[220:223], v[156:159], v[208:211]
 ds_read_b64_tr_b16 a[208:209], v239 offset:16384
 v_mul_f32 v197, v197, v10
 v_mfma_f32_16x16x32_bf16 v[208:211], a[216:219], v[144:147], v[208:211]
 ds_read_b64_tr_b16 a[210:211], v239 offset:18432
 v_mul_f32 v198, v198, v10
 v_mfma_f32_16x16x32_bf16 v[204:207], a[216:219], v[140:143], v[204:207]
 ds_read_b64_tr_b16 a[212:213], v239 offset:20480
 v_mfma_f32_16x16x32_bf16 v[204:207], a[220:223], v[152:155], v[204:207]
 ds_read_b64_tr_b16 a[214:215], v239 offset:22528
 v_mul_f32 v199, v199, v10
 v_mfma_f32_16x16x32_bf16 v[200:203], a[220:223], v[148:151], v[200:203]
 v_cvt_pk_bf16_f32 v184, v184, v185
 v_cvt_pk_bf16_f32 v185, v186, v187
L1_PAD13:
 s_cbranch_execz L1_PRL0
 v_mfma_f32_16x16x32_bf16 v[200:203], a[216:219], v[136:139], v[200:203]
 s_waitcnt lgkmcnt(8)
 v_cvt_pk_bf16_f32 v186, v196, v197
 v_mfma_f32_16x16x32_bf16 v[212:215], a[192:195], v[64:67], 0
 ds_read_b64_tr_b16 a[216:217], v239 offset:24576
 v_cvt_pk_bf16_f32 v187, v198, v199
 v_mfma_f32_16x16x32_bf16 v[212:215], a[196:199], v[76:79], v[212:215]
 ds_read_b64_tr_b16 a[218:219], v239 offset:26624
 v_mul_f32 v180, v180, v9
 v_mfma_f32_16x16x32_bf16 v[216:219], a[196:199], v[80:83], 0
 ds_read_b64_tr_b16 a[220:221], v239 offset:28672
 v_mfma_f32_16x16x32_bf16 v[216:219], a[192:195], v[68:71], v[216:219]
 ds_read_b64_tr_b16 a[222:223], v239 offset:30720
 v_mul_f32 v181, v181, v9
 v_mfma_f32_16x16x32_bf16 v[220:223], a[192:195], v[72:75], 0
 buffer_store_dwordx4 v[184:187], v241, s[64:67], s84 offen sc0 sc1
 v_mfma_f32_16x16x32_bf16 v[220:223], a[196:199], v[84:87], v[220:223]
 s_waitcnt lgkmcnt(8)
 v_mul_f32 v182, v182, v9
 v_mfma_f32_16x16x32_bf16 v[220:223], a[204:207], v[108:111], v[220:223]
 v_mul_f32 v183, v183, v9
 v_mul_f32 v192, v192, v9
 v_mfma_f32_16x16x32_bf16 v[220:223], a[200:203], v[96:99], v[220:223]
 v_mul_f32 v193, v193, v9
 v_mfma_f32_16x16x32_bf16 v[216:219], a[200:203], v[92:95], v[216:219]
 v_mul_f32 v194, v194, v9
 v_mfma_f32_16x16x32_bf16 v[216:219], a[204:207], v[104:107], v[216:219]
 v_mul_f32 v195, v195, v9
 v_cvt_pk_bf16_f32 v180, v180, v181
 v_mfma_f32_16x16x32_bf16 v[212:215], a[204:207], v[100:103], v[212:215]
 v_cvt_pk_bf16_f32 v181, v182, v183
 v_mfma_f32_16x16x32_bf16 v[212:215], a[200:203], v[88:91], v[212:215]
 s_waitcnt lgkmcnt(4)
 v_cvt_pk_bf16_f32 v182, v192, v193
 v_cvt_pk_bf16_f32 v183, v194, v195
 v_mfma_f32_16x16x32_bf16 v[212:215], a[208:211], v[112:115], v[212:215]
 buffer_store_dwordx4 v[180:183], v240, s[64:67], s84 offen sc0 sc1
 v_mfma_f32_16x16x32_bf16 v[212:215], a[212:215], v[124:127], v[212:215]
 v_mul_f32 v176, v176, v8
 v_mfma_f32_16x16x32_bf16 v[216:219], a[212:215], v[128:131], v[216:219]
 v_mul_f32 v177, v177, v8
 v_mfma_f32_16x16x32_bf16 v[216:219], a[208:211], v[116:119], v[216:219]
 v_mul_f32 v178, v178, v8
 v_mfma_f32_16x16x32_bf16 v[220:223], a[208:211], v[120:123], v[220:223]
 v_mul_f32 v179, v179, v8
 v_mul_f32 v188, v188, v8
 v_mfma_f32_16x16x32_bf16 v[220:223], a[212:215], v[132:135], v[220:223]
 s_waitcnt lgkmcnt(0)
 v_mul_f32 v189, v189, v8
 v_mfma_f32_16x16x32_bf16 v[220:223], a[220:223], v[156:159], v[220:223]
 v_mul_f32 v190, v190, v8
 v_mul_f32 v191, v191, v8
 v_mfma_f32_16x16x32_bf16 v[220:223], a[216:219], v[144:147], v[220:223]
 v_cvt_pk_bf16_f32 v176, v176, v177
 v_mfma_f32_16x16x32_bf16 v[216:219], a[216:219], v[140:143], v[216:219]
 v_cvt_pk_bf16_f32 v177, v178, v179
 v_mfma_f32_16x16x32_bf16 v[216:219], a[220:223], v[152:155], v[216:219]
 v_cvt_pk_bf16_f32 v178, v188, v189
 v_cvt_pk_bf16_f32 v179, v190, v191
 v_mfma_f32_16x16x32_bf16 v[212:215], a[220:223], v[148:151], v[212:215]
 buffer_store_dwordx4 v[176:179], v5, s[64:67], s84 offen sc0 sc1
 v_mfma_f32_16x16x32_bf16 v[212:215], a[216:219], v[136:139], v[212:215]
 s_mov_b32 s85, 0x34000
 v_mul_f32 v208, v208, v10
 v_mul_f32 v209, v209, v10
 v_mul_f32 v210, v210, v10
 v_mul_f32 v211, v211, v10
 v_mul_f32 v220, v220, v10
 v_mul_f32 v221, v221, v10
 v_mul_f32 v222, v222, v10
 v_mul_f32 v223, v223, v10
 v_cvt_pk_bf16_f32 v208, v208, v209
 v_cvt_pk_bf16_f32 v209, v210, v211
 v_cvt_pk_bf16_f32 v210, v220, v221
 v_cvt_pk_bf16_f32 v211, v222, v223
 buffer_store_dwordx4 v[208:211], v241, s[64:67], s85 offen sc0 sc1
 v_mul_f32 v204, v204, v9
 v_mul_f32 v205, v205, v9
 v_mul_f32 v206, v206, v9
 v_mul_f32 v207, v207, v9
 v_mul_f32 v216, v216, v9
 v_mul_f32 v217, v217, v9
 v_mul_f32 v218, v218, v9
 v_mul_f32 v219, v219, v9
 v_cvt_pk_bf16_f32 v204, v204, v205
 v_cvt_pk_bf16_f32 v205, v206, v207
 v_cvt_pk_bf16_f32 v206, v216, v217
 v_cvt_pk_bf16_f32 v207, v218, v219
 buffer_store_dwordx4 v[204:207], v240, s[64:67], s85 offen sc0 sc1
 v_mul_f32 v200, v200, v8
 v_mul_f32 v201, v201, v8
 v_mul_f32 v202, v202, v8
 v_mul_f32 v203, v203, v8
 v_mul_f32 v212, v212, v8
 v_mul_f32 v213, v213, v8
 v_mul_f32 v214, v214, v8
 v_mul_f32 v215, v215, v8
 v_cvt_pk_bf16_f32 v200, v200, v201
 v_cvt_pk_bf16_f32 v201, v202, v203
 v_cvt_pk_bf16_f32 v202, v212, v213
 v_cvt_pk_bf16_f32 v203, v214, v215
 buffer_store_dwordx4 v[200:203], v5, s[64:67], s85 offen sc0 sc1
 s_mov_b32 s52, 0
 s_mov_b32 s23, 0
 s_waitcnt vmcnt(0)
 s_barrier
 s_branch L1_DLOOK
L1_DIDLE:
L1_DLOOK:
 ds_read_b32 v28, v31
 s_waitcnt lgkmcnt(0)
 v_readfirstlane_b32 s55, v28
 s_and_b32 s55, s55, 0xffff
 s_cbranch_scc0 L1_DOUT
 s_lshr_b32 s54, s55, 1
 s_and_b32 s54, s54, s55
 s_and_b32 s54, s54, 0x5555
 s_andn2_b32 s54, s54, s52
 s_cbranch_scc0 L1_DIDLE
 s_cmp_eq_u32 s55, 0xffff
 s_cbranch_scc1 L1_DFAST
 s_ff1_i32_b32 s10, s54
 s_lshl_b32 s54, 1, s10
 s_or_b32 s52, s52, s54
 s_cmp_eq_u32 s21, 0
 s_cbranch_scc1 L1_DT7
 s_bitcmp1_b32 s54, 0
 s_cbranch_scc0 L1_DT0
 s_waitcnt vmcnt(60)
 buffer_load_dwordx4 a[0:3], v40, s[56:59], 0 offen offset:0 sc0 sc1
 buffer_load_dwordx4 a[4:7], v40, s[56:59], 0 offen offset:256 sc0 sc1
 s_cmp_le_u32 s21, 1
 s_cbranch_scc1 L1_DT0
 s_waitcnt vmcnt(60)
 buffer_load_dwordx4 a[64:67], v41, s[56:59], 0 offen offset:0 sc0 sc1
 buffer_load_dwordx4 a[68:71], v41, s[56:59], 0 offen offset:256 sc0 sc1
 s_cmp_le_u32 s21, 2
 s_cbranch_scc1 L1_DT0
 s_waitcnt vmcnt(60)
 buffer_load_dwordx4 a[128:131], v42, s[56:59], 0 offen offset:0 sc0 sc1
 buffer_load_dwordx4 a[132:135], v42, s[56:59], 0 offen offset:256 sc0 sc1
 s_cmp_le_u32 s21, 3
 s_cbranch_scc1 L1_DT0
 s_waitcnt vmcnt(60)
 buffer_load_dwordx4 a[192:195], v43, s[56:59], 0 offen offset:0 sc0 sc1
 buffer_load_dwordx4 a[196:199], v43, s[56:59], 0 offen offset:256 sc0 sc1
L1_DT0:
 s_bitcmp1_b32 s54, 2
 s_cbranch_scc0 L1_DT1
 s_waitcnt vmcnt(60)
 buffer_load_dwordx4 a[8:11], v40, s[56:59], 0 offen offset:2048 sc0 sc1
 buffer_load_dwordx4 a[12:15], v40, s[56:59], 0 offen offset:2304 sc0 sc1
 s_cmp_le_u32 s21, 1
 s_cbranch_scc1 L1_DT1
 s_waitcnt vmcnt(60)
 buffer_load_dwordx4 a[72:75], v41, s[56:59], 0 offen offset:2048 sc0 sc1
 buffer_load_dwordx4 a[76:79], v41, s[56:59], 0 offen offset:2304 sc0 sc1
 s_cmp_le_u32 s21, 2
 s_cbranch_scc1 L1_DT1
 s_waitcnt vmcnt(60)
 buffer_load_dwordx4 a[136:139], v42, s[56:59], 0 offen offset:2048 sc0 sc1
 buffer_load_dwordx4 a[140:143], v42, s[56:59], 0 offen offset:2304 sc0 sc1
 s_cmp_le_u32 s21, 3
 s_cbranch_scc1 L1_DT1
 s_waitcnt vmcnt(60)
 buffer_load_dwordx4 a[200:203], v43, s[56:59], 0 offen offset:2048 sc0 sc1
 buffer_load_dwordx4 a[204:207], v43, s[56:59], 0 offen offset:2304 sc0 sc1
L1_DT1:
 s_bitcmp1_b32 s54, 4
 s_cbranch_scc0 L1_DT2
 s_waitcnt vmcnt(60)
 buffer_load_dwordx4 a[16:19], v40, s[56:59], s14 offen offset:0 sc0 sc1
 buffer_load_dwordx4 a[20:23], v40, s[56:59], s14 offen offset:256 sc0 sc1
 s_cmp_le_u32 s21, 1
 s_cbranch_scc1 L1_DT2
 s_waitcnt vmcnt(60)
 buffer_load_dwordx4 a[80:83], v41, s[56:59], s14 offen offset:0 sc0 sc1
 buffer_load_dwordx4 a[84:87], v41, s[56:59], s14 offen offset:256 sc0 sc1
 s_cmp_le_u32 s21, 2
 s_cbranch_scc1 L1_DT2
 s_waitcnt vmcnt(60)
 buffer_load_dwordx4 a[144:147], v42, s[56:59], s14 offen offset:0 sc0 sc1
 buffer_load_dwordx4 a[148:151], v42, s[56:59], s14 offen offset:256 sc0 sc1
 s_cmp_le_u32 s21, 3
 s_cbranch_scc1 L1_DT2
 s_waitcnt vmcnt(60)
 buffer_load_dwordx4 a[208:211], v43, s[56:59], s14 offen offset:0 sc0 sc1
 buffer_load_dwordx4 a[212:215], v43, s[56:59], s14 offen offset:256 sc0 sc1
L1_DT2:
 s_bitcmp1_b32 s54, 6
 s_cbranch_scc0 L1_DT3
 s_waitcnt vmcnt(60)
 buffer_load_dwordx4 a[24:27], v40, s[56:59], s14 offen offset:2048 sc0 sc1
 buffer_load_dwordx4 a[28:31], v40, s[56:59], s14 offen offset:2304 sc0 sc1
 s_cmp_le_u32 s21, 1
 s_cbranch_scc1 L1_DT3
 s_waitcnt vmcnt(60)
 buffer_load_dwordx4 a[88:91], v41, s[56:59], s14 offen offset:2048 sc0 sc1
 buffer_load_dwordx4 a[92:95], v41, s[56:59], s14 offen offset:2304 sc0 sc1
 s_cmp_le_u32 s21, 2
 s_cbranch_scc1 L1_DT3
 s_waitcnt vmcnt(60)
 buffer_load_dwordx4 a[152:155], v42, s[56:59], s14 offen offset:2048 sc0 sc1
 buffer_load_dwordx4 a[156:159], v42, s[56:59], s14 offen offset:2304 sc0 sc1
 s_cmp_le_u32 s21, 3
 s_cbranch_scc1 L1_DT3
 s_waitcnt vmcnt(60)
 buffer_load_dwordx4 a[216:219], v43, s[56:59], s14 offen offset:2048 sc0 sc1
 buffer_load_dwordx4 a[220:223], v43, s[56:59], s14 offen offset:2304 sc0 sc1
L1_DT3:
 s_bitcmp1_b32 s54, 8
 s_cbranch_scc0 L1_DT4
 s_waitcnt vmcnt(60)
 buffer_load_dwordx4 a[32:35], v40, s[56:59], s15 offen offset:0 sc0 sc1
 buffer_load_dwordx4 a[36:39], v40, s[56:59], s15 offen offset:256 sc0 sc1
 s_cmp_le_u32 s21, 1
 s_cbranch_scc1 L1_DT4
 s_waitcnt vmcnt(60)
 buffer_load_dwordx4 a[96:99], v41, s[56:59], s15 offen offset:0 sc0 sc1
 buffer_load_dwordx4 a[100:103], v41, s[56:59], s15 offen offset:256 sc0 sc1
 s_cmp_le_u32 s21, 2
 s_cbranch_scc1 L1_DT4
 s_waitcnt vmcnt(60)
 buffer_load_dwordx4 a[160:163], v42, s[56:59], s15 offen offset:0 sc0 sc1
 buffer_load_dwordx4 a[164:167], v42, s[56:59], s15 offen offset:256 sc0 sc1
 s_cmp_le_u32 s21, 3
 s_cbranch_scc1 L1_DT4
 s_waitcnt vmcnt(60)
 buffer_load_dwordx4 a[224:227], v43, s[56:59], s15 offen offset:0 sc0 sc1
 buffer_load_dwordx4 a[228:231], v43, s[56:59], s15 offen offset:256 sc0 sc1
L1_DT4:
 s_bitcmp1_b32 s54, 10
 s_cbranch_scc0 L1_DT5
 s_waitcnt vmcnt(60)
 buffer_load_dwordx4 a[40:43], v40, s[56:59], s15 offen offset:2048 sc0 sc1
 buffer_load_dwordx4 a[44:47], v40, s[56:59], s15 offen offset:2304 sc0 sc1
 s_cmp_le_u32 s21, 1
 s_cbranch_scc1 L1_DT5
 s_waitcnt vmcnt(60)
 buffer_load_dwordx4 a[104:107], v41, s[56:59], s15 offen offset:2048 sc0 sc1
 buffer_load_dwordx4 a[108:111], v41, s[56:59], s15 offen offset:2304 sc0 sc1
 s_cmp_le_u32 s21, 2
 s_cbranch_scc1 L1_DT5
 s_waitcnt vmcnt(60)
 buffer_load_dwordx4 a[168:171], v42, s[56:59], s15 offen offset:2048 sc0 sc1
 buffer_load_dwordx4 a[172:175], v42, s[56:59], s15 offen offset:2304 sc0 sc1
 s_cmp_le_u32 s21, 3
 s_cbranch_scc1 L1_DT5
 s_waitcnt vmcnt(60)
 buffer_load_dwordx4 a[232:235], v43, s[56:59], s15 offen offset:2048 sc0 sc1
 buffer_load_dwordx4 a[236:239], v43, s[56:59], s15 offen offset:2304 sc0 sc1
L1_DT5:
 s_bitcmp1_b32 s54, 12
 s_cbranch_scc0 L1_DT6
 s_waitcnt vmcnt(60)
 buffer_load_dwordx4 a[48:51], v40, s[56:59], s42 offen offset:0 sc0 sc1
 buffer_load_dwordx4 a[52:55], v40, s[56:59], s42 offen offset:256 sc0 sc1
 s_cmp_le_u32 s21, 1
 s_cbranch_scc1 L1_DT6
 s_waitcnt vmcnt(60)
 buffer_load_dwordx4 a[112:115], v41, s[56:59], s42 offen offset:0 sc0 sc1
 buffer_load_dwordx4 a[116:119], v41, s[56:59], s42 offen offset:256 sc0 sc1
 s_cmp_le_u32 s21, 2
 s_cbranch_scc1 L1_DT6
 s_waitcnt vmcnt(60)
 buffer_load_dwordx4 a[176:179], v42, s[56:59], s42 offen offset:0 sc0 sc1
 buffer_load_dwordx4 a[180:183], v42, s[56:59], s42 offen offset:256 sc0 sc1
 s_cmp_le_u32 s21, 3
 s_cbranch_scc1 L1_DT6
 s_waitcnt vmcnt(60)
 buffer_load_dwordx4 a[240:243], v43, s[56:59], s42 offen offset:0 sc0 sc1
 buffer_load_dwordx4 a[244:247], v43, s[56:59], s42 offen offset:256 sc0 sc1
L1_DT6:
 s_bitcmp1_b32 s54, 14
 s_cbranch_scc0 L1_DT7
 s_waitcnt vmcnt(60)
 buffer_load_dwordx4 a[56:59], v40, s[56:59], s42 offen offset:2048 sc0 sc1
 buffer_load_dwordx4 a[60:63], v40, s[56:59], s42 offen offset:2304 sc0 sc1
 s_cmp_le_u32 s21, 1
 s_cbranch_scc1 L1_DT7
 s_waitcnt vmcnt(60)
 buffer_load_dwordx4 a[120:123], v41, s[56:59], s42 offen offset:2048 sc0 sc1
 buffer_load_dwordx4 a[124:127], v41, s[56:59], s42 offen offset:2304 sc0 sc1
 s_cmp_le_u32 s21, 2
 s_cbranch_scc1 L1_DT7
 s_waitcnt vmcnt(60)
 buffer_load_dwordx4 a[184:187], v42, s[56:59], s42 offen offset:2048 sc0 sc1
 buffer_load_dwordx4 a[188:191], v42, s[56:59], s42 offen offset:2304 sc0 sc1
 s_cmp_le_u32 s21, 3
 s_cbranch_scc1 L1_DT7
 s_waitcnt vmcnt(60)
 buffer_load_dwordx4 a[248:251], v43, s[56:59], s42 offen offset:2048 sc0 sc1
 buffer_load_dwordx4 a[252:255], v43, s[56:59], s42 offen offset:2304 sc0 sc1
L1_DT7:
 s_branch L1_DLOOK
L1_DFAST:
 s_cmp_eq_u32 s21, 0
 s_cbranch_scc1 L1_DF7
 s_bitcmp1_b32 s54, 0
 s_cbranch_scc0 L1_DF0
 buffer_load_dwordx4 a[0:3], v40, s[56:59], 0 offen offset:0 sc0 sc1
 buffer_load_dwordx4 a[4:7], v40, s[56:59], 0 offen offset:256 sc0 sc1
 s_cmp_le_u32 s21, 1
 s_cbranch_scc1 L1_DF0
 buffer_load_dwordx4 a[64:67], v41, s[56:59], 0 offen offset:0 sc0 sc1
 buffer_load_dwordx4 a[68:71], v41, s[56:59], 0 offen offset:256 sc0 sc1
 s_cmp_le_u32 s21, 2
 s_cbranch_scc1 L1_DF0
 buffer_load_dwordx4 a[128:131], v42, s[56:59], 0 offen offset:0 sc0 sc1
 buffer_load_dwordx4 a[132:135], v42, s[56:59], 0 offen offset:256 sc0 sc1
 s_cmp_le_u32 s21, 3
 s_cbranch_scc1 L1_DF0
 buffer_load_dwordx4 a[192:195], v43, s[56:59], 0 offen offset:0 sc0 sc1
 buffer_load_dwordx4 a[196:199], v43, s[56:59], 0 offen offset:256 sc0 sc1
L1_DF0:
 s_bitcmp1_b32 s54, 2
 s_cbranch_scc0 L1_DF1
 buffer_load_dwordx4 a[8:11], v40, s[56:59], 0 offen offset:2048 sc0 sc1
 buffer_load_dwordx4 a[12:15], v40, s[56:59], 0 offen offset:2304 sc0 sc1
 s_cmp_le_u32 s21, 1
 s_cbranch_scc1 L1_DF1
 buffer_load_dwordx4 a[72:75], v41, s[56:59], 0 offen offset:2048 sc0 sc1
 buffer_load_dwordx4 a[76:79], v41, s[56:59], 0 offen offset:2304 sc0 sc1
 s_cmp_le_u32 s21, 2
 s_cbranch_scc1 L1_DF1
 buffer_load_dwordx4 a[136:139], v42, s[56:59], 0 offen offset:2048 sc0 sc1
 buffer_load_dwordx4 a[140:143], v42, s[56:59], 0 offen offset:2304 sc0 sc1
 s_cmp_le_u32 s21, 3
 s_cbranch_scc1 L1_DF1
 buffer_load_dwordx4 a[200:203], v43, s[56:59], 0 offen offset:2048 sc0 sc1
 buffer_load_dwordx4 a[204:207], v43, s[56:59], 0 offen offset:2304 sc0 sc1
L1_DF1:
 s_bitcmp1_b32 s54, 4
 s_cbranch_scc0 L1_DF2
 buffer_load_dwordx4 a[16:19], v40, s[56:59], s14 offen offset:0 sc0 sc1
 buffer_load_dwordx4 a[20:23], v40, s[56:59], s14 offen offset:256 sc0 sc1
 s_cmp_le_u32 s21, 1
 s_cbranch_scc1 L1_DF2
 buffer_load_dwordx4 a[80:83], v41, s[56:59], s14 offen offset:0 sc0 sc1
 buffer_load_dwordx4 a[84:87], v41, s[56:59], s14 offen offset:256 sc0 sc1
 s_cmp_le_u32 s21, 2
 s_cbranch_scc1 L1_DF2
 buffer_load_dwordx4 a[144:147], v42, s[56:59], s14 offen offset:0 sc0 sc1
 buffer_load_dwordx4 a[148:151], v42, s[56:59], s14 offen offset:256 sc0 sc1
 s_cmp_le_u32 s21, 3
 s_cbranch_scc1 L1_DF2
 buffer_load_dwordx4 a[208:211], v43, s[56:59], s14 offen offset:0 sc0 sc1
 buffer_load_dwordx4 a[212:215], v43, s[56:59], s14 offen offset:256 sc0 sc1
L1_DF2:
 s_bitcmp1_b32 s54, 6
 s_cbranch_scc0 L1_DF3
 buffer_load_dwordx4 a[24:27], v40, s[56:59], s14 offen offset:2048 sc0 sc1
 buffer_load_dwordx4 a[28:31], v40, s[56:59], s14 offen offset:2304 sc0 sc1
 s_cmp_le_u32 s21, 1
 s_cbranch_scc1 L1_DF3
 buffer_load_dwordx4 a[88:91], v41, s[56:59], s14 offen offset:2048 sc0 sc1
 buffer_load_dwordx4 a[92:95], v41, s[56:59], s14 offen offset:2304 sc0 sc1
 s_cmp_le_u32 s21, 2
 s_cbranch_scc1 L1_DF3
 buffer_load_dwordx4 a[152:155], v42, s[56:59], s14 offen offset:2048 sc0 sc1
 buffer_load_dwordx4 a[156:159], v42, s[56:59], s14 offen offset:2304 sc0 sc1
 s_cmp_le_u32 s21, 3
 s_cbranch_scc1 L1_DF3
 buffer_load_dwordx4 a[216:219], v43, s[56:59], s14 offen offset:2048 sc0 sc1
 buffer_load_dwordx4 a[220:223], v43, s[56:59], s14 offen offset:2304 sc0 sc1
L1_DF3:
 s_bitcmp1_b32 s54, 8
 s_cbranch_scc0 L1_DF4
 buffer_load_dwordx4 a[32:35], v40, s[56:59], s15 offen offset:0 sc0 sc1
 buffer_load_dwordx4 a[36:39], v40, s[56:59], s15 offen offset:256 sc0 sc1
 s_cmp_le_u32 s21, 1
 s_cbranch_scc1 L1_DF4
 buffer_load_dwordx4 a[96:99], v41, s[56:59], s15 offen offset:0 sc0 sc1
 buffer_load_dwordx4 a[100:103], v41, s[56:59], s15 offen offset:256 sc0 sc1
 s_cmp_le_u32 s21, 2
 s_cbranch_scc1 L1_DF4
 buffer_load_dwordx4 a[160:163], v42, s[56:59], s15 offen offset:0 sc0 sc1
 buffer_load_dwordx4 a[164:167], v42, s[56:59], s15 offen offset:256 sc0 sc1
 s_cmp_le_u32 s21, 3
 s_cbranch_scc1 L1_DF4
 buffer_load_dwordx4 a[224:227], v43, s[56:59], s15 offen offset:0 sc0 sc1
 buffer_load_dwordx4 a[228:231], v43, s[56:59], s15 offen offset:256 sc0 sc1
L1_DF4:
 s_bitcmp1_b32 s54, 10
 s_cbranch_scc0 L1_DF5
 buffer_load_dwordx4 a[40:43], v40, s[56:59], s15 offen offset:2048 sc0 sc1
 buffer_load_dwordx4 a[44:47], v40, s[56:59], s15 offen offset:2304 sc0 sc1
 s_cmp_le_u32 s21, 1
 s_cbranch_scc1 L1_DF5
 buffer_load_dwordx4 a[104:107], v41, s[56:59], s15 offen offset:2048 sc0 sc1
 buffer_load_dwordx4 a[108:111], v41, s[56:59], s15 offen offset:2304 sc0 sc1
 s_cmp_le_u32 s21, 2
 s_cbranch_scc1 L1_DF5
 buffer_load_dwordx4 a[168:171], v42, s[56:59], s15 offen offset:2048 sc0 sc1
 buffer_load_dwordx4 a[172:175], v42, s[56:59], s15 offen offset:2304 sc0 sc1
 s_cmp_le_u32 s21, 3
 s_cbranch_scc1 L1_DF5
 buffer_load_dwordx4 a[232:235], v43, s[56:59], s15 offen offset:2048 sc0 sc1
 buffer_load_dwordx4 a[236:239], v43, s[56:59], s15 offen offset:2304 sc0 sc1
L1_DF5:
 s_bitcmp1_b32 s54, 12
 s_cbranch_scc0 L1_DF6
 buffer_load_dwordx4 a[48:51], v40, s[56:59], s42 offen offset:0 sc0 sc1
 buffer_load_dwordx4 a[52:55], v40, s[56:59], s42 offen offset:256 sc0 sc1
 s_cmp_le_u32 s21, 1
 s_cbranch_scc1 L1_DF6
 buffer_load_dwordx4 a[112:115], v41, s[56:59], s42 offen offset:0 sc0 sc1
 buffer_load_dwordx4 a[116:119], v41, s[56:59], s42 offen offset:256 sc0 sc1
 s_cmp_le_u32 s21, 2
 s_cbranch_scc1 L1_DF6
 buffer_load_dwordx4 a[176:179], v42, s[56:59], s42 offen offset:0 sc0 sc1
 buffer_load_dwordx4 a[180:183], v42, s[56:59], s42 offen offset:256 sc0 sc1
 s_cmp_le_u32 s21, 3
 s_cbranch_scc1 L1_DF6
 buffer_load_dwordx4 a[240:243], v43, s[56:59], s42 offen offset:0 sc0 sc1
 buffer_load_dwordx4 a[244:247], v43, s[56:59], s42 offen offset:256 sc0 sc1
L1_DF6:
 s_bitcmp1_b32 s54, 14
 s_cbranch_scc0 L1_DF7
 buffer_load_dwordx4 a[56:59], v40, s[56:59], s42 offen offset:2048 sc0 sc1
 buffer_load_dwordx4 a[60:63], v40, s[56:59], s42 offen offset:2304 sc0 sc1
 s_cmp_le_u32 s21, 1
 s_cbranch_scc1 L1_DF7
 buffer_load_dwordx4 a[120:123], v41, s[56:59], s42 offen offset:2048 sc0 sc1
 buffer_load_dwordx4 a[124:127], v41, s[56:59], s42 offen offset:2304 sc0 sc1
 s_cmp_le_u32 s21, 2
 s_cbranch_scc1 L1_DF7
 buffer_load_dwordx4 a[184:187], v42, s[56:59], s42 offen offset:2048 sc0 sc1
 buffer_load_dwordx4 a[188:191], v42, s[56:59], s42 offen offset:2304 sc0 sc1
 s_cmp_le_u32 s21, 3
 s_cbranch_scc1 L1_DF7
 buffer_load_dwordx4 a[248:251], v43, s[56:59], s42 offen offset:2048 sc0 sc1
 buffer_load_dwordx4 a[252:255], v43, s[56:59], s42 offen offset:2304 sc0 sc1
L1_DF7:
 s_waitcnt vmcnt(0)
 s_cmp_le_u32 s21, 0
 s_cbranch_scc1 L1_DDONE
 v_mfma_f32_16x16x32_bf16 v[64:67], v[48:51], a[0:3], 0
 v_mfma_f32_16x16x32_bf16 v[68:71], v[48:51], a[4:7], 0
 v_mfma_f32_16x16x32_bf16 v[64:67], v[48:51], a[8:11], v[64:67]
 v_mfma_f32_16x16x32_bf16 v[68:71], v[48:51], a[12:15], v[68:71]
 v_mfma_f32_16x16x32_bf16 v[64:67], v[48:51], a[16:19], v[64:67]
 v_mfma_f32_16x16x32_bf16 v[68:71], v[48:51], a[20:23], v[68:71]
 v_mfma_f32_16x16x32_bf16 v[64:67], v[48:51], a[24:27], v[64:67]
 v_mfma_f32_16x16x32_bf16 v[68:71], v[48:51], a[28:31], v[68:71]
 v_mfma_f32_16x16x32_bf16 v[64:67], v[48:51], a[32:35], v[64:67]
 v_mfma_f32_16x16x32_bf16 v[68:71], v[48:51], a[36:39], v[68:71]
 v_mfma_f32_16x16x32_bf16 v[64:67], v[48:51], a[40:43], v[64:67]
 v_mfma_f32_16x16x32_bf16 v[68:71], v[48:51], a[44:47], v[68:71]
 v_mfma_f32_16x16x32_bf16 v[64:67], v[48:51], a[48:51], v[64:67]
 v_mfma_f32_16x16x32_bf16 v[68:71], v[48:51], a[52:55], v[68:71]
 v_mfma_f32_16x16x32_bf16 v[64:67], v[48:51], a[56:59], v[64:67]
 v_mfma_f32_16x16x32_bf16 v[68:71], v[48:51], a[60:63], v[68:71]
 s_nop 6
 v_cvt_pk_bf16_f32 v64, v64, v65
 v_cvt_pk_bf16_f32 v65, v66, v67
 v_cvt_pk_bf16_f32 v66, v68, v69
 v_cvt_pk_bf16_f32 v67, v70, v71
 buffer_store_dwordx4 v[64:67], v45, s[48:51], s16 offen
 s_cmp_le_u32 s21, 1
 s_cbranch_scc1 L1_DDONE
 v_mfma_f32_16x16x32_bf16 v[72:75], v[48:51], a[64:67], 0
 v_mfma_f32_16x16x32_bf16 v[76:79], v[48:51], a[68:71], 0
 v_mfma_f32_16x16x32_bf16 v[72:75], v[48:51], a[72:75], v[72:75]
 v_mfma_f32_16x16x32_bf16 v[76:79], v[48:51], a[76:79], v[76:79]
 v_mfma_f32_16x16x32_bf16 v[72:75], v[48:51], a[80:83], v[72:75]
 v_mfma_f32_16x16x32_bf16 v[76:79], v[48:51], a[84:87], v[76:79]
 v_mfma_f32_16x16x32_bf16 v[72:75], v[48:51], a[88:91], v[72:75]
 v_mfma_f32_16x16x32_bf16 v[76:79], v[48:51], a[92:95], v[76:79]
 v_mfma_f32_16x16x32_bf16 v[72:75], v[48:51], a[96:99], v[72:75]
 v_mfma_f32_16x16x32_bf16 v[76:79], v[48:51], a[100:103], v[76:79]
 v_mfma_f32_16x16x32_bf16 v[72:75], v[48:51], a[104:107], v[72:75]
 v_mfma_f32_16x16x32_bf16 v[76:79], v[48:51], a[108:111], v[76:79]
 v_mfma_f32_16x16x32_bf16 v[72:75], v[48:51], a[112:115], v[72:75]
 v_mfma_f32_16x16x32_bf16 v[76:79], v[48:51], a[116:119], v[76:79]
 v_mfma_f32_16x16x32_bf16 v[72:75], v[48:51], a[120:123], v[72:75]
 v_mfma_f32_16x16x32_bf16 v[76:79], v[48:51], a[124:127], v[76:79]
 s_nop 6
 v_cvt_pk_bf16_f32 v72, v72, v73
 v_cvt_pk_bf16_f32 v73, v74, v75
 v_cvt_pk_bf16_f32 v74, v76, v77
 v_cvt_pk_bf16_f32 v75, v78, v79
 buffer_store_dwordx4 v[72:75], v45, s[48:51], s17 offen
 s_cmp_le_u32 s21, 2
 s_cbranch_scc1 L1_DDONE
 v_mfma_f32_16x16x32_bf16 v[80:83], v[48:51], a[128:131], 0
 v_mfma_f32_16x16x32_bf16 v[84:87], v[48:51], a[132:135], 0
 v_mfma_f32_16x16x32_bf16 v[80:83], v[48:51], a[136:139], v[80:83]
 v_mfma_f32_16x16x32_bf16 v[84:87], v[48:51], a[140:143], v[84:87]
 v_mfma_f32_16x16x32_bf16 v[80:83], v[48:51], a[144:147], v[80:83]
 v_mfma_f32_16x16x32_bf16 v[84:87], v[48:51], a[148:151], v[84:87]
 v_mfma_f32_16x16x32_bf16 v[80:83], v[48:51], a[152:155], v[80:83]
 v_mfma_f32_16x16x32_bf16 v[84:87], v[48:51], a[156:159], v[84:87]
 v_mfma_f32_16x16x32_bf16 v[80:83], v[48:51], a[160:163], v[80:83]
 v_mfma_f32_16x16x32_bf16 v[84:87], v[48:51], a[164:167], v[84:87]
 v_mfma_f32_16x16x32_bf16 v[80:83], v[48:51], a[168:171], v[80:83]
 v_mfma_f32_16x16x32_bf16 v[84:87], v[48:51], a[172:175], v[84:87]
 v_mfma_f32_16x16x32_bf16 v[80:83], v[48:51], a[176:179], v[80:83]
 v_mfma_f32_16x16x32_bf16 v[84:87], v[48:51], a[180:183], v[84:87]
 v_mfma_f32_16x16x32_bf16 v[80:83], v[48:51], a[184:187], v[80:83]
 v_mfma_f32_16x16x32_bf16 v[84:87], v[48:51], a[188:191], v[84:87]
 s_nop 6
 v_cvt_pk_bf16_f32 v80, v80, v81
 v_cvt_pk_bf16_f32 v81, v82, v83
 v_cvt_pk_bf16_f32 v82, v84, v85
 v_cvt_pk_bf16_f32 v83, v86, v87
 buffer_store_dwordx4 v[80:83], v45, s[48:51], s18 offen
 s_cmp_le_u32 s21, 3
 s_cbranch_scc1 L1_DDONE
 v_mfma_f32_16x16x32_bf16 v[88:91], v[48:51], a[192:195], 0
 v_mfma_f32_16x16x32_bf16 v[92:95], v[48:51], a[196:199], 0
 v_mfma_f32_16x16x32_bf16 v[88:91], v[48:51], a[200:203], v[88:91]
 v_mfma_f32_16x16x32_bf16 v[92:95], v[48:51], a[204:207], v[92:95]
 v_mfma_f32_16x16x32_bf16 v[88:91], v[48:51], a[208:211], v[88:91]
 v_mfma_f32_16x16x32_bf16 v[92:95], v[48:51], a[212:215], v[92:95]
 v_mfma_f32_16x16x32_bf16 v[88:91], v[48:51], a[216:219], v[88:91]
 v_mfma_f32_16x16x32_bf16 v[92:95], v[48:51], a[220:223], v[92:95]
 v_mfma_f32_16x16x32_bf16 v[88:91], v[48:51], a[224:227], v[88:91]
 v_mfma_f32_16x16x32_bf16 v[92:95], v[48:51], a[228:231], v[92:95]
 v_mfma_f32_16x16x32_bf16 v[88:91], v[48:51], a[232:235], v[88:91]
 v_mfma_f32_16x16x32_bf16 v[92:95], v[48:51], a[236:239], v[92:95]
 v_mfma_f32_16x16x32_bf16 v[88:91], v[48:51], a[240:243], v[88:91]
 v_mfma_f32_16x16x32_bf16 v[92:95], v[48:51], a[244:247], v[92:95]
 v_mfma_f32_16x16x32_bf16 v[88:91], v[48:51], a[248:251], v[88:91]
 v_mfma_f32_16x16x32_bf16 v[92:95], v[48:51], a[252:255], v[92:95]
 s_nop 6
 v_cvt_pk_bf16_f32 v88, v88, v89
 v_cvt_pk_bf16_f32 v89, v90, v91
 v_cvt_pk_bf16_f32 v90, v92, v93
 v_cvt_pk_bf16_f32 v91, v94, v95
 buffer_store_dwordx4 v[88:91], v45, s[48:51], s19 offen
L1_DDONE:
 s_cmp_lg_u32 s23, 0
 s_cbranch_scc1 L1_DMORE
L1_DOUT:
 s_barrier
 ds_read_b32 v28, v31
 s_mov_b32 s23, 1
 s_waitcnt lgkmcnt(0)
 v_readfirstlane_b32 s44, v28
 s_lshr_b32 s44, s44, 16
L1_DMORE:
 s_cmp_eq_u32 s44, 0
 s_cbranch_scc1 L1_DBYE
 s_ff1_i32_b32 s9, s44
 s_bitset0_b32 s44, s9
 s_waitcnt vmcnt(0)
 s_mov_b32 s24, 0x24180c00
 s_mov_b32 s25, 0x54483c30
 s_mov_b32 s26, 0x7f766b60
 s_mov_b32 s27, 0x97948e88
 s_cmp_lt_u32 s9, 8
 s_cselect_b64 s[24:25], s[24:25], s[26:27]
 s_lshl_b32 s10, s9, 3
 s_lshr_b64 s[24:25], s[24:25], s10
 s_and_b32 s10, s24, 0xff
 s_add_u32 s10, s10, s72
 s_mov_b32 s26, 0xcccccccc
 s_mov_b32 s27, 0x336699bb
 s_lshl_b32 s11, s9, 2
 s_lshr_b64 s[26:27], s[26:27], s11
 s_and_b32 s11, s26, 15
 s_sub_u32 s11, s11, s72
 s_add_u32 s11, s11, 2
 s_mul_i32 s11, s11, 43
 s_lshr_b32 s21, s11, 7
 s_lshl_b32 s11, s10, 14
 v_add_u32 v40, s11, v46
 s_mul_i32 s11, s10, 4682
 s_lshr_b32 s11, s11, 16
 s_mul_i32 s11, s11, 27776
 s_lshl_b32 s12, s10, 6
 s_add_u32 s16, s11, s12
 s_add_u32 s10, s10, 3
 s_lshl_b32 s11, s10, 14
 v_add_u32 v41, s11, v46
 s_mul_i32 s11, s10, 4682
 s_lshr_b32 s11, s11, 16
 s_mul_i32 s11, s11, 27776
 s_lshl_b32 s12, s10, 6
 s_add_u32 s17, s11, s12
 s_add_u32 s10, s10, 3
 s_lshl_b32 s11, s10, 14
 v_add_u32 v42, s11, v46
 s_mul_i32 s11, s10, 4682
 s_lshr_b32 s11, s11, 16
 s_mul_i32 s11, s11, 27776
 s_lshl_b32 s12, s10, 6
 s_add_u32 s18, s11, s12
 s_add_u32 s10, s10, 3
 s_lshl_b32 s11, s10, 14
 v_add_u32 v43, s11, v46
 s_mul_i32 s11, s10, 4682
 s_lshr_b32 s11, s11, 16
 s_mul_i32 s11, s11, 27776
 s_lshl_b32 s12, s10, 6
 s_add_u32 s19, s11, s12
 s_add_u32 s10, s10, 3
 s_mov_b32 s54, 0x5555
 s_branch L1_DFAST
L1_DBYE:
 s_waitcnt vmcnt(0)
L1_END:
L1_FIN:
 s_endpgm
L1_RARE0:
 s_nop 7
 v_max3_f32 v236, v128, v129, v130
 v_max3_f32 v236, v236, v131, v140
 v_max3_f32 v236, v236, v141, v142
 v_max3_f32 v236, v236, v143, v152
 v_max3_f32 v236, v236, v153, v154
 v_max3_f32 v236, v236, v155, v164
 v_max3_f32 v236, v236, v165, v166
 v_max_f32 v236, v236, v167
 v_max3_f32 v237, v132, v133, v134
 v_max3_f32 v237, v237, v135, v144
 v_max3_f32 v237, v237, v145, v146
 v_max3_f32 v237, v237, v147, v156
 v_max3_f32 v237, v237, v157, v158
 v_max3_f32 v237, v237, v159, v168
 v_max3_f32 v237, v237, v169, v170
 v_max_f32 v237, v237, v171
 v_max3_f32 v238, v136, v137, v138
 v_max3_f32 v238, v238, v139, v148
 v_max3_f32 v238, v238, v149, v150
 v_max3_f32 v238, v238, v151, v160
 v_max3_f32 v238, v238, v161, v162
 v_max3_f32 v238, v238, v163, v172
 v_max3_f32 v238, v238, v173, v174
 v_max_f32 v238, v238, v175
 v_mov_b32 v244, v236
 v_mov_b32 v245, v237
 v_mov_b32 v246, v238
 v_permlane32_swap_b32 v236, v244
 v_permlane32_swap_b32 v237, v245
 v_permlane32_swap_b32 v238, v246
 v_max_f32 v236, v236, v244
 v_max_f32 v237, v237, v245
 v_max_f32 v238, v238, v246
 v_mov_b32 v244, v236
 v_mov_b32 v245, v237
 v_mov_b32 v246, v238
 v_permlane16_swap_b32 v236, v244
 v_permlane16_swap_b32 v237, v245
 v_permlane16_swap_b32 v238, v246
 v_max_f32 v236, v236, v244
 v_max_f32 v237, v237, v245
 v_max_f32 v238, v238, v246
 s_branch L1_RESC
L1_RARE1:
 s_nop 7
 v_max3_f32 v236, v176, v177, v178
 v_max3_f32 v236, v236, v179, v188
 v_max3_f32 v236, v236, v189, v190
 v_max3_f32 v236, v236, v191, v200
 v_max3_f32 v236, v236, v201, v202
 v_max3_f32 v236, v236, v203, v212
 v_max3_f32 v236, v236, v213, v214
 v_max_f32 v236, v236, v215
 v_max3_f32 v237, v180, v181, v182
 v_max3_f32 v237, v237, v183, v192
 v_max3_f32 v237, v237, v193, v194
 v_max3_f32 v237, v237, v195, v204
 v_max3_f32 v237, v237, v205, v206
 v_max3_f32 v237, v237, v207, v216
 v_max3_f32 v237, v237, v217, v218
 v_max_f32 v237, v237, v219
 v_max3_f32 v238, v184, v185, v186
 v_max3_f32 v238, v238, v187, v196
 v_max3_f32 v238, v238, v197, v198
 v_max3_f32 v238, v238, v199, v208
 v_max3_f32 v238, v238, v209, v210
 v_max3_f32 v238, v238, v211, v220
 v_max3_f32 v238, v238, v221, v222
 v_max_f32 v238, v238, v223
 v_mov_b32 v244, v236
 v_mov_b32 v245, v237
 v_mov_b32 v246, v238
 v_permlane32_swap_b32 v236, v244
 v_permlane32_swap_b32 v237, v245
 v_permlane32_swap_b32 v238, v246
 v_max_f32 v236, v236, v244
 v_max_f32 v237, v237, v245
 v_max_f32 v238, v238, v246
 v_mov_b32 v244, v236
 v_mov_b32 v245, v237
 v_mov_b32 v246, v238
 v_permlane16_swap_b32 v236, v244
 v_permlane16_swap_b32 v237, v245
 v_permlane16_swap_b32 v238, v246
 v_max_f32 v236, v236, v244
 v_max_f32 v237, v237, v245
 v_max_f32 v238, v238, v246
L1_RESC:
 v_max_f32 v236, 0, v236
 v_max_f32 v237, 0, v237
 v_max_f32 v238, 0, v238
 v_exp_f32 v240, -v236
 v_exp_f32 v241, -v237
 v_exp_f32 v242, -v238
 v_sub_f32 v128, v128, v236
 v_sub_f32 v129, v129, v236
 v_sub_f32 v130, v130, v236
 v_sub_f32 v131, v131, v236
 v_sub_f32 v140, v140, v236
 v_sub_f32 v141, v141, v236
 v_sub_f32 v142, v142, v236
 v_sub_f32 v143, v143, v236
 v_sub_f32 v152, v152, v236
 v_sub_f32 v153, v153, v236
 v_sub_f32 v154, v154, v236
 v_sub_f32 v155, v155, v236
 v_sub_f32 v164, v164, v236
 v_sub_f32 v165, v165, v236
 v_sub_f32 v166, v166, v236
 v_sub_f32 v167, v167, v236
 v_sub_f32 v132, v132, v237
 v_sub_f32 v133, v133, v237
 v_sub_f32 v134, v134, v237
 v_sub_f32 v135, v135, v237
 v_sub_f32 v144, v144, v237
 v_sub_f32 v145, v145, v237
 v_sub_f32 v146, v146, v237
 v_sub_f32 v147, v147, v237
 v_sub_f32 v156, v156, v237
 v_sub_f32 v157, v157, v237
 v_sub_f32 v158, v158, v237
 v_sub_f32 v159, v159, v237
 v_sub_f32 v168, v168, v237
 v_sub_f32 v169, v169, v237
 v_sub_f32 v170, v170, v237
 v_sub_f32 v171, v171, v237
 v_sub_f32 v136, v136, v238
 v_sub_f32 v137, v137, v238
 v_sub_f32 v138, v138, v238
 v_sub_f32 v139, v139, v238
 v_sub_f32 v148, v148, v238
 v_sub_f32 v149, v149, v238
 v_sub_f32 v150, v150, v238
 v_sub_f32 v151, v151, v238
 v_sub_f32 v160, v160, v238
 v_sub_f32 v161, v161, v238
 v_sub_f32 v162, v162, v238
 v_sub_f32 v163, v163, v238
 v_sub_f32 v172, v172, v238
 v_sub_f32 v173, v173, v238
 v_sub_f32 v174, v174, v238
 v_sub_f32 v175, v175, v238
 v_sub_f32 v176, v176, v236
 v_sub_f32 v177, v177, v236
 v_sub_f32 v178, v178, v236
 v_sub_f32 v179, v179, v236
 v_sub_f32 v188, v188, v236
 v_sub_f32 v189, v189, v236
 v_sub_f32 v190, v190, v236
 v_sub_f32 v191, v191, v236
 v_sub_f32 v200, v200, v236
 v_sub_f32 v201, v201, v236
 v_sub_f32 v202, v202, v236
 v_sub_f32 v203, v203, v236
 v_sub_f32 v212, v212, v236
 v_sub_f32 v213, v213, v236
 v_sub_f32 v214, v214, v236
 v_sub_f32 v215, v215, v236
 v_sub_f32 v180, v180, v237
 v_sub_f32 v181, v181, v237
 v_sub_f32 v182, v182, v237
 v_sub_f32 v183, v183, v237
 v_sub_f32 v192, v192, v237
 v_sub_f32 v193, v193, v237
 v_sub_f32 v194, v194, v237
 v_sub_f32 v195, v195, v237
 v_sub_f32 v204, v204, v237
 v_sub_f32 v205, v205, v237
 v_sub_f32 v206, v206, v237
 v_sub_f32 v207, v207, v237
 v_sub_f32 v216, v216, v237
 v_sub_f32 v217, v217, v237
 v_sub_f32 v218, v218, v237
 v_sub_f32 v219, v219, v237
 v_sub_f32 v184, v184, v238
 v_sub_f32 v185, v185, v238
 v_sub_f32 v186, v186, v238
 v_sub_f32 v187, v187, v238
 v_sub_f32 v196, v196, v238
 v_sub_f32 v197, v197, v238
 v_sub_f32 v198, v198, v238
 v_sub_f32 v199, v199, v238
 v_sub_f32 v208, v208, v238
 v_sub_f32 v209, v209, v238
 v_sub_f32 v210, v210, v238
 v_sub_f32 v211, v211, v238
 v_sub_f32 v220, v220, v238
 v_sub_f32 v221, v221, v238
 v_sub_f32 v222, v222, v238
 v_sub_f32 v223, v223, v238
 v_sub_f32 v16, v16, v236
 v_sub_f32 v17, v17, v236
 v_sub_f32 v18, v18, v236
 v_sub_f32 v19, v19, v236
 v_mul_f32 v8, v8, v240
 v_sub_f32 v20, v20, v237
 v_sub_f32 v21, v21, v237
 v_sub_f32 v22, v22, v237
 v_sub_f32 v23, v23, v237
 v_mul_f32 v9, v9, v241
 v_sub_f32 v24, v24, v238
 v_sub_f32 v25, v25, v238
 v_sub_f32 v26, v26, v238
 v_sub_f32 v27, v27, v238
 v_mul_f32 v10, v10, v242
 v_accvgpr_read_b32 v28, a0
 v_accvgpr_read_b32 v29, a1
 v_accvgpr_read_b32 v30, a2
 v_accvgpr_read_b32 v31, a3
 v_mul_f32 v28, v28, v240
 v_mul_f32 v29, v29, v240
 v_mul_f32 v30, v30, v240
 v_mul_f32 v31, v31, v240
 v_accvgpr_write_b32 a0, v28
 v_accvgpr_write_b32 a1, v29
 v_accvgpr_write_b32 a2, v30
 v_accvgpr_write_b32 a3, v31
 v_accvgpr_read_b32 v28, a4
 v_accvgpr_read_b32 v29, a5
 v_accvgpr_read_b32 v30, a6
 v_accvgpr_read_b32 v31, a7
 v_mul_f32 v28, v28, v241
 v_mul_f32 v29, v29, v241
 v_mul_f32 v30, v30, v241
 v_mul_f32 v31, v31, v241
 v_accvgpr_write_b32 a4, v28
 v_accvgpr_write_b32 a5, v29
 v_accvgpr_write_b32 a6, v30
 v_accvgpr_write_b32 a7, v31
 v_accvgpr_read_b32 v28, a8
 v_accvgpr_read_b32 v29, a9
 v_accvgpr_read_b32 v30, a10
 v_accvgpr_read_b32 v31, a11
 v_mul_f32 v28, v28, v242
 v_mul_f32 v29, v29, v242
 v_mul_f32 v30, v30, v242
 v_mul_f32 v31, v31, v242
 v_accvgpr_write_b32 a8, v28
 v_accvgpr_write_b32 a9, v29
 v_accvgpr_write_b32 a10, v30
 v_accvgpr_write_b32 a11, v31
 v_accvgpr_read_b32 v28, a12
 v_accvgpr_read_b32 v29, a13
 v_accvgpr_read_b32 v30, a14
 v_accvgpr_read_b32 v31, a15
 v_mul_f32 v28, v28, v240
 v_mul_f32 v29, v29, v240
 v_mul_f32 v30, v30, v240
 v_mul_f32 v31, v31, v240
 v_accvgpr_write_b32 a12, v28
 v_accvgpr_write_b32 a13, v29
 v_accvgpr_write_b32 a14, v30
 v_accvgpr_write_b32 a15, v31
 v_accvgpr_read_b32 v28, a16
 v_accvgpr_read_b32 v29, a17
 v_accvgpr_read_b32 v30, a18
 v_accvgpr_read_b32 v31, a19
 v_mul_f32 v28, v28, v241
 v_mul_f32 v29, v29, v241
 v_mul_f32 v30, v30, v241
 v_mul_f32 v31, v31, v241
 v_accvgpr_write_b32 a16, v28
 v_accvgpr_write_b32 a17, v29
 v_accvgpr_write_b32 a18, v30
 v_accvgpr_write_b32 a19, v31
 v_accvgpr_read_b32 v28, a20
 v_accvgpr_read_b32 v29, a21
 v_accvgpr_read_b32 v30, a22
 v_accvgpr_read_b32 v31, a23
 v_mul_f32 v28, v28, v242
 v_mul_f32 v29, v29, v242
 v_mul_f32 v30, v30, v242
 v_mul_f32 v31, v31, v242
 v_accvgpr_write_b32 a20, v28
 v_accvgpr_write_b32 a21, v29
 v_accvgpr_write_b32 a22, v30
 v_accvgpr_write_b32 a23, v31
 v_accvgpr_read_b32 v28, a24
 v_accvgpr_read_b32 v29, a25
 v_accvgpr_read_b32 v30, a26
 v_accvgpr_read_b32 v31, a27
 v_mul_f32 v28, v28, v240
 v_mul_f32 v29, v29, v240
 v_mul_f32 v30, v30, v240
 v_mul_f32 v31, v31, v240
 v_accvgpr_write_b32 a24, v28
 v_accvgpr_write_b32 a25, v29
 v_accvgpr_write_b32 a26, v30
 v_accvgpr_write_b32 a27, v31
 v_accvgpr_read_b32 v28, a28
 v_accvgpr_read_b32 v29, a29
 v_accvgpr_read_b32 v30, a30
 v_accvgpr_read_b32 v31, a31
 v_mul_f32 v28, v28, v241
 v_mul_f32 v29, v29, v241
 v_mul_f32 v30, v30, v241
 v_mul_f32 v31, v31, v241
 v_accvgpr_write_b32 a28, v28
 v_accvgpr_write_b32 a29, v29
 v_accvgpr_write_b32 a30, v30
 v_accvgpr_write_b32 a31, v31
 v_accvgpr_read_b32 v28, a32
 v_accvgpr_read_b32 v29, a33
 v_accvgpr_read_b32 v30, a34
 v_accvgpr_read_b32 v31, a35
 v_mul_f32 v28, v28, v242
 v_mul_f32 v29, v29, v242
 v_mul_f32 v30, v30, v242
 v_mul_f32 v31, v31, v242
 v_accvgpr_write_b32 a32, v28
 v_accvgpr_write_b32 a33, v29
 v_accvgpr_write_b32 a34, v30
 v_accvgpr_write_b32 a35, v31
 v_accvgpr_read_b32 v28, a36
 v_accvgpr_read_b32 v29, a37
 v_accvgpr_read_b32 v30, a38
 v_accvgpr_read_b32 v31, a39
 v_mul_f32 v28, v28, v240
 v_mul_f32 v29, v29, v240
 v_mul_f32 v30, v30, v240
 v_mul_f32 v31, v31, v240
 v_accvgpr_write_b32 a36, v28
 v_accvgpr_write_b32 a37, v29
 v_accvgpr_write_b32 a38, v30
 v_accvgpr_write_b32 a39, v31
 v_accvgpr_read_b32 v28, a40
 v_accvgpr_read_b32 v29, a41
 v_accvgpr_read_b32 v30, a42
 v_accvgpr_read_b32 v31, a43
 v_mul_f32 v28, v28, v241
 v_mul_f32 v29, v29, v241
 v_mul_f32 v30, v30, v241
 v_mul_f32 v31, v31, v241
 v_accvgpr_write_b32 a40, v28
 v_accvgpr_write_b32 a41, v29
 v_accvgpr_write_b32 a42, v30
 v_accvgpr_write_b32 a43, v31
 v_accvgpr_read_b32 v28, a44
 v_accvgpr_read_b32 v29, a45
 v_accvgpr_read_b32 v30, a46
 v_accvgpr_read_b32 v31, a47
 v_mul_f32 v28, v28, v242
 v_mul_f32 v29, v29, v242
 v_mul_f32 v30, v30, v242
 v_mul_f32 v31, v31, v242
 v_accvgpr_write_b32 a44, v28
 v_accvgpr_write_b32 a45, v29
 v_accvgpr_write_b32 a46, v30
 v_accvgpr_write_b32 a47, v31
 v_accvgpr_read_b32 v28, a48
 v_accvgpr_read_b32 v29, a49
 v_accvgpr_read_b32 v30, a50
 v_accvgpr_read_b32 v31, a51
 v_mul_f32 v28, v28, v240
 v_mul_f32 v29, v29, v240
 v_mul_f32 v30, v30, v240
 v_mul_f32 v31, v31, v240
 v_accvgpr_write_b32 a48, v28
 v_accvgpr_write_b32 a49, v29
 v_accvgpr_write_b32 a50, v30
 v_accvgpr_write_b32 a51, v31
 v_accvgpr_read_b32 v28, a52
 v_accvgpr_read_b32 v29, a53
 v_accvgpr_read_b32 v30, a54
 v_accvgpr_read_b32 v31, a55
 v_mul_f32 v28, v28, v241
 v_mul_f32 v29, v29, v241
 v_mul_f32 v30, v30, v241
 v_mul_f32 v31, v31, v241
 v_accvgpr_write_b32 a52, v28
 v_accvgpr_write_b32 a53, v29
 v_accvgpr_write_b32 a54, v30
 v_accvgpr_write_b32 a55, v31
 v_accvgpr_read_b32 v28, a56
 v_accvgpr_read_b32 v29, a57
 v_accvgpr_read_b32 v30, a58
 v_accvgpr_read_b32 v31, a59
 v_mul_f32 v28, v28, v242
 v_mul_f32 v29, v29, v242
 v_mul_f32 v30, v30, v242
 v_mul_f32 v31, v31, v242
 v_accvgpr_write_b32 a56, v28
 v_accvgpr_write_b32 a57, v29
 v_accvgpr_write_b32 a58, v30
 v_accvgpr_write_b32 a59, v31
 v_accvgpr_read_b32 v28, a60
 v_accvgpr_read_b32 v29, a61
 v_accvgpr_read_b32 v30, a62
 v_accvgpr_read_b32 v31, a63
 v_mul_f32 v28, v28, v240
 v_mul_f32 v29, v29, v240
 v_mul_f32 v30, v30, v240
 v_mul_f32 v31, v31, v240
 v_accvgpr_write_b32 a60, v28
 v_accvgpr_write_b32 a61, v29
 v_accvgpr_write_b32 a62, v30
 v_accvgpr_write_b32 a63, v31
 v_accvgpr_read_b32 v28, a64
 v_accvgpr_read_b32 v29, a65
 v_accvgpr_read_b32 v30, a66
 v_accvgpr_read_b32 v31, a67
 v_mul_f32 v28, v28, v241
 v_mul_f32 v29, v29, v241
 v_mul_f32 v30, v30, v241
 v_mul_f32 v31, v31, v241
 v_accvgpr_write_b32 a64, v28
 v_accvgpr_write_b32 a65, v29
 v_accvgpr_write_b32 a66, v30
 v_accvgpr_write_b32 a67, v31
 v_accvgpr_read_b32 v28, a68
 v_accvgpr_read_b32 v29, a69
 v_accvgpr_read_b32 v30, a70
 v_accvgpr_read_b32 v31, a71
 v_mul_f32 v28, v28, v242
 v_mul_f32 v29, v29, v242
 v_mul_f32 v30, v30, v242
 v_mul_f32 v31, v31, v242
 v_accvgpr_write_b32 a68, v28
 v_accvgpr_write_b32 a69, v29
 v_accvgpr_write_b32 a70, v30
 v_accvgpr_write_b32 a71, v31
 v_accvgpr_read_b32 v28, a72
 v_accvgpr_read_b32 v29, a73
 v_accvgpr_read_b32 v30, a74
 v_accvgpr_read_b32 v31, a75
 v_mul_f32 v28, v28, v240
 v_mul_f32 v29, v29, v240
 v_mul_f32 v30, v30, v240
 v_mul_f32 v31, v31, v240
 v_accvgpr_write_b32 a72, v28
 v_accvgpr_write_b32 a73, v29
 v_accvgpr_write_b32 a74, v30
 v_accvgpr_write_b32 a75, v31
 v_accvgpr_read_b32 v28, a76
 v_accvgpr_read_b32 v29, a77
 v_accvgpr_read_b32 v30, a78
 v_accvgpr_read_b32 v31, a79
 v_mul_f32 v28, v28, v241
 v_mul_f32 v29, v29, v241
 v_mul_f32 v30, v30, v241
 v_mul_f32 v31, v31, v241
 v_accvgpr_write_b32 a76, v28
 v_accvgpr_write_b32 a77, v29
 v_accvgpr_write_b32 a78, v30
 v_accvgpr_write_b32 a79, v31
 v_accvgpr_read_b32 v28, a80
 v_accvgpr_read_b32 v29, a81
 v_accvgpr_read_b32 v30, a82
 v_accvgpr_read_b32 v31, a83
 v_mul_f32 v28, v28, v242
 v_mul_f32 v29, v29, v242
 v_mul_f32 v30, v30, v242
 v_mul_f32 v31, v31, v242
 v_accvgpr_write_b32 a80, v28
 v_accvgpr_write_b32 a81, v29
 v_accvgpr_write_b32 a82, v30
 v_accvgpr_write_b32 a83, v31
 v_accvgpr_read_b32 v28, a84
 v_accvgpr_read_b32 v29, a85
 v_accvgpr_read_b32 v30, a86
 v_accvgpr_read_b32 v31, a87
 v_mul_f32 v28, v28, v240
 v_mul_f32 v29, v29, v240
 v_mul_f32 v30, v30, v240
 v_mul_f32 v31, v31, v240
 v_accvgpr_write_b32 a84, v28
 v_accvgpr_write_b32 a85, v29
 v_accvgpr_write_b32 a86, v30
 v_accvgpr_write_b32 a87, v31
 v_accvgpr_read_b32 v28, a88
 v_accvgpr_read_b32 v29, a89
 v_accvgpr_read_b32 v30, a90
 v_accvgpr_read_b32 v31, a91
 v_mul_f32 v28, v28, v241
 v_mul_f32 v29, v29, v241
 v_mul_f32 v30, v30, v241
 v_mul_f32 v31, v31, v241
 v_accvgpr_write_b32 a88, v28
 v_accvgpr_write_b32 a89, v29
 v_accvgpr_write_b32 a90, v30
 v_accvgpr_write_b32 a91, v31
 v_accvgpr_read_b32 v28, a92
 v_accvgpr_read_b32 v29, a93
 v_accvgpr_read_b32 v30, a94
 v_accvgpr_read_b32 v31, a95
 v_mul_f32 v28, v28, v242
 v_mul_f32 v29, v29, v242
 v_mul_f32 v30, v30, v242
 v_mul_f32 v31, v31, v242
 v_accvgpr_write_b32 a92, v28
 v_accvgpr_write_b32 a93, v29
 v_accvgpr_write_b32 a94, v30
 v_accvgpr_write_b32 a95, v31
 v_accvgpr_read_b32 v28, a96
 v_accvgpr_read_b32 v29, a97
 v_accvgpr_read_b32 v30, a98
 v_accvgpr_read_b32 v31, a99
 v_mul_f32 v28, v28, v240
 v_mul_f32 v29, v29, v240
 v_mul_f32 v30, v30, v240
 v_mul_f32 v31, v31, v240
 v_accvgpr_write_b32 a96, v28
 v_accvgpr_write_b32 a97, v29
 v_accvgpr_write_b32 a98, v30
 v_accvgpr_write_b32 a99, v31
 v_accvgpr_read_b32 v28, a100
 v_accvgpr_read_b32 v29, a101
 v_accvgpr_read_b32 v30, a102
 v_accvgpr_read_b32 v31, a103
 v_mul_f32 v28, v28, v241
 v_mul_f32 v29, v29, v241
 v_mul_f32 v30, v30, v241
 v_mul_f32 v31, v31, v241
 v_accvgpr_write_b32 a100, v28
 v_accvgpr_write_b32 a101, v29
 v_accvgpr_write_b32 a102, v30
 v_accvgpr_write_b32 a103, v31
 v_accvgpr_read_b32 v28, a104
 v_accvgpr_read_b32 v29, a105
 v_accvgpr_read_b32 v30, a106
 v_accvgpr_read_b32 v31, a107
 v_mul_f32 v28, v28, v242
 v_mul_f32 v29, v29, v242
 v_mul_f32 v30, v30, v242
 v_mul_f32 v31, v31, v242
 v_accvgpr_write_b32 a104, v28
 v_accvgpr_write_b32 a105, v29
 v_accvgpr_write_b32 a106, v30
 v_accvgpr_write_b32 a107, v31
 v_accvgpr_read_b32 v28, a108
 v_accvgpr_read_b32 v29, a109
 v_accvgpr_read_b32 v30, a110
 v_accvgpr_read_b32 v31, a111
 v_mul_f32 v28, v28, v240
 v_mul_f32 v29, v29, v240
 v_mul_f32 v30, v30, v240
 v_mul_f32 v31, v31, v240
 v_accvgpr_write_b32 a108, v28
 v_accvgpr_write_b32 a109, v29
 v_accvgpr_write_b32 a110, v30
 v_accvgpr_write_b32 a111, v31
 v_accvgpr_read_b32 v28, a112
 v_accvgpr_read_b32 v29, a113
 v_accvgpr_read_b32 v30, a114
 v_accvgpr_read_b32 v31, a115
 v_mul_f32 v28, v28, v241
 v_mul_f32 v29, v29, v241
 v_mul_f32 v30, v30, v241
 v_mul_f32 v31, v31, v241
 v_accvgpr_write_b32 a112, v28
 v_accvgpr_write_b32 a113, v29
 v_accvgpr_write_b32 a114, v30
 v_accvgpr_write_b32 a115, v31
 v_accvgpr_read_b32 v28, a116
 v_accvgpr_read_b32 v29, a117
 v_accvgpr_read_b32 v30, a118
 v_accvgpr_read_b32 v31, a119
 v_mul_f32 v28, v28, v242
 v_mul_f32 v29, v29, v242
 v_mul_f32 v30, v30, v242
 v_mul_f32 v31, v31, v242
 v_accvgpr_write_b32 a116, v28
 v_accvgpr_write_b32 a117, v29
 v_accvgpr_write_b32 a118, v30
 v_accvgpr_write_b32 a119, v31
 v_accvgpr_read_b32 v28, a120
 v_accvgpr_read_b32 v29, a121
 v_accvgpr_read_b32 v30, a122
 v_accvgpr_read_b32 v31, a123
 v_mul_f32 v28, v28, v240
 v_mul_f32 v29, v29, v240
 v_mul_f32 v30, v30, v240
 v_mul_f32 v31, v31, v240
 v_accvgpr_write_b32 a120, v28
 v_accvgpr_write_b32 a121, v29
 v_accvgpr_write_b32 a122, v30
 v_accvgpr_write_b32 a123, v31
 v_accvgpr_read_b32 v28, a124
 v_accvgpr_read_b32 v29, a125
 v_accvgpr_read_b32 v30, a126
 v_accvgpr_read_b32 v31, a127
 v_mul_f32 v28, v28, v241
 v_mul_f32 v29, v29, v241
 v_mul_f32 v30, v30, v241
 v_mul_f32 v31, v31, v241
 v_accvgpr_write_b32 a124, v28
 v_accvgpr_write_b32 a125, v29
 v_accvgpr_write_b32 a126, v30
 v_accvgpr_write_b32 a127, v31
 v_accvgpr_read_b32 v28, a128
 v_accvgpr_read_b32 v29, a129
 v_accvgpr_read_b32 v30, a130
 v_accvgpr_read_b32 v31, a131
 v_mul_f32 v28, v28, v242
 v_mul_f32 v29, v29, v242
 v_mul_f32 v30, v30, v242
 v_mul_f32 v31, v31, v242
 v_accvgpr_write_b32 a128, v28
 v_accvgpr_write_b32 a129, v29
 v_accvgpr_write_b32 a130, v30
 v_accvgpr_write_b32 a131, v31
 v_accvgpr_read_b32 v28, a132
 v_accvgpr_read_b32 v29, a133
 v_accvgpr_read_b32 v30, a134
 v_accvgpr_read_b32 v31, a135
 v_mul_f32 v28, v28, v240
 v_mul_f32 v29, v29, v240
 v_mul_f32 v30, v30, v240
 v_mul_f32 v31, v31, v240
 v_accvgpr_write_b32 a132, v28
 v_accvgpr_write_b32 a133, v29
 v_accvgpr_write_b32 a134, v30
 v_accvgpr_write_b32 a135, v31
 v_accvgpr_read_b32 v28, a136
 v_accvgpr_read_b32 v29, a137
 v_accvgpr_read_b32 v30, a138
 v_accvgpr_read_b32 v31, a139
 v_mul_f32 v28, v28, v241
 v_mul_f32 v29, v29, v241
 v_mul_f32 v30, v30, v241
 v_mul_f32 v31, v31, v241
 v_accvgpr_write_b32 a136, v28
 v_accvgpr_write_b32 a137, v29
 v_accvgpr_write_b32 a138, v30
 v_accvgpr_write_b32 a139, v31
 v_accvgpr_read_b32 v28, a140
 v_accvgpr_read_b32 v29, a141
 v_accvgpr_read_b32 v30, a142
 v_accvgpr_read_b32 v31, a143
 v_mul_f32 v28, v28, v242
 v_mul_f32 v29, v29, v242
 v_mul_f32 v30, v30, v242
 v_mul_f32 v31, v31, v242
 v_accvgpr_write_b32 a140, v28
 v_accvgpr_write_b32 a141, v29
 v_accvgpr_write_b32 a142, v30
 v_accvgpr_write_b32 a143, v31
 v_accvgpr_read_b32 v28, a144
 v_accvgpr_read_b32 v29, a145
 v_accvgpr_read_b32 v30, a146
 v_accvgpr_read_b32 v31, a147
 v_mul_f32 v28, v28, v240
 v_mul_f32 v29, v29, v240
 v_mul_f32 v30, v30, v240
 v_mul_f32 v31, v31, v240
 v_accvgpr_write_b32 a144, v28
 v_accvgpr_write_b32 a145, v29
 v_accvgpr_write_b32 a146, v30
 v_accvgpr_write_b32 a147, v31
 v_accvgpr_read_b32 v28, a148
 v_accvgpr_read_b32 v29, a149
 v_accvgpr_read_b32 v30, a150
 v_accvgpr_read_b32 v31, a151
 v_mul_f32 v28, v28, v241
 v_mul_f32 v29, v29, v241
 v_mul_f32 v30, v30, v241
 v_mul_f32 v31, v31, v241
 v_accvgpr_write_b32 a148, v28
 v_accvgpr_write_b32 a149, v29
 v_accvgpr_write_b32 a150, v30
 v_accvgpr_write_b32 a151, v31
 v_accvgpr_read_b32 v28, a152
 v_accvgpr_read_b32 v29, a153
 v_accvgpr_read_b32 v30, a154
 v_accvgpr_read_b32 v31, a155
 v_mul_f32 v28, v28, v242
 v_mul_f32 v29, v29, v242
 v_mul_f32 v30, v30, v242
 v_mul_f32 v31, v31, v242
 v_accvgpr_write_b32 a152, v28
 v_accvgpr_write_b32 a153, v29
 v_accvgpr_write_b32 a154, v30
 v_accvgpr_write_b32 a155, v31
 v_accvgpr_read_b32 v28, a156
 v_accvgpr_read_b32 v29, a157
 v_accvgpr_read_b32 v30, a158
 v_accvgpr_read_b32 v31, a159
 v_mul_f32 v28, v28, v240
 v_mul_f32 v29, v29, v240
 v_mul_f32 v30, v30, v240
 v_mul_f32 v31, v31, v240
 v_accvgpr_write_b32 a156, v28
 v_accvgpr_write_b32 a157, v29
 v_accvgpr_write_b32 a158, v30
 v_accvgpr_write_b32 a159, v31
 v_accvgpr_read_b32 v28, a160
 v_accvgpr_read_b32 v29, a161
 v_accvgpr_read_b32 v30, a162
 v_accvgpr_read_b32 v31, a163
 v_mul_f32 v28, v28, v241
 v_mul_f32 v29, v29, v241
 v_mul_f32 v30, v30, v241
 v_mul_f32 v31, v31, v241
 v_accvgpr_write_b32 a160, v28
 v_accvgpr_write_b32 a161, v29
 v_accvgpr_write_b32 a162, v30
 v_accvgpr_write_b32 a163, v31
 v_accvgpr_read_b32 v28, a164
 v_accvgpr_read_b32 v29, a165
 v_accvgpr_read_b32 v30, a166
 v_accvgpr_read_b32 v31, a167
 v_mul_f32 v28, v28, v242
 v_mul_f32 v29, v29, v242
 v_mul_f32 v30, v30, v242
 v_mul_f32 v31, v31, v242
 v_accvgpr_write_b32 a164, v28
 v_accvgpr_write_b32 a165, v29
 v_accvgpr_write_b32 a166, v30
 v_accvgpr_write_b32 a167, v31
 v_accvgpr_read_b32 v28, a168
 v_accvgpr_read_b32 v29, a169
 v_accvgpr_read_b32 v30, a170
 v_accvgpr_read_b32 v31, a171
 v_mul_f32 v28, v28, v240
 v_mul_f32 v29, v29, v240
 v_mul_f32 v30, v30, v240
 v_mul_f32 v31, v31, v240
 v_accvgpr_write_b32 a168, v28
 v_accvgpr_write_b32 a169, v29
 v_accvgpr_write_b32 a170, v30
 v_accvgpr_write_b32 a171, v31
 v_accvgpr_read_b32 v28, a172
 v_accvgpr_read_b32 v29, a173
 v_accvgpr_read_b32 v30, a174
 v_accvgpr_read_b32 v31, a175
 v_mul_f32 v28, v28, v241
 v_mul_f32 v29, v29, v241
 v_mul_f32 v30, v30, v241
 v_mul_f32 v31, v31, v241
 v_accvgpr_write_b32 a172, v28
 v_accvgpr_write_b32 a173, v29
 v_accvgpr_write_b32 a174, v30
 v_accvgpr_write_b32 a175, v31
 v_accvgpr_read_b32 v28, a176
 v_accvgpr_read_b32 v29, a177
 v_accvgpr_read_b32 v30, a178
 v_accvgpr_read_b32 v31, a179
 v_mul_f32 v28, v28, v242
 v_mul_f32 v29, v29, v242
 v_mul_f32 v30, v30, v242
 v_mul_f32 v31, v31, v242
 v_accvgpr_write_b32 a176, v28
 v_accvgpr_write_b32 a177, v29
 v_accvgpr_write_b32 a178, v30
 v_accvgpr_write_b32 a179, v31
 v_accvgpr_read_b32 v28, a180
 v_accvgpr_read_b32 v29, a181
 v_accvgpr_read_b32 v30, a182
 v_accvgpr_read_b32 v31, a183
 v_mul_f32 v28, v28, v240
 v_mul_f32 v29, v29, v240
 v_mul_f32 v30, v30, v240
 v_mul_f32 v31, v31, v240
 v_accvgpr_write_b32 a180, v28
 v_accvgpr_write_b32 a181, v29
 v_accvgpr_write_b32 a182, v30
 v_accvgpr_write_b32 a183, v31
 v_accvgpr_read_b32 v28, a184
 v_accvgpr_read_b32 v29, a185
 v_accvgpr_read_b32 v30, a186
 v_accvgpr_read_b32 v31, a187
 v_mul_f32 v28, v28, v241
 v_mul_f32 v29, v29, v241
 v_mul_f32 v30, v30, v241
 v_mul_f32 v31, v31, v241
 v_accvgpr_write_b32 a184, v28
 v_accvgpr_write_b32 a185, v29
 v_accvgpr_write_b32 a186, v30
 v_accvgpr_write_b32 a187, v31
 v_accvgpr_read_b32 v28, a188
 v_accvgpr_read_b32 v29, a189
 v_accvgpr_read_b32 v30, a190
 v_accvgpr_read_b32 v31, a191
 v_mul_f32 v28, v28, v242
 v_mul_f32 v29, v29, v242
 v_mul_f32 v30, v30, v242
 v_mul_f32 v31, v31, v242
 v_accvgpr_write_b32 a188, v28
 v_accvgpr_write_b32 a189, v29
 v_accvgpr_write_b32 a190, v30
 v_accvgpr_write_b32 a191, v31
 s_cmp_eq_u32 s90, 4
 s_cbranch_scc1 L1_POST1
 s_cmp_eq_u32 s90, 1
 s_cbranch_scc1 L1_POST2
 s_cmp_eq_u32 s90, 3
 s_cbranch_scc1 L1_POST2
 s_cmp_eq_u32 s90, 5
 s_cbranch_scc1 L1_POST3
L1_POST0:
 v_exp_f32 v28, v128
 v_exp_f32 v29, v129
 v_exp_f32 v30, v130
 v_exp_f32 v31, v131
 v_cvt_pk_bf16_f32 v52, v28, v29
 v_exp_f32 v32, v140
 v_dot2_f32_bf16 v11, v52, s79, 0
 v_exp_f32 v33, v141
 v_cvt_pk_bf16_f32 v53, v30, v31
 v_exp_f32 v34, v142
 v_dot2c_f32_bf16 v11, s79, v53
 v_exp_f32 v35, v143
 v_cvt_pk_bf16_f32 v54, v32, v33
 v_dot2c_f32_bf16 v11, s79, v54
 v_cvt_pk_bf16_f32 v55, v34, v35
 v_dot2c_f32_bf16 v11, s79, v55
 v_exp_f32 v28, v132
 v_exp_f32 v29, v133
 v_exp_f32 v30, v134
 v_exp_f32 v31, v135
 v_cvt_pk_bf16_f32 v56, v28, v29
 v_exp_f32 v32, v144
 v_dot2_f32_bf16 v12, v56, s79, 0
 v_exp_f32 v33, v145
 v_cvt_pk_bf16_f32 v57, v30, v31
 v_exp_f32 v34, v146
 v_dot2c_f32_bf16 v12, s79, v57
 v_exp_f32 v35, v147
 v_cvt_pk_bf16_f32 v58, v32, v33
 v_dot2c_f32_bf16 v12, s79, v58
 v_cvt_pk_bf16_f32 v59, v34, v35
 v_dot2c_f32_bf16 v12, s79, v59
 v_exp_f32 v28, v136
 v_exp_f32 v29, v137
 v_exp_f32 v30, v138
 v_exp_f32 v31, v139
 v_cvt_pk_bf16_f32 v60, v28, v29
 v_exp_f32 v32, v148
 v_dot2_f32_bf16 v13, v60, s79, 0
 v_exp_f32 v33, v149
 v_cvt_pk_bf16_f32 v61, v30, v31
 v_exp_f32 v34, v150
 v_dot2c_f32_bf16 v13, s79, v61
 v_exp_f32 v35, v151
 v_cvt_pk_bf16_f32 v62, v32, v33
 v_dot2c_f32_bf16 v13, s79, v62
 v_cvt_pk_bf16_f32 v63, v34, v35
 v_dot2c_f32_bf16 v13, s79, v63
 v_exp_f32 v28, v152
 v_exp_f32 v29, v153
 v_exp_f32 v30, v154
 v_exp_f32 v31, v155
 v_cvt_pk_bf16_f32 v40, v28, v29
 v_exp_f32 v32, v164
 v_dot2c_f32_bf16 v11, s79, v40
 v_exp_f32 v33, v165
 v_cvt_pk_bf16_f32 v41, v30, v31
 v_exp_f32 v34, v166
 v_dot2c_f32_bf16 v11, s79, v41
 v_exp_f32 v35, v167
 v_cvt_pk_bf16_f32 v42, v32, v33
 v_dot2c_f32_bf16 v11, s79, v42
 v_cvt_pk_bf16_f32 v43, v34, v35
 v_dot2c_f32_bf16 v11, s79, v43
 v_exp_f32 v28, v156
 v_exp_f32 v29, v157
 v_exp_f32 v30, v158
 v_exp_f32 v31, v159
 v_cvt_pk_bf16_f32 v44, v28, v29
 v_exp_f32 v32, v168
 v_dot2c_f32_bf16 v12, s79, v44
 v_exp_f32 v33, v169
 v_cvt_pk_bf16_f32 v45, v30, v31
 v_exp_f32 v34, v170
 v_dot2c_f32_bf16 v12, s79, v45
 v_exp_f32 v35, v171
 v_cvt_pk_bf16_f32 v46, v32, v33
 v_dot2c_f32_bf16 v12, s79, v46
 v_cvt_pk_bf16_f32 v47, v34, v35
 v_dot2c_f32_bf16 v12, s79, v47
 v_exp_f32 v28, v160
 v_exp_f32 v29, v161
 v_exp_f32 v30, v162
 v_exp_f32 v31, v163
 v_cvt_pk_bf16_f32 v48, v28, v29
 v_exp_f32 v32, v172
 v_dot2c_f32_bf16 v13, s79, v48
 v_exp_f32 v33, v173
 v_cvt_pk_bf16_f32 v49, v30, v31
 v_exp_f32 v34, v174
 v_dot2c_f32_bf16 v13, s79, v49
 v_exp_f32 v35, v175
 v_cvt_pk_bf16_f32 v50, v32, v33
 v_dot2c_f32_bf16 v13, s79, v50
 v_cvt_pk_bf16_f32 v51, v34, v35
 v_dot2c_f32_bf16 v13, s79, v51
 s_cmp_eq_u32 s90, 0
 s_cbranch_scc1 L1_BACK0
 s_nop 1
 s_branch L1_BACK2
L1_POST1:
 v_exp_f32 v28, v128
 v_exp_f32 v29, v129
 v_exp_f32 v30, v130
 v_exp_f32 v31, v131
 v_cvt_pk_bf16_f32 v52, v28, v29
 v_exp_f32 v32, v140
 v_dot2_f32_bf16 v11, v52, s79, 0
 v_exp_f32 v33, v141
 v_cvt_pk_bf16_f32 v53, v30, v31
 v_exp_f32 v34, v142
 v_dot2c_f32_bf16 v11, s79, v53
 v_exp_f32 v35, v143
 v_cvt_pk_bf16_f32 v54, v32, v33
 v_dot2c_f32_bf16 v11, s79, v54
 v_cvt_pk_bf16_f32 v55, v34, v35
 v_dot2c_f32_bf16 v11, s79, v55
 v_exp_f32 v28, v132
 v_exp_f32 v29, v133
 v_exp_f32 v30, v134
 v_exp_f32 v31, v135
 v_cvt_pk_bf16_f32 v56, v28, v29
 v_exp_f32 v32, v144
 v_dot2_f32_bf16 v12, v56, s79, 0
 v_exp_f32 v33, v145
 v_cvt_pk_bf16_f32 v57, v30, v31
 v_exp_f32 v34, v146
 v_dot2c_f32_bf16 v12, s79, v57
 v_exp_f32 v35, v147
 v_cvt_pk_bf16_f32 v58, v32, v33
 v_dot2c_f32_bf16 v12, s79, v58
 v_cvt_pk_bf16_f32 v59, v34, v35
 v_dot2c_f32_bf16 v12, s79, v59
 v_exp_f32 v28, v136
 v_exp_f32 v29, v137
 v_exp_f32 v30, v138
 v_exp_f32 v31, v139
 v_cvt_pk_bf16_f32 v60, v28, v29
 v_exp_f32 v32, v148
 v_dot2_f32_bf16 v13, v60, s79, 0
 v_exp_f32 v33, v149
 v_cvt_pk_bf16_f32 v61, v30, v31
 v_exp_f32 v34, v150
 v_dot2c_f32_bf16 v13, s79, v61
 v_exp_f32 v35, v151
 v_cvt_pk_bf16_f32 v62, v32, v33
 v_dot2c_f32_bf16 v13, s79, v62
 v_cvt_pk_bf16_f32 v63, v34, v35
 v_dot2c_f32_bf16 v13, s79, v63
 v_exp_f32 v28, v152
 v_exp_f32 v29, v153
 v_exp_f32 v30, v154
 v_exp_f32 v31, v155
 v_cvt_pk_bf16_f32 v40, v28, v29
 v_exp_f32 v32, v164
 v_dot2c_f32_bf16 v11, s79, v40
 v_exp_f32 v33, v165
 v_cvt_pk_bf16_f32 v41, v30, v31
 v_exp_f32 v34, v166
 v_dot2c_f32_bf16 v11, s79, v41
 v_exp_f32 v35, v167
 v_cvt_pk_bf16_f32 v42, v32, v33
 v_dot2c_f32_bf16 v11, s79, v42
 v_cvt_pk_bf16_f32 v43, v34, v35
 v_dot2c_f32_bf16 v11, s79, v43
 v_exp_f32 v28, v156
 v_exp_f32 v29, v157
 v_exp_f32 v30, v158
 v_exp_f32 v31, v159
 v_cvt_pk_bf16_f32 v44, v28, v29
 v_exp_f32 v32, v168
 v_dot2c_f32_bf16 v12, s79, v44
 v_exp_f32 v33, v169
 v_cvt_pk_bf16_f32 v45, v30, v31
 v_exp_f32 v34, v170
 v_dot2c_f32_bf16 v12, s79, v45
 v_exp_f32 v35, v171
 v_cvt_pk_bf16_f32 v46, v32, v33
 v_dot2c_f32_bf16 v12, s79, v46
 v_cvt_pk_bf16_f32 v47, v34, v35
 v_dot2c_f32_bf16 v12, s79, v47
 v_exp_f32 v28, v160
 v_exp_f32 v29, v161
 v_exp_f32 v30, v162
 v_exp_f32 v31, v163
 v_cvt_pk_bf16_f32 v48, v28, v29
 v_exp_f32 v32, v172
 v_dot2c_f32_bf16 v13, s79, v48
 v_exp_f32 v33, v173
 v_cvt_pk_bf16_f32 v49, v30, v31
 v_exp_f32 v34, v174
 v_dot2c_f32_bf16 v13, s79, v49
 v_exp_f32 v35, v175
 v_cvt_pk_bf16_f32 v50, v32, v33
 v_dot2c_f32_bf16 v13, s79, v50
 v_cvt_pk_bf16_f32 v51, v34, v35
 v_dot2c_f32_bf16 v13, s79, v51
 v_exp_f32 v28, v184
 v_exp_f32 v29, v185
 v_exp_f32 v30, v186
 v_exp_f32 v31, v187
 v_add_f32 v250, v28, v29
 v_cvt_pk_bf16_f32 v232, v28, v29
 v_exp_f32 v32, v196
 v_add_f32 v250, v250, v30
 v_exp_f32 v33, v197
 v_add_f32 v250, v250, v31
 v_cvt_pk_bf16_f32 v233, v30, v31
 v_exp_f32 v34, v198
 v_add_f32 v250, v250, v32
 v_exp_f32 v35, v199
 v_add_f32 v250, v250, v33
 v_cvt_pk_bf16_f32 v234, v32, v33
 v_add_f32 v250, v250, v34
 v_add_f32 v250, v250, v35
 v_cvt_pk_bf16_f32 v235, v34, v35
 v_exp_f32 v28, v180
 v_exp_f32 v29, v181
 v_exp_f32 v30, v182
 v_exp_f32 v31, v183
 v_add_f32 v249, v28, v29
 v_cvt_pk_bf16_f32 v228, v28, v29
 v_exp_f32 v32, v192
 v_add_f32 v249, v249, v30
 v_exp_f32 v33, v193
 v_add_f32 v249, v249, v31
 v_cvt_pk_bf16_f32 v229, v30, v31
 v_exp_f32 v34, v194
 v_add_f32 v249, v249, v32
 v_exp_f32 v35, v195
 v_add_f32 v249, v249, v33
 v_cvt_pk_bf16_f32 v230, v32, v33
 v_add_f32 v249, v249, v34
 v_add_f32 v249, v249, v35
 v_cvt_pk_bf16_f32 v231, v34, v35
 v_exp_f32 v28, v176
 v_exp_f32 v29, v177
 v_exp_f32 v30, v178
 v_exp_f32 v31, v179
 v_add_f32 v248, v28, v29
 v_cvt_pk_bf16_f32 v224, v28, v29
 v_exp_f32 v32, v188
 s_nop 1
 s_branch L1_BACK4
L1_POST2:
 v_exp_f32 v28, v176
 v_exp_f32 v29, v177
 v_exp_f32 v30, v178
 v_exp_f32 v31, v179
 v_cvt_pk_bf16_f32 v224, v28, v29
 v_exp_f32 v32, v188
 v_dot2_f32_bf16 v11, v224, s79, 0
 v_exp_f32 v33, v189
 v_cvt_pk_bf16_f32 v225, v30, v31
 v_exp_f32 v34, v190
 v_dot2c_f32_bf16 v11, s79, v225
 v_exp_f32 v35, v191
 v_cvt_pk_bf16_f32 v226, v32, v33
 v_dot2c_f32_bf16 v11, s79, v226
 v_cvt_pk_bf16_f32 v227, v34, v35
 v_dot2c_f32_bf16 v11, s79, v227
 v_exp_f32 v28, v180
 v_exp_f32 v29, v181
 v_exp_f32 v30, v182
 v_exp_f32 v31, v183
 v_cvt_pk_bf16_f32 v228, v28, v29
 v_exp_f32 v32, v192
 v_dot2_f32_bf16 v12, v228, s79, 0
 v_exp_f32 v33, v193
 v_cvt_pk_bf16_f32 v229, v30, v31
 v_exp_f32 v34, v194
 v_dot2c_f32_bf16 v12, s79, v229
 v_exp_f32 v35, v195
 v_cvt_pk_bf16_f32 v230, v32, v33
 v_dot2c_f32_bf16 v12, s79, v230
 v_cvt_pk_bf16_f32 v231, v34, v35
 v_dot2c_f32_bf16 v12, s79, v231
 v_exp_f32 v28, v184
 v_exp_f32 v29, v185
 v_exp_f32 v30, v186
 v_exp_f32 v31, v187
 v_cvt_pk_bf16_f32 v232, v28, v29
 v_exp_f32 v32, v196
 v_dot2_f32_bf16 v13, v232, s79, 0
 v_exp_f32 v33, v197
 v_cvt_pk_bf16_f32 v233, v30, v31
 v_exp_f32 v34, v198
 v_dot2c_f32_bf16 v13, s79, v233
 v_exp_f32 v35, v199
 v_cvt_pk_bf16_f32 v234, v32, v33
 v_dot2c_f32_bf16 v13, s79, v234
 v_cvt_pk_bf16_f32 v235, v34, v35
 v_dot2c_f32_bf16 v13, s79, v235
 v_exp_f32 v28, v200
 v_exp_f32 v29, v201
 v_exp_f32 v30, v202
 v_exp_f32 v31, v203
 v_cvt_pk_bf16_f32 v40, v28, v29
 v_exp_f32 v32, v212
 v_dot2c_f32_bf16 v11, s79, v40
 v_exp_f32 v33, v213
 v_cvt_pk_bf16_f32 v41, v30, v31
 v_exp_f32 v34, v214
 v_dot2c_f32_bf16 v11, s79, v41
 v_exp_f32 v35, v215
 v_cvt_pk_bf16_f32 v42, v32, v33
 v_dot2c_f32_bf16 v11, s79, v42
 v_cvt_pk_bf16_f32 v43, v34, v35
 v_dot2c_f32_bf16 v11, s79, v43
 v_exp_f32 v28, v204
 v_exp_f32 v29, v205
 v_exp_f32 v30, v206
 v_exp_f32 v31, v207
 v_cvt_pk_bf16_f32 v44, v28, v29
 v_exp_f32 v32, v216
 v_dot2c_f32_bf16 v12, s79, v44
 v_exp_f32 v33, v217
 v_cvt_pk_bf16_f32 v45, v30, v31
 v_exp_f32 v34, v218
 v_dot2c_f32_bf16 v12, s79, v45
 v_exp_f32 v35, v219
 v_cvt_pk_bf16_f32 v46, v32, v33
 v_dot2c_f32_bf16 v12, s79, v46
 v_cvt_pk_bf16_f32 v47, v34, v35
 v_dot2c_f32_bf16 v12, s79, v47
 v_exp_f32 v28, v208
 v_exp_f32 v29, v209
 v_exp_f32 v30, v210
 v_exp_f32 v31, v211
 v_cvt_pk_bf16_f32 v48, v28, v29
 v_exp_f32 v32, v220
 v_dot2c_f32_bf16 v13, s79, v48
 v_exp_f32 v33, v221
 v_cvt_pk_bf16_f32 v49, v30, v31
 v_exp_f32 v34, v222
 v_dot2c_f32_bf16 v13, s79, v49
 v_exp_f32 v35, v223
 v_cvt_pk_bf16_f32 v50, v32, v33
 v_dot2c_f32_bf16 v13, s79, v50
 v_cvt_pk_bf16_f32 v51, v34, v35
 v_dot2c_f32_bf16 v13, s79, v51
 s_cmp_eq_u32 s90, 1
 s_cbranch_scc1 L1_BACK1
 s_nop 1
 s_branch L1_BACK3
L1_POST3:
 v_exp_f32 v28, v176
 v_exp_f32 v29, v177
 v_exp_f32 v30, v178
 v_exp_f32 v31, v179
 v_cvt_pk_bf16_f32 v224, v28, v29
 v_exp_f32 v32, v188
 v_dot2_f32_bf16 v248, v224, s79, 0
 v_exp_f32 v33, v189
 v_cvt_pk_bf16_f32 v225, v30, v31
 v_exp_f32 v34, v190
 v_dot2c_f32_bf16 v248, s79, v225
 v_exp_f32 v35, v191
 v_cvt_pk_bf16_f32 v226, v32, v33
 v_dot2c_f32_bf16 v248, s79, v226
 v_cvt_pk_bf16_f32 v227, v34, v35
 v_dot2c_f32_bf16 v248, s79, v227
 v_exp_f32 v28, v180
 v_exp_f32 v29, v181
 v_exp_f32 v30, v182
 v_exp_f32 v31, v183
 v_cvt_pk_bf16_f32 v228, v28, v29
 v_exp_f32 v32, v192
 v_dot2_f32_bf16 v249, v228, s79, 0
 v_exp_f32 v33, v193
 v_cvt_pk_bf16_f32 v229, v30, v31
 v_exp_f32 v34, v194
 v_dot2c_f32_bf16 v249, s79, v229
 v_exp_f32 v35, v195
 v_cvt_pk_bf16_f32 v230, v32, v33
 v_dot2c_f32_bf16 v249, s79, v230
 v_cvt_pk_bf16_f32 v231, v34, v35
 v_dot2c_f32_bf16 v249, s79, v231
 v_exp_f32 v28, v184
 v_exp_f32 v29, v185
 v_exp_f32 v30, v186
 v_exp_f32 v31, v187
 v_cvt_pk_bf16_f32 v232, v28, v29
 v_exp_f32 v32, v196
 v_dot2_f32_bf16 v250, v232, s79, 0
 v_exp_f32 v33, v197
 v_cvt_pk_bf16_f32 v233, v30, v31
 v_exp_f32 v34, v198
 v_dot2c_f32_bf16 v250, s79, v233
 v_exp_f32 v35, v199
 v_cvt_pk_bf16_f32 v234, v32, v33
 v_dot2c_f32_bf16 v250, s79, v234
 v_cvt_pk_bf16_f32 v235, v34, v35
 v_dot2c_f32_bf16 v250, s79, v235
 v_exp_f32 v28, v200
 v_exp_f32 v29, v201
 v_exp_f32 v30, v202
 v_exp_f32 v31, v203
 v_cvt_pk_bf16_f32 v160, v28, v29
 v_exp_f32 v32, v212
 v_dot2c_f32_bf16 v248, s79, v160
 v_exp_f32 v33, v213
 v_cvt_pk_bf16_f32 v161, v30, v31
 v_exp_f32 v34, v214
 v_dot2c_f32_bf16 v248, s79, v161
 v_exp_f32 v35, v215
 v_cvt_pk_bf16_f32 v162, v32, v33
 v_dot2c_f32_bf16 v248, s79, v162
 v_cvt_pk_bf16_f32 v163, v34, v35
 v_dot2c_f32_bf16 v248, s79, v163
 v_exp_f32 v28, v204
 v_exp_f32 v29, v205
 v_exp_f32 v30, v206
 v_exp_f32 v31, v207
 v_cvt_pk_bf16_f32 v164, v28, v29
 v_exp_f32 v32, v216
 v_dot2c_f32_bf16 v249, s79, v164
 v_exp_f32 v33, v217
 v_cvt_pk_bf16_f32 v165, v30, v31
 v_exp_f32 v34, v218
 v_dot2c_f32_bf16 v249, s79, v165
 v_exp_f32 v35, v219
 v_cvt_pk_bf16_f32 v166, v32, v33
 v_dot2c_f32_bf16 v249, s79, v166
 v_cvt_pk_bf16_f32 v167, v34, v35
 v_dot2c_f32_bf16 v249, s79, v167
 v_exp_f32 v28, v208
 v_exp_f32 v29, v209
 v_exp_f32 v30, v210
 v_exp_f32 v31, v211
 v_cvt_pk_bf16_f32 v168, v28, v29
 v_exp_f32 v32, v220
 v_dot2c_f32_bf16 v250, s79, v168
 v_exp_f32 v33, v221
 v_cvt_pk_bf16_f32 v169, v30, v31
 v_exp_f32 v34, v222
 v_dot2c_f32_bf16 v250, s79, v169
 v_exp_f32 v35, v223
 v_cvt_pk_bf16_f32 v170, v32, v33
 v_dot2c_f32_bf16 v250, s79, v170
 v_cvt_pk_bf16_f32 v171, v34, v35
 v_dot2c_f32_bf16 v250, s79, v171
 s_nop 1
 s_branch L1_BACK5
.p2align 6
L1_W3:
 ds_read_b64_tr_b16 a[192:193], v41 offset:33792
 ds_read_b64_tr_b16 a[194:195], v41 offset:34304
 ds_read_b64_tr_b16 a[196:197], v41 offset:50688
 ds_read_b64_tr_b16 a[198:199], v41 offset:51200
 ds_read_b64_tr_b16 a[200:201], v41 offset:33800
 ds_read_b64_tr_b16 a[202:203], v41 offset:34312
 ds_read_b64_tr_b16 a[204:205], v41 offset:50696
 ds_read_b64_tr_b16 a[206:207], v41 offset:51208
 ds_read_b64_tr_b16 a[208:209], v59 offset:33824
 ds_read_b64_tr_b16 a[210:211], v59 offset:34336
 ds_read_b64_tr_b16 a[212:213], v59 offset:50720
 ds_read_b64_tr_b16 a[214:215], v59 offset:51232
 s_waitcnt lgkmcnt(8)
 v_mfma_f32_16x16x32_bf16 v[64:67], a[192:195], a[0:3], 0
 s_mov_b32 s82, 0x100
 s_add_u32 m0, s71, 0x0
 ds_read_b64_tr_b16 a[216:217], v59 offset:33832
 v_mfma_f32_16x16x32_bf16 v[64:67], a[196:199], a[12:15], v[64:67]
 buffer_load_dwordx4 v43, s[44:47], s82 offen lds
 ds_read_b64_tr_b16 a[218:219], v59 offset:34344
 v_mfma_f32_16x16x32_bf16 v[128:131], a[196:199], a[16:19], 0
 ds_read_b64_tr_b16 a[220:221], v59 offset:50728
 v_mfma_f32_16x16x32_bf16 v[128:131], a[192:195], a[4:7], v[128:131]
 s_waitcnt lgkmcnt(7)
 s_mov_b32 s83, 0x100
 s_add_u32 m0, s71, 0x400
 ds_read_b64_tr_b16 a[222:223], v59 offset:51240
 v_mfma_f32_16x16x32_bf16 v[132:135], a[200:203], a[4:7], 0
 buffer_load_dwordx4 v44, s[44:47], s83 offen lds
 ds_read_b64_tr_b16 a[192:193], v41 offset:33856
 v_mfma_f32_16x16x32_bf16 v[132:135], a[204:207], a[16:19], v[132:135]
 ds_read_b64_tr_b16 a[194:195], v41 offset:34368
 v_mfma_f32_16x16x32_bf16 v[68:71], a[204:207], a[12:15], 0
 ds_read_b64_tr_b16 a[196:197], v41 offset:50752
 v_mfma_f32_16x16x32_bf16 v[68:71], a[200:203], a[0:3], v[68:71]
 s_waitcnt lgkmcnt(7)
 s_mov_b32 s82, 0x3900
 s_add_u32 m0, s71, 0x800
 ds_read_b64_tr_b16 a[198:199], v41 offset:51264
 v_mfma_f32_16x16x32_bf16 v[72:75], a[208:211], a[0:3], 0
 buffer_load_dwordx4 v43, s[44:47], s82 offen lds
 ds_read_b64_tr_b16 a[200:201], v41 offset:33864
 s_waitcnt vmcnt(11)
 ds_read_b128 a[24:27], v46 offset:0
 v_mfma_f32_16x16x32_bf16 v[72:75], a[212:215], a[12:15], v[72:75]
 ds_read_b64_tr_b16 a[202:203], v41 offset:34376
 v_mfma_f32_16x16x32_bf16 v[136:139], a[212:215], a[16:19], 0
 s_mov_b32 s83, 0x3900
 s_add_u32 m0, s71, 0xc00
 ds_read_b64_tr_b16 a[204:205], v41 offset:50760
 v_mfma_f32_16x16x32_bf16 v[136:139], a[208:211], a[4:7], v[136:139]
 s_waitcnt lgkmcnt(8)
 buffer_load_dwordx4 v44, s[44:47], s83 offen lds
 ds_read_b64_tr_b16 a[206:207], v41 offset:51272
 ds_read_b128 a[36:39], v47 offset:0
 v_mfma_f32_16x16x32_bf16 v[140:143], a[216:219], a[4:7], 0
 ds_read_b64_tr_b16 a[208:209], v59 offset:33888
 v_mfma_f32_16x16x32_bf16 v[140:143], a[220:223], a[16:19], v[140:143]
 ds_read_b64_tr_b16 a[210:211], v59 offset:34400
 v_mfma_f32_16x16x32_bf16 v[76:79], a[220:223], a[12:15], 0
 s_mov_b32 s82, 0x100000
 s_add_u32 m0, s74, 0x10800
 ds_read_b64_tr_b16 a[212:213], v59 offset:50784
 ds_read_b128 a[28:31], v46 offset:2048
 v_mfma_f32_16x16x32_bf16 v[76:79], a[216:219], a[0:3], v[76:79]
 s_waitcnt lgkmcnt(10)
 buffer_load_dwordx4 v42, s[56:59], s82 offen nt lds
 ds_read_b64_tr_b16 a[214:215], v59 offset:51296
 v_mfma_f32_16x16x32_bf16 v[80:83], a[192:195], a[0:3], 0
 ds_read_b64_tr_b16 a[216:217], v59 offset:33896
 v_mfma_f32_16x16x32_bf16 v[80:83], a[196:199], a[12:15], v[80:83]
 ds_read_b64_tr_b16 a[218:219], v59 offset:34408
 ds_read_b128 a[40:43], v47 offset:2048
 v_mfma_f32_16x16x32_bf16 v[144:147], a[196:199], a[16:19], 0
 s_mov_b32 s83, 0x102000
 s_add_u32 m0, s74, 0x10c28
 ds_read_b64_tr_b16 a[220:221], v59 offset:50792
 v_mfma_f32_16x16x32_bf16 v[144:147], a[192:195], a[4:7], v[144:147]
 s_waitcnt lgkmcnt(10)
 buffer_load_dwordx4 v42, s[56:59], s83 offen nt lds
 ds_read_b64_tr_b16 a[222:223], v59 offset:51304
 v_mfma_f32_16x16x32_bf16 v[148:151], a[200:203], a[4:7], 0
 ds_read_b64_tr_b16 a[192:193], v41 offset:33920
 v_mfma_f32_16x16x32_bf16 v[148:151], a[204:207], a[16:19], v[148:151]
 s_mov_b32 s82, 0x104000
 s_add_u32 m0, s74, 0x11040
 ds_read_b64_tr_b16 a[194:195], v41 offset:34432
 v_mfma_f32_16x16x32_bf16 v[84:87], a[204:207], a[12:15], 0
 buffer_load_dwordx4 v42, s[56:59], s82 offen nt lds
 ds_read_b64_tr_b16 a[196:197], v41 offset:50816
 v_mfma_f32_16x16x32_bf16 v[84:87], a[200:203], a[0:3], v[84:87]
 s_waitcnt lgkmcnt(8)
 ds_read_b64_tr_b16 a[198:199], v41 offset:51328
 v_mfma_f32_16x16x32_bf16 v[88:91], a[208:211], a[0:3], 0
 ds_read_b64_tr_b16 a[200:201], v41 offset:33928
 v_mfma_f32_16x16x32_bf16 v[88:91], a[212:215], a[12:15], v[88:91]
 s_mov_b32 s83, 0x106000
 s_add_u32 m0, s74, 0x11468
 ds_read_b64_tr_b16 a[202:203], v41 offset:34440
 v_mfma_f32_16x16x32_bf16 v[152:155], a[212:215], a[16:19], 0
 buffer_load_dwordx4 v42, s[56:59], s83 offen nt lds
 ds_read_b64_tr_b16 a[204:205], v41 offset:50824
 v_mfma_f32_16x16x32_bf16 v[152:155], a[208:211], a[4:7], v[152:155]
 s_waitcnt lgkmcnt(7)
 ds_read_b64_tr_b16 a[206:207], v41 offset:51336
 v_mfma_f32_16x16x32_bf16 v[156:159], a[216:219], a[4:7], 0
 ds_read_b64_tr_b16 a[208:209], v59 offset:33952
 v_mfma_f32_16x16x32_bf16 v[156:159], a[220:223], a[16:19], v[156:159]
 s_mov_b32 s82, 0x110000
 s_add_u32 m0, s74, 0x11880
 ds_read_b64_tr_b16 a[210:211], v59 offset:34464
 v_mfma_f32_16x16x32_bf16 v[92:95], a[220:223], a[12:15], 0
 buffer_load_dwordx4 v42, s[56:59], s82 offen nt lds
 ds_read_b64_tr_b16 a[212:213], v59 offset:50848
 v_mfma_f32_16x16x32_bf16 v[92:95], a[216:219], a[0:3], v[92:95]
 s_waitcnt lgkmcnt(7)
 ds_read_b64_tr_b16 a[214:215], v59 offset:51360
 v_mfma_f32_16x16x32_bf16 v[96:99], a[192:195], a[0:3], 0
 s_mov_b32 s83, 0x112000
 s_add_u32 m0, s74, 0x11ca8
 ds_read_b64_tr_b16 a[216:217], v59 offset:33960
 v_mfma_f32_16x16x32_bf16 v[96:99], a[196:199], a[12:15], v[96:99]
 buffer_load_dwordx4 v42, s[56:59], s83 offen nt lds
 ds_read_b64_tr_b16 a[218:219], v59 offset:34472
 v_mfma_f32_16x16x32_bf16 v[160:163], a[196:199], a[16:19], 0
 ds_read_b64_tr_b16 a[220:221], v59 offset:50856
 v_mfma_f32_16x16x32_bf16 v[160:163], a[192:195], a[4:7], v[160:163]
 s_waitcnt lgkmcnt(7)
 ds_read_b64_tr_b16 a[222:223], v59 offset:51368
 v_mfma_f32_16x16x32_bf16 v[164:167], a[200:203], a[4:7], 0
 s_mov_b32 s82, 0x114000
 s_add_u32 m0, s74, 0x120c0
 ds_read_b64_tr_b16 a[192:193], v41 offset:33984
 v_mfma_f32_16x16x32_bf16 v[164:167], a[204:207], a[16:19], v[164:167]
 buffer_load_dwordx4 v42, s[56:59], s82 offen nt lds
 ds_read_b64_tr_b16 a[194:195], v41 offset:34496
 v_mfma_f32_16x16x32_bf16 v[100:103], a[204:207], a[12:15], 0
 ds_read_b64_tr_b16 a[196:197], v41 offset:50880
 v_mfma_f32_16x16x32_bf16 v[100:103], a[200:203], a[0:3], v[100:103]
 s_waitcnt lgkmcnt(7)
 s_mov_b32 s83, 0x116000
 s_add_u32 m0, s74, 0x124e8
 ds_read_b64_tr_b16 a[198:199], v41 offset:51392
 v_mfma_f32_16x16x32_bf16 v[104:107], a[208:211], a[0:3], 0
 buffer_load_dwordx4 v42, s[56:59], s83 offen nt lds
 ds_read_b64_tr_b16 a[200:201], v41 offset:33992
 v_mfma_f32_16x16x32_bf16 v[104:107], a[212:215], a[12:15], v[104:107]
 ds_read_b64_tr_b16 a[202:203], v41 offset:34504
 v_mfma_f32_16x16x32_bf16 v[168:171], a[212:215], a[16:19], 0
 ds_read_b64_tr_b16 a[204:205], v41 offset:50888
 v_mfma_f32_16x16x32_bf16 v[168:171], a[208:211], a[4:7], v[168:171]
 s_waitcnt lgkmcnt(7)
 s_mov_b32 s82, 0x180
 s_add_u32 m0, s73, 0x0
 ds_read_b64_tr_b16 a[206:207], v41 offset:51400
 v_mfma_f32_16x16x32_bf16 v[172:175], a[216:219], a[4:7], 0
 buffer_load_dwordx4 v43, s[44:47], s82 offen lds
 ds_read_b64_tr_b16 a[208:209], v59 offset:34016
 v_mfma_f32_16x16x32_bf16 v[172:175], a[220:223], a[16:19], v[172:175]
 ds_read_b64_tr_b16 a[210:211], v59 offset:34528
 v_mfma_f32_16x16x32_bf16 v[108:111], a[220:223], a[12:15], 0
 ds_read_b64_tr_b16 a[212:213], v59 offset:50912
 v_mfma_f32_16x16x32_bf16 v[108:111], a[216:219], a[0:3], v[108:111]
 s_waitcnt lgkmcnt(7)
 s_mov_b32 s83, 0x180
 s_add_u32 m0, s73, 0x400
 ds_read_b64_tr_b16 a[214:215], v59 offset:51424
 v_mfma_f32_16x16x32_bf16 v[112:115], a[192:195], a[0:3], 0
 buffer_load_dwordx4 v44, s[44:47], s83 offen lds
 ds_read_b64_tr_b16 a[216:217], v59 offset:34024
 v_mfma_f32_16x16x32_bf16 v[112:115], a[196:199], a[12:15], v[112:115]
 ds_read_b64_tr_b16 a[218:219], v59 offset:34536
 v_mfma_f32_16x16x32_bf16 v[176:179], a[196:199], a[16:19], 0
 s_mov_b32 s82, 0x3980
 s_add_u32 m0, s73, 0x800
 ds_read_b64_tr_b16 a[220:221], v59 offset:50920
 v_mfma_f32_16x16x32_bf16 v[176:179], a[192:195], a[4:7], v[176:179]
 s_waitcnt lgkmcnt(7)
 buffer_load_dwordx4 v43, s[44:47], s82 offen lds
 ds_read_b64_tr_b16 a[222:223], v59 offset:51432
 v_mfma_f32_16x16x32_bf16 v[180:183], a[200:203], a[4:7], 0
 s_waitcnt vmcnt(15) lgkmcnt(0)
 s_barrier
 s_mov_b64 exec, 0
 s_branch L1_PAD2
L1_PRT2:
 s_mov_b64 exec, -1
 v_mfma_f32_16x16x32_bf16 v[180:183], a[204:207], a[16:19], v[180:183]
 ds_read_b64_tr_b16 a[192:193], v40 offset:33792
 v_mfma_f32_16x16x32_bf16 v[116:119], a[204:207], a[12:15], 0
 s_mov_b32 s83, 0x3980
 s_add_u32 m0, s73, 0xc00
 ds_read_b64_tr_b16 a[194:195], v40 offset:34304
 v_mfma_f32_16x16x32_bf16 v[116:119], a[200:203], a[0:3], v[116:119]
 buffer_load_dwordx4 v44, s[44:47], s83 offen lds
 ds_read_b64_tr_b16 a[196:197], v40 offset:50688
 v_mfma_f32_16x16x32_bf16 v[120:123], a[208:211], a[0:3], 0
 ds_read_b64_tr_b16 a[198:199], v40 offset:51200
 v_mfma_f32_16x16x32_bf16 v[120:123], a[212:215], a[12:15], v[120:123]
 ds_read_b64_tr_b16 a[200:201], v40 offset:33800
 v_mfma_f32_16x16x32_bf16 v[184:187], a[212:215], a[16:19], 0
 ds_read_b64_tr_b16 a[202:203], v40 offset:34312
 v_mfma_f32_16x16x32_bf16 v[184:187], a[208:211], a[4:7], v[184:187]
 ds_read_b64_tr_b16 a[204:205], v40 offset:50696
 v_mfma_f32_16x16x32_bf16 v[188:191], a[216:219], a[4:7], 0
 ds_read_b64_tr_b16 a[206:207], v40 offset:51208
 v_mfma_f32_16x16x32_bf16 v[188:191], a[220:223], a[16:19], v[188:191]
 ds_read_b64_tr_b16 a[208:209], v58 offset:33824
 v_mfma_f32_16x16x32_bf16 v[124:127], a[220:223], a[12:15], 0
 ds_read_b64_tr_b16 a[210:211], v58 offset:34336
 v_mfma_f32_16x16x32_bf16 v[124:127], a[216:219], a[0:3], v[124:127]
 s_waitcnt lgkmcnt(6)
 ds_read_b64_tr_b16 a[212:213], v58 offset:50720
 ds_read_b64_tr_b16 a[214:215], v58 offset:51232
 v_mfma_f32_16x16x32_bf16 v[64:67], a[192:195], a[24:27], v[64:67]
 s_mov_b32 s82, 0x180000
 s_add_u32 m0, s74, 0x18c00
 ds_read_b64_tr_b16 a[216:217], v58 offset:33832
 v_mfma_f32_16x16x32_bf16 v[64:67], a[196:199], a[36:39], v[64:67]
 buffer_load_dwordx4 v42, s[56:59], s82 offen nt lds
 ds_read_b64_tr_b16 a[218:219], v58 offset:34344
 v_mfma_f32_16x16x32_bf16 v[128:131], a[196:199], a[40:43], v[128:131]
 ds_read_b64_tr_b16 a[220:221], v58 offset:50728
 v_mfma_f32_16x16x32_bf16 v[128:131], a[192:195], a[28:31], v[128:131]
 s_waitcnt lgkmcnt(7)
 ds_read_b64_tr_b16 a[222:223], v58 offset:51240
 v_mfma_f32_16x16x32_bf16 v[132:135], a[200:203], a[28:31], v[132:135]
 s_mov_b32 s83, 0x182000
 s_add_u32 m0, s74, 0x19028
 ds_read_b64_tr_b16 a[192:193], v40 offset:33856
 v_mfma_f32_16x16x32_bf16 v[132:135], a[204:207], a[40:43], v[132:135]
 buffer_load_dwordx4 v42, s[56:59], s83 offen nt lds
 ds_read_b64_tr_b16 a[194:195], v40 offset:34368
 v_mfma_f32_16x16x32_bf16 v[68:71], a[204:207], a[36:39], v[68:71]
 ds_read_b64_tr_b16 a[196:197], v40 offset:50752
 v_mfma_f32_16x16x32_bf16 v[68:71], a[200:203], a[24:27], v[68:71]
 s_waitcnt lgkmcnt(7)
 ds_read_b64_tr_b16 a[198:199], v40 offset:51264
 v_mfma_f32_16x16x32_bf16 v[72:75], a[208:211], a[24:27], v[72:75]
 ds_read_b64_tr_b16 a[200:201], v40 offset:33864
 s_waitcnt vmcnt(14)
 ds_read_b128 a[48:51], v48 offset:0
 v_mfma_f32_16x16x32_bf16 v[72:75], a[212:215], a[36:39], v[72:75]
 s_mov_b32 s82, 0x184000
 s_add_u32 m0, s74, 0x19440
 ds_read_b64_tr_b16 a[202:203], v40 offset:34376
 v_mfma_f32_16x16x32_bf16 v[136:139], a[212:215], a[40:43], v[136:139]
 buffer_load_dwordx4 v42, s[56:59], s82 offen nt lds
 ds_read_b64_tr_b16 a[204:205], v40 offset:50760
 v_mfma_f32_16x16x32_bf16 v[136:139], a[208:211], a[28:31], v[136:139]
 s_waitcnt lgkmcnt(8)
 ds_read_b64_tr_b16 a[206:207], v40 offset:51272
 ds_read_b128 a[60:63], v49 offset:0
 v_mfma_f32_16x16x32_bf16 v[140:143], a[216:219], a[28:31], v[140:143]
 ds_read_b64_tr_b16 a[208:209], v58 offset:33888
 v_mfma_f32_16x16x32_bf16 v[140:143], a[220:223], a[40:43], v[140:143]
 ds_read_b64_tr_b16 a[210:211], v58 offset:34400
 v_mfma_f32_16x16x32_bf16 v[76:79], a[220:223], a[36:39], v[76:79]
 s_mov_b32 s83, 0x186000
 s_add_u32 m0, s74, 0x19868
 ds_read_b64_tr_b16 a[212:213], v58 offset:50784
 ds_read_b128 a[52:55], v48 offset:2048
 v_mfma_f32_16x16x32_bf16 v[76:79], a[216:219], a[24:27], v[76:79]
 s_waitcnt lgkmcnt(10)
 buffer_load_dwordx4 v42, s[56:59], s83 offen nt lds
 ds_read_b64_tr_b16 a[214:215], v58 offset:51296
 v_mfma_f32_16x16x32_bf16 v[80:83], a[192:195], a[24:27], v[80:83]
 ds_read_b64_tr_b16 a[216:217], v58 offset:33896
 v_mfma_f32_16x16x32_bf16 v[80:83], a[196:199], a[36:39], v[80:83]
 ds_read_b64_tr_b16 a[218:219], v58 offset:34408
 ds_read_b128 a[64:67], v49 offset:2048
 v_mfma_f32_16x16x32_bf16 v[144:147], a[196:199], a[40:43], v[144:147]
 ds_read_b64_tr_b16 a[220:221], v58 offset:50792
 v_mfma_f32_16x16x32_bf16 v[144:147], a[192:195], a[28:31], v[144:147]
 s_waitcnt lgkmcnt(10)
 s_mov_b32 s82, 0x190000
 s_add_u32 m0, s74, 0x19c80
 ds_read_b64_tr_b16 a[222:223], v58 offset:51304
 v_mfma_f32_16x16x32_bf16 v[148:151], a[200:203], a[28:31], v[148:151]
 buffer_load_dwordx4 v42, s[56:59], s82 offen nt lds
 ds_read_b64_tr_b16 a[192:193], v40 offset:33920
 v_mfma_f32_16x16x32_bf16 v[148:151], a[204:207], a[40:43], v[148:151]
 ds_read_b64_tr_b16 a[194:195], v40 offset:34432
 v_mfma_f32_16x16x32_bf16 v[84:87], a[204:207], a[36:39], v[84:87]
 ds_read_b64_tr_b16 a[196:197], v40 offset:50816
 v_mfma_f32_16x16x32_bf16 v[84:87], a[200:203], a[24:27], v[84:87]
 s_waitcnt lgkmcnt(8)
 ds_read_b64_tr_b16 a[198:199], v40 offset:51328
 v_mfma_f32_16x16x32_bf16 v[88:91], a[208:211], a[24:27], v[88:91]
 s_mov_b32 s83, 0x192000
 s_add_u32 m0, s74, 0x1a0a8
 ds_read_b64_tr_b16 a[200:201], v40 offset:33928
 v_mfma_f32_16x16x32_bf16 v[88:91], a[212:215], a[36:39], v[88:91]
 buffer_load_dwordx4 v42, s[56:59], s83 offen nt lds
 ds_read_b64_tr_b16 a[202:203], v40 offset:34440
 v_mfma_f32_16x16x32_bf16 v[152:155], a[212:215], a[40:43], v[152:155]
 ds_read_b64_tr_b16 a[204:205], v40 offset:50824
 v_mfma_f32_16x16x32_bf16 v[152:155], a[208:211], a[28:31], v[152:155]
 s_waitcnt lgkmcnt(7)
 ds_read_b64_tr_b16 a[206:207], v40 offset:51336
 v_mfma_f32_16x16x32_bf16 v[156:159], a[216:219], a[28:31], v[156:159]
 ds_read_b64_tr_b16 a[208:209], v58 offset:33952
 v_mfma_f32_16x16x32_bf16 v[156:159], a[220:223], a[40:43], v[156:159]
 s_mov_b32 s82, 0x194000
 s_add_u32 m0, s74, 0x1a4c0
 ds_read_b64_tr_b16 a[210:211], v58 offset:34464
 v_mfma_f32_16x16x32_bf16 v[92:95], a[220:223], a[36:39], v[92:95]
 buffer_load_dwordx4 v42, s[56:59], s82 offen nt lds
 ds_read_b64_tr_b16 a[212:213], v58 offset:50848
 v_mfma_f32_16x16x32_bf16 v[92:95], a[216:219], a[24:27], v[92:95]
 s_waitcnt lgkmcnt(7)
 ds_read_b64_tr_b16 a[214:215], v58 offset:51360
 v_mfma_f32_16x16x32_bf16 v[96:99], a[192:195], a[24:27], v[96:99]
 ds_read_b64_tr_b16 a[216:217], v58 offset:33960
 v_mfma_f32_16x16x32_bf16 v[96:99], a[196:199], a[36:39], v[96:99]
 s_mov_b32 s83, 0x196000
 s_add_u32 m0, s74, 0x1a8e8
 ds_read_b64_tr_b16 a[218:219], v58 offset:34472
 v_mfma_f32_16x16x32_bf16 v[160:163], a[196:199], a[40:43], v[160:163]
 buffer_load_dwordx4 v42, s[56:59], s83 offen nt lds
 ds_read_b64_tr_b16 a[220:221], v58 offset:50856
 v_mfma_f32_16x16x32_bf16 v[160:163], a[192:195], a[28:31], v[160:163]
 s_waitcnt lgkmcnt(7)
 ds_read_b64_tr_b16 a[222:223], v58 offset:51368
 v_mfma_f32_16x16x32_bf16 v[164:167], a[200:203], a[28:31], v[164:167]
 ds_read_b64_tr_b16 a[192:193], v40 offset:33984
 v_mfma_f32_16x16x32_bf16 v[164:167], a[204:207], a[40:43], v[164:167]
 ds_read_b64_tr_b16 a[194:195], v40 offset:34496
 v_mfma_f32_16x16x32_bf16 v[100:103], a[204:207], a[36:39], v[100:103]
 s_mov_b32 s82, 0x200
 s_add_u32 m0, s71, 0x0
 ds_read_b64_tr_b16 a[196:197], v40 offset:50880
 v_mfma_f32_16x16x32_bf16 v[100:103], a[200:203], a[24:27], v[100:103]
 s_waitcnt lgkmcnt(7)
 buffer_load_dwordx4 v43, s[44:47], s82 offen lds
 ds_read_b64_tr_b16 a[198:199], v40 offset:51392
 v_mfma_f32_16x16x32_bf16 v[104:107], a[208:211], a[24:27], v[104:107]
 ds_read_b64_tr_b16 a[200:201], v40 offset:33992
 v_mfma_f32_16x16x32_bf16 v[104:107], a[212:215], a[36:39], v[104:107]
 ds_read_b64_tr_b16 a[202:203], v40 offset:34504
 v_mfma_f32_16x16x32_bf16 v[168:171], a[212:215], a[40:43], v[168:171]
 ds_read_b64_tr_b16 a[204:205], v40 offset:50888
 v_mfma_f32_16x16x32_bf16 v[168:171], a[208:211], a[28:31], v[168:171]
 s_waitcnt lgkmcnt(7)
 s_mov_b32 s83, 0x200
 s_add_u32 m0, s71, 0x400
 ds_read_b64_tr_b16 a[206:207], v40 offset:51400
 v_mfma_f32_16x16x32_bf16 v[172:175], a[216:219], a[28:31], v[172:175]
 buffer_load_dwordx4 v44, s[44:47], s83 offen lds
 ds_read_b64_tr_b16 a[208:209], v58 offset:34016
 v_mfma_f32_16x16x32_bf16 v[172:175], a[220:223], a[40:43], v[172:175]
 ds_read_b64_tr_b16 a[210:211], v58 offset:34528
 v_mfma_f32_16x16x32_bf16 v[108:111], a[220:223], a[36:39], v[108:111]
 ds_read_b64_tr_b16 a[212:213], v58 offset:50912
 v_mfma_f32_16x16x32_bf16 v[108:111], a[216:219], a[24:27], v[108:111]
 s_waitcnt lgkmcnt(7)
 ds_read_b64_tr_b16 a[214:215], v58 offset:51424
 v_mfma_f32_16x16x32_bf16 v[112:115], a[192:195], a[24:27], v[112:115]
 s_mov_b32 s82, 0x3a00
 s_add_u32 m0, s71, 0x800
 ds_read_b64_tr_b16 a[216:217], v58 offset:34024
 v_mfma_f32_16x16x32_bf16 v[112:115], a[196:199], a[36:39], v[112:115]
 buffer_load_dwordx4 v43, s[44:47], s82 offen lds
 ds_read_b64_tr_b16 a[218:219], v58 offset:34536
 v_mfma_f32_16x16x32_bf16 v[176:179], a[196:199], a[40:43], v[176:179]
 ds_read_b64_tr_b16 a[220:221], v58 offset:50920
 v_mfma_f32_16x16x32_bf16 v[176:179], a[192:195], a[28:31], v[176:179]
 s_waitcnt lgkmcnt(7)
 ds_read_b64_tr_b16 a[222:223], v58 offset:51432
 v_mfma_f32_16x16x32_bf16 v[180:183], a[200:203], a[28:31], v[180:183]
 s_waitcnt vmcnt(15) lgkmcnt(0)
 s_barrier
 s_lshl_b32 s10, s6, 3
 s_add_u32 s10, s10, s7
 s_lshl_b32 s10, s10, 7
 s_add_u32 s10, s10, 0x6780000
 v_lshl_add_u32 v196, v7, 2, s10
 s_mov_b64 exec, 0xffff
 global_load_dword v208, v196, s[40:41] sc0 sc1
 s_mov_b64 exec, -1
 s_mov_b64 exec, 0
 s_branch L1_PAD3
L1_PRT3:
 s_mov_b64 exec, -1
 v_mfma_f32_16x16x32_bf16 v[180:183], a[204:207], a[40:43], v[180:183]
 s_mov_b32 s83, 0x3a00
 s_add_u32 m0, s71, 0xc00
 ds_read_b64_tr_b16 a[192:193], v41 offset:0
 v_mfma_f32_16x16x32_bf16 v[116:119], a[204:207], a[36:39], v[116:119]
 buffer_load_dwordx4 v44, s[44:47], s83 offen lds
 ds_read_b64_tr_b16 a[194:195], v41 offset:512
 v_mfma_f32_16x16x32_bf16 v[116:119], a[200:203], a[24:27], v[116:119]
 ds_read_b64_tr_b16 a[196:197], v41 offset:16896
 v_mfma_f32_16x16x32_bf16 v[120:123], a[208:211], a[24:27], v[120:123]
 ds_read_b64_tr_b16 a[198:199], v41 offset:17408
 v_mfma_f32_16x16x32_bf16 v[120:123], a[212:215], a[36:39], v[120:123]
 ds_read_b64_tr_b16 a[200:201], v41 offset:8
 v_mfma_f32_16x16x32_bf16 v[184:187], a[212:215], a[40:43], v[184:187]
 ds_read_b64_tr_b16 a[202:203], v41 offset:520
 v_mfma_f32_16x16x32_bf16 v[184:187], a[208:211], a[28:31], v[184:187]
 ds_read_b64_tr_b16 a[204:205], v41 offset:16904
 v_mfma_f32_16x16x32_bf16 v[188:191], a[216:219], a[28:31], v[188:191]
 ds_read_b64_tr_b16 a[206:207], v41 offset:17416
 v_mfma_f32_16x16x32_bf16 v[188:191], a[220:223], a[40:43], v[188:191]
 ds_read_b64_tr_b16 a[208:209], v59 offset:32
 v_mfma_f32_16x16x32_bf16 v[124:127], a[220:223], a[36:39], v[124:127]
 ds_read_b64_tr_b16 a[210:211], v59 offset:544
 v_mfma_f32_16x16x32_bf16 v[124:127], a[216:219], a[24:27], v[124:127]
 s_waitcnt lgkmcnt(6)
 ds_read_b64_tr_b16 a[212:213], v59 offset:16928
 ds_read_b64_tr_b16 a[214:215], v59 offset:17440
 v_mfma_f32_16x16x32_bf16 v[64:67], a[192:195], a[48:51], v[64:67]
 s_mov_b32 s82, 0x200000
 s_add_u32 m0, s74, 0x8400
 ds_read_b64_tr_b16 a[216:217], v59 offset:40
 v_mfma_f32_16x16x32_bf16 v[64:67], a[196:199], a[60:63], v[64:67]
 buffer_load_dwordx4 v42, s[56:59], s82 offen nt lds
 ds_read_b64_tr_b16 a[218:219], v59 offset:552
 v_mfma_f32_16x16x32_bf16 v[128:131], a[196:199], a[64:67], v[128:131]
 ds_read_b64_tr_b16 a[220:221], v59 offset:16936
 v_mfma_f32_16x16x32_bf16 v[128:131], a[192:195], a[52:55], v[128:131]
 s_waitcnt lgkmcnt(7)
 ds_read_b64_tr_b16 a[222:223], v59 offset:17448
 v_mfma_f32_16x16x32_bf16 v[132:135], a[200:203], a[52:55], v[132:135]
 s_mov_b32 s83, 0x202000
 s_add_u32 m0, s74, 0x8828
 ds_read_b64_tr_b16 a[192:193], v41 offset:64
 v_mfma_f32_16x16x32_bf16 v[132:135], a[204:207], a[64:67], v[132:135]
 buffer_load_dwordx4 v42, s[56:59], s83 offen nt lds
 ds_read_b64_tr_b16 a[194:195], v41 offset:576
 v_mfma_f32_16x16x32_bf16 v[68:71], a[204:207], a[60:63], v[68:71]
 ds_read_b64_tr_b16 a[196:197], v41 offset:16960
 v_mfma_f32_16x16x32_bf16 v[68:71], a[200:203], a[48:51], v[68:71]
 s_waitcnt lgkmcnt(7)
 ds_read_b64_tr_b16 a[198:199], v41 offset:17472
 v_mfma_f32_16x16x32_bf16 v[72:75], a[208:211], a[48:51], v[72:75]
 ds_read_b64_tr_b16 a[200:201], v41 offset:72
 s_waitcnt vmcnt(15)
 ds_read_b128 a[72:75], v46 offset:0
 v_mfma_f32_16x16x32_bf16 v[72:75], a[212:215], a[60:63], v[72:75]
 s_mov_b32 s82, 0x204000
 s_add_u32 m0, s74, 0x8c40
 ds_read_b64_tr_b16 a[202:203], v41 offset:584
 v_mfma_f32_16x16x32_bf16 v[136:139], a[212:215], a[64:67], v[136:139]
 buffer_load_dwordx4 v42, s[56:59], s82 offen nt lds
 ds_read_b64_tr_b16 a[204:205], v41 offset:16968
 v_mfma_f32_16x16x32_bf16 v[136:139], a[208:211], a[52:55], v[136:139]
 s_waitcnt lgkmcnt(8)
 ds_read_b64_tr_b16 a[206:207], v41 offset:17480
 ds_read_b128 a[84:87], v47 offset:0
 v_mfma_f32_16x16x32_bf16 v[140:143], a[216:219], a[52:55], v[140:143]
 ds_read_b64_tr_b16 a[208:209], v59 offset:96
 v_mfma_f32_16x16x32_bf16 v[140:143], a[220:223], a[64:67], v[140:143]
 ds_read_b64_tr_b16 a[210:211], v59 offset:608
 v_mfma_f32_16x16x32_bf16 v[76:79], a[220:223], a[60:63], v[76:79]
 s_mov_b32 s83, 0x206000
 s_add_u32 m0, s74, 0x9068
 ds_read_b64_tr_b16 a[212:213], v59 offset:16992
 ds_read_b128 a[76:79], v46 offset:2048
 v_mfma_f32_16x16x32_bf16 v[76:79], a[216:219], a[48:51], v[76:79]
 s_waitcnt lgkmcnt(10)
 buffer_load_dwordx4 v42, s[56:59], s83 offen nt lds
 ds_read_b64_tr_b16 a[214:215], v59 offset:17504
 v_mfma_f32_16x16x32_bf16 v[80:83], a[192:195], a[48:51], v[80:83]
 ds_read_b64_tr_b16 a[216:217], v59 offset:104
 v_mfma_f32_16x16x32_bf16 v[80:83], a[196:199], a[60:63], v[80:83]
 ds_read_b64_tr_b16 a[218:219], v59 offset:616
 ds_read_b128 a[88:91], v47 offset:2048
 v_mfma_f32_16x16x32_bf16 v[144:147], a[196:199], a[64:67], v[144:147]
 ds_read_b64_tr_b16 a[220:221], v59 offset:17000
 v_mfma_f32_16x16x32_bf16 v[144:147], a[192:195], a[52:55], v[144:147]
 s_waitcnt lgkmcnt(10)
 s_mov_b32 s82, 0x210000
 s_add_u32 m0, s74, 0x9480
 ds_read_b64_tr_b16 a[222:223], v59 offset:17512
 v_mfma_f32_16x16x32_bf16 v[148:151], a[200:203], a[52:55], v[148:151]
 buffer_load_dwordx4 v42, s[56:59], s82 offen nt lds
 ds_read_b64_tr_b16 a[192:193], v41 offset:128
 v_mfma_f32_16x16x32_bf16 v[148:151], a[204:207], a[64:67], v[148:151]
 ds_read_b64_tr_b16 a[194:195], v41 offset:640
 v_mfma_f32_16x16x32_bf16 v[84:87], a[204:207], a[60:63], v[84:87]
 ds_read_b64_tr_b16 a[196:197], v41 offset:17024
 v_mfma_f32_16x16x32_bf16 v[84:87], a[200:203], a[48:51], v[84:87]
 s_waitcnt lgkmcnt(8)
 ds_read_b64_tr_b16 a[198:199], v41 offset:17536
 v_mfma_f32_16x16x32_bf16 v[88:91], a[208:211], a[48:51], v[88:91]
 s_mov_b32 s83, 0x212000
 s_add_u32 m0, s74, 0x98a8
 ds_read_b64_tr_b16 a[200:201], v41 offset:136
 v_mfma_f32_16x16x32_bf16 v[88:91], a[212:215], a[60:63], v[88:91]
 buffer_load_dwordx4 v42, s[56:59], s83 offen nt lds
 ds_read_b64_tr_b16 a[202:203], v41 offset:648
 v_mfma_f32_16x16x32_bf16 v[152:155], a[212:215], a[64:67], v[152:155]
 ds_read_b64_tr_b16 a[204:205], v41 offset:17032
 v_mfma_f32_16x16x32_bf16 v[152:155], a[208:211], a[52:55], v[152:155]
 s_waitcnt lgkmcnt(7)
 ds_read_b64_tr_b16 a[206:207], v41 offset:17544
 v_mfma_f32_16x16x32_bf16 v[156:159], a[216:219], a[52:55], v[156:159]
 ds_read_b64_tr_b16 a[208:209], v59 offset:160
 v_mfma_f32_16x16x32_bf16 v[156:159], a[220:223], a[64:67], v[156:159]
 s_mov_b32 s82, 0x214000
 s_add_u32 m0, s74, 0x9cc0
 ds_read_b64_tr_b16 a[210:211], v59 offset:672
 v_mfma_f32_16x16x32_bf16 v[92:95], a[220:223], a[60:63], v[92:95]
 buffer_load_dwordx4 v42, s[56:59], s82 offen nt lds
 ds_read_b64_tr_b16 a[212:213], v59 offset:17056
 v_mfma_f32_16x16x32_bf16 v[92:95], a[216:219], a[48:51], v[92:95]
 s_waitcnt lgkmcnt(7)
 ds_read_b64_tr_b16 a[214:215], v59 offset:17568
 v_mfma_f32_16x16x32_bf16 v[96:99], a[192:195], a[48:51], v[96:99]
 ds_read_b64_tr_b16 a[216:217], v59 offset:168
 v_mfma_f32_16x16x32_bf16 v[96:99], a[196:199], a[60:63], v[96:99]
 s_mov_b32 s83, 0x216000
 s_add_u32 m0, s74, 0xa0e8
 ds_read_b64_tr_b16 a[218:219], v59 offset:680
 v_mfma_f32_16x16x32_bf16 v[160:163], a[196:199], a[64:67], v[160:163]
 buffer_load_dwordx4 v42, s[56:59], s83 offen nt lds
 ds_read_b64_tr_b16 a[220:221], v59 offset:17064
 v_mfma_f32_16x16x32_bf16 v[160:163], a[192:195], a[52:55], v[160:163]
 s_waitcnt lgkmcnt(7)
 ds_read_b64_tr_b16 a[222:223], v59 offset:17576
 v_mfma_f32_16x16x32_bf16 v[164:167], a[200:203], a[52:55], v[164:167]
 ds_read_b64_tr_b16 a[192:193], v41 offset:192
 v_mfma_f32_16x16x32_bf16 v[164:167], a[204:207], a[64:67], v[164:167]
 ds_read_b64_tr_b16 a[194:195], v41 offset:704
 v_mfma_f32_16x16x32_bf16 v[100:103], a[204:207], a[60:63], v[100:103]
 s_mov_b32 s82, 0x280
 s_add_u32 m0, s73, 0x0
 ds_read_b64_tr_b16 a[196:197], v41 offset:17088
 v_mfma_f32_16x16x32_bf16 v[100:103], a[200:203], a[48:51], v[100:103]
 s_waitcnt lgkmcnt(7)
 buffer_load_dwordx4 v43, s[44:47], s82 offen lds
 ds_read_b64_tr_b16 a[198:199], v41 offset:17600
 v_mfma_f32_16x16x32_bf16 v[104:107], a[208:211], a[48:51], v[104:107]
 ds_read_b64_tr_b16 a[200:201], v41 offset:200
 v_mfma_f32_16x16x32_bf16 v[104:107], a[212:215], a[60:63], v[104:107]
 ds_read_b64_tr_b16 a[202:203], v41 offset:712
 v_mfma_f32_16x16x32_bf16 v[168:171], a[212:215], a[64:67], v[168:171]
 ds_read_b64_tr_b16 a[204:205], v41 offset:17096
 v_mfma_f32_16x16x32_bf16 v[168:171], a[208:211], a[52:55], v[168:171]
 s_waitcnt lgkmcnt(7)
 s_mov_b32 s83, 0x280
 s_add_u32 m0, s73, 0x400
 ds_read_b64_tr_b16 a[206:207], v41 offset:17608
 v_mfma_f32_16x16x32_bf16 v[172:175], a[216:219], a[52:55], v[172:175]
 buffer_load_dwordx4 v44, s[44:47], s83 offen lds
 ds_read_b64_tr_b16 a[208:209], v59 offset:224
 v_mfma_f32_16x16x32_bf16 v[172:175], a[220:223], a[64:67], v[172:175]
 ds_read_b64_tr_b16 a[210:211], v59 offset:736
 v_mfma_f32_16x16x32_bf16 v[108:111], a[220:223], a[60:63], v[108:111]
 ds_read_b64_tr_b16 a[212:213], v59 offset:17120
 v_mfma_f32_16x16x32_bf16 v[108:111], a[216:219], a[48:51], v[108:111]
 s_waitcnt lgkmcnt(7)
 ds_read_b64_tr_b16 a[214:215], v59 offset:17632
 v_mfma_f32_16x16x32_bf16 v[112:115], a[192:195], a[48:51], v[112:115]
 s_mov_b32 s82, 0x3a80
 s_add_u32 m0, s73, 0x800
 ds_read_b64_tr_b16 a[216:217], v59 offset:232
 v_mfma_f32_16x16x32_bf16 v[112:115], a[196:199], a[60:63], v[112:115]
 buffer_load_dwordx4 v43, s[44:47], s82 offen lds
 ds_read_b64_tr_b16 a[218:219], v59 offset:744
 v_mfma_f32_16x16x32_bf16 v[176:179], a[196:199], a[64:67], v[176:179]
 ds_read_b64_tr_b16 a[220:221], v59 offset:17128
 v_mfma_f32_16x16x32_bf16 v[176:179], a[192:195], a[52:55], v[176:179]
 s_waitcnt lgkmcnt(7)
 ds_read_b64_tr_b16 a[222:223], v59 offset:17640
 v_mfma_f32_16x16x32_bf16 v[180:183], a[200:203], a[52:55], v[180:183]
 s_waitcnt vmcnt(16) lgkmcnt(0)
 s_barrier
 s_mov_b64 exec, 0
 s_branch L1_PAD4
L1_PRT4:
 s_mov_b64 exec, -1
 v_mfma_f32_16x16x32_bf16 v[180:183], a[204:207], a[64:67], v[180:183]
 s_mov_b32 s83, 0x3a80
 s_add_u32 m0, s73, 0xc00
 ds_read_b64_tr_b16 a[192:193], v41 offset:33792
 v_mfma_f32_16x16x32_bf16 v[116:119], a[204:207], a[60:63], v[116:119]
 buffer_load_dwordx4 v44, s[44:47], s83 offen lds
 ds_read_b64_tr_b16 a[194:195], v41 offset:34304
 v_mfma_f32_16x16x32_bf16 v[116:119], a[200:203], a[48:51], v[116:119]
 ds_read_b64_tr_b16 a[196:197], v41 offset:50688
 v_mfma_f32_16x16x32_bf16 v[120:123], a[208:211], a[48:51], v[120:123]
 ds_read_b64_tr_b16 a[198:199], v41 offset:51200
 v_mfma_f32_16x16x32_bf16 v[120:123], a[212:215], a[60:63], v[120:123]
 ds_read_b64_tr_b16 a[200:201], v41 offset:33800
 v_mfma_f32_16x16x32_bf16 v[184:187], a[212:215], a[64:67], v[184:187]
 ds_read_b64_tr_b16 a[202:203], v41 offset:34312
 v_mfma_f32_16x16x32_bf16 v[184:187], a[208:211], a[52:55], v[184:187]
 ds_read_b64_tr_b16 a[204:205], v41 offset:50696
 v_mfma_f32_16x16x32_bf16 v[188:191], a[216:219], a[52:55], v[188:191]
 ds_read_b64_tr_b16 a[206:207], v41 offset:51208
 v_mfma_f32_16x16x32_bf16 v[188:191], a[220:223], a[64:67], v[188:191]
 ds_read_b64_tr_b16 a[208:209], v59 offset:33824
 v_mfma_f32_16x16x32_bf16 v[124:127], a[220:223], a[60:63], v[124:127]
 ds_read_b64_tr_b16 a[210:211], v59 offset:34336
 v_mfma_f32_16x16x32_bf16 v[124:127], a[216:219], a[48:51], v[124:127]
 s_waitcnt lgkmcnt(6)
 ds_read_b64_tr_b16 a[212:213], v59 offset:50720
 ds_read_b64_tr_b16 a[214:215], v59 offset:51232
 v_mfma_f32_16x16x32_bf16 v[64:67], a[192:195], a[72:75], v[64:67]
 s_mov_b32 s82, 0x280000
 s_add_u32 m0, s74, 0x10800
 ds_read_b64_tr_b16 a[216:217], v59 offset:33832
 v_mfma_f32_16x16x32_bf16 v[64:67], a[196:199], a[84:87], v[64:67]
 buffer_load_dwordx4 v42, s[56:59], s82 offen nt lds
 ds_read_b64_tr_b16 a[218:219], v59 offset:34344
 v_mfma_f32_16x16x32_bf16 v[128:131], a[196:199], a[88:91], v[128:131]
 ds_read_b64_tr_b16 a[220:221], v59 offset:50728
 v_mfma_f32_16x16x32_bf16 v[128:131], a[192:195], a[76:79], v[128:131]
 s_waitcnt lgkmcnt(7)
 ds_read_b64_tr_b16 a[222:223], v59 offset:51240
 v_mfma_f32_16x16x32_bf16 v[132:135], a[200:203], a[76:79], v[132:135]
 s_mov_b32 s83, 0x282000
 s_add_u32 m0, s74, 0x10c28
 ds_read_b64_tr_b16 a[192:193], v41 offset:33856
 v_mfma_f32_16x16x32_bf16 v[132:135], a[204:207], a[88:91], v[132:135]
 buffer_load_dwordx4 v42, s[56:59], s83 offen nt lds
 ds_read_b64_tr_b16 a[194:195], v41 offset:34368
 v_mfma_f32_16x16x32_bf16 v[68:71], a[204:207], a[84:87], v[68:71]
 ds_read_b64_tr_b16 a[196:197], v41 offset:50752
 v_mfma_f32_16x16x32_bf16 v[68:71], a[200:203], a[72:75], v[68:71]
 s_waitcnt lgkmcnt(7)
 ds_read_b64_tr_b16 a[198:199], v41 offset:51264
 v_mfma_f32_16x16x32_bf16 v[72:75], a[208:211], a[72:75], v[72:75]
 ds_read_b64_tr_b16 a[200:201], v41 offset:33864
 s_waitcnt vmcnt(14)
 ds_read_b128 a[96:99], v48 offset:0
 v_mfma_f32_16x16x32_bf16 v[72:75], a[212:215], a[84:87], v[72:75]
 s_mov_b32 s82, 0x284000
 s_add_u32 m0, s74, 0x11040
 ds_read_b64_tr_b16 a[202:203], v41 offset:34376
 v_mfma_f32_16x16x32_bf16 v[136:139], a[212:215], a[88:91], v[136:139]
 buffer_load_dwordx4 v42, s[56:59], s82 offen nt lds
 ds_read_b64_tr_b16 a[204:205], v41 offset:50760
 v_mfma_f32_16x16x32_bf16 v[136:139], a[208:211], a[76:79], v[136:139]
 s_waitcnt lgkmcnt(8)
 ds_read_b64_tr_b16 a[206:207], v41 offset:51272
 ds_read_b128 a[108:111], v49 offset:0
 v_mfma_f32_16x16x32_bf16 v[140:143], a[216:219], a[76:79], v[140:143]
 ds_read_b64_tr_b16 a[208:209], v59 offset:33888
 v_mfma_f32_16x16x32_bf16 v[140:143], a[220:223], a[88:91], v[140:143]
 ds_read_b64_tr_b16 a[210:211], v59 offset:34400
 v_mfma_f32_16x16x32_bf16 v[76:79], a[220:223], a[84:87], v[76:79]
 s_mov_b32 s83, 0x286000
 s_add_u32 m0, s74, 0x11468
 ds_read_b64_tr_b16 a[212:213], v59 offset:50784
 ds_read_b128 a[100:103], v48 offset:2048
 v_mfma_f32_16x16x32_bf16 v[76:79], a[216:219], a[72:75], v[76:79]
 s_waitcnt lgkmcnt(10)
 buffer_load_dwordx4 v42, s[56:59], s83 offen nt lds
 ds_read_b64_tr_b16 a[214:215], v59 offset:51296
 v_mfma_f32_16x16x32_bf16 v[80:83], a[192:195], a[72:75], v[80:83]
 ds_read_b64_tr_b16 a[216:217], v59 offset:33896
 v_mfma_f32_16x16x32_bf16 v[80:83], a[196:199], a[84:87], v[80:83]
 ds_read_b64_tr_b16 a[218:219], v59 offset:34408
 ds_read_b128 a[112:115], v49 offset:2048
 v_mfma_f32_16x16x32_bf16 v[144:147], a[196:199], a[88:91], v[144:147]
 ds_read_b64_tr_b16 a[220:221], v59 offset:50792
 v_mfma_f32_16x16x32_bf16 v[144:147], a[192:195], a[76:79], v[144:147]
 s_waitcnt lgkmcnt(10)
 s_mov_b32 s82, 0x290000
 s_add_u32 m0, s74, 0x11880
 ds_read_b64_tr_b16 a[222:223], v59 offset:51304
 v_mfma_f32_16x16x32_bf16 v[148:151], a[200:203], a[76:79], v[148:151]
 buffer_load_dwordx4 v42, s[56:59], s82 offen nt lds
 ds_read_b64_tr_b16 a[192:193], v41 offset:33920
 v_mfma_f32_16x16x32_bf16 v[148:151], a[204:207], a[88:91], v[148:151]
 ds_read_b64_tr_b16 a[194:195], v41 offset:34432
 v_mfma_f32_16x16x32_bf16 v[84:87], a[204:207], a[84:87], v[84:87]
 ds_read_b64_tr_b16 a[196:197], v41 offset:50816
 v_mfma_f32_16x16x32_bf16 v[84:87], a[200:203], a[72:75], v[84:87]
 s_waitcnt lgkmcnt(8)
 ds_read_b64_tr_b16 a[198:199], v41 offset:51328
 v_mfma_f32_16x16x32_bf16 v[88:91], a[208:211], a[72:75], v[88:91]
 s_mov_b32 s83, 0x292000
 s_add_u32 m0, s74, 0x11ca8
 ds_read_b64_tr_b16 a[200:201], v41 offset:33928
 v_mfma_f32_16x16x32_bf16 v[88:91], a[212:215], a[84:87], v[88:91]
 buffer_load_dwordx4 v42, s[56:59], s83 offen nt lds
 ds_read_b64_tr_b16 a[202:203], v41 offset:34440
 v_mfma_f32_16x16x32_bf16 v[152:155], a[212:215], a[88:91], v[152:155]
 ds_read_b64_tr_b16 a[204:205], v41 offset:50824
 v_mfma_f32_16x16x32_bf16 v[152:155], a[208:211], a[76:79], v[152:155]
 s_waitcnt lgkmcnt(7)
 ds_read_b64_tr_b16 a[206:207], v41 offset:51336
 v_mfma_f32_16x16x32_bf16 v[156:159], a[216:219], a[76:79], v[156:159]
 ds_read_b64_tr_b16 a[208:209], v59 offset:33952
 v_mfma_f32_16x16x32_bf16 v[156:159], a[220:223], a[88:91], v[156:159]
 s_mov_b32 s82, 0x294000
 s_add_u32 m0, s74, 0x120c0
 ds_read_b64_tr_b16 a[210:211], v59 offset:34464
 v_mfma_f32_16x16x32_bf16 v[92:95], a[220:223], a[84:87], v[92:95]
 buffer_load_dwordx4 v42, s[56:59], s82 offen nt lds
 ds_read_b64_tr_b16 a[212:213], v59 offset:50848
 v_mfma_f32_16x16x32_bf16 v[92:95], a[216:219], a[72:75], v[92:95]
 s_waitcnt lgkmcnt(7)
 ds_read_b64_tr_b16 a[214:215], v59 offset:51360
 v_mfma_f32_16x16x32_bf16 v[96:99], a[192:195], a[72:75], v[96:99]
 ds_read_b64_tr_b16 a[216:217], v59 offset:33960
 v_mfma_f32_16x16x32_bf16 v[96:99], a[196:199], a[84:87], v[96:99]
 s_mov_b32 s83, 0x296000
 s_add_u32 m0, s74, 0x124e8
 ds_read_b64_tr_b16 a[218:219], v59 offset:34472
 v_mfma_f32_16x16x32_bf16 v[160:163], a[196:199], a[88:91], v[160:163]
 buffer_load_dwordx4 v42, s[56:59], s83 offen nt lds
 ds_read_b64_tr_b16 a[220:221], v59 offset:50856
 v_mfma_f32_16x16x32_bf16 v[160:163], a[192:195], a[76:79], v[160:163]
 s_waitcnt lgkmcnt(7)
 ds_read_b64_tr_b16 a[222:223], v59 offset:51368
 v_mfma_f32_16x16x32_bf16 v[164:167], a[200:203], a[76:79], v[164:167]
 ds_read_b64_tr_b16 a[192:193], v41 offset:33984
 v_mfma_f32_16x16x32_bf16 v[164:167], a[204:207], a[88:91], v[164:167]
 ds_read_b64_tr_b16 a[194:195], v41 offset:34496
 v_mfma_f32_16x16x32_bf16 v[100:103], a[204:207], a[84:87], v[100:103]
 s_mov_b32 s82, 0x300
 s_add_u32 m0, s71, 0x0
 ds_read_b64_tr_b16 a[196:197], v41 offset:50880
 v_mfma_f32_16x16x32_bf16 v[100:103], a[200:203], a[72:75], v[100:103]
 s_waitcnt lgkmcnt(7)
 buffer_load_dwordx4 v43, s[44:47], s82 offen lds
 ds_read_b64_tr_b16 a[198:199], v41 offset:51392
 v_mfma_f32_16x16x32_bf16 v[104:107], a[208:211], a[72:75], v[104:107]
 ds_read_b64_tr_b16 a[200:201], v41 offset:33992
 v_mfma_f32_16x16x32_bf16 v[104:107], a[212:215], a[84:87], v[104:107]
 ds_read_b64_tr_b16 a[202:203], v41 offset:34504
 v_mfma_f32_16x16x32_bf16 v[168:171], a[212:215], a[88:91], v[168:171]
 ds_read_b64_tr_b16 a[204:205], v41 offset:50888
 v_mfma_f32_16x16x32_bf16 v[168:171], a[208:211], a[76:79], v[168:171]
 s_waitcnt lgkmcnt(7)
 s_mov_b32 s83, 0x300
 s_add_u32 m0, s71, 0x400
 ds_read_b64_tr_b16 a[206:207], v41 offset:51400
 v_mfma_f32_16x16x32_bf16 v[172:175], a[216:219], a[76:79], v[172:175]
 buffer_load_dwordx4 v44, s[44:47], s83 offen lds
 ds_read_b64_tr_b16 a[208:209], v59 offset:34016
 v_mfma_f32_16x16x32_bf16 v[172:175], a[220:223], a[88:91], v[172:175]
 ds_read_b64_tr_b16 a[210:211], v59 offset:34528
 v_mfma_f32_16x16x32_bf16 v[108:111], a[220:223], a[84:87], v[108:111]
 ds_read_b64_tr_b16 a[212:213], v59 offset:50912
 v_mfma_f32_16x16x32_bf16 v[108:111], a[216:219], a[72:75], v[108:111]
 s_waitcnt lgkmcnt(7)
 ds_read_b64_tr_b16 a[214:215], v59 offset:51424
 v_mfma_f32_16x16x32_bf16 v[112:115], a[192:195], a[72:75], v[112:115]
 s_mov_b32 s82, 0x3b00
 s_add_u32 m0, s71, 0x800
 ds_read_b64_tr_b16 a[216:217], v59 offset:34024
 v_mfma_f32_16x16x32_bf16 v[112:115], a[196:199], a[84:87], v[112:115]
 buffer_load_dwordx4 v43, s[44:47], s82 offen lds
 ds_read_b64_tr_b16 a[218:219], v59 offset:34536
 v_mfma_f32_16x16x32_bf16 v[176:179], a[196:199], a[88:91], v[176:179]
 ds_read_b64_tr_b16 a[220:221], v59 offset:50920
 v_mfma_f32_16x16x32_bf16 v[176:179], a[192:195], a[76:79], v[176:179]
 s_waitcnt lgkmcnt(7)
 ds_read_b64_tr_b16 a[222:223], v59 offset:51432
 v_mfma_f32_16x16x32_bf16 v[180:183], a[200:203], a[76:79], v[180:183]
 s_waitcnt vmcnt(15) lgkmcnt(0)
 s_barrier
 s_mov_b64 exec, 0
 s_branch L1_PAD5
L1_PRT5:
 s_mov_b64 exec, -1
 v_mfma_f32_16x16x32_bf16 v[180:183], a[204:207], a[88:91], v[180:183]
 s_mov_b32 s83, 0x3b00
 s_add_u32 m0, s71, 0xc00
 ds_read_b64_tr_b16 a[192:193], v40 offset:33792
 v_mfma_f32_16x16x32_bf16 v[116:119], a[204:207], a[84:87], v[116:119]
 buffer_load_dwordx4 v44, s[44:47], s83 offen lds
 ds_read_b64_tr_b16 a[194:195], v40 offset:34304
 v_mfma_f32_16x16x32_bf16 v[116:119], a[200:203], a[72:75], v[116:119]
 ds_read_b64_tr_b16 a[196:197], v40 offset:50688
 v_mfma_f32_16x16x32_bf16 v[120:123], a[208:211], a[72:75], v[120:123]
 ds_read_b64_tr_b16 a[198:199], v40 offset:51200
 v_mfma_f32_16x16x32_bf16 v[120:123], a[212:215], a[84:87], v[120:123]
 ds_read_b64_tr_b16 a[200:201], v40 offset:33800
 v_mfma_f32_16x16x32_bf16 v[184:187], a[212:215], a[88:91], v[184:187]
 ds_read_b64_tr_b16 a[202:203], v40 offset:34312
 v_mfma_f32_16x16x32_bf16 v[184:187], a[208:211], a[76:79], v[184:187]
 ds_read_b64_tr_b16 a[204:205], v40 offset:50696
 v_mfma_f32_16x16x32_bf16 v[188:191], a[216:219], a[76:79], v[188:191]
 ds_read_b64_tr_b16 a[206:207], v40 offset:51208
 v_mfma_f32_16x16x32_bf16 v[188:191], a[220:223], a[88:91], v[188:191]
 ds_read_b64_tr_b16 a[208:209], v58 offset:33824
 v_mfma_f32_16x16x32_bf16 v[124:127], a[220:223], a[84:87], v[124:127]
 ds_read_b64_tr_b16 a[210:211], v58 offset:34336
 v_mfma_f32_16x16x32_bf16 v[124:127], a[216:219], a[72:75], v[124:127]
 s_waitcnt lgkmcnt(6)
 ds_read_b64_tr_b16 a[212:213], v58 offset:50720
 ds_read_b64_tr_b16 a[214:215], v58 offset:51232
 v_mfma_f32_16x16x32_bf16 v[64:67], a[192:195], a[96:99], v[64:67]
 s_mov_b32 s82, 0x300000
 s_add_u32 m0, s74, 0x18c00
 ds_read_b64_tr_b16 a[216:217], v58 offset:33832
 v_mfma_f32_16x16x32_bf16 v[64:67], a[196:199], a[108:111], v[64:67]
 buffer_load_dwordx4 v42, s[56:59], s82 offen nt lds
 ds_read_b64_tr_b16 a[218:219], v58 offset:34344
 v_mfma_f32_16x16x32_bf16 v[128:131], a[196:199], a[112:115], v[128:131]
 ds_read_b64_tr_b16 a[220:221], v58 offset:50728
 v_mfma_f32_16x16x32_bf16 v[128:131], a[192:195], a[100:103], v[128:131]
 s_waitcnt lgkmcnt(7)
 s_mov_b32 s83, 0x302000
 s_add_u32 m0, s74, 0x19028
 ds_read_b64_tr_b16 a[222:223], v58 offset:51240
 v_mfma_f32_16x16x32_bf16 v[132:135], a[200:203], a[100:103], v[132:135]
 buffer_load_dwordx4 v42, s[56:59], s83 offen nt lds
 ds_read_b64_tr_b16 a[192:193], v40 offset:33856
 v_mfma_f32_16x16x32_bf16 v[132:135], a[204:207], a[112:115], v[132:135]
 ds_read_b64_tr_b16 a[194:195], v40 offset:34368
 v_mfma_f32_16x16x32_bf16 v[68:71], a[204:207], a[108:111], v[68:71]
 ds_read_b64_tr_b16 a[196:197], v40 offset:50752
 v_mfma_f32_16x16x32_bf16 v[68:71], a[200:203], a[96:99], v[68:71]
 s_waitcnt lgkmcnt(7)
 s_mov_b32 s82, 0x304000
 s_add_u32 m0, s74, 0x19440
 ds_read_b64_tr_b16 a[198:199], v40 offset:51264
 v_mfma_f32_16x16x32_bf16 v[72:75], a[208:211], a[96:99], v[72:75]
 buffer_load_dwordx4 v42, s[56:59], s82 offen nt lds
 ds_read_b64_tr_b16 a[200:201], v40 offset:33864
 s_waitcnt vmcnt(15)
 ds_read_b128 a[120:123], v46 offset:0
 v_mfma_f32_16x16x32_bf16 v[72:75], a[212:215], a[108:111], v[72:75]
 ds_read_b64_tr_b16 a[202:203], v40 offset:34376
 v_mfma_f32_16x16x32_bf16 v[136:139], a[212:215], a[112:115], v[136:139]
 s_mov_b32 s83, 0x306000
 s_add_u32 m0, s74, 0x19868
 ds_read_b64_tr_b16 a[204:205], v40 offset:50760
 v_mfma_f32_16x16x32_bf16 v[136:139], a[208:211], a[100:103], v[136:139]
 s_waitcnt lgkmcnt(8)
 buffer_load_dwordx4 v42, s[56:59], s83 offen nt lds
 ds_read_b64_tr_b16 a[206:207], v40 offset:51272
 ds_read_b128 a[132:135], v47 offset:0
 v_mfma_f32_16x16x32_bf16 v[140:143], a[216:219], a[100:103], v[140:143]
 ds_read_b64_tr_b16 a[208:209], v58 offset:33888
 v_mfma_f32_16x16x32_bf16 v[140:143], a[220:223], a[112:115], v[140:143]
 ds_read_b64_tr_b16 a[210:211], v58 offset:34400
 v_mfma_f32_16x16x32_bf16 v[76:79], a[220:223], a[108:111], v[76:79]
 s_mov_b32 s82, 0x310000
 s_add_u32 m0, s74, 0x19c80
 ds_read_b64_tr_b16 a[212:213], v58 offset:50784
 ds_read_b128 a[124:127], v46 offset:2048
 v_mfma_f32_16x16x32_bf16 v[76:79], a[216:219], a[96:99], v[76:79]
 s_waitcnt lgkmcnt(10)
 buffer_load_dwordx4 v42, s[56:59], s82 offen nt lds
 ds_read_b64_tr_b16 a[214:215], v58 offset:51296
 v_mfma_f32_16x16x32_bf16 v[80:83], a[192:195], a[96:99], v[80:83]
 ds_read_b64_tr_b16 a[216:217], v58 offset:33896
 v_mfma_f32_16x16x32_bf16 v[80:83], a[196:199], a[108:111], v[80:83]
 ds_read_b64_tr_b16 a[218:219], v58 offset:34408
 ds_read_b128 a[136:139], v47 offset:2048
 v_mfma_f32_16x16x32_bf16 v[144:147], a[196:199], a[112:115], v[144:147]
 s_mov_b32 s83, 0x312000
 s_add_u32 m0, s74, 0x1a0a8
 ds_read_b64_tr_b16 a[220:221], v58 offset:50792
 v_mfma_f32_16x16x32_bf16 v[144:147], a[192:195], a[100:103], v[144:147]
 s_waitcnt lgkmcnt(10)
 buffer_load_dwordx4 v42, s[56:59], s83 offen nt lds
 ds_read_b64_tr_b16 a[222:223], v58 offset:51304
 v_mfma_f32_16x16x32_bf16 v[148:151], a[200:203], a[100:103], v[148:151]
 ds_read_b64_tr_b16 a[192:193], v40 offset:33920
 v_mfma_f32_16x16x32_bf16 v[148:151], a[204:207], a[112:115], v[148:151]
 s_mov_b32 s82, 0x314000
 s_add_u32 m0, s74, 0x1a4c0
 ds_read_b64_tr_b16 a[194:195], v40 offset:34432
 v_mfma_f32_16x16x32_bf16 v[84:87], a[204:207], a[108:111], v[84:87]
 buffer_load_dwordx4 v42, s[56:59], s82 offen nt lds
 ds_read_b64_tr_b16 a[196:197], v40 offset:50816
 v_mfma_f32_16x16x32_bf16 v[84:87], a[200:203], a[96:99], v[84:87]
 s_waitcnt lgkmcnt(8)
 ds_read_b64_tr_b16 a[198:199], v40 offset:51328
 v_mfma_f32_16x16x32_bf16 v[88:91], a[208:211], a[96:99], v[88:91]
 ds_read_b64_tr_b16 a[200:201], v40 offset:33928
 v_mfma_f32_16x16x32_bf16 v[88:91], a[212:215], a[108:111], v[88:91]
 s_mov_b32 s83, 0x316000
 s_add_u32 m0, s74, 0x1a8e8
 ds_read_b64_tr_b16 a[202:203], v40 offset:34440
 v_mfma_f32_16x16x32_bf16 v[152:155], a[212:215], a[112:115], v[152:155]
 buffer_load_dwordx4 v42, s[56:59], s83 offen nt lds
 ds_read_b64_tr_b16 a[204:205], v40 offset:50824
 v_mfma_f32_16x16x32_bf16 v[152:155], a[208:211], a[100:103], v[152:155]
 s_waitcnt lgkmcnt(7)
 ds_read_b64_tr_b16 a[206:207], v40 offset:51336
 v_mfma_f32_16x16x32_bf16 v[156:159], a[216:219], a[100:103], v[156:159]
 ds_read_b64_tr_b16 a[208:209], v58 offset:33952
 v_mfma_f32_16x16x32_bf16 v[156:159], a[220:223], a[112:115], v[156:159]
 s_add_u32 m0, s73, 0x0
 ds_read_b64_tr_b16 a[210:211], v58 offset:34464
 v_mfma_f32_16x16x32_bf16 v[92:95], a[220:223], a[108:111], v[92:95]
 buffer_load_dwordx4 v3, s[48:51], s75 offen offset:0 nt lds
 ds_read_b64_tr_b16 a[212:213], v58 offset:50848
 v_mfma_f32_16x16x32_bf16 v[92:95], a[216:219], a[96:99], v[92:95]
 s_waitcnt lgkmcnt(7)
 ds_read_b64_tr_b16 a[214:215], v58 offset:51360
 v_mfma_f32_16x16x32_bf16 v[96:99], a[192:195], a[96:99], v[96:99]
 s_add_u32 m0, s73, 0x10
 ds_read_b64_tr_b16 a[216:217], v58 offset:33960
 v_mfma_f32_16x16x32_bf16 v[96:99], a[196:199], a[108:111], v[96:99]
 buffer_load_dwordx4 v3, s[48:51], s75 offen offset:1024 nt lds
 ds_read_b64_tr_b16 a[218:219], v58 offset:34472
 v_mfma_f32_16x16x32_bf16 v[160:163], a[196:199], a[112:115], v[160:163]
 ds_read_b64_tr_b16 a[220:221], v58 offset:50856
 v_mfma_f32_16x16x32_bf16 v[160:163], a[192:195], a[100:103], v[160:163]
 s_waitcnt lgkmcnt(7)
 ds_read_b64_tr_b16 a[222:223], v58 offset:51368
 v_mfma_f32_16x16x32_bf16 v[164:167], a[200:203], a[100:103], v[164:167]
 s_add_u32 m0, s73, 0x20
 ds_read_b64_tr_b16 a[192:193], v40 offset:33984
 v_mfma_f32_16x16x32_bf16 v[164:167], a[204:207], a[112:115], v[164:167]
 buffer_load_dwordx4 v3, s[48:51], s75 offen offset:2048 nt lds
 ds_read_b64_tr_b16 a[194:195], v40 offset:34496
 v_mfma_f32_16x16x32_bf16 v[100:103], a[204:207], a[108:111], v[100:103]
 ds_read_b64_tr_b16 a[196:197], v40 offset:50880
 v_mfma_f32_16x16x32_bf16 v[100:103], a[200:203], a[96:99], v[100:103]
 s_waitcnt lgkmcnt(7)
 s_add_u32 m0, s73, 0x30
 ds_read_b64_tr_b16 a[198:199], v40 offset:51392
 v_mfma_f32_16x16x32_bf16 v[104:107], a[208:211], a[96:99], v[104:107]
 buffer_load_dwordx4 v3, s[48:51], s75 offen offset:3072 nt lds
 ds_read_b64_tr_b16 a[200:201], v40 offset:33992
 v_mfma_f32_16x16x32_bf16 v[104:107], a[212:215], a[108:111], v[104:107]
 ds_read_b64_tr_b16 a[202:203], v40 offset:34504
 v_mfma_f32_16x16x32_bf16 v[168:171], a[212:215], a[112:115], v[168:171]
 ds_read_b64_tr_b16 a[204:205], v40 offset:50888
 v_mfma_f32_16x16x32_bf16 v[168:171], a[208:211], a[100:103], v[168:171]
 s_waitcnt lgkmcnt(7)
 s_add_u32 m0, s73, 0x1040
 ds_read_b64_tr_b16 a[206:207], v40 offset:51400
 v_mfma_f32_16x16x32_bf16 v[172:175], a[216:219], a[100:103], v[172:175]
 buffer_load_dwordx4 v4, s[48:51], s75 offen offset:0 nt lds
 ds_read_b64_tr_b16 a[208:209], v58 offset:34016
 v_mfma_f32_16x16x32_bf16 v[172:175], a[220:223], a[112:115], v[172:175]
 ds_read_b64_tr_b16 a[210:211], v58 offset:34528
 v_mfma_f32_16x16x32_bf16 v[108:111], a[220:223], a[108:111], v[108:111]
 ds_read_b64_tr_b16 a[212:213], v58 offset:50912
 v_mfma_f32_16x16x32_bf16 v[108:111], a[216:219], a[96:99], v[108:111]
 s_waitcnt lgkmcnt(7)
 s_add_u32 m0, s73, 0x1050
 ds_read_b64_tr_b16 a[214:215], v58 offset:51424
 v_mfma_f32_16x16x32_bf16 v[112:115], a[192:195], a[96:99], v[112:115]
 buffer_load_dwordx4 v4, s[48:51], s75 offen offset:1024 nt lds
 ds_read_b64_tr_b16 a[216:217], v58 offset:34024
 v_mfma_f32_16x16x32_bf16 v[112:115], a[196:199], a[108:111], v[112:115]
 ds_read_b64_tr_b16 a[218:219], v58 offset:34536
 v_mfma_f32_16x16x32_bf16 v[176:179], a[196:199], a[112:115], v[176:179]
 s_add_u32 m0, s73, 0x1060
 ds_read_b64_tr_b16 a[220:221], v58 offset:50920
 v_mfma_f32_16x16x32_bf16 v[176:179], a[192:195], a[100:103], v[176:179]
 s_waitcnt lgkmcnt(7)
 buffer_load_dwordx4 v4, s[48:51], s75 offen offset:2048 nt lds
 ds_read_b64_tr_b16 a[222:223], v58 offset:51432
 v_mfma_f32_16x16x32_bf16 v[180:183], a[200:203], a[100:103], v[180:183]
 s_waitcnt vmcnt(19) lgkmcnt(0)
 s_barrier
 s_mov_b64 exec, 0
 s_branch L1_PAD6
L1_PRT6:
 s_mov_b64 exec, -1
 v_mfma_f32_16x16x32_bf16 v[180:183], a[204:207], a[112:115], v[180:183]
 ds_read_b64_tr_b16 a[192:193], v41 offset:0
 v_mfma_f32_16x16x32_bf16 v[116:119], a[204:207], a[108:111], v[116:119]
 s_add_u32 m0, s73, 0x1070
 ds_read_b64_tr_b16 a[194:195], v41 offset:512
 v_mfma_f32_16x16x32_bf16 v[116:119], a[200:203], a[96:99], v[116:119]
 buffer_load_dwordx4 v4, s[48:51], s75 offen offset:3072 nt lds
 ds_read_b64_tr_b16 a[196:197], v41 offset:16896
 v_mfma_f32_16x16x32_bf16 v[120:123], a[208:211], a[96:99], v[120:123]
 ds_read_b64_tr_b16 a[198:199], v41 offset:17408
 v_mfma_f32_16x16x32_bf16 v[120:123], a[212:215], a[108:111], v[120:123]
 ds_read_b64_tr_b16 a[200:201], v41 offset:8
 v_mfma_f32_16x16x32_bf16 v[184:187], a[212:215], a[112:115], v[184:187]
 ds_read_b64_tr_b16 a[202:203], v41 offset:520
 v_mfma_f32_16x16x32_bf16 v[184:187], a[208:211], a[100:103], v[184:187]
 ds_read_b64_tr_b16 a[204:205], v41 offset:16904
 v_mfma_f32_16x16x32_bf16 v[188:191], a[216:219], a[100:103], v[188:191]
 ds_read_b64_tr_b16 a[206:207], v41 offset:17416
 v_mfma_f32_16x16x32_bf16 v[188:191], a[220:223], a[112:115], v[188:191]
 ds_read_b64_tr_b16 a[208:209], v59 offset:32
 v_mfma_f32_16x16x32_bf16 v[124:127], a[220:223], a[108:111], v[124:127]
 ds_read_b64_tr_b16 a[210:211], v59 offset:544
 v_mfma_f32_16x16x32_bf16 v[124:127], a[216:219], a[96:99], v[124:127]
 s_waitcnt lgkmcnt(6)
 s_add_u32 s75, s75, 0x8000
 ds_read_b64_tr_b16 a[212:213], v59 offset:16928
 ds_read_b64_tr_b16 a[214:215], v59 offset:17440
 v_mfma_f32_16x16x32_bf16 v[64:67], a[192:195], a[120:123], v[64:67]
 s_add_u32 m0, s73, 0x8400
 ds_read_b64_tr_b16 a[216:217], v59 offset:40
 v_mfma_f32_16x16x32_bf16 v[64:67], a[196:199], a[132:135], v[64:67]
 buffer_load_dwordx4 v3, s[48:51], s75 offen offset:0 nt lds
 ds_read_b64_tr_b16 a[218:219], v59 offset:552
 v_mfma_f32_16x16x32_bf16 v[128:131], a[196:199], a[136:139], v[128:131]
 ds_read_b64_tr_b16 a[220:221], v59 offset:16936
 v_mfma_f32_16x16x32_bf16 v[128:131], a[192:195], a[124:127], v[128:131]
 s_waitcnt lgkmcnt(7)
 ds_read_b64_tr_b16 a[222:223], v59 offset:17448
 v_mfma_f32_16x16x32_bf16 v[132:135], a[200:203], a[124:127], v[132:135]
 ds_read_b64_tr_b16 a[192:193], v41 offset:64
 v_mfma_f32_16x16x32_bf16 v[132:135], a[204:207], a[136:139], v[132:135]
 ds_read_b64_tr_b16 a[194:195], v41 offset:576
 v_mfma_f32_16x16x32_bf16 v[68:71], a[204:207], a[132:135], v[68:71]
 ds_read_b64_tr_b16 a[196:197], v41 offset:16960
 v_mfma_f32_16x16x32_bf16 v[68:71], a[200:203], a[120:123], v[68:71]
 s_waitcnt lgkmcnt(7)
 s_add_u32 m0, s73, 0x8410
 ds_read_b64_tr_b16 a[198:199], v41 offset:17472
 v_mfma_f32_16x16x32_bf16 v[72:75], a[208:211], a[120:123], v[72:75]
 buffer_load_dwordx4 v3, s[48:51], s75 offen offset:1024 nt lds
 ds_read_b64_tr_b16 a[200:201], v41 offset:72
 s_waitcnt vmcnt(18)
 ds_read_b128 a[144:147], v48 offset:0
 v_mfma_f32_16x16x32_bf16 v[72:75], a[212:215], a[132:135], v[72:75]
 ds_read_b64_tr_b16 a[202:203], v41 offset:584
 v_mfma_f32_16x16x32_bf16 v[136:139], a[212:215], a[136:139], v[136:139]
 ds_read_b64_tr_b16 a[204:205], v41 offset:16968
 v_mfma_f32_16x16x32_bf16 v[136:139], a[208:211], a[124:127], v[136:139]
 s_waitcnt lgkmcnt(8)
 ds_read_b64_tr_b16 a[206:207], v41 offset:17480
 ds_read_b128 a[156:159], v49 offset:0
 v_mfma_f32_16x16x32_bf16 v[140:143], a[216:219], a[124:127], v[140:143]
 ds_read_b64_tr_b16 a[208:209], v59 offset:96
 v_mfma_f32_16x16x32_bf16 v[140:143], a[220:223], a[136:139], v[140:143]
 ds_read_b64_tr_b16 a[210:211], v59 offset:608
 v_mfma_f32_16x16x32_bf16 v[76:79], a[220:223], a[132:135], v[76:79]
 s_add_u32 m0, s73, 0x8420
 ds_read_b64_tr_b16 a[212:213], v59 offset:16992
 ds_read_b128 a[148:151], v48 offset:2048
 v_mfma_f32_16x16x32_bf16 v[76:79], a[216:219], a[120:123], v[76:79]
 s_waitcnt lgkmcnt(10)
 buffer_load_dwordx4 v3, s[48:51], s75 offen offset:2048 nt lds
 ds_read_b64_tr_b16 a[214:215], v59 offset:17504
 v_mfma_f32_16x16x32_bf16 v[80:83], a[192:195], a[120:123], v[80:83]
 ds_read_b64_tr_b16 a[216:217], v59 offset:104
 v_mfma_f32_16x16x32_bf16 v[80:83], a[196:199], a[132:135], v[80:83]
 ds_read_b64_tr_b16 a[218:219], v59 offset:616
 ds_read_b128 a[160:163], v49 offset:2048
 v_mfma_f32_16x16x32_bf16 v[144:147], a[196:199], a[136:139], v[144:147]
 ds_read_b64_tr_b16 a[220:221], v59 offset:17000
 v_mfma_f32_16x16x32_bf16 v[144:147], a[192:195], a[124:127], v[144:147]
 s_waitcnt lgkmcnt(10)
 ds_read_b64_tr_b16 a[222:223], v59 offset:17512
 v_mfma_f32_16x16x32_bf16 v[148:151], a[200:203], a[124:127], v[148:151]
 ds_read_b64_tr_b16 a[192:193], v41 offset:128
 v_mfma_f32_16x16x32_bf16 v[148:151], a[204:207], a[136:139], v[148:151]
 s_add_u32 m0, s73, 0x8430
 ds_read_b64_tr_b16 a[194:195], v41 offset:640
 v_mfma_f32_16x16x32_bf16 v[84:87], a[204:207], a[132:135], v[84:87]
 buffer_load_dwordx4 v3, s[48:51], s75 offen offset:3072 nt lds
 ds_read_b64_tr_b16 a[196:197], v41 offset:17024
 v_mfma_f32_16x16x32_bf16 v[84:87], a[200:203], a[120:123], v[84:87]
 s_waitcnt lgkmcnt(8)
 ds_read_b64_tr_b16 a[198:199], v41 offset:17536
 v_mfma_f32_16x16x32_bf16 v[88:91], a[208:211], a[120:123], v[88:91]
 ds_read_b64_tr_b16 a[200:201], v41 offset:136
 v_mfma_f32_16x16x32_bf16 v[88:91], a[212:215], a[132:135], v[88:91]
 ds_read_b64_tr_b16 a[202:203], v41 offset:648
 v_mfma_f32_16x16x32_bf16 v[152:155], a[212:215], a[136:139], v[152:155]
 ds_read_b64_tr_b16 a[204:205], v41 offset:17032
 v_mfma_f32_16x16x32_bf16 v[152:155], a[208:211], a[124:127], v[152:155]
 s_waitcnt lgkmcnt(7)
 ds_read_b64_tr_b16 a[206:207], v41 offset:17544
 v_mfma_f32_16x16x32_bf16 v[156:159], a[216:219], a[124:127], v[156:159]
 ds_read_b64_tr_b16 a[208:209], v59 offset:160
 v_mfma_f32_16x16x32_bf16 v[156:159], a[220:223], a[136:139], v[156:159]
 s_add_u32 m0, s73, 0x9440
 ds_read_b64_tr_b16 a[210:211], v59 offset:672
 v_mfma_f32_16x16x32_bf16 v[92:95], a[220:223], a[132:135], v[92:95]
 buffer_load_dwordx4 v4, s[48:51], s75 offen offset:0 nt lds
 ds_read_b64_tr_b16 a[212:213], v59 offset:17056
 v_mfma_f32_16x16x32_bf16 v[92:95], a[216:219], a[120:123], v[92:95]
 s_waitcnt lgkmcnt(7)
 ds_read_b64_tr_b16 a[214:215], v59 offset:17568
 v_mfma_f32_16x16x32_bf16 v[96:99], a[192:195], a[120:123], v[96:99]
 ds_read_b64_tr_b16 a[216:217], v59 offset:168
 v_mfma_f32_16x16x32_bf16 v[96:99], a[196:199], a[132:135], v[96:99]
 ds_read_b64_tr_b16 a[218:219], v59 offset:680
 v_mfma_f32_16x16x32_bf16 v[160:163], a[196:199], a[136:139], v[160:163]
 ds_read_b64_tr_b16 a[220:221], v59 offset:17064
 v_mfma_f32_16x16x32_bf16 v[160:163], a[192:195], a[124:127], v[160:163]
 s_waitcnt lgkmcnt(7)
 ds_read_b64_tr_b16 a[222:223], v59 offset:17576
 v_mfma_f32_16x16x32_bf16 v[164:167], a[200:203], a[124:127], v[164:167]
 s_add_u32 m0, s73, 0x9450
 ds_read_b64_tr_b16 a[192:193], v41 offset:192
 v_mfma_f32_16x16x32_bf16 v[164:167], a[204:207], a[136:139], v[164:167]
 buffer_load_dwordx4 v4, s[48:51], s75 offen offset:1024 nt lds
 ds_read_b64_tr_b16 a[194:195], v41 offset:704
 v_mfma_f32_16x16x32_bf16 v[100:103], a[204:207], a[132:135], v[100:103]
 ds_read_b64_tr_b16 a[196:197], v41 offset:17088
 v_mfma_f32_16x16x32_bf16 v[100:103], a[200:203], a[120:123], v[100:103]
 s_waitcnt lgkmcnt(7)
 ds_read_b64_tr_b16 a[198:199], v41 offset:17600
 v_mfma_f32_16x16x32_bf16 v[104:107], a[208:211], a[120:123], v[104:107]
 ds_read_b64_tr_b16 a[200:201], v41 offset:200
 v_mfma_f32_16x16x32_bf16 v[104:107], a[212:215], a[132:135], v[104:107]
 ds_read_b64_tr_b16 a[202:203], v41 offset:712
 v_mfma_f32_16x16x32_bf16 v[168:171], a[212:215], a[136:139], v[168:171]
 ds_read_b64_tr_b16 a[204:205], v41 offset:17096
 v_mfma_f32_16x16x32_bf16 v[168:171], a[208:211], a[124:127], v[168:171]
 s_waitcnt lgkmcnt(7)
 s_add_u32 m0, s73, 0x9460
 ds_read_b64_tr_b16 a[206:207], v41 offset:17608
 v_mfma_f32_16x16x32_bf16 v[172:175], a[216:219], a[124:127], v[172:175]
 buffer_load_dwordx4 v4, s[48:51], s75 offen offset:2048 nt lds
 ds_read_b64_tr_b16 a[208:209], v59 offset:224
 v_mfma_f32_16x16x32_bf16 v[172:175], a[220:223], a[136:139], v[172:175]
 ds_read_b64_tr_b16 a[210:211], v59 offset:736
 v_mfma_f32_16x16x32_bf16 v[108:111], a[220:223], a[132:135], v[108:111]
 ds_read_b64_tr_b16 a[212:213], v59 offset:17120
 v_mfma_f32_16x16x32_bf16 v[108:111], a[216:219], a[120:123], v[108:111]
 s_waitcnt lgkmcnt(7)
 ds_read_b64_tr_b16 a[214:215], v59 offset:17632
 v_mfma_f32_16x16x32_bf16 v[112:115], a[192:195], a[120:123], v[112:115]
 ds_read_b64_tr_b16 a[216:217], v59 offset:232
 v_mfma_f32_16x16x32_bf16 v[112:115], a[196:199], a[132:135], v[112:115]
 ds_read_b64_tr_b16 a[218:219], v59 offset:744
 v_mfma_f32_16x16x32_bf16 v[176:179], a[196:199], a[136:139], v[176:179]
 s_add_u32 m0, s73, 0x9470
 ds_read_b64_tr_b16 a[220:221], v59 offset:17128
 v_mfma_f32_16x16x32_bf16 v[176:179], a[192:195], a[124:127], v[176:179]
 s_waitcnt lgkmcnt(7)
 buffer_load_dwordx4 v4, s[48:51], s75 offen offset:3072 nt lds
 ds_read_b64_tr_b16 a[222:223], v59 offset:17640
 v_mfma_f32_16x16x32_bf16 v[180:183], a[200:203], a[124:127], v[180:183]
 s_waitcnt vmcnt(16) lgkmcnt(0)
 s_barrier
 s_mov_b64 exec, 0
 s_branch L1_PAD7
L1_PRT7:
 s_mov_b64 exec, -1
 v_mfma_f32_16x16x32_bf16 v[180:183], a[204:207], a[136:139], v[180:183]
 ds_read_b64_tr_b16 a[192:193], v41 offset:33792
 v_mfma_f32_16x16x32_bf16 v[116:119], a[204:207], a[132:135], v[116:119]
 ds_read_b64_tr_b16 a[194:195], v41 offset:34304
 v_mfma_f32_16x16x32_bf16 v[116:119], a[200:203], a[120:123], v[116:119]
 ds_read_b64_tr_b16 a[196:197], v41 offset:50688
 v_mfma_f32_16x16x32_bf16 v[120:123], a[208:211], a[120:123], v[120:123]
 ds_read_b64_tr_b16 a[198:199], v41 offset:51200
 v_mfma_f32_16x16x32_bf16 v[120:123], a[212:215], a[132:135], v[120:123]
 ds_read_b64_tr_b16 a[200:201], v41 offset:33800
 v_mfma_f32_16x16x32_bf16 v[184:187], a[212:215], a[136:139], v[184:187]
 ds_read_b64_tr_b16 a[202:203], v41 offset:34312
 v_mfma_f32_16x16x32_bf16 v[184:187], a[208:211], a[124:127], v[184:187]
 ds_read_b64_tr_b16 a[204:205], v41 offset:50696
 v_mfma_f32_16x16x32_bf16 v[188:191], a[216:219], a[124:127], v[188:191]
 ds_read_b64_tr_b16 a[206:207], v41 offset:51208
 v_mfma_f32_16x16x32_bf16 v[188:191], a[220:223], a[136:139], v[188:191]
 ds_read_b64_tr_b16 a[208:209], v59 offset:33824
 v_mfma_f32_16x16x32_bf16 v[124:127], a[220:223], a[132:135], v[124:127]
 ds_read_b64_tr_b16 a[210:211], v59 offset:34336
 v_mfma_f32_16x16x32_bf16 v[124:127], a[216:219], a[120:123], v[124:127]
 s_waitcnt lgkmcnt(6)
 s_add_u32 s75, s75, 0x8000
 ds_read_b64_tr_b16 a[212:213], v59 offset:50720
 ds_read_b64_tr_b16 a[214:215], v59 offset:51232
 v_mfma_f32_16x16x32_bf16 v[64:67], a[192:195], a[144:147], v[64:67]
 s_add_u32 m0, s74, 0x10800
 ds_read_b64_tr_b16 a[216:217], v59 offset:33832
 v_mfma_f32_16x16x32_bf16 v[64:67], a[196:199], a[156:159], v[64:67]
 buffer_load_dwordx4 v3, s[52:55], s76 offen offset:0 nt lds
 ds_read_b64_tr_b16 a[218:219], v59 offset:34344
 v_mfma_f32_16x16x32_bf16 v[128:131], a[196:199], a[160:163], v[128:131]
 ds_read_b64_tr_b16 a[220:221], v59 offset:50728
 v_mfma_f32_16x16x32_bf16 v[128:131], a[192:195], a[148:151], v[128:131]
 s_waitcnt lgkmcnt(7)
 ds_read_b64_tr_b16 a[222:223], v59 offset:51240
 v_mfma_f32_16x16x32_bf16 v[132:135], a[200:203], a[148:151], v[132:135]
 ds_read_b64_tr_b16 a[192:193], v41 offset:33856
 v_mfma_f32_16x16x32_bf16 v[132:135], a[204:207], a[160:163], v[132:135]
 ds_read_b64_tr_b16 a[194:195], v41 offset:34368
 v_mfma_f32_16x16x32_bf16 v[68:71], a[204:207], a[156:159], v[68:71]
 ds_read_b64_tr_b16 a[196:197], v41 offset:50752
 v_mfma_f32_16x16x32_bf16 v[68:71], a[200:203], a[144:147], v[68:71]
 s_waitcnt lgkmcnt(7)
 s_add_u32 m0, s74, 0x10820
 ds_read_b64_tr_b16 a[198:199], v41 offset:51264
 v_mfma_f32_16x16x32_bf16 v[72:75], a[208:211], a[144:147], v[72:75]
 buffer_load_dwordx4 v3, s[52:55], s76 offen offset:1024 nt lds
 ds_read_b64_tr_b16 a[200:201], v41 offset:33864
 v_mfma_f32_16x16x32_bf16 v[72:75], a[212:215], a[156:159], v[72:75]
 ds_read_b64_tr_b16 a[202:203], v41 offset:34376
 v_mfma_f32_16x16x32_bf16 v[136:139], a[212:215], a[160:163], v[136:139]
 ds_read_b64_tr_b16 a[204:205], v41 offset:50760
 v_mfma_f32_16x16x32_bf16 v[136:139], a[208:211], a[148:151], v[136:139]
 s_waitcnt lgkmcnt(7)
 ds_read_b64_tr_b16 a[206:207], v41 offset:51272
 v_mfma_f32_16x16x32_bf16 v[140:143], a[216:219], a[148:151], v[140:143]
 ds_read_b64_tr_b16 a[208:209], v59 offset:33888
 v_mfma_f32_16x16x32_bf16 v[140:143], a[220:223], a[160:163], v[140:143]
 ds_read_b64_tr_b16 a[210:211], v59 offset:34400
 v_mfma_f32_16x16x32_bf16 v[76:79], a[220:223], a[156:159], v[76:79]
 s_add_u32 m0, s74, 0x10840
 ds_read_b64_tr_b16 a[212:213], v59 offset:50784
 v_mfma_f32_16x16x32_bf16 v[76:79], a[216:219], a[144:147], v[76:79]
 s_waitcnt lgkmcnt(7)
 buffer_load_dwordx4 v3, s[52:55], s76 offen offset:2048 nt lds
 ds_read_b64_tr_b16 a[214:215], v59 offset:51296
 v_mfma_f32_16x16x32_bf16 v[80:83], a[192:195], a[144:147], v[80:83]
 ds_read_b64_tr_b16 a[216:217], v59 offset:33896
 v_mfma_f32_16x16x32_bf16 v[80:83], a[196:199], a[156:159], v[80:83]
 ds_read_b64_tr_b16 a[218:219], v59 offset:34408
 v_mfma_f32_16x16x32_bf16 v[144:147], a[196:199], a[160:163], v[144:147]
 ds_read_b64_tr_b16 a[220:221], v59 offset:50792
 v_mfma_f32_16x16x32_bf16 v[144:147], a[192:195], a[148:151], v[144:147]
 s_waitcnt lgkmcnt(7)
 ds_read_b64_tr_b16 a[222:223], v59 offset:51304
 v_mfma_f32_16x16x32_bf16 v[148:151], a[200:203], a[148:151], v[148:151]
 ds_read_b64_tr_b16 a[192:193], v41 offset:33920
 v_mfma_f32_16x16x32_bf16 v[148:151], a[204:207], a[160:163], v[148:151]
 s_add_u32 m0, s74, 0x10860
 ds_read_b64_tr_b16 a[194:195], v41 offset:34432
 v_mfma_f32_16x16x32_bf16 v[84:87], a[204:207], a[156:159], v[84:87]
 buffer_load_dwordx4 v3, s[52:55], s76 offen offset:3072 nt lds
 ds_read_b64_tr_b16 a[196:197], v41 offset:50816
 v_mfma_f32_16x16x32_bf16 v[84:87], a[200:203], a[144:147], v[84:87]
 s_waitcnt lgkmcnt(7)
 ds_read_b64_tr_b16 a[198:199], v41 offset:51328
 v_mfma_f32_16x16x32_bf16 v[88:91], a[208:211], a[144:147], v[88:91]
 ds_read_b64_tr_b16 a[200:201], v41 offset:33928
 v_mfma_f32_16x16x32_bf16 v[88:91], a[212:215], a[156:159], v[88:91]
 ds_read_b64_tr_b16 a[202:203], v41 offset:34440
 v_mfma_f32_16x16x32_bf16 v[152:155], a[212:215], a[160:163], v[152:155]
 ds_read_b64_tr_b16 a[204:205], v41 offset:50824
 v_mfma_f32_16x16x32_bf16 v[152:155], a[208:211], a[148:151], v[152:155]
 s_waitcnt lgkmcnt(7)
 ds_read_b64_tr_b16 a[206:207], v41 offset:51336
 v_mfma_f32_16x16x32_bf16 v[156:159], a[216:219], a[148:151], v[156:159]
 ds_read_b64_tr_b16 a[208:209], v59 offset:33952
 v_mfma_f32_16x16x32_bf16 v[156:159], a[220:223], a[160:163], v[156:159]
 s_add_u32 m0, s74, 0x11880
 ds_read_b64_tr_b16 a[210:211], v59 offset:34464
 v_mfma_f32_16x16x32_bf16 v[92:95], a[220:223], a[156:159], v[92:95]
 buffer_load_dwordx4 v4, s[52:55], s76 offen offset:0 nt lds
 ds_read_b64_tr_b16 a[212:213], v59 offset:50848
 v_mfma_f32_16x16x32_bf16 v[92:95], a[216:219], a[144:147], v[92:95]
 s_waitcnt lgkmcnt(7)
 ds_read_b64_tr_b16 a[214:215], v59 offset:51360
 v_mfma_f32_16x16x32_bf16 v[96:99], a[192:195], a[144:147], v[96:99]
 ds_read_b64_tr_b16 a[216:217], v59 offset:33960
 v_mfma_f32_16x16x32_bf16 v[96:99], a[196:199], a[156:159], v[96:99]
 ds_read_b64_tr_b16 a[218:219], v59 offset:34472
 v_mfma_f32_16x16x32_bf16 v[160:163], a[196:199], a[160:163], v[160:163]
 ds_read_b64_tr_b16 a[220:221], v59 offset:50856
 v_mfma_f32_16x16x32_bf16 v[160:163], a[192:195], a[148:151], v[160:163]
 s_waitcnt lgkmcnt(7)
 ds_read_b64_tr_b16 a[222:223], v59 offset:51368
 v_mfma_f32_16x16x32_bf16 v[164:167], a[200:203], a[148:151], v[164:167]
 s_add_u32 m0, s74, 0x118a0
 ds_read_b64_tr_b16 a[192:193], v41 offset:33984
 v_mfma_f32_16x16x32_bf16 v[164:167], a[204:207], a[160:163], v[164:167]
 buffer_load_dwordx4 v4, s[52:55], s76 offen offset:1024 nt lds
 ds_read_b64_tr_b16 a[194:195], v41 offset:34496
 v_mfma_f32_16x16x32_bf16 v[100:103], a[204:207], a[156:159], v[100:103]
 ds_read_b64_tr_b16 a[196:197], v41 offset:50880
 v_mfma_f32_16x16x32_bf16 v[100:103], a[200:203], a[144:147], v[100:103]
 s_waitcnt lgkmcnt(7)
 ds_read_b64_tr_b16 a[198:199], v41 offset:51392
 v_mfma_f32_16x16x32_bf16 v[104:107], a[208:211], a[144:147], v[104:107]
 ds_read_b64_tr_b16 a[200:201], v41 offset:33992
 v_mfma_f32_16x16x32_bf16 v[104:107], a[212:215], a[156:159], v[104:107]
 ds_read_b64_tr_b16 a[202:203], v41 offset:34504
 v_mfma_f32_16x16x32_bf16 v[168:171], a[212:215], a[160:163], v[168:171]
 ds_read_b64_tr_b16 a[204:205], v41 offset:50888
 v_mfma_f32_16x16x32_bf16 v[168:171], a[208:211], a[148:151], v[168:171]
 s_waitcnt lgkmcnt(7)
 s_add_u32 m0, s74, 0x118c0
 ds_read_b64_tr_b16 a[206:207], v41 offset:51400
 v_mfma_f32_16x16x32_bf16 v[172:175], a[216:219], a[148:151], v[172:175]
 buffer_load_dwordx4 v4, s[52:55], s76 offen offset:2048 nt lds
 ds_read_b64_tr_b16 a[208:209], v59 offset:34016
 v_mfma_f32_16x16x32_bf16 v[172:175], a[220:223], a[160:163], v[172:175]
 ds_read_b64_tr_b16 a[210:211], v59 offset:34528
 v_mfma_f32_16x16x32_bf16 v[108:111], a[220:223], a[156:159], v[108:111]
 ds_read_b64_tr_b16 a[212:213], v59 offset:50912
 v_mfma_f32_16x16x32_bf16 v[108:111], a[216:219], a[144:147], v[108:111]
 s_waitcnt lgkmcnt(7)
 ds_read_b64_tr_b16 a[214:215], v59 offset:51424
 v_mfma_f32_16x16x32_bf16 v[112:115], a[192:195], a[144:147], v[112:115]
 ds_read_b64_tr_b16 a[216:217], v59 offset:34024
 v_mfma_f32_16x16x32_bf16 v[112:115], a[196:199], a[156:159], v[112:115]
 ds_read_b64_tr_b16 a[218:219], v59 offset:34536
 v_mfma_f32_16x16x32_bf16 v[176:179], a[196:199], a[160:163], v[176:179]
 s_add_u32 m0, s74, 0x118e0
 ds_read_b64_tr_b16 a[220:221], v59 offset:50920
 v_mfma_f32_16x16x32_bf16 v[176:179], a[192:195], a[148:151], v[176:179]
 s_waitcnt lgkmcnt(7)
 buffer_load_dwordx4 v4, s[52:55], s76 offen offset:3072 nt lds
 ds_read_b64_tr_b16 a[222:223], v59 offset:51432
 v_mfma_f32_16x16x32_bf16 v[180:183], a[200:203], a[148:151], v[180:183]
 s_waitcnt vmcnt(16) lgkmcnt(0)
 s_barrier
 v_mfma_f32_16x16x32_bf16 v[180:183], a[204:207], a[160:163], v[180:183]
 ds_read_b128 a[192:195], v1 offset:0
 v_mfma_f32_16x16x32_bf16 v[116:119], a[204:207], a[156:159], v[116:119]
 ds_read_b128 a[196:199], v1 offset:32
 v_mfma_f32_16x16x32_bf16 v[116:119], a[200:203], a[144:147], v[116:119]
 v_mfma_f32_16x16x32_bf16 v[120:123], a[208:211], a[144:147], v[120:123]
 ds_read_b128 a[200:203], v1 offset:64
 v_mfma_f32_16x16x32_bf16 v[120:123], a[212:215], a[156:159], v[120:123]
 ds_read_b128 a[204:207], v1 offset:96
 v_mfma_f32_16x16x32_bf16 v[184:187], a[212:215], a[160:163], v[184:187]
 v_mfma_f32_16x16x32_bf16 v[184:187], a[208:211], a[148:151], v[184:187]
 v_mfma_f32_16x16x32_bf16 v[188:191], a[216:219], a[148:151], v[188:191]
 ds_read_b128 a[208:211], v1 offset:128
 v_mfma_f32_16x16x32_bf16 v[188:191], a[220:223], a[160:163], v[188:191]
 ds_read_b128 a[212:215], v1 offset:160
 v_mfma_f32_16x16x32_bf16 v[124:127], a[220:223], a[156:159], v[124:127]
 v_mfma_f32_16x16x32_bf16 v[124:127], a[216:219], a[144:147], v[124:127]
 s_waitcnt lgkmcnt(4)
 s_add_u32 s76, s76, 0x8000
.p2align 3
 v_pk_mul_f32 v[64:65], v[64:65], s[80:81]
 v_pk_mul_f32 v[66:67], v[66:67], s[80:81]
 v_pk_mul_f32 v[68:69], v[68:69], s[80:81]
 v_pk_mul_f32 v[70:71], v[70:71], s[80:81]
 v_cvt_pk_bf16_f32 v64, v64, v65
 v_cvt_pk_bf16_f32 v65, v66, v67
 v_cvt_pk_bf16_f32 v66, v68, v69
 v_cvt_pk_bf16_f32 v67, v70, v71
 v_pk_mul_f32 v[72:73], v[72:73], s[80:81]
 v_pk_mul_f32 v[74:75], v[74:75], s[80:81]
 v_pk_mul_f32 v[76:77], v[76:77], s[80:81]
 v_pk_mul_f32 v[78:79], v[78:79], s[80:81]
 v_cvt_pk_bf16_f32 v68, v72, v73
 v_cvt_pk_bf16_f32 v69, v74, v75
 v_cvt_pk_bf16_f32 v70, v76, v77
 v_cvt_pk_bf16_f32 v71, v78, v79
 v_pk_mul_f32 v[80:81], v[80:81], s[80:81]
 v_pk_mul_f32 v[82:83], v[82:83], s[80:81]
 v_pk_mul_f32 v[84:85], v[84:85], s[80:81]
 v_pk_mul_f32 v[86:87], v[86:87], s[80:81]
 v_cvt_pk_bf16_f32 v72, v80, v81
 v_cvt_pk_bf16_f32 v73, v82, v83
 v_cvt_pk_bf16_f32 v74, v84, v85
 v_cvt_pk_bf16_f32 v75, v86, v87
 v_pk_mul_f32 v[88:89], v[88:89], s[80:81]
 v_pk_mul_f32 v[90:91], v[90:91], s[80:81]
 v_pk_mul_f32 v[92:93], v[92:93], s[80:81]
 v_pk_mul_f32 v[94:95], v[94:95], s[80:81]
 v_cvt_pk_bf16_f32 v76, v88, v89
 v_cvt_pk_bf16_f32 v77, v90, v91
 v_cvt_pk_bf16_f32 v78, v92, v93
 v_cvt_pk_bf16_f32 v79, v94, v95
 v_pk_mul_f32 v[96:97], v[96:97], s[80:81]
 v_pk_mul_f32 v[98:99], v[98:99], s[80:81]
 v_pk_mul_f32 v[100:101], v[100:101], s[80:81]
 v_pk_mul_f32 v[102:103], v[102:103], s[80:81]
 v_cvt_pk_bf16_f32 v80, v96, v97
 v_cvt_pk_bf16_f32 v81, v98, v99
 v_cvt_pk_bf16_f32 v82, v100, v101
 v_cvt_pk_bf16_f32 v83, v102, v103
 v_pk_mul_f32 v[104:105], v[104:105], s[80:81]
 v_pk_mul_f32 v[106:107], v[106:107], s[80:81]
 v_pk_mul_f32 v[108:109], v[108:109], s[80:81]
 v_pk_mul_f32 v[110:111], v[110:111], s[80:81]
 v_cvt_pk_bf16_f32 v84, v104, v105
 v_cvt_pk_bf16_f32 v85, v106, v107
 v_cvt_pk_bf16_f32 v86, v108, v109
 v_cvt_pk_bf16_f32 v87, v110, v111
 v_pk_mul_f32 v[112:113], v[112:113], s[80:81]
 v_pk_mul_f32 v[114:115], v[114:115], s[80:81]
 v_pk_mul_f32 v[116:117], v[116:117], s[80:81]
 v_pk_mul_f32 v[118:119], v[118:119], s[80:81]
 v_cvt_pk_bf16_f32 v88, v112, v113
 v_cvt_pk_bf16_f32 v89, v114, v115
 v_cvt_pk_bf16_f32 v90, v116, v117
 v_cvt_pk_bf16_f32 v91, v118, v119
 v_pk_mul_f32 v[120:121], v[120:121], s[80:81]
 v_pk_mul_f32 v[122:123], v[122:123], s[80:81]
 v_pk_mul_f32 v[124:125], v[124:125], s[80:81]
 v_pk_mul_f32 v[126:127], v[126:127], s[80:81]
 v_cvt_pk_bf16_f32 v92, v120, v121
 v_cvt_pk_bf16_f32 v93, v122, v123
 v_cvt_pk_bf16_f32 v94, v124, v125
 v_cvt_pk_bf16_f32 v95, v126, v127
 v_pk_mul_f32 v[128:129], v[128:129], s[80:81]
 v_pk_mul_f32 v[130:131], v[130:131], s[80:81]
 v_pk_mul_f32 v[132:133], v[132:133], s[80:81]
 v_pk_mul_f32 v[134:135], v[134:135], s[80:81]
 v_cvt_pk_bf16_f32 v96, v128, v129
 v_cvt_pk_bf16_f32 v97, v130, v131
 v_cvt_pk_bf16_f32 v98, v132, v133
 v_cvt_pk_bf16_f32 v99, v134, v135
 v_pk_mul_f32 v[136:137], v[136:137], s[80:81]
 v_pk_mul_f32 v[138:139], v[138:139], s[80:81]
 v_pk_mul_f32 v[140:141], v[140:141], s[80:81]
 v_pk_mul_f32 v[142:143], v[142:143], s[80:81]
 v_cvt_pk_bf16_f32 v100, v136, v137
 v_cvt_pk_bf16_f32 v101, v138, v139
 v_cvt_pk_bf16_f32 v102, v140, v141
 v_cvt_pk_bf16_f32 v103, v142, v143
 v_pk_mul_f32 v[144:145], v[144:145], s[80:81]
 v_pk_mul_f32 v[146:147], v[146:147], s[80:81]
 v_pk_mul_f32 v[148:149], v[148:149], s[80:81]
 v_pk_mul_f32 v[150:151], v[150:151], s[80:81]
 v_cvt_pk_bf16_f32 v104, v144, v145
 v_cvt_pk_bf16_f32 v105, v146, v147
 v_cvt_pk_bf16_f32 v106, v148, v149
 v_cvt_pk_bf16_f32 v107, v150, v151
 v_pk_mul_f32 v[152:153], v[152:153], s[80:81]
 v_pk_mul_f32 v[154:155], v[154:155], s[80:81]
 v_pk_mul_f32 v[156:157], v[156:157], s[80:81]
 v_pk_mul_f32 v[158:159], v[158:159], s[80:81]
 v_cvt_pk_bf16_f32 v108, v152, v153
 v_cvt_pk_bf16_f32 v109, v154, v155
 v_cvt_pk_bf16_f32 v110, v156, v157
 v_cvt_pk_bf16_f32 v111, v158, v159
 v_pk_mul_f32 v[160:161], v[160:161], s[80:81]
 v_pk_mul_f32 v[162:163], v[162:163], s[80:81]
 v_pk_mul_f32 v[164:165], v[164:165], s[80:81]
 v_pk_mul_f32 v[166:167], v[166:167], s[80:81]
 v_cvt_pk_bf16_f32 v112, v160, v161
 v_cvt_pk_bf16_f32 v113, v162, v163
 v_cvt_pk_bf16_f32 v114, v164, v165
 v_cvt_pk_bf16_f32 v115, v166, v167
 v_pk_mul_f32 v[168:169], v[168:169], s[80:81]
 v_pk_mul_f32 v[170:171], v[170:171], s[80:81]
 v_pk_mul_f32 v[172:173], v[172:173], s[80:81]
 v_pk_mul_f32 v[174:175], v[174:175], s[80:81]
 v_cvt_pk_bf16_f32 v116, v168, v169
 v_cvt_pk_bf16_f32 v117, v170, v171
 v_cvt_pk_bf16_f32 v118, v172, v173
 v_cvt_pk_bf16_f32 v119, v174, v175
 v_pk_mul_f32 v[176:177], v[176:177], s[80:81]
 v_pk_mul_f32 v[178:179], v[178:179], s[80:81]
 v_pk_mul_f32 v[180:181], v[180:181], s[80:81]
 v_pk_mul_f32 v[182:183], v[182:183], s[80:81]
 v_cvt_pk_bf16_f32 v120, v176, v177
 v_cvt_pk_bf16_f32 v121, v178, v179
 v_cvt_pk_bf16_f32 v122, v180, v181
 v_cvt_pk_bf16_f32 v123, v182, v183
 v_pk_mul_f32 v[184:185], v[184:185], s[80:81]
 v_pk_mul_f32 v[186:187], v[186:187], s[80:81]
 v_pk_mul_f32 v[188:189], v[188:189], s[80:81]
 v_pk_mul_f32 v[190:191], v[190:191], s[80:81]
 v_cvt_pk_bf16_f32 v124, v184, v185
 v_cvt_pk_bf16_f32 v125, v186, v187
 v_cvt_pk_bf16_f32 v126, v188, v189
 v_cvt_pk_bf16_f32 v127, v190, v191
 v_mfma_f32_16x16x32_bf16 v[128:131], a[192:195], v[64:67], 0
 s_add_u32 m0, s74, 0x18c00
 ds_read_b128 a[216:219], v1 offset:192
 v_mfma_f32_16x16x32_bf16 v[128:131], a[196:199], v[68:71], v[128:131]
 buffer_load_dwordx4 v3, s[52:55], s76 offen offset:0 nt lds
 s_add_u32 m0, s74, 0x18c20
 v_mfma_f32_16x16x32_bf16 v[132:135], a[196:199], v[100:103], 0
 buffer_load_dwordx4 v3, s[52:55], s76 offen offset:1024 nt lds
 ds_read_b128 a[220:223], v1 offset:224
 v_mfma_f32_16x16x32_bf16 v[132:135], a[192:195], v[96:99], v[132:135]
 s_waitcnt lgkmcnt(4)
 s_add_u32 m0, s74, 0x18c40
 v_mfma_f32_16x16x32_bf16 v[132:135], a[200:203], v[104:107], v[132:135]
 buffer_load_dwordx4 v3, s[52:55], s76 offen offset:2048 nt lds
 ds_read_b128 a[192:195], v1 offset:512
 v_mfma_f32_16x16x32_bf16 v[132:135], a[204:207], v[108:111], v[132:135]
 s_add_u32 m0, s74, 0x18c60
 v_mfma_f32_16x16x32_bf16 v[128:131], a[204:207], v[76:79], v[128:131]
 buffer_load_dwordx4 v3, s[52:55], s76 offen offset:3072 nt lds
 ds_read_b128 a[196:199], v1 offset:544
 v_mfma_f32_16x16x32_bf16 v[128:131], a[200:203], v[72:75], v[128:131]
 s_waitcnt lgkmcnt(4)
 s_add_u32 m0, s74, 0x19c80
 v_mfma_f32_16x16x32_bf16 v[128:131], a[208:211], v[80:83], v[128:131]
 buffer_load_dwordx4 v4, s[52:55], s76 offen offset:0 nt lds
 s_add_u32 m0, s74, 0x19ca0
 ds_read_b128 a[200:203], v1 offset:576
 v_mfma_f32_16x16x32_bf16 v[128:131], a[212:215], v[84:87], v[128:131]
 buffer_load_dwordx4 v4, s[52:55], s76 offen offset:1024 nt lds
 v_mfma_f32_16x16x32_bf16 v[132:135], a[212:215], v[116:119], v[132:135]
 s_add_u32 m0, s74, 0x19cc0
 ds_read_b128 a[204:207], v1 offset:608
 v_mfma_f32_16x16x32_bf16 v[132:135], a[208:211], v[112:115], v[132:135]
 s_waitcnt lgkmcnt(4)
 buffer_load_dwordx4 v4, s[52:55], s76 offen offset:2048 nt lds
 v_mfma_f32_16x16x32_bf16 v[132:135], a[216:219], v[120:123], v[132:135]
 s_add_u32 m0, s74, 0x19ce0
 ds_read_b128 a[208:211], v1 offset:640
 v_mfma_f32_16x16x32_bf16 v[132:135], a[220:223], v[124:127], v[132:135]
 buffer_load_dwordx4 v4, s[52:55], s76 offen offset:3072 nt lds
 v_mfma_f32_16x16x32_bf16 v[128:131], a[220:223], v[92:95], v[128:131]
 ds_read_b128 a[212:215], v1 offset:672
 v_mfma_f32_16x16x32_bf16 v[128:131], a[216:219], v[88:91], v[128:131]
 s_waitcnt lgkmcnt(4)
 v_mfma_f32_16x16x32_bf16 v[140:143], a[192:195], v[64:67], 0
 ds_read_b128 a[216:219], v1 offset:704
 v_mfma_f32_16x16x32_bf16 v[140:143], a[196:199], v[68:71], v[140:143]
 v_mfma_f32_16x16x32_bf16 v[144:147], a[196:199], v[100:103], 0
 ds_read_b128 a[220:223], v1 offset:736
 v_max3_f32 v238, v132, v133, v134
 v_mfma_f32_16x16x32_bf16 v[144:147], a[192:195], v[96:99], v[144:147]
 s_waitcnt lgkmcnt(4)
 v_max_f32 v238, v238, v135
 v_mov_b32 v239, v238
 v_mfma_f32_16x16x32_bf16 v[144:147], a[200:203], v[104:107], v[144:147]
 ds_read_b128 a[192:195], v1 offset:16640
 v_max3_f32 v236, v128, v129, v130
 v_mfma_f32_16x16x32_bf16 v[144:147], a[204:207], v[108:111], v[144:147]
 v_max_f32 v236, v236, v131
 v_mov_b32 v237, v236
 v_permlane32_swap_b32 v238, v239
 v_mfma_f32_16x16x32_bf16 v[140:143], a[204:207], v[76:79], v[140:143]
 ds_read_b128 a[196:199], v1 offset:16672
 v_max_f32 v238, v238, v239
 v_mfma_f32_16x16x32_bf16 v[140:143], a[200:203], v[72:75], v[140:143]
 s_waitcnt lgkmcnt(4)
 v_permlane32_swap_b32 v236, v237
 v_max_f32 v236, v236, v237
 v_mov_b32 v237, v236
 v_mfma_f32_16x16x32_bf16 v[140:143], a[208:211], v[80:83], v[140:143]
 ds_read_b128 a[200:203], v1 offset:16704
 v_mov_b32 v239, v238
 v_mfma_f32_16x16x32_bf16 v[140:143], a[212:215], v[84:87], v[140:143]
 v_permlane16_swap_b32 v236, v237
 v_max_f32 v236, v236, v237
 v_sub_f32 v16, 0, v236
 v_mfma_f32_16x16x32_bf16 v[144:147], a[212:215], v[116:119], v[144:147]
 ds_read_b128 a[204:207], v1 offset:16736
 v_sub_f32 v17, 0, v236
 v_mfma_f32_16x16x32_bf16 v[144:147], a[208:211], v[112:115], v[144:147]
 s_waitcnt lgkmcnt(4)
 v_sub_f32 v18, 0, v236
 v_sub_f32 v19, 0, v236
 v_permlane16_swap_b32 v238, v239
 v_mfma_f32_16x16x32_bf16 v[144:147], a[216:219], v[120:123], v[144:147]
 ds_read_b128 a[208:211], v1 offset:16768
 v_max_f32 v238, v238, v239
 v_mfma_f32_16x16x32_bf16 v[144:147], a[220:223], v[124:127], v[144:147]
 v_sub_f32 v20, 0, v238
 v_sub_f32 v21, 0, v238
 v_sub_f32 v22, 0, v238
 v_mfma_f32_16x16x32_bf16 v[140:143], a[220:223], v[92:95], v[140:143]
 ds_read_b128 a[212:215], v1 offset:16800
 v_sub_f32 v23, 0, v238
 v_mfma_f32_16x16x32_bf16 v[140:143], a[216:219], v[88:91], v[140:143]
 s_waitcnt lgkmcnt(4)
 v_add_f32 v128, v128, v16
 v_exp_f32 v28, v128
 v_mfma_f32_16x16x32_bf16 v[152:155], a[192:195], v[64:67], v[16:19]
 ds_read_b128 a[216:219], v1 offset:16832
 v_add_f32 v129, v129, v16
 v_mfma_f32_16x16x32_bf16 v[152:155], a[196:199], v[68:71], v[152:155]
 v_exp_f32 v29, v129
 v_add_f32 v132, v132, v20
 v_mfma_f32_16x16x32_bf16 v[156:159], a[196:199], v[100:103], v[20:23]
 ds_read_b128 a[220:223], v1 offset:16864
 v_add_f32 v133, v133, v20
 v_mfma_f32_16x16x32_bf16 v[156:159], a[192:195], v[96:99], v[156:159]
 s_waitcnt lgkmcnt(4)
 v_cvt_pk_bf16_f32 v52, v28, v29
 v_exp_f32 v28, v132
 v_mfma_f32_16x16x32_bf16 v[156:159], a[200:203], v[104:107], v[156:159]
 ds_read_b128 a[192:195], v1 offset:17152
 v_dot2_f32_bf16 v11, v52, s79, 0
 v_mfma_f32_16x16x32_bf16 v[156:159], a[204:207], v[108:111], v[156:159]
 v_exp_f32 v29, v133
 v_add_f32 v130, v130, v16
 v_mfma_f32_16x16x32_bf16 v[152:155], a[204:207], v[76:79], v[152:155]
 ds_read_b128 a[196:199], v1 offset:17184
 v_cvt_pk_bf16_f32 v56, v28, v29
 v_mfma_f32_16x16x32_bf16 v[152:155], a[200:203], v[72:75], v[152:155]
 s_waitcnt lgkmcnt(4)
 v_exp_f32 v30, v130
 v_dot2_f32_bf16 v12, v56, s79, 0
 v_mfma_f32_16x16x32_bf16 v[152:155], a[208:211], v[80:83], v[152:155]
 ds_read_b128 a[200:203], v1 offset:17216
 v_add_f32 v131, v131, v16
 v_mfma_f32_16x16x32_bf16 v[152:155], a[212:215], v[84:87], v[152:155]
 v_exp_f32 v31, v131
 v_add_f32 v140, v140, v16
 v_mfma_f32_16x16x32_bf16 v[156:159], a[212:215], v[116:119], v[156:159]
 ds_read_b128 a[204:207], v1 offset:17248
 v_add_f32 v141, v141, v16
 v_mfma_f32_16x16x32_bf16 v[156:159], a[208:211], v[112:115], v[156:159]
 s_waitcnt lgkmcnt(4)
 v_exp_f32 v32, v140
 v_add_f32 v142, v142, v16
 v_mfma_f32_16x16x32_bf16 v[156:159], a[216:219], v[120:123], v[156:159]
 ds_read_b128 a[208:211], v1 offset:17280
 v_add_f32 v143, v143, v16
 v_mfma_f32_16x16x32_bf16 v[156:159], a[220:223], v[124:127], v[156:159]
 v_exp_f32 v33, v141
 v_add_f32 v134, v134, v20
 v_mfma_f32_16x16x32_bf16 v[152:155], a[220:223], v[92:95], v[152:155]
 ds_read_b128 a[212:215], v1 offset:17312
 v_add_f32 v135, v135, v20
 v_mfma_f32_16x16x32_bf16 v[152:155], a[216:219], v[88:91], v[152:155]
 s_waitcnt lgkmcnt(4)
 v_exp_f32 v34, v142
 v_add_f32 v144, v144, v20
 v_mfma_f32_16x16x32_bf16 v[164:167], a[192:195], v[64:67], v[16:19]
 ds_read_b128 a[216:219], v1 offset:17344
 v_add_f32 v145, v145, v20
 v_mfma_f32_16x16x32_bf16 v[164:167], a[196:199], v[68:71], v[164:167]
 v_exp_f32 v35, v143
 v_mfma_f32_16x16x32_bf16 v[168:171], a[196:199], v[100:103], v[20:23]
 ds_read_b128 a[220:223], v1 offset:17376
 v_add_f32 v146, v146, v20
 v_add_f32 v147, v147, v20
 v_mfma_f32_16x16x32_bf16 v[168:171], a[192:195], v[96:99], v[168:171]
 s_waitcnt lgkmcnt(4)
 v_cvt_pk_bf16_f32 v53, v30, v31
 v_cvt_pk_bf16_f32 v54, v32, v33
 v_mfma_f32_16x16x32_bf16 v[168:171], a[200:203], v[104:107], v[168:171]
 v_exp_f32 v30, v134
 v_cvt_pk_bf16_f32 v55, v34, v35
 v_mfma_f32_16x16x32_bf16 v[168:171], a[204:207], v[108:111], v[168:171]
 v_exp_f32 v31, v135
 v_mfma_f32_16x16x32_bf16 v[164:167], a[204:207], v[76:79], v[164:167]
 v_exp_f32 v32, v144
 v_mov_b32 v8, 0
 v_mfma_f32_16x16x32_bf16 v[164:167], a[200:203], v[72:75], v[164:167]
 s_waitcnt lgkmcnt(2)
 v_exp_f32 v33, v145
 v_mfma_f32_16x16x32_bf16 v[164:167], a[208:211], v[80:83], v[164:167]
 v_exp_f32 v34, v146
 v_mfma_f32_16x16x32_bf16 v[164:167], a[212:215], v[84:87], v[164:167]
 v_exp_f32 v35, v147
 v_mov_b32 v9, 0
 v_mfma_f32_16x16x32_bf16 v[168:171], a[212:215], v[116:119], v[168:171]
 v_dot2c_f32_bf16 v11, s79, v53
 v_dot2c_f32_bf16 v11, s79, v54
 v_mfma_f32_16x16x32_bf16 v[168:171], a[208:211], v[112:115], v[168:171]
 s_waitcnt lgkmcnt(0)
 v_dot2c_f32_bf16 v11, s79, v55
 v_cvt_pk_bf16_f32 v57, v30, v31
 v_dot2c_f32_bf16 v12, s79, v57
 v_mfma_f32_16x16x32_bf16 v[168:171], a[216:219], v[120:123], v[168:171]
 v_cvt_pk_bf16_f32 v58, v32, v33
 v_dot2c_f32_bf16 v12, s79, v58
 v_mfma_f32_16x16x32_bf16 v[168:171], a[220:223], v[124:127], v[168:171]
 s_waitcnt vmcnt(16)
 s_barrier
 v_mfma_f32_16x16x32_bf16 v[164:167], a[220:223], v[92:95], v[164:167]
 ds_read_b128 a[192:195], v1 offset:33792
 v_cvt_pk_bf16_f32 v59, v34, v35
 v_dot2c_f32_bf16 v12, s79, v59
 v_mfma_f32_16x16x32_bf16 v[164:167], a[216:219], v[88:91], v[164:167]
 s_waitcnt lgkmcnt(0)
 s_add_u32 s76, s76, 0x8000
 ds_read_b128 a[196:199], v1 offset:33824
 ds_read_b128 a[200:203], v1 offset:33856
 ds_read_b128 a[204:207], v1 offset:33888
 ds_read_b128 a[208:211], v1 offset:33920
 ds_read_b128 a[212:215], v1 offset:33952
 s_waitcnt lgkmcnt(4)
 v_mfma_f32_16x16x32_bf16 v[176:179], a[192:195], v[64:67], v[16:19]
 s_add_u32 m0, s73, 0x0
 ds_read_b128 a[216:219], v1 offset:33984
 v_mfma_f32_16x16x32_bf16 v[176:179], a[196:199], v[68:71], v[176:179]
 buffer_load_dwordx4 v3, s[48:51], s75 offen offset:0 nt lds
 v_mfma_f32_16x16x32_bf16 v[180:183], a[196:199], v[100:103], v[20:23]
 ds_read_b128 a[220:223], v1 offset:34016
 v_mfma_f32_16x16x32_bf16 v[180:183], a[192:195], v[96:99], v[180:183]
 s_waitcnt lgkmcnt(4)
 v_exp_f32 v28, v152
 v_mfma_f32_16x16x32_bf16 v[180:183], a[200:203], v[104:107], v[180:183]
 ds_read_b128 a[192:195], v1 offset:34304
 v_mfma_f32_16x16x32_bf16 v[180:183], a[204:207], v[108:111], v[180:183]
 v_exp_f32 v29, v153
 v_mfma_f32_16x16x32_bf16 v[176:179], a[204:207], v[76:79], v[176:179]
 ds_read_b128 a[196:199], v1 offset:34336
 v_cvt_pk_bf16_f32 v40, v28, v29
 v_mfma_f32_16x16x32_bf16 v[176:179], a[200:203], v[72:75], v[176:179]
 s_waitcnt lgkmcnt(4)
 s_add_u32 m0, s73, 0x10
 v_exp_f32 v30, v154
 v_mfma_f32_16x16x32_bf16 v[176:179], a[208:211], v[80:83], v[176:179]
 buffer_load_dwordx4 v3, s[48:51], s75 offen offset:1024 nt lds
 ds_read_b128 a[200:203], v1 offset:34368
 v_mfma_f32_16x16x32_bf16 v[176:179], a[212:215], v[84:87], v[176:179]
 v_mfma_f32_16x16x32_bf16 v[180:183], a[212:215], v[116:119], v[180:183]
 ds_read_b128 a[204:207], v1 offset:34400
 v_mfma_f32_16x16x32_bf16 v[180:183], a[208:211], v[112:115], v[180:183]
 s_waitcnt lgkmcnt(4)
 v_exp_f32 v31, v155
 v_mfma_f32_16x16x32_bf16 v[180:183], a[216:219], v[120:123], v[180:183]
 ds_read_b128 a[208:211], v1 offset:34432
 v_cvt_pk_bf16_f32 v41, v30, v31
 v_mfma_f32_16x16x32_bf16 v[180:183], a[220:223], v[124:127], v[180:183]
 v_exp_f32 v32, v164
 v_mfma_f32_16x16x32_bf16 v[176:179], a[220:223], v[92:95], v[176:179]
 ds_read_b128 a[212:215], v1 offset:34464
 v_mfma_f32_16x16x32_bf16 v[176:179], a[216:219], v[88:91], v[176:179]
 s_waitcnt lgkmcnt(4)
 s_add_u32 m0, s73, 0x20
 v_exp_f32 v33, v165
 v_mfma_f32_16x16x32_bf16 v[188:191], a[192:195], v[64:67], v[16:19]
 buffer_load_dwordx4 v3, s[48:51], s75 offen offset:2048 nt lds
 ds_read_b128 a[216:219], v1 offset:34496
 v_mfma_f32_16x16x32_bf16 v[188:191], a[196:199], v[68:71], v[188:191]
 v_mfma_f32_16x16x32_bf16 v[192:195], a[196:199], v[100:103], v[20:23]
 ds_read_b128 a[220:223], v1 offset:34528
 v_cvt_pk_bf16_f32 v42, v32, v33
 v_mfma_f32_16x16x32_bf16 v[192:195], a[192:195], v[96:99], v[192:195]
 s_waitcnt lgkmcnt(4)
 v_exp_f32 v34, v166
 v_mfma_f32_16x16x32_bf16 v[192:195], a[200:203], v[104:107], v[192:195]
 ds_read_b128 a[192:195], v1 offset:50432
 v_mfma_f32_16x16x32_bf16 v[192:195], a[204:207], v[108:111], v[192:195]
 v_exp_f32 v35, v167
 v_mfma_f32_16x16x32_bf16 v[188:191], a[204:207], v[76:79], v[188:191]
 ds_read_b128 a[196:199], v1 offset:50464
 v_mfma_f32_16x16x32_bf16 v[188:191], a[200:203], v[72:75], v[188:191]
 s_waitcnt lgkmcnt(4)
 s_add_u32 m0, s73, 0x30
 v_mfma_f32_16x16x32_bf16 v[188:191], a[208:211], v[80:83], v[188:191]
 buffer_load_dwordx4 v3, s[48:51], s75 offen offset:3072 nt lds
 ds_read_b128 a[200:203], v1 offset:50496
 v_mfma_f32_16x16x32_bf16 v[188:191], a[212:215], v[84:87], v[188:191]
 v_exp_f32 v28, v156
 v_mfma_f32_16x16x32_bf16 v[192:195], a[212:215], v[116:119], v[192:195]
 ds_read_b128 a[204:207], v1 offset:50528
 v_mfma_f32_16x16x32_bf16 v[192:195], a[208:211], v[112:115], v[192:195]
 s_waitcnt lgkmcnt(4)
 v_exp_f32 v29, v157
 v_mfma_f32_16x16x32_bf16 v[192:195], a[216:219], v[120:123], v[192:195]
 ds_read_b128 a[208:211], v1 offset:50560
 v_mfma_f32_16x16x32_bf16 v[192:195], a[220:223], v[124:127], v[192:195]
 v_exp_f32 v30, v158
 v_mfma_f32_16x16x32_bf16 v[188:191], a[220:223], v[92:95], v[188:191]
 ds_read_b128 a[212:215], v1 offset:50592
 v_mfma_f32_16x16x32_bf16 v[188:191], a[216:219], v[88:91], v[188:191]
 s_waitcnt lgkmcnt(4)
 s_add_u32 m0, s73, 0x1040
 v_exp_f32 v31, v159
 v_mfma_f32_16x16x32_bf16 v[200:203], a[192:195], v[64:67], v[16:19]
 buffer_load_dwordx4 v4, s[48:51], s75 offen offset:0 nt lds
 ds_read_b128 a[216:219], v1 offset:50624
 v_mfma_f32_16x16x32_bf16 v[200:203], a[196:199], v[68:71], v[200:203]
 v_mfma_f32_16x16x32_bf16 v[204:207], a[196:199], v[100:103], v[20:23]
 ds_read_b128 a[220:223], v1 offset:50656
 v_cvt_pk_bf16_f32 v43, v34, v35
 v_mfma_f32_16x16x32_bf16 v[204:207], a[192:195], v[96:99], v[204:207]
 s_waitcnt lgkmcnt(4)
 v_exp_f32 v32, v168
 v_mfma_f32_16x16x32_bf16 v[204:207], a[200:203], v[104:107], v[204:207]
 ds_read_b128 a[192:195], v1 offset:50944
 v_mfma_f32_16x16x32_bf16 v[204:207], a[204:207], v[108:111], v[204:207]
 v_exp_f32 v33, v169
 v_mfma_f32_16x16x32_bf16 v[200:203], a[204:207], v[76:79], v[200:203]
 s_add_u32 m0, s73, 0x1050
 ds_read_b128 a[196:199], v1 offset:50976
 v_mfma_f32_16x16x32_bf16 v[200:203], a[200:203], v[72:75], v[200:203]
 s_waitcnt lgkmcnt(4)
 buffer_load_dwordx4 v4, s[48:51], s75 offen offset:1024 nt lds
 v_mfma_f32_16x16x32_bf16 v[200:203], a[208:211], v[80:83], v[200:203]
 ds_read_b128 a[200:203], v1 offset:51008
 v_mfma_f32_16x16x32_bf16 v[200:203], a[212:215], v[84:87], v[200:203]
 v_exp_f32 v34, v170
 v_mfma_f32_16x16x32_bf16 v[204:207], a[212:215], v[116:119], v[204:207]
 ds_read_b128 a[204:207], v1 offset:51040
 v_mfma_f32_16x16x32_bf16 v[204:207], a[208:211], v[112:115], v[204:207]
 s_waitcnt lgkmcnt(4)
 v_exp_f32 v35, v171
 v_mfma_f32_16x16x32_bf16 v[204:207], a[216:219], v[120:123], v[204:207]
 ds_read_b128 a[208:211], v1 offset:51072
 v_mfma_f32_16x16x32_bf16 v[204:207], a[220:223], v[124:127], v[204:207]
 v_dot2c_f32_bf16 v11, s79, v40
 v_mfma_f32_16x16x32_bf16 v[200:203], a[220:223], v[92:95], v[200:203]
 s_add_u32 m0, s73, 0x1060
 ds_read_b128 a[212:215], v1 offset:51104
 v_mfma_f32_16x16x32_bf16 v[200:203], a[216:219], v[88:91], v[200:203]
 s_waitcnt lgkmcnt(4)
 buffer_load_dwordx4 v4, s[48:51], s75 offen offset:2048 nt lds
 v_mfma_f32_16x16x32_bf16 v[212:215], a[192:195], v[64:67], v[16:19]
 ds_read_b128 a[216:219], v1 offset:51136
 v_dot2c_f32_bf16 v11, s79, v41
 v_mfma_f32_16x16x32_bf16 v[212:215], a[196:199], v[68:71], v[212:215]
 v_dot2c_f32_bf16 v11, s79, v42
 v_mfma_f32_16x16x32_bf16 v[216:219], a[196:199], v[100:103], v[20:23]
 ds_read_b128 a[220:223], v1 offset:51168
 v_mfma_f32_16x16x32_bf16 v[216:219], a[192:195], v[96:99], v[216:219]
 s_waitcnt lgkmcnt(4)
 v_dot2c_f32_bf16 v11, s79, v43
 v_cvt_pk_bf16_f32 v44, v28, v29
 v_mfma_f32_16x16x32_bf16 v[216:219], a[200:203], v[104:107], v[216:219]
 v_dot2c_f32_bf16 v12, s79, v44
 v_mfma_f32_16x16x32_bf16 v[216:219], a[204:207], v[108:111], v[216:219]
 v_cvt_pk_bf16_f32 v45, v30, v31
 v_mfma_f32_16x16x32_bf16 v[212:215], a[204:207], v[76:79], v[212:215]
 s_add_u32 m0, s73, 0x1070
 v_dot2c_f32_bf16 v12, s79, v45
 v_mfma_f32_16x16x32_bf16 v[212:215], a[200:203], v[72:75], v[212:215]
 s_waitcnt lgkmcnt(2)
 buffer_load_dwordx4 v4, s[48:51], s75 offen offset:3072 nt lds
 v_mfma_f32_16x16x32_bf16 v[212:215], a[208:211], v[80:83], v[212:215]
 v_cvt_pk_bf16_f32 v46, v32, v33
 v_mfma_f32_16x16x32_bf16 v[212:215], a[212:215], v[84:87], v[212:215]
 v_dot2c_f32_bf16 v12, s79, v46
 v_mfma_f32_16x16x32_bf16 v[216:219], a[212:215], v[116:119], v[216:219]
 v_cvt_pk_bf16_f32 v47, v34, v35
 v_dot2c_f32_bf16 v12, s79, v47
 v_mfma_f32_16x16x32_bf16 v[216:219], a[208:211], v[112:115], v[216:219]
 s_waitcnt lgkmcnt(0)
 v_mfma_f32_16x16x32_bf16 v[216:219], a[216:219], v[120:123], v[216:219]
 v_mfma_f32_16x16x32_bf16 v[216:219], a[220:223], v[124:127], v[216:219]
 s_waitcnt vmcnt(16)
 s_barrier
 v_mfma_f32_16x16x32_bf16 v[212:215], a[220:223], v[92:95], v[212:215]
 s_add_u32 s75, s75, 0x8000
 ds_read_b64_tr_b16 a[192:193], v2 offset:0
 v_max_f32 v14, v11, v12
 v_cmp_nge_f32 vcc, s78, v14
 v_mfma_f32_16x16x32_bf16 v[212:215], a[216:219], v[88:91], v[212:215]
 s_waitcnt lgkmcnt(0)
 s_mov_b32 s90, 0
 ds_read_b64_tr_b16 a[194:195], v2 offset:512
 ds_read_b64_tr_b16 a[196:197], v2 offset:16896
 ds_read_b64_tr_b16 a[198:199], v2 offset:17408
 ds_read_b64_tr_b16 a[200:201], v2 offset:32
 ds_read_b64_tr_b16 a[202:203], v2 offset:544
 ds_read_b64_tr_b16 a[204:205], v2 offset:16928
 ds_read_b64_tr_b16 a[206:207], v2 offset:17440
 ds_read_b64_tr_b16 a[208:209], v2 offset:64
 ds_read_b64_tr_b16 a[210:211], v2 offset:576
 ds_read_b64_tr_b16 a[212:213], v2 offset:16960
 ds_read_b64_tr_b16 a[214:215], v2 offset:17472
 s_cbranch_vccnz L1_RARE0_W3
L1_BACK0_W3:
 s_waitcnt lgkmcnt(8)
 v_mfma_f32_16x16x32_bf16 a[0:3], a[192:195], v[52:55], 0
 s_add_u32 m0, s73, 0x8400
 ds_read_b64_tr_b16 a[216:217], v2 offset:96
 v_add_f32 v8, v8, v11
 v_mfma_f32_16x16x32_bf16 a[0:3], a[196:199], v[40:43], a[0:3]
 buffer_load_dwordx4 v3, s[48:51], s75 offen offset:0 nt lds
 ds_read_b64_tr_b16 a[218:219], v2 offset:608
 v_mfma_f32_16x16x32_bf16 a[4:7], a[196:199], v[44:47], 0
 ds_read_b64_tr_b16 a[220:221], v2 offset:16992
 v_mfma_f32_16x16x32_bf16 a[4:7], a[192:195], v[56:59], a[4:7]
 s_waitcnt lgkmcnt(7)
 ds_read_b64_tr_b16 a[222:223], v2 offset:17504
 v_add_f32 v9, v9, v12
 v_mfma_f32_16x16x32_bf16 a[16:19], a[200:203], v[56:59], 0
 ds_read_b64_tr_b16 a[192:193], v2 offset:128
 v_mfma_f32_16x16x32_bf16 a[16:19], a[204:207], v[44:47], a[16:19]
 ds_read_b64_tr_b16 a[194:195], v2 offset:640
 v_mfma_f32_16x16x32_bf16 a[12:15], a[204:207], v[40:43], 0
 ds_read_b64_tr_b16 a[196:197], v2 offset:17024
 v_mfma_f32_16x16x32_bf16 a[12:15], a[200:203], v[52:55], a[12:15]
 s_waitcnt lgkmcnt(7)
 s_add_u32 m0, s73, 0x8410
 ds_read_b64_tr_b16 a[198:199], v2 offset:17536
 v_mfma_f32_16x16x32_bf16 a[24:27], a[208:211], v[52:55], 0
 buffer_load_dwordx4 v3, s[48:51], s75 offen offset:1024 nt lds
 ds_read_b64_tr_b16 a[200:201], v2 offset:160
 v_mfma_f32_16x16x32_bf16 a[24:27], a[212:215], v[40:43], a[24:27]
 ds_read_b64_tr_b16 a[202:203], v2 offset:672
 v_mfma_f32_16x16x32_bf16 a[28:31], a[212:215], v[44:47], 0
 ds_read_b64_tr_b16 a[204:205], v2 offset:17056
 v_mfma_f32_16x16x32_bf16 a[28:31], a[208:211], v[56:59], a[28:31]
 s_waitcnt lgkmcnt(7)
 ds_read_b64_tr_b16 a[206:207], v2 offset:17568
 v_mfma_f32_16x16x32_bf16 a[40:43], a[216:219], v[56:59], 0
 ds_read_b64_tr_b16 a[208:209], v2 offset:192
 v_mfma_f32_16x16x32_bf16 a[40:43], a[220:223], v[44:47], a[40:43]
 ds_read_b64_tr_b16 a[210:211], v2 offset:704
 v_mfma_f32_16x16x32_bf16 a[36:39], a[220:223], v[40:43], 0
 ds_read_b64_tr_b16 a[212:213], v2 offset:17088
 v_mfma_f32_16x16x32_bf16 a[36:39], a[216:219], v[52:55], a[36:39]
 s_waitcnt lgkmcnt(7)
 s_add_u32 m0, s73, 0x8420
 ds_read_b64_tr_b16 a[214:215], v2 offset:17600
 v_mfma_f32_16x16x32_bf16 a[48:51], a[192:195], v[52:55], 0
 buffer_load_dwordx4 v3, s[48:51], s75 offen offset:2048 nt lds
 ds_read_b64_tr_b16 a[216:217], v2 offset:224
 v_mfma_f32_16x16x32_bf16 a[48:51], a[196:199], v[40:43], a[48:51]
 ds_read_b64_tr_b16 a[218:219], v2 offset:736
 v_mfma_f32_16x16x32_bf16 a[52:55], a[196:199], v[44:47], 0
 ds_read_b64_tr_b16 a[220:221], v2 offset:17120
 v_mfma_f32_16x16x32_bf16 a[52:55], a[192:195], v[56:59], a[52:55]
 s_waitcnt lgkmcnt(7)
 ds_read_b64_tr_b16 a[222:223], v2 offset:17632
 v_mfma_f32_16x16x32_bf16 a[64:67], a[200:203], v[56:59], 0
 ds_read_b64_tr_b16 a[192:193], v2 offset:256
 v_mfma_f32_16x16x32_bf16 a[64:67], a[204:207], v[44:47], a[64:67]
 ds_read_b64_tr_b16 a[194:195], v2 offset:768
 v_mfma_f32_16x16x32_bf16 a[60:63], a[204:207], v[40:43], 0
 ds_read_b64_tr_b16 a[196:197], v2 offset:17152
 v_mfma_f32_16x16x32_bf16 a[60:63], a[200:203], v[52:55], a[60:63]
 s_waitcnt lgkmcnt(7)
 s_add_u32 m0, s73, 0x8430
 ds_read_b64_tr_b16 a[198:199], v2 offset:17664
 v_mfma_f32_16x16x32_bf16 a[72:75], a[208:211], v[52:55], 0
 buffer_load_dwordx4 v3, s[48:51], s75 offen offset:3072 nt lds
 ds_read_b64_tr_b16 a[200:201], v2 offset:288
 v_mfma_f32_16x16x32_bf16 a[72:75], a[212:215], v[40:43], a[72:75]
 ds_read_b64_tr_b16 a[202:203], v2 offset:800
 v_exp_f32 v28, v176
 v_mfma_f32_16x16x32_bf16 a[76:79], a[212:215], v[44:47], 0
 ds_read_b64_tr_b16 a[204:205], v2 offset:17184
 v_mfma_f32_16x16x32_bf16 a[76:79], a[208:211], v[56:59], a[76:79]
 s_waitcnt lgkmcnt(7)
 ds_read_b64_tr_b16 a[206:207], v2 offset:17696
 v_mfma_f32_16x16x32_bf16 a[88:91], a[216:219], v[56:59], 0
 ds_read_b64_tr_b16 a[208:209], v2 offset:320
 v_mfma_f32_16x16x32_bf16 a[88:91], a[220:223], v[44:47], a[88:91]
 ds_read_b64_tr_b16 a[210:211], v2 offset:832
 v_exp_f32 v29, v177
 v_mfma_f32_16x16x32_bf16 a[84:87], a[220:223], v[40:43], 0
 ds_read_b64_tr_b16 a[212:213], v2 offset:17216
 v_cvt_pk_bf16_f32 v224, v28, v29
 v_mfma_f32_16x16x32_bf16 a[84:87], a[216:219], v[52:55], a[84:87]
 s_waitcnt lgkmcnt(7)
 s_add_u32 m0, s73, 0x9440
 ds_read_b64_tr_b16 a[214:215], v2 offset:17728
 v_dot2_f32_bf16 v11, v224, s79, 0
 v_mfma_f32_16x16x32_bf16 a[96:99], a[192:195], v[52:55], 0
 buffer_load_dwordx4 v4, s[48:51], s75 offen offset:0 nt lds
 ds_read_b64_tr_b16 a[216:217], v2 offset:352
 v_mfma_f32_16x16x32_bf16 a[96:99], a[196:199], v[40:43], a[96:99]
 ds_read_b64_tr_b16 a[218:219], v2 offset:864
 v_exp_f32 v28, v180
 v_mfma_f32_16x16x32_bf16 a[100:103], a[196:199], v[44:47], 0
 ds_read_b64_tr_b16 a[220:221], v2 offset:17248
 v_mfma_f32_16x16x32_bf16 a[100:103], a[192:195], v[56:59], a[100:103]
 s_waitcnt lgkmcnt(7)
 ds_read_b64_tr_b16 a[222:223], v2 offset:17760
 v_mfma_f32_16x16x32_bf16 a[112:115], a[200:203], v[56:59], 0
 ds_read_b64_tr_b16 a[192:193], v2 offset:384
 v_exp_f32 v29, v181
 v_mfma_f32_16x16x32_bf16 a[112:115], a[204:207], v[44:47], a[112:115]
 ds_read_b64_tr_b16 a[194:195], v2 offset:896
 v_cvt_pk_bf16_f32 v228, v28, v29
 v_mfma_f32_16x16x32_bf16 a[108:111], a[204:207], v[40:43], 0
 s_add_u32 m0, s73, 0x9450
 ds_read_b64_tr_b16 a[196:197], v2 offset:17280
 v_dot2_f32_bf16 v12, v228, s79, 0
 v_mfma_f32_16x16x32_bf16 a[108:111], a[200:203], v[52:55], a[108:111]
 s_waitcnt lgkmcnt(7)
 buffer_load_dwordx4 v4, s[48:51], s75 offen offset:1024 nt lds
 ds_read_b64_tr_b16 a[198:199], v2 offset:17792
 v_mfma_f32_16x16x32_bf16 a[120:123], a[208:211], v[52:55], 0
 ds_read_b64_tr_b16 a[200:201], v2 offset:416
 v_mfma_f32_16x16x32_bf16 a[120:123], a[212:215], v[40:43], a[120:123]
 ds_read_b64_tr_b16 a[202:203], v2 offset:928
 v_mfma_f32_16x16x32_bf16 a[124:127], a[212:215], v[44:47], 0
 ds_read_b64_tr_b16 a[204:205], v2 offset:17312
 v_exp_f32 v30, v178
 v_mfma_f32_16x16x32_bf16 a[124:127], a[208:211], v[56:59], a[124:127]
 s_waitcnt lgkmcnt(7)
 ds_read_b64_tr_b16 a[206:207], v2 offset:17824
 v_mfma_f32_16x16x32_bf16 a[136:139], a[216:219], v[56:59], 0
 ds_read_b64_tr_b16 a[208:209], v2 offset:448
 v_exp_f32 v31, v179
 v_mfma_f32_16x16x32_bf16 a[136:139], a[220:223], v[44:47], a[136:139]
 ds_read_b64_tr_b16 a[210:211], v2 offset:960
 v_cvt_pk_bf16_f32 v225, v30, v31
 v_mfma_f32_16x16x32_bf16 a[132:135], a[220:223], v[40:43], 0
 s_add_u32 m0, s73, 0x9460
 ds_read_b64_tr_b16 a[212:213], v2 offset:17344
 v_exp_f32 v32, v188
 v_mfma_f32_16x16x32_bf16 a[132:135], a[216:219], v[52:55], a[132:135]
 s_waitcnt lgkmcnt(7)
 buffer_load_dwordx4 v4, s[48:51], s75 offen offset:2048 nt lds
 ds_read_b64_tr_b16 a[214:215], v2 offset:17856
 v_dot2c_f32_bf16 v11, s79, v225
 v_mfma_f32_16x16x32_bf16 a[144:147], a[192:195], v[52:55], 0
 ds_read_b64_tr_b16 a[216:217], v2 offset:480
 v_mfma_f32_16x16x32_bf16 a[144:147], a[196:199], v[40:43], a[144:147]
 ds_read_b64_tr_b16 a[218:219], v2 offset:992
 v_exp_f32 v33, v189
 v_mfma_f32_16x16x32_bf16 a[148:151], a[196:199], v[44:47], 0
 ds_read_b64_tr_b16 a[220:221], v2 offset:17376
 v_cvt_pk_bf16_f32 v226, v32, v33
 v_mfma_f32_16x16x32_bf16 a[148:151], a[192:195], v[56:59], a[148:151]
 s_waitcnt lgkmcnt(7)
 ds_read_b64_tr_b16 a[222:223], v2 offset:17888
 v_exp_f32 v34, v190
 v_mfma_f32_16x16x32_bf16 a[160:163], a[200:203], v[56:59], 0
 v_exp_f32 v35, v191
 v_mfma_f32_16x16x32_bf16 a[160:163], a[204:207], v[44:47], a[160:163]
 v_exp_f32 v30, v182
 v_cvt_pk_bf16_f32 v227, v34, v35
 v_mfma_f32_16x16x32_bf16 a[156:159], a[204:207], v[40:43], 0
 s_add_u32 m0, s73, 0x9470
 v_exp_f32 v31, v183
 v_mfma_f32_16x16x32_bf16 a[156:159], a[200:203], v[52:55], a[156:159]
 s_waitcnt lgkmcnt(4)
 buffer_load_dwordx4 v4, s[48:51], s75 offen offset:3072 nt lds
 v_dot2c_f32_bf16 v11, s79, v226
 v_mfma_f32_16x16x32_bf16 a[168:171], a[208:211], v[52:55], 0
 v_exp_f32 v32, v192
 v_mfma_f32_16x16x32_bf16 a[168:171], a[212:215], v[40:43], a[168:171]
 v_exp_f32 v33, v193
 v_dot2c_f32_bf16 v11, s79, v227
 v_mfma_f32_16x16x32_bf16 a[172:175], a[212:215], v[44:47], 0
 v_exp_f32 v34, v194
 v_cvt_pk_bf16_f32 v229, v30, v31
 v_mfma_f32_16x16x32_bf16 a[172:175], a[208:211], v[56:59], a[172:175]
 s_waitcnt lgkmcnt(0)
 v_exp_f32 v35, v195
 v_mfma_f32_16x16x32_bf16 a[184:187], a[216:219], v[56:59], 0
 v_dot2c_f32_bf16 v12, s79, v229
 v_cvt_pk_bf16_f32 v230, v32, v33
 v_dot2c_f32_bf16 v12, s79, v230
 v_mfma_f32_16x16x32_bf16 a[184:187], a[220:223], v[44:47], a[184:187]
 s_waitcnt vmcnt(8)
 s_barrier
 v_mfma_f32_16x16x32_bf16 a[180:183], a[220:223], v[40:43], 0
 s_add_u32 s75, s75, 0x8000
 ds_read_b128 a[192:195], v1 offset:0
 v_cvt_pk_bf16_f32 v231, v34, v35
 v_mfma_f32_16x16x32_bf16 a[180:183], a[216:219], v[52:55], a[180:183]
 s_waitcnt lgkmcnt(0)
 s_mov_b32 s77, 14
 ds_read_b128 a[196:199], v1 offset:32
 ds_read_b128 a[200:203], v1 offset:64
 ds_read_b128 a[204:207], v1 offset:96
 ds_read_b128 a[208:211], v1 offset:128
 ds_read_b128 a[212:215], v1 offset:160
 v_dot2c_f32_bf16 v12, s79, v231
.p2align 6
L1_LOOP_W3:
 s_waitcnt lgkmcnt(4)
 v_mfma_f32_16x16x32_bf16 v[128:131], a[192:195], v[64:67], v[16:19]
 s_add_u32 m0, s74, 0x10800
 ds_read_b128 a[216:219], v1 offset:192
 v_mfma_f32_16x16x32_bf16 v[128:131], a[196:199], v[68:71], v[128:131]
 buffer_load_dwordx4 v3, s[52:55], s76 offen offset:0 nt lds
 v_mfma_f32_16x16x32_bf16 v[132:135], a[196:199], v[100:103], v[20:23]
 ds_read_b128 a[220:223], v1 offset:224
 v_mfma_f32_16x16x32_bf16 v[132:135], a[192:195], v[96:99], v[132:135]
 s_waitcnt lgkmcnt(4)
 v_exp_f32 v28, v200
 v_mfma_f32_16x16x32_bf16 v[132:135], a[200:203], v[104:107], v[132:135]
 ds_read_b128 a[192:195], v1 offset:512
 v_mfma_f32_16x16x32_bf16 v[132:135], a[204:207], v[108:111], v[132:135]
 v_exp_f32 v29, v201
 v_mfma_f32_16x16x32_bf16 v[128:131], a[204:207], v[76:79], v[128:131]
 ds_read_b128 a[196:199], v1 offset:544
 v_cvt_pk_bf16_f32 v40, v28, v29
 v_mfma_f32_16x16x32_bf16 v[128:131], a[200:203], v[72:75], v[128:131]
 s_waitcnt lgkmcnt(4)
 s_add_u32 m0, s74, 0x10820
 v_exp_f32 v30, v202
 v_mfma_f32_16x16x32_bf16 v[128:131], a[208:211], v[80:83], v[128:131]
 buffer_load_dwordx4 v3, s[52:55], s76 offen offset:1024 nt lds
 ds_read_b128 a[200:203], v1 offset:576
 v_mfma_f32_16x16x32_bf16 v[128:131], a[212:215], v[84:87], v[128:131]
 v_mfma_f32_16x16x32_bf16 v[132:135], a[212:215], v[116:119], v[132:135]
 ds_read_b128 a[204:207], v1 offset:608
 v_mfma_f32_16x16x32_bf16 v[132:135], a[208:211], v[112:115], v[132:135]
 s_waitcnt lgkmcnt(4)
 v_exp_f32 v31, v203
 v_mfma_f32_16x16x32_bf16 v[132:135], a[216:219], v[120:123], v[132:135]
 ds_read_b128 a[208:211], v1 offset:640
 v_cvt_pk_bf16_f32 v41, v30, v31
 v_mfma_f32_16x16x32_bf16 v[132:135], a[220:223], v[124:127], v[132:135]
 v_exp_f32 v32, v212
 v_mfma_f32_16x16x32_bf16 v[128:131], a[220:223], v[92:95], v[128:131]
 ds_read_b128 a[212:215], v1 offset:672
 v_mfma_f32_16x16x32_bf16 v[128:131], a[216:219], v[88:91], v[128:131]
 s_waitcnt lgkmcnt(4)
 s_add_u32 m0, s74, 0x10840
 v_exp_f32 v33, v213
 v_mfma_f32_16x16x32_bf16 v[140:143], a[192:195], v[64:67], v[16:19]
 buffer_load_dwordx4 v3, s[52:55], s76 offen offset:2048 nt lds
 ds_read_b128 a[216:219], v1 offset:704
 v_mfma_f32_16x16x32_bf16 v[140:143], a[196:199], v[68:71], v[140:143]
 v_mfma_f32_16x16x32_bf16 v[144:147], a[196:199], v[100:103], v[20:23]
 ds_read_b128 a[220:223], v1 offset:736
 v_cvt_pk_bf16_f32 v42, v32, v33
 v_mfma_f32_16x16x32_bf16 v[144:147], a[192:195], v[96:99], v[144:147]
 s_waitcnt lgkmcnt(4)
 v_exp_f32 v34, v214
 v_mfma_f32_16x16x32_bf16 v[144:147], a[200:203], v[104:107], v[144:147]
 ds_read_b128 a[192:195], v1 offset:16640
 v_mfma_f32_16x16x32_bf16 v[144:147], a[204:207], v[108:111], v[144:147]
 v_exp_f32 v35, v215
 v_mfma_f32_16x16x32_bf16 v[140:143], a[204:207], v[76:79], v[140:143]
 ds_read_b128 a[196:199], v1 offset:16672
 v_mfma_f32_16x16x32_bf16 v[140:143], a[200:203], v[72:75], v[140:143]
 s_waitcnt lgkmcnt(4)
 s_add_u32 m0, s74, 0x10860
 v_mfma_f32_16x16x32_bf16 v[140:143], a[208:211], v[80:83], v[140:143]
 buffer_load_dwordx4 v3, s[52:55], s76 offen offset:3072 nt lds
 ds_read_b128 a[200:203], v1 offset:16704
 v_mfma_f32_16x16x32_bf16 v[140:143], a[212:215], v[84:87], v[140:143]
 v_exp_f32 v28, v204
 v_mfma_f32_16x16x32_bf16 v[144:147], a[212:215], v[116:119], v[144:147]
 ds_read_b128 a[204:207], v1 offset:16736
 v_mfma_f32_16x16x32_bf16 v[144:147], a[208:211], v[112:115], v[144:147]
 s_waitcnt lgkmcnt(4)
 v_exp_f32 v29, v205
 v_mfma_f32_16x16x32_bf16 v[144:147], a[216:219], v[120:123], v[144:147]
 ds_read_b128 a[208:211], v1 offset:16768
 v_mfma_f32_16x16x32_bf16 v[144:147], a[220:223], v[124:127], v[144:147]
 v_exp_f32 v30, v206
 v_mfma_f32_16x16x32_bf16 v[140:143], a[220:223], v[92:95], v[140:143]
 ds_read_b128 a[212:215], v1 offset:16800
 v_mfma_f32_16x16x32_bf16 v[140:143], a[216:219], v[88:91], v[140:143]
 s_waitcnt lgkmcnt(4)
 s_add_u32 m0, s74, 0x11880
 v_exp_f32 v31, v207
 v_mfma_f32_16x16x32_bf16 v[152:155], a[192:195], v[64:67], v[16:19]
 buffer_load_dwordx4 v4, s[52:55], s76 offen offset:0 nt lds
 ds_read_b128 a[216:219], v1 offset:16832
 v_mfma_f32_16x16x32_bf16 v[152:155], a[196:199], v[68:71], v[152:155]
 v_mfma_f32_16x16x32_bf16 v[156:159], a[196:199], v[100:103], v[20:23]
 ds_read_b128 a[220:223], v1 offset:16864
 v_cvt_pk_bf16_f32 v43, v34, v35
 v_mfma_f32_16x16x32_bf16 v[156:159], a[192:195], v[96:99], v[156:159]
 s_waitcnt lgkmcnt(4)
 v_exp_f32 v32, v216
 v_mfma_f32_16x16x32_bf16 v[156:159], a[200:203], v[104:107], v[156:159]
 ds_read_b128 a[192:195], v1 offset:17152
 v_mfma_f32_16x16x32_bf16 v[156:159], a[204:207], v[108:111], v[156:159]
 v_exp_f32 v33, v217
 v_mfma_f32_16x16x32_bf16 v[152:155], a[204:207], v[76:79], v[152:155]
 s_add_u32 m0, s74, 0x118a0
 ds_read_b128 a[196:199], v1 offset:17184
 v_mfma_f32_16x16x32_bf16 v[152:155], a[200:203], v[72:75], v[152:155]
 s_waitcnt lgkmcnt(4)
 buffer_load_dwordx4 v4, s[52:55], s76 offen offset:1024 nt lds
 v_mfma_f32_16x16x32_bf16 v[152:155], a[208:211], v[80:83], v[152:155]
 ds_read_b128 a[200:203], v1 offset:17216
 v_mfma_f32_16x16x32_bf16 v[152:155], a[212:215], v[84:87], v[152:155]
 v_exp_f32 v34, v218
 v_mfma_f32_16x16x32_bf16 v[156:159], a[212:215], v[116:119], v[156:159]
 ds_read_b128 a[204:207], v1 offset:17248
 v_mfma_f32_16x16x32_bf16 v[156:159], a[208:211], v[112:115], v[156:159]
 s_waitcnt lgkmcnt(4)
 v_exp_f32 v35, v219
 v_mfma_f32_16x16x32_bf16 v[156:159], a[216:219], v[120:123], v[156:159]
 ds_read_b128 a[208:211], v1 offset:17280
 v_mfma_f32_16x16x32_bf16 v[156:159], a[220:223], v[124:127], v[156:159]
 v_dot2c_f32_bf16 v11, s79, v40
 v_mfma_f32_16x16x32_bf16 v[152:155], a[220:223], v[92:95], v[152:155]
 s_add_u32 m0, s74, 0x118c0
 ds_read_b128 a[212:215], v1 offset:17312
 v_mfma_f32_16x16x32_bf16 v[152:155], a[216:219], v[88:91], v[152:155]
 s_waitcnt lgkmcnt(4)
 buffer_load_dwordx4 v4, s[52:55], s76 offen offset:2048 nt lds
 v_mfma_f32_16x16x32_bf16 v[164:167], a[192:195], v[64:67], v[16:19]
 ds_read_b128 a[216:219], v1 offset:17344
 v_dot2c_f32_bf16 v11, s79, v41
 v_mfma_f32_16x16x32_bf16 v[164:167], a[196:199], v[68:71], v[164:167]
 v_dot2c_f32_bf16 v11, s79, v42
 v_mfma_f32_16x16x32_bf16 v[168:171], a[196:199], v[100:103], v[20:23]
 ds_read_b128 a[220:223], v1 offset:17376
 v_mfma_f32_16x16x32_bf16 v[168:171], a[192:195], v[96:99], v[168:171]
 s_waitcnt lgkmcnt(4)
 v_dot2c_f32_bf16 v11, s79, v43
 v_cvt_pk_bf16_f32 v44, v28, v29
 v_mfma_f32_16x16x32_bf16 v[168:171], a[200:203], v[104:107], v[168:171]
 v_dot2c_f32_bf16 v12, s79, v44
 v_mfma_f32_16x16x32_bf16 v[168:171], a[204:207], v[108:111], v[168:171]
 v_cvt_pk_bf16_f32 v45, v30, v31
 v_mfma_f32_16x16x32_bf16 v[164:167], a[204:207], v[76:79], v[164:167]
 s_add_u32 m0, s74, 0x118e0
 v_dot2c_f32_bf16 v12, s79, v45
 v_mfma_f32_16x16x32_bf16 v[164:167], a[200:203], v[72:75], v[164:167]
 s_waitcnt lgkmcnt(2)
 buffer_load_dwordx4 v4, s[52:55], s76 offen offset:3072 nt lds
 v_mfma_f32_16x16x32_bf16 v[164:167], a[208:211], v[80:83], v[164:167]
 v_cvt_pk_bf16_f32 v46, v32, v33
 v_mfma_f32_16x16x32_bf16 v[164:167], a[212:215], v[84:87], v[164:167]
 v_dot2c_f32_bf16 v12, s79, v46
 v_mfma_f32_16x16x32_bf16 v[168:171], a[212:215], v[116:119], v[168:171]
 v_cvt_pk_bf16_f32 v47, v34, v35
 v_dot2c_f32_bf16 v12, s79, v47
 v_mfma_f32_16x16x32_bf16 v[168:171], a[208:211], v[112:115], v[168:171]
 s_waitcnt lgkmcnt(0)
 v_mfma_f32_16x16x32_bf16 v[168:171], a[216:219], v[120:123], v[168:171]
 v_mfma_f32_16x16x32_bf16 v[168:171], a[220:223], v[124:127], v[168:171]
 s_waitcnt vmcnt(16)
 s_barrier
 s_mov_b64 exec, 0
 s_cmp_eq_u32 s77, 12
 s_cbranch_scc1 L1_PAD8
 s_cmp_eq_u32 s77, 11
 s_cbranch_scc1 L1_PAD9
 s_cmp_eq_u32 s77, 10
 s_cbranch_scc1 L1_PAD10
 s_cmp_eq_u32 s77, 9
 s_cbranch_scc1 L1_PAD11
 s_cmp_eq_u32 s77, 8
 s_cbranch_scc1 L1_PAD12
 s_cmp_eq_u32 s77, 7
 s_cbranch_scc1 L1_PAD13
L1_PRL0:
 s_mov_b64 exec, -1
 v_mfma_f32_16x16x32_bf16 v[164:167], a[220:223], v[92:95], v[164:167]
 s_add_u32 s76, s76, 0x8000
 ds_read_b64_tr_b16 a[192:193], v2 offset:33792
 v_max_f32 v14, v11, v12
 v_cmp_nge_f32 vcc, s78, v14
 v_mfma_f32_16x16x32_bf16 v[164:167], a[216:219], v[88:91], v[164:167]
 s_waitcnt lgkmcnt(0)
 s_mov_b32 s90, 1
 ds_read_b64_tr_b16 a[194:195], v2 offset:34304
 ds_read_b64_tr_b16 a[196:197], v2 offset:50688
 ds_read_b64_tr_b16 a[198:199], v2 offset:51200
 ds_read_b64_tr_b16 a[200:201], v2 offset:33824
 ds_read_b64_tr_b16 a[202:203], v2 offset:34336
 ds_read_b64_tr_b16 a[204:205], v2 offset:50720
 ds_read_b64_tr_b16 a[206:207], v2 offset:51232
 ds_read_b64_tr_b16 a[208:209], v2 offset:33856
 ds_read_b64_tr_b16 a[210:211], v2 offset:34368
 ds_read_b64_tr_b16 a[212:213], v2 offset:50752
 ds_read_b64_tr_b16 a[214:215], v2 offset:51264
 s_cbranch_vccnz L1_RARE1_W3
L1_BACK1_W3:
 s_waitcnt lgkmcnt(8)
 v_mfma_f32_16x16x32_bf16 a[0:3], a[192:195], v[224:227], a[0:3]
 s_add_u32 m0, s73, 0x0
 ds_read_b64_tr_b16 a[216:217], v2 offset:33888
 v_add_f32 v8, v8, v11
 v_mfma_f32_16x16x32_bf16 a[0:3], a[196:199], v[40:43], a[0:3]
 buffer_load_dwordx4 v3, s[48:51], s75 offen offset:0 nt lds
 ds_read_b64_tr_b16 a[218:219], v2 offset:34400
 v_mfma_f32_16x16x32_bf16 a[4:7], a[196:199], v[44:47], a[4:7]
 ds_read_b64_tr_b16 a[220:221], v2 offset:50784
 v_mfma_f32_16x16x32_bf16 a[4:7], a[192:195], v[228:231], a[4:7]
 s_waitcnt lgkmcnt(7)
 ds_read_b64_tr_b16 a[222:223], v2 offset:51296
 v_add_f32 v9, v9, v12
 v_mfma_f32_16x16x32_bf16 a[16:19], a[200:203], v[228:231], a[16:19]
 ds_read_b64_tr_b16 a[192:193], v2 offset:33920
 v_mfma_f32_16x16x32_bf16 a[16:19], a[204:207], v[44:47], a[16:19]
 ds_read_b64_tr_b16 a[194:195], v2 offset:34432
 v_mfma_f32_16x16x32_bf16 a[12:15], a[204:207], v[40:43], a[12:15]
 ds_read_b64_tr_b16 a[196:197], v2 offset:50816
 v_mfma_f32_16x16x32_bf16 a[12:15], a[200:203], v[224:227], a[12:15]
 s_waitcnt lgkmcnt(7)
 s_add_u32 m0, s73, 0x10
 ds_read_b64_tr_b16 a[198:199], v2 offset:51328
 v_mfma_f32_16x16x32_bf16 a[24:27], a[208:211], v[224:227], a[24:27]
 buffer_load_dwordx4 v3, s[48:51], s75 offen offset:1024 nt lds
 ds_read_b64_tr_b16 a[200:201], v2 offset:33952
 v_mfma_f32_16x16x32_bf16 a[24:27], a[212:215], v[40:43], a[24:27]
 ds_read_b64_tr_b16 a[202:203], v2 offset:34464
 v_mfma_f32_16x16x32_bf16 a[28:31], a[212:215], v[44:47], a[28:31]
 ds_read_b64_tr_b16 a[204:205], v2 offset:50848
 v_mfma_f32_16x16x32_bf16 a[28:31], a[208:211], v[228:231], a[28:31]
 s_waitcnt lgkmcnt(7)
 ds_read_b64_tr_b16 a[206:207], v2 offset:51360
 v_mfma_f32_16x16x32_bf16 a[40:43], a[216:219], v[228:231], a[40:43]
 ds_read_b64_tr_b16 a[208:209], v2 offset:33984
 v_mfma_f32_16x16x32_bf16 a[40:43], a[220:223], v[44:47], a[40:43]
 ds_read_b64_tr_b16 a[210:211], v2 offset:34496
 v_mfma_f32_16x16x32_bf16 a[36:39], a[220:223], v[40:43], a[36:39]
 ds_read_b64_tr_b16 a[212:213], v2 offset:50880
 v_mfma_f32_16x16x32_bf16 a[36:39], a[216:219], v[224:227], a[36:39]
 s_waitcnt lgkmcnt(7)
 s_add_u32 m0, s73, 0x20
 ds_read_b64_tr_b16 a[214:215], v2 offset:51392
 v_mfma_f32_16x16x32_bf16 a[48:51], a[192:195], v[224:227], a[48:51]
 buffer_load_dwordx4 v3, s[48:51], s75 offen offset:2048 nt lds
 ds_read_b64_tr_b16 a[216:217], v2 offset:34016
 v_mfma_f32_16x16x32_bf16 a[48:51], a[196:199], v[40:43], a[48:51]
 ds_read_b64_tr_b16 a[218:219], v2 offset:34528
 v_mfma_f32_16x16x32_bf16 a[52:55], a[196:199], v[44:47], a[52:55]
 ds_read_b64_tr_b16 a[220:221], v2 offset:50912
 v_mfma_f32_16x16x32_bf16 a[52:55], a[192:195], v[228:231], a[52:55]
 s_waitcnt lgkmcnt(7)
 ds_read_b64_tr_b16 a[222:223], v2 offset:51424
 v_mfma_f32_16x16x32_bf16 a[64:67], a[200:203], v[228:231], a[64:67]
 ds_read_b64_tr_b16 a[192:193], v2 offset:34048
 v_mfma_f32_16x16x32_bf16 a[64:67], a[204:207], v[44:47], a[64:67]
 ds_read_b64_tr_b16 a[194:195], v2 offset:34560
 v_mfma_f32_16x16x32_bf16 a[60:63], a[204:207], v[40:43], a[60:63]
 ds_read_b64_tr_b16 a[196:197], v2 offset:50944
 v_mfma_f32_16x16x32_bf16 a[60:63], a[200:203], v[224:227], a[60:63]
 s_waitcnt lgkmcnt(7)
 s_add_u32 m0, s73, 0x30
 ds_read_b64_tr_b16 a[198:199], v2 offset:51456
 v_mfma_f32_16x16x32_bf16 a[72:75], a[208:211], v[224:227], a[72:75]
 buffer_load_dwordx4 v3, s[48:51], s75 offen offset:3072 nt lds
 ds_read_b64_tr_b16 a[200:201], v2 offset:34080
 v_mfma_f32_16x16x32_bf16 a[72:75], a[212:215], v[40:43], a[72:75]
 ds_read_b64_tr_b16 a[202:203], v2 offset:34592
 v_exp_f32 v28, v128
 v_mfma_f32_16x16x32_bf16 a[76:79], a[212:215], v[44:47], a[76:79]
 ds_read_b64_tr_b16 a[204:205], v2 offset:50976
 v_mfma_f32_16x16x32_bf16 a[76:79], a[208:211], v[228:231], a[76:79]
 s_waitcnt lgkmcnt(7)
 ds_read_b64_tr_b16 a[206:207], v2 offset:51488
 v_mfma_f32_16x16x32_bf16 a[88:91], a[216:219], v[228:231], a[88:91]
 ds_read_b64_tr_b16 a[208:209], v2 offset:34112
 v_mfma_f32_16x16x32_bf16 a[88:91], a[220:223], v[44:47], a[88:91]
 ds_read_b64_tr_b16 a[210:211], v2 offset:34624
 v_exp_f32 v29, v129
 v_mfma_f32_16x16x32_bf16 a[84:87], a[220:223], v[40:43], a[84:87]
 ds_read_b64_tr_b16 a[212:213], v2 offset:51008
 v_cvt_pk_bf16_f32 v52, v28, v29
 v_mfma_f32_16x16x32_bf16 a[84:87], a[216:219], v[224:227], a[84:87]
 s_waitcnt lgkmcnt(7)
 s_add_u32 m0, s73, 0x1040
 ds_read_b64_tr_b16 a[214:215], v2 offset:51520
 v_dot2_f32_bf16 v11, v52, s79, 0
 v_mfma_f32_16x16x32_bf16 a[96:99], a[192:195], v[224:227], a[96:99]
 buffer_load_dwordx4 v4, s[48:51], s75 offen offset:0 nt lds
 ds_read_b64_tr_b16 a[216:217], v2 offset:34144
 v_mfma_f32_16x16x32_bf16 a[96:99], a[196:199], v[40:43], a[96:99]
 ds_read_b64_tr_b16 a[218:219], v2 offset:34656
 v_exp_f32 v28, v132
 v_mfma_f32_16x16x32_bf16 a[100:103], a[196:199], v[44:47], a[100:103]
 ds_read_b64_tr_b16 a[220:221], v2 offset:51040
 v_mfma_f32_16x16x32_bf16 a[100:103], a[192:195], v[228:231], a[100:103]
 s_waitcnt lgkmcnt(7)
 ds_read_b64_tr_b16 a[222:223], v2 offset:51552
 v_mfma_f32_16x16x32_bf16 a[112:115], a[200:203], v[228:231], a[112:115]
 ds_read_b64_tr_b16 a[192:193], v2 offset:34176
 v_exp_f32 v29, v133
 v_mfma_f32_16x16x32_bf16 a[112:115], a[204:207], v[44:47], a[112:115]
 ds_read_b64_tr_b16 a[194:195], v2 offset:34688
 v_cvt_pk_bf16_f32 v56, v28, v29
 v_mfma_f32_16x16x32_bf16 a[108:111], a[204:207], v[40:43], a[108:111]
 s_add_u32 m0, s73, 0x1050
 ds_read_b64_tr_b16 a[196:197], v2 offset:51072
 v_dot2_f32_bf16 v12, v56, s79, 0
 v_mfma_f32_16x16x32_bf16 a[108:111], a[200:203], v[224:227], a[108:111]
 s_waitcnt lgkmcnt(7)
 buffer_load_dwordx4 v4, s[48:51], s75 offen offset:1024 nt lds
 ds_read_b64_tr_b16 a[198:199], v2 offset:51584
 v_mfma_f32_16x16x32_bf16 a[120:123], a[208:211], v[224:227], a[120:123]
 ds_read_b64_tr_b16 a[200:201], v2 offset:34208
 v_mfma_f32_16x16x32_bf16 a[120:123], a[212:215], v[40:43], a[120:123]
 ds_read_b64_tr_b16 a[202:203], v2 offset:34720
 v_mfma_f32_16x16x32_bf16 a[124:127], a[212:215], v[44:47], a[124:127]
 ds_read_b64_tr_b16 a[204:205], v2 offset:51104
 v_exp_f32 v30, v130
 v_mfma_f32_16x16x32_bf16 a[124:127], a[208:211], v[228:231], a[124:127]
 s_waitcnt lgkmcnt(7)
 ds_read_b64_tr_b16 a[206:207], v2 offset:51616
 v_mfma_f32_16x16x32_bf16 a[136:139], a[216:219], v[228:231], a[136:139]
 ds_read_b64_tr_b16 a[208:209], v2 offset:34240
 v_exp_f32 v31, v131
 v_mfma_f32_16x16x32_bf16 a[136:139], a[220:223], v[44:47], a[136:139]
 ds_read_b64_tr_b16 a[210:211], v2 offset:34752
 v_cvt_pk_bf16_f32 v53, v30, v31
 v_mfma_f32_16x16x32_bf16 a[132:135], a[220:223], v[40:43], a[132:135]
 s_add_u32 m0, s73, 0x1060
 ds_read_b64_tr_b16 a[212:213], v2 offset:51136
 v_exp_f32 v32, v140
 v_mfma_f32_16x16x32_bf16 a[132:135], a[216:219], v[224:227], a[132:135]
 s_waitcnt lgkmcnt(7)
 buffer_load_dwordx4 v4, s[48:51], s75 offen offset:2048 nt lds
 ds_read_b64_tr_b16 a[214:215], v2 offset:51648
 v_dot2c_f32_bf16 v11, s79, v53
 v_mfma_f32_16x16x32_bf16 a[144:147], a[192:195], v[224:227], a[144:147]
 ds_read_b64_tr_b16 a[216:217], v2 offset:34272
 v_mfma_f32_16x16x32_bf16 a[144:147], a[196:199], v[40:43], a[144:147]
 ds_read_b64_tr_b16 a[218:219], v2 offset:34784
 v_exp_f32 v33, v141
 v_mfma_f32_16x16x32_bf16 a[148:151], a[196:199], v[44:47], a[148:151]
 ds_read_b64_tr_b16 a[220:221], v2 offset:51168
 v_cvt_pk_bf16_f32 v54, v32, v33
 v_mfma_f32_16x16x32_bf16 a[148:151], a[192:195], v[228:231], a[148:151]
 s_waitcnt lgkmcnt(7)
 ds_read_b64_tr_b16 a[222:223], v2 offset:51680
 v_exp_f32 v34, v142
 v_mfma_f32_16x16x32_bf16 a[160:163], a[200:203], v[228:231], a[160:163]
 v_exp_f32 v35, v143
 v_mfma_f32_16x16x32_bf16 a[160:163], a[204:207], v[44:47], a[160:163]
 v_exp_f32 v30, v134
 v_cvt_pk_bf16_f32 v55, v34, v35
 v_mfma_f32_16x16x32_bf16 a[156:159], a[204:207], v[40:43], a[156:159]
 s_add_u32 m0, s73, 0x1070
 v_exp_f32 v31, v135
 v_mfma_f32_16x16x32_bf16 a[156:159], a[200:203], v[224:227], a[156:159]
 s_waitcnt lgkmcnt(4)
 buffer_load_dwordx4 v4, s[48:51], s75 offen offset:3072 nt lds
 v_dot2c_f32_bf16 v11, s79, v54
 v_mfma_f32_16x16x32_bf16 a[168:171], a[208:211], v[224:227], a[168:171]
 v_exp_f32 v32, v144
 v_mfma_f32_16x16x32_bf16 a[168:171], a[212:215], v[40:43], a[168:171]
 v_exp_f32 v33, v145
 v_dot2c_f32_bf16 v11, s79, v55
 v_mfma_f32_16x16x32_bf16 a[172:175], a[212:215], v[44:47], a[172:175]
 v_exp_f32 v34, v146
 v_cvt_pk_bf16_f32 v57, v30, v31
 v_mfma_f32_16x16x32_bf16 a[172:175], a[208:211], v[228:231], a[172:175]
 s_waitcnt lgkmcnt(0)
 v_exp_f32 v35, v147
 v_mfma_f32_16x16x32_bf16 a[184:187], a[216:219], v[228:231], a[184:187]
 v_dot2c_f32_bf16 v12, s79, v57
 v_cvt_pk_bf16_f32 v58, v32, v33
 v_dot2c_f32_bf16 v12, s79, v58
 v_mfma_f32_16x16x32_bf16 a[184:187], a[220:223], v[44:47], a[184:187]
 s_waitcnt vmcnt(16)
 s_barrier
 v_mfma_f32_16x16x32_bf16 a[180:183], a[220:223], v[40:43], a[180:183]
 ds_read_b128 a[192:195], v1 offset:33792
 v_cvt_pk_bf16_f32 v59, v34, v35
 v_mfma_f32_16x16x32_bf16 a[180:183], a[216:219], v[224:227], a[180:183]
 s_waitcnt lgkmcnt(0)
 s_add_u32 s75, s75, 0x8000
 ds_read_b128 a[196:199], v1 offset:33824
 ds_read_b128 a[200:203], v1 offset:33856
 ds_read_b128 a[204:207], v1 offset:33888
 ds_read_b128 a[208:211], v1 offset:33920
 ds_read_b128 a[212:215], v1 offset:33952
 v_dot2c_f32_bf16 v12, s79, v59
 s_waitcnt lgkmcnt(4)
 v_mfma_f32_16x16x32_bf16 v[176:179], a[192:195], v[64:67], v[16:19]
 s_add_u32 m0, s74, 0x18c00
 ds_read_b128 a[216:219], v1 offset:33984
 v_mfma_f32_16x16x32_bf16 v[176:179], a[196:199], v[68:71], v[176:179]
 buffer_load_dwordx4 v3, s[52:55], s76 offen offset:0 nt lds
 v_mfma_f32_16x16x32_bf16 v[180:183], a[196:199], v[100:103], v[20:23]
 ds_read_b128 a[220:223], v1 offset:34016
 v_mfma_f32_16x16x32_bf16 v[180:183], a[192:195], v[96:99], v[180:183]
 s_waitcnt lgkmcnt(4)
 v_exp_f32 v28, v152
 v_mfma_f32_16x16x32_bf16 v[180:183], a[200:203], v[104:107], v[180:183]
 ds_read_b128 a[192:195], v1 offset:34304
 v_mfma_f32_16x16x32_bf16 v[180:183], a[204:207], v[108:111], v[180:183]
 v_exp_f32 v29, v153
 v_mfma_f32_16x16x32_bf16 v[176:179], a[204:207], v[76:79], v[176:179]
 ds_read_b128 a[196:199], v1 offset:34336
 v_cvt_pk_bf16_f32 v40, v28, v29
 v_mfma_f32_16x16x32_bf16 v[176:179], a[200:203], v[72:75], v[176:179]
 s_waitcnt lgkmcnt(4)
 s_add_u32 m0, s74, 0x18c20
 v_exp_f32 v30, v154
 v_mfma_f32_16x16x32_bf16 v[176:179], a[208:211], v[80:83], v[176:179]
 buffer_load_dwordx4 v3, s[52:55], s76 offen offset:1024 nt lds
 ds_read_b128 a[200:203], v1 offset:34368
 v_mfma_f32_16x16x32_bf16 v[176:179], a[212:215], v[84:87], v[176:179]
 v_mfma_f32_16x16x32_bf16 v[180:183], a[212:215], v[116:119], v[180:183]
 ds_read_b128 a[204:207], v1 offset:34400
 v_mfma_f32_16x16x32_bf16 v[180:183], a[208:211], v[112:115], v[180:183]
 s_waitcnt lgkmcnt(4)
 v_exp_f32 v31, v155
 v_mfma_f32_16x16x32_bf16 v[180:183], a[216:219], v[120:123], v[180:183]
 ds_read_b128 a[208:211], v1 offset:34432
 v_cvt_pk_bf16_f32 v41, v30, v31
 v_mfma_f32_16x16x32_bf16 v[180:183], a[220:223], v[124:127], v[180:183]
 v_exp_f32 v32, v164
 v_mfma_f32_16x16x32_bf16 v[176:179], a[220:223], v[92:95], v[176:179]
 ds_read_b128 a[212:215], v1 offset:34464
 v_mfma_f32_16x16x32_bf16 v[176:179], a[216:219], v[88:91], v[176:179]
 s_waitcnt lgkmcnt(4)
 s_add_u32 m0, s74, 0x18c40
 v_exp_f32 v33, v165
 v_mfma_f32_16x16x32_bf16 v[188:191], a[192:195], v[64:67], v[16:19]
 buffer_load_dwordx4 v3, s[52:55], s76 offen offset:2048 nt lds
 ds_read_b128 a[216:219], v1 offset:34496
 v_mfma_f32_16x16x32_bf16 v[188:191], a[196:199], v[68:71], v[188:191]
 v_mfma_f32_16x16x32_bf16 v[192:195], a[196:199], v[100:103], v[20:23]
 ds_read_b128 a[220:223], v1 offset:34528
 v_cvt_pk_bf16_f32 v42, v32, v33
 v_mfma_f32_16x16x32_bf16 v[192:195], a[192:195], v[96:99], v[192:195]
 s_waitcnt lgkmcnt(4)
 v_exp_f32 v34, v166
 v_mfma_f32_16x16x32_bf16 v[192:195], a[200:203], v[104:107], v[192:195]
 ds_read_b128 a[192:195], v1 offset:50432
 v_mfma_f32_16x16x32_bf16 v[192:195], a[204:207], v[108:111], v[192:195]
 v_exp_f32 v35, v167
 v_mfma_f32_16x16x32_bf16 v[188:191], a[204:207], v[76:79], v[188:191]
 ds_read_b128 a[196:199], v1 offset:50464
 v_mfma_f32_16x16x32_bf16 v[188:191], a[200:203], v[72:75], v[188:191]
 s_waitcnt lgkmcnt(4)
 s_add_u32 m0, s74, 0x18c60
 v_mfma_f32_16x16x32_bf16 v[188:191], a[208:211], v[80:83], v[188:191]
 buffer_load_dwordx4 v3, s[52:55], s76 offen offset:3072 nt lds
 ds_read_b128 a[200:203], v1 offset:50496
 v_mfma_f32_16x16x32_bf16 v[188:191], a[212:215], v[84:87], v[188:191]
 v_exp_f32 v28, v156
 v_mfma_f32_16x16x32_bf16 v[192:195], a[212:215], v[116:119], v[192:195]
 ds_read_b128 a[204:207], v1 offset:50528
 v_mfma_f32_16x16x32_bf16 v[192:195], a[208:211], v[112:115], v[192:195]
 s_waitcnt lgkmcnt(4)
 v_exp_f32 v29, v157
 v_mfma_f32_16x16x32_bf16 v[192:195], a[216:219], v[120:123], v[192:195]
 ds_read_b128 a[208:211], v1 offset:50560
 v_mfma_f32_16x16x32_bf16 v[192:195], a[220:223], v[124:127], v[192:195]
 v_exp_f32 v30, v158
 v_mfma_f32_16x16x32_bf16 v[188:191], a[220:223], v[92:95], v[188:191]
 ds_read_b128 a[212:215], v1 offset:50592
 v_mfma_f32_16x16x32_bf16 v[188:191], a[216:219], v[88:91], v[188:191]
 s_waitcnt lgkmcnt(4)
 s_add_u32 m0, s74, 0x19c80
 v_exp_f32 v31, v159
 v_mfma_f32_16x16x32_bf16 v[200:203], a[192:195], v[64:67], v[16:19]
 buffer_load_dwordx4 v4, s[52:55], s76 offen offset:0 nt lds
 ds_read_b128 a[216:219], v1 offset:50624
 v_mfma_f32_16x16x32_bf16 v[200:203], a[196:199], v[68:71], v[200:203]
 v_mfma_f32_16x16x32_bf16 v[204:207], a[196:199], v[100:103], v[20:23]
 ds_read_b128 a[220:223], v1 offset:50656
 v_cvt_pk_bf16_f32 v43, v34, v35
 v_mfma_f32_16x16x32_bf16 v[204:207], a[192:195], v[96:99], v[204:207]
 s_waitcnt lgkmcnt(4)
 v_exp_f32 v32, v168
 v_mfma_f32_16x16x32_bf16 v[204:207], a[200:203], v[104:107], v[204:207]
 ds_read_b128 a[192:195], v1 offset:50944
 v_mfma_f32_16x16x32_bf16 v[204:207], a[204:207], v[108:111], v[204:207]
 v_exp_f32 v33, v169
 v_mfma_f32_16x16x32_bf16 v[200:203], a[204:207], v[76:79], v[200:203]
 s_add_u32 m0, s74, 0x19ca0
 ds_read_b128 a[196:199], v1 offset:50976
 v_mfma_f32_16x16x32_bf16 v[200:203], a[200:203], v[72:75], v[200:203]
 s_waitcnt lgkmcnt(4)
 buffer_load_dwordx4 v4, s[52:55], s76 offen offset:1024 nt lds
 v_mfma_f32_16x16x32_bf16 v[200:203], a[208:211], v[80:83], v[200:203]
 ds_read_b128 a[200:203], v1 offset:51008
 v_mfma_f32_16x16x32_bf16 v[200:203], a[212:215], v[84:87], v[200:203]
 v_exp_f32 v34, v170
 v_mfma_f32_16x16x32_bf16 v[204:207], a[212:215], v[116:119], v[204:207]
 ds_read_b128 a[204:207], v1 offset:51040
 v_mfma_f32_16x16x32_bf16 v[204:207], a[208:211], v[112:115], v[204:207]
 s_waitcnt lgkmcnt(4)
 v_exp_f32 v35, v171
 v_mfma_f32_16x16x32_bf16 v[204:207], a[216:219], v[120:123], v[204:207]
 ds_read_b128 a[208:211], v1 offset:51072
 v_mfma_f32_16x16x32_bf16 v[204:207], a[220:223], v[124:127], v[204:207]
 v_dot2c_f32_bf16 v11, s79, v40
 v_mfma_f32_16x16x32_bf16 v[200:203], a[220:223], v[92:95], v[200:203]
 s_add_u32 m0, s74, 0x19cc0
 ds_read_b128 a[212:215], v1 offset:51104
 v_mfma_f32_16x16x32_bf16 v[200:203], a[216:219], v[88:91], v[200:203]
 s_waitcnt lgkmcnt(4)
 buffer_load_dwordx4 v4, s[52:55], s76 offen offset:2048 nt lds
 v_mfma_f32_16x16x32_bf16 v[212:215], a[192:195], v[64:67], v[16:19]
 ds_read_b128 a[216:219], v1 offset:51136
 v_dot2c_f32_bf16 v11, s79, v41
 v_mfma_f32_16x16x32_bf16 v[212:215], a[196:199], v[68:71], v[212:215]
 v_dot2c_f32_bf16 v11, s79, v42
 v_mfma_f32_16x16x32_bf16 v[216:219], a[196:199], v[100:103], v[20:23]
 ds_read_b128 a[220:223], v1 offset:51168
 v_mfma_f32_16x16x32_bf16 v[216:219], a[192:195], v[96:99], v[216:219]
 s_waitcnt lgkmcnt(4)
 v_dot2c_f32_bf16 v11, s79, v43
 v_cvt_pk_bf16_f32 v44, v28, v29
 v_mfma_f32_16x16x32_bf16 v[216:219], a[200:203], v[104:107], v[216:219]
 v_dot2c_f32_bf16 v12, s79, v44
 v_mfma_f32_16x16x32_bf16 v[216:219], a[204:207], v[108:111], v[216:219]
 v_cvt_pk_bf16_f32 v45, v30, v31
 v_mfma_f32_16x16x32_bf16 v[212:215], a[204:207], v[76:79], v[212:215]
 s_add_u32 m0, s74, 0x19ce0
 v_dot2c_f32_bf16 v12, s79, v45
 v_mfma_f32_16x16x32_bf16 v[212:215], a[200:203], v[72:75], v[212:215]
 s_waitcnt lgkmcnt(2)
 buffer_load_dwordx4 v4, s[52:55], s76 offen offset:3072 nt lds
 v_mfma_f32_16x16x32_bf16 v[212:215], a[208:211], v[80:83], v[212:215]
 v_cvt_pk_bf16_f32 v46, v32, v33
 v_mfma_f32_16x16x32_bf16 v[212:215], a[212:215], v[84:87], v[212:215]
 v_dot2c_f32_bf16 v12, s79, v46
 v_mfma_f32_16x16x32_bf16 v[216:219], a[212:215], v[116:119], v[216:219]
 v_cvt_pk_bf16_f32 v47, v34, v35
 v_dot2c_f32_bf16 v12, s79, v47
 v_mfma_f32_16x16x32_bf16 v[216:219], a[208:211], v[112:115], v[216:219]
 s_waitcnt lgkmcnt(0)
 v_mfma_f32_16x16x32_bf16 v[216:219], a[216:219], v[120:123], v[216:219]
 v_mfma_f32_16x16x32_bf16 v[216:219], a[220:223], v[124:127], v[216:219]
 s_waitcnt vmcnt(16)
 s_barrier
 s_mov_b64 exec, 0
 s_cmp_eq_u32 s77, 12
 s_cbranch_scc1 L1_PADW0
 s_cmp_eq_u32 s77, 11
 s_cbranch_scc1 L1_PADW1
 s_cmp_eq_u32 s77, 10
 s_cbranch_scc1 L1_PADW2
 s_cmp_eq_u32 s77, 9
 s_cbranch_scc1 L1_PADW3
 s_cmp_eq_u32 s77, 8
 s_cbranch_scc1 L1_PADW4
L1_PRL1:
 s_mov_b64 exec, -1
 v_mfma_f32_16x16x32_bf16 v[212:215], a[220:223], v[92:95], v[212:215]
 s_add_u32 s76, s76, 0x8000
 ds_read_b64_tr_b16 a[192:193], v2 offset:0
 v_max_f32 v14, v11, v12
 v_cmp_nge_f32 vcc, s78, v14
 v_mfma_f32_16x16x32_bf16 v[212:215], a[216:219], v[88:91], v[212:215]
 s_waitcnt lgkmcnt(0)
 s_mov_b32 s90, 2
 ds_read_b64_tr_b16 a[194:195], v2 offset:512
 ds_read_b64_tr_b16 a[196:197], v2 offset:16896
 ds_read_b64_tr_b16 a[198:199], v2 offset:17408
 ds_read_b64_tr_b16 a[200:201], v2 offset:32
 ds_read_b64_tr_b16 a[202:203], v2 offset:544
 ds_read_b64_tr_b16 a[204:205], v2 offset:16928
 ds_read_b64_tr_b16 a[206:207], v2 offset:17440
 ds_read_b64_tr_b16 a[208:209], v2 offset:64
 ds_read_b64_tr_b16 a[210:211], v2 offset:576
 ds_read_b64_tr_b16 a[212:213], v2 offset:16960
 ds_read_b64_tr_b16 a[214:215], v2 offset:17472
 s_cbranch_vccnz L1_RARE0_W3
L1_BACK2_W3:
 s_waitcnt lgkmcnt(8)
 v_mfma_f32_16x16x32_bf16 a[0:3], a[192:195], v[52:55], a[0:3]
 s_add_u32 m0, s73, 0x8400
 ds_read_b64_tr_b16 a[216:217], v2 offset:96
 v_add_f32 v8, v8, v11
 v_mfma_f32_16x16x32_bf16 a[0:3], a[196:199], v[40:43], a[0:3]
 buffer_load_dwordx4 v3, s[48:51], s75 offen offset:0 nt lds
 ds_read_b64_tr_b16 a[218:219], v2 offset:608
 v_mfma_f32_16x16x32_bf16 a[4:7], a[196:199], v[44:47], a[4:7]
 ds_read_b64_tr_b16 a[220:221], v2 offset:16992
 v_mfma_f32_16x16x32_bf16 a[4:7], a[192:195], v[56:59], a[4:7]
 s_waitcnt lgkmcnt(7)
 ds_read_b64_tr_b16 a[222:223], v2 offset:17504
 v_add_f32 v9, v9, v12
 v_mfma_f32_16x16x32_bf16 a[16:19], a[200:203], v[56:59], a[16:19]
 ds_read_b64_tr_b16 a[192:193], v2 offset:128
 v_mfma_f32_16x16x32_bf16 a[16:19], a[204:207], v[44:47], a[16:19]
 ds_read_b64_tr_b16 a[194:195], v2 offset:640
 v_mfma_f32_16x16x32_bf16 a[12:15], a[204:207], v[40:43], a[12:15]
 ds_read_b64_tr_b16 a[196:197], v2 offset:17024
 v_mfma_f32_16x16x32_bf16 a[12:15], a[200:203], v[52:55], a[12:15]
 s_waitcnt lgkmcnt(7)
 s_add_u32 m0, s73, 0x8410
 ds_read_b64_tr_b16 a[198:199], v2 offset:17536
 v_mfma_f32_16x16x32_bf16 a[24:27], a[208:211], v[52:55], a[24:27]
 buffer_load_dwordx4 v3, s[48:51], s75 offen offset:1024 nt lds
 ds_read_b64_tr_b16 a[200:201], v2 offset:160
 v_mfma_f32_16x16x32_bf16 a[24:27], a[212:215], v[40:43], a[24:27]
 ds_read_b64_tr_b16 a[202:203], v2 offset:672
 v_mfma_f32_16x16x32_bf16 a[28:31], a[212:215], v[44:47], a[28:31]
 ds_read_b64_tr_b16 a[204:205], v2 offset:17056
 v_mfma_f32_16x16x32_bf16 a[28:31], a[208:211], v[56:59], a[28:31]
 s_waitcnt lgkmcnt(7)
 ds_read_b64_tr_b16 a[206:207], v2 offset:17568
 v_mfma_f32_16x16x32_bf16 a[40:43], a[216:219], v[56:59], a[40:43]
 ds_read_b64_tr_b16 a[208:209], v2 offset:192
 v_mfma_f32_16x16x32_bf16 a[40:43], a[220:223], v[44:47], a[40:43]
 ds_read_b64_tr_b16 a[210:211], v2 offset:704
 v_mfma_f32_16x16x32_bf16 a[36:39], a[220:223], v[40:43], a[36:39]
 ds_read_b64_tr_b16 a[212:213], v2 offset:17088
 v_mfma_f32_16x16x32_bf16 a[36:39], a[216:219], v[52:55], a[36:39]
 s_waitcnt lgkmcnt(7)
 s_add_u32 m0, s73, 0x8420
 ds_read_b64_tr_b16 a[214:215], v2 offset:17600
 v_mfma_f32_16x16x32_bf16 a[48:51], a[192:195], v[52:55], a[48:51]
 buffer_load_dwordx4 v3, s[48:51], s75 offen offset:2048 nt lds
 ds_read_b64_tr_b16 a[216:217], v2 offset:224
 v_mfma_f32_16x16x32_bf16 a[48:51], a[196:199], v[40:43], a[48:51]
 ds_read_b64_tr_b16 a[218:219], v2 offset:736
 v_mfma_f32_16x16x32_bf16 a[52:55], a[196:199], v[44:47], a[52:55]
 ds_read_b64_tr_b16 a[220:221], v2 offset:17120
 v_mfma_f32_16x16x32_bf16 a[52:55], a[192:195], v[56:59], a[52:55]
 s_waitcnt lgkmcnt(7)
 ds_read_b64_tr_b16 a[222:223], v2 offset:17632
 v_mfma_f32_16x16x32_bf16 a[64:67], a[200:203], v[56:59], a[64:67]
 ds_read_b64_tr_b16 a[192:193], v2 offset:256
 v_mfma_f32_16x16x32_bf16 a[64:67], a[204:207], v[44:47], a[64:67]
 ds_read_b64_tr_b16 a[194:195], v2 offset:768
 v_mfma_f32_16x16x32_bf16 a[60:63], a[204:207], v[40:43], a[60:63]
 ds_read_b64_tr_b16 a[196:197], v2 offset:17152
 v_mfma_f32_16x16x32_bf16 a[60:63], a[200:203], v[52:55], a[60:63]
 s_waitcnt lgkmcnt(7)
 s_add_u32 m0, s73, 0x8430
 ds_read_b64_tr_b16 a[198:199], v2 offset:17664
 v_mfma_f32_16x16x32_bf16 a[72:75], a[208:211], v[52:55], a[72:75]
 buffer_load_dwordx4 v3, s[48:51], s75 offen offset:3072 nt lds
 ds_read_b64_tr_b16 a[200:201], v2 offset:288
 v_mfma_f32_16x16x32_bf16 a[72:75], a[212:215], v[40:43], a[72:75]
 ds_read_b64_tr_b16 a[202:203], v2 offset:800
 v_exp_f32 v28, v176
 v_mfma_f32_16x16x32_bf16 a[76:79], a[212:215], v[44:47], a[76:79]
 ds_read_b64_tr_b16 a[204:205], v2 offset:17184
 v_mfma_f32_16x16x32_bf16 a[76:79], a[208:211], v[56:59], a[76:79]
 s_waitcnt lgkmcnt(7)
 ds_read_b64_tr_b16 a[206:207], v2 offset:17696
 v_mfma_f32_16x16x32_bf16 a[88:91], a[216:219], v[56:59], a[88:91]
 ds_read_b64_tr_b16 a[208:209], v2 offset:320
 v_mfma_f32_16x16x32_bf16 a[88:91], a[220:223], v[44:47], a[88:91]
 ds_read_b64_tr_b16 a[210:211], v2 offset:832
 v_exp_f32 v29, v177
 v_mfma_f32_16x16x32_bf16 a[84:87], a[220:223], v[40:43], a[84:87]
 ds_read_b64_tr_b16 a[212:213], v2 offset:17216
 v_cvt_pk_bf16_f32 v224, v28, v29
 v_mfma_f32_16x16x32_bf16 a[84:87], a[216:219], v[52:55], a[84:87]
 s_waitcnt lgkmcnt(7)
 s_add_u32 m0, s73, 0x9440
 ds_read_b64_tr_b16 a[214:215], v2 offset:17728
 v_dot2_f32_bf16 v11, v224, s79, 0
 v_mfma_f32_16x16x32_bf16 a[96:99], a[192:195], v[52:55], a[96:99]
 buffer_load_dwordx4 v4, s[48:51], s75 offen offset:0 nt lds
 ds_read_b64_tr_b16 a[216:217], v2 offset:352
 v_mfma_f32_16x16x32_bf16 a[96:99], a[196:199], v[40:43], a[96:99]
 ds_read_b64_tr_b16 a[218:219], v2 offset:864
 v_exp_f32 v28, v180
 v_mfma_f32_16x16x32_bf16 a[100:103], a[196:199], v[44:47], a[100:103]
 ds_read_b64_tr_b16 a[220:221], v2 offset:17248
 v_mfma_f32_16x16x32_bf16 a[100:103], a[192:195], v[56:59], a[100:103]
 s_waitcnt lgkmcnt(7)
 ds_read_b64_tr_b16 a[222:223], v2 offset:17760
 v_mfma_f32_16x16x32_bf16 a[112:115], a[200:203], v[56:59], a[112:115]
 ds_read_b64_tr_b16 a[192:193], v2 offset:384
 v_exp_f32 v29, v181
 v_mfma_f32_16x16x32_bf16 a[112:115], a[204:207], v[44:47], a[112:115]
 ds_read_b64_tr_b16 a[194:195], v2 offset:896
 v_cvt_pk_bf16_f32 v228, v28, v29
 v_mfma_f32_16x16x32_bf16 a[108:111], a[204:207], v[40:43], a[108:111]
 s_add_u32 m0, s73, 0x9450
 ds_read_b64_tr_b16 a[196:197], v2 offset:17280
 v_dot2_f32_bf16 v12, v228, s79, 0
 v_mfma_f32_16x16x32_bf16 a[108:111], a[200:203], v[52:55], a[108:111]
 s_waitcnt lgkmcnt(7)
 buffer_load_dwordx4 v4, s[48:51], s75 offen offset:1024 nt lds
 ds_read_b64_tr_b16 a[198:199], v2 offset:17792
 v_mfma_f32_16x16x32_bf16 a[120:123], a[208:211], v[52:55], a[120:123]
 ds_read_b64_tr_b16 a[200:201], v2 offset:416
 v_mfma_f32_16x16x32_bf16 a[120:123], a[212:215], v[40:43], a[120:123]
 ds_read_b64_tr_b16 a[202:203], v2 offset:928
 v_mfma_f32_16x16x32_bf16 a[124:127], a[212:215], v[44:47], a[124:127]
 ds_read_b64_tr_b16 a[204:205], v2 offset:17312
 v_exp_f32 v30, v178
 v_mfma_f32_16x16x32_bf16 a[124:127], a[208:211], v[56:59], a[124:127]
 s_waitcnt lgkmcnt(7)
 ds_read_b64_tr_b16 a[206:207], v2 offset:17824
 v_mfma_f32_16x16x32_bf16 a[136:139], a[216:219], v[56:59], a[136:139]
 ds_read_b64_tr_b16 a[208:209], v2 offset:448
 v_exp_f32 v31, v179
 v_mfma_f32_16x16x32_bf16 a[136:139], a[220:223], v[44:47], a[136:139]
 ds_read_b64_tr_b16 a[210:211], v2 offset:960
 v_cvt_pk_bf16_f32 v225, v30, v31
 v_mfma_f32_16x16x32_bf16 a[132:135], a[220:223], v[40:43], a[132:135]
 s_add_u32 m0, s73, 0x9460
 ds_read_b64_tr_b16 a[212:213], v2 offset:17344
 v_exp_f32 v32, v188
 v_mfma_f32_16x16x32_bf16 a[132:135], a[216:219], v[52:55], a[132:135]
 s_waitcnt lgkmcnt(7)
 buffer_load_dwordx4 v4, s[48:51], s75 offen offset:2048 nt lds
 ds_read_b64_tr_b16 a[214:215], v2 offset:17856
 v_dot2c_f32_bf16 v11, s79, v225
 v_mfma_f32_16x16x32_bf16 a[144:147], a[192:195], v[52:55], a[144:147]
 ds_read_b64_tr_b16 a[216:217], v2 offset:480
 v_mfma_f32_16x16x32_bf16 a[144:147], a[196:199], v[40:43], a[144:147]
 ds_read_b64_tr_b16 a[218:219], v2 offset:992
 v_exp_f32 v33, v189
 v_mfma_f32_16x16x32_bf16 a[148:151], a[196:199], v[44:47], a[148:151]
 ds_read_b64_tr_b16 a[220:221], v2 offset:17376
 v_cvt_pk_bf16_f32 v226, v32, v33
 v_mfma_f32_16x16x32_bf16 a[148:151], a[192:195], v[56:59], a[148:151]
 s_waitcnt lgkmcnt(7)
 ds_read_b64_tr_b16 a[222:223], v2 offset:17888
 v_exp_f32 v34, v190
 v_mfma_f32_16x16x32_bf16 a[160:163], a[200:203], v[56:59], a[160:163]
 v_exp_f32 v35, v191
 v_mfma_f32_16x16x32_bf16 a[160:163], a[204:207], v[44:47], a[160:163]
 v_exp_f32 v30, v182
 v_cvt_pk_bf16_f32 v227, v34, v35
 v_mfma_f32_16x16x32_bf16 a[156:159], a[204:207], v[40:43], a[156:159]
 s_add_u32 m0, s73, 0x9470
 v_exp_f32 v31, v183
 v_mfma_f32_16x16x32_bf16 a[156:159], a[200:203], v[52:55], a[156:159]
 s_waitcnt lgkmcnt(4)
 buffer_load_dwordx4 v4, s[48:51], s75 offen offset:3072 nt lds
 v_dot2c_f32_bf16 v11, s79, v226
 v_mfma_f32_16x16x32_bf16 a[168:171], a[208:211], v[52:55], a[168:171]
 v_exp_f32 v32, v192
 v_mfma_f32_16x16x32_bf16 a[168:171], a[212:215], v[40:43], a[168:171]
 v_exp_f32 v33, v193
 v_dot2c_f32_bf16 v11, s79, v227
 v_mfma_f32_16x16x32_bf16 a[172:175], a[212:215], v[44:47], a[172:175]
 v_exp_f32 v34, v194
 v_cvt_pk_bf16_f32 v229, v30, v31
 v_mfma_f32_16x16x32_bf16 a[172:175], a[208:211], v[56:59], a[172:175]
 s_waitcnt lgkmcnt(0)
 v_exp_f32 v35, v195
 v_mfma_f32_16x16x32_bf16 a[184:187], a[216:219], v[56:59], a[184:187]
 v_dot2c_f32_bf16 v12, s79, v229
 v_cvt_pk_bf16_f32 v230, v32, v33
 v_dot2c_f32_bf16 v12, s79, v230
 v_mfma_f32_16x16x32_bf16 a[184:187], a[220:223], v[44:47], a[184:187]
 s_add_u32 s75, s75, 0x8000
 s_waitcnt vmcnt(16)
 s_barrier
 v_mfma_f32_16x16x32_bf16 a[180:183], a[220:223], v[40:43], a[180:183]
 s_sub_u32 s77, s77, 1
 ds_read_b128 a[192:195], v1 offset:0
 v_cvt_pk_bf16_f32 v231, v34, v35
 v_mfma_f32_16x16x32_bf16 a[180:183], a[216:219], v[52:55], a[180:183]
 s_waitcnt lgkmcnt(0)
 s_cmp_lg_u32 s77, 0
 ds_read_b128 a[196:199], v1 offset:32
 ds_read_b128 a[200:203], v1 offset:64
 ds_read_b128 a[204:207], v1 offset:96
 ds_read_b128 a[208:211], v1 offset:128
 ds_read_b128 a[212:215], v1 offset:160
 v_dot2c_f32_bf16 v12, s79, v231
 s_cbranch_scc1 L1_LOOP_W3
 s_waitcnt lgkmcnt(4)
 v_mfma_f32_16x16x32_bf16 v[128:131], a[192:195], v[64:67], v[16:19]
 s_add_u32 m0, s74, 0x10800
 ds_read_b128 a[216:219], v1 offset:192
 v_mfma_f32_16x16x32_bf16 v[128:131], a[196:199], v[68:71], v[128:131]
 buffer_load_dwordx4 v3, s[52:55], s76 offen offset:0 nt lds
 v_mfma_f32_16x16x32_bf16 v[132:135], a[196:199], v[100:103], v[20:23]
 ds_read_b128 a[220:223], v1 offset:224
 v_mfma_f32_16x16x32_bf16 v[132:135], a[192:195], v[96:99], v[132:135]
 s_waitcnt lgkmcnt(4)
 v_exp_f32 v28, v200
 v_mfma_f32_16x16x32_bf16 v[132:135], a[200:203], v[104:107], v[132:135]
 ds_read_b128 a[192:195], v1 offset:512
 v_add_f32 v11, v11, v28
 v_mfma_f32_16x16x32_bf16 v[132:135], a[204:207], v[108:111], v[132:135]
 v_exp_f32 v29, v201
 v_mfma_f32_16x16x32_bf16 v[128:131], a[204:207], v[76:79], v[128:131]
 ds_read_b128 a[196:199], v1 offset:544
 v_add_f32 v11, v11, v29
 v_mfma_f32_16x16x32_bf16 v[128:131], a[200:203], v[72:75], v[128:131]
 s_waitcnt lgkmcnt(4)
 s_add_u32 m0, s74, 0x10820
 v_exp_f32 v30, v202
 v_mfma_f32_16x16x32_bf16 v[128:131], a[208:211], v[80:83], v[128:131]
 buffer_load_dwordx4 v3, s[52:55], s76 offen offset:1024 nt lds
 ds_read_b128 a[200:203], v1 offset:576
 v_mfma_f32_16x16x32_bf16 v[128:131], a[212:215], v[84:87], v[128:131]
 v_mfma_f32_16x16x32_bf16 v[132:135], a[212:215], v[116:119], v[132:135]
 ds_read_b128 a[204:207], v1 offset:608
 v_cvt_pk_bf16_f32 v40, v28, v29
 v_mfma_f32_16x16x32_bf16 v[132:135], a[208:211], v[112:115], v[132:135]
 s_waitcnt lgkmcnt(4)
 v_exp_f32 v31, v203
 v_mfma_f32_16x16x32_bf16 v[132:135], a[216:219], v[120:123], v[132:135]
 ds_read_b128 a[208:211], v1 offset:640
 v_mfma_f32_16x16x32_bf16 v[132:135], a[220:223], v[124:127], v[132:135]
 v_exp_f32 v32, v212
 v_mfma_f32_16x16x32_bf16 v[128:131], a[220:223], v[92:95], v[128:131]
 ds_read_b128 a[212:215], v1 offset:672
 v_mfma_f32_16x16x32_bf16 v[128:131], a[216:219], v[88:91], v[128:131]
 s_waitcnt lgkmcnt(4)
 s_add_u32 m0, s74, 0x10840
 v_exp_f32 v33, v213
 v_mfma_f32_16x16x32_bf16 v[140:143], a[192:195], v[64:67], v[16:19]
 buffer_load_dwordx4 v3, s[52:55], s76 offen offset:2048 nt lds
 ds_read_b128 a[216:219], v1 offset:704
 v_mfma_f32_16x16x32_bf16 v[140:143], a[196:199], v[68:71], v[140:143]
 v_exp_f32 v34, v214
 v_mfma_f32_16x16x32_bf16 v[144:147], a[196:199], v[100:103], v[20:23]
 ds_read_b128 a[220:223], v1 offset:736
 v_mfma_f32_16x16x32_bf16 v[144:147], a[192:195], v[96:99], v[144:147]
 s_waitcnt lgkmcnt(4)
 v_exp_f32 v35, v215
 v_mfma_f32_16x16x32_bf16 v[144:147], a[200:203], v[104:107], v[144:147]
 ds_read_b128 a[192:195], v1 offset:16640
 v_mfma_f32_16x16x32_bf16 v[144:147], a[204:207], v[108:111], v[144:147]
 v_exp_f32 v28, v204
 v_mfma_f32_16x16x32_bf16 v[140:143], a[204:207], v[76:79], v[140:143]
 ds_read_b128 a[196:199], v1 offset:16672
 v_mfma_f32_16x16x32_bf16 v[140:143], a[200:203], v[72:75], v[140:143]
 s_waitcnt lgkmcnt(4)
 s_add_u32 m0, s74, 0x10860
 v_exp_f32 v29, v205
 v_mfma_f32_16x16x32_bf16 v[140:143], a[208:211], v[80:83], v[140:143]
 buffer_load_dwordx4 v3, s[52:55], s76 offen offset:3072 nt lds
 ds_read_b128 a[200:203], v1 offset:16704
 v_mfma_f32_16x16x32_bf16 v[140:143], a[212:215], v[84:87], v[140:143]
 v_add_f32 v11, v11, v30
 v_mfma_f32_16x16x32_bf16 v[144:147], a[212:215], v[116:119], v[144:147]
 ds_read_b128 a[204:207], v1 offset:16736
 v_add_f32 v11, v11, v31
 v_mfma_f32_16x16x32_bf16 v[144:147], a[208:211], v[112:115], v[144:147]
 s_waitcnt lgkmcnt(4)
 v_cvt_pk_bf16_f32 v41, v30, v31
 v_mfma_f32_16x16x32_bf16 v[144:147], a[216:219], v[120:123], v[144:147]
 ds_read_b128 a[208:211], v1 offset:16768
 v_add_f32 v11, v11, v32
 v_mfma_f32_16x16x32_bf16 v[144:147], a[220:223], v[124:127], v[144:147]
 v_exp_f32 v30, v206
 v_mfma_f32_16x16x32_bf16 v[140:143], a[220:223], v[92:95], v[140:143]
 ds_read_b128 a[212:215], v1 offset:16800
 v_mfma_f32_16x16x32_bf16 v[140:143], a[216:219], v[88:91], v[140:143]
 s_waitcnt lgkmcnt(4)
 s_add_u32 m0, s74, 0x11880
 v_exp_f32 v31, v207
 v_mfma_f32_16x16x32_bf16 v[152:155], a[192:195], v[64:67], v[16:19]
 buffer_load_dwordx4 v4, s[52:55], s76 offen offset:0 nt lds
 ds_read_b128 a[216:219], v1 offset:16832
 v_mfma_f32_16x16x32_bf16 v[152:155], a[196:199], v[68:71], v[152:155]
 v_add_f32 v11, v11, v33
 v_mfma_f32_16x16x32_bf16 v[156:159], a[196:199], v[100:103], v[20:23]
 ds_read_b128 a[220:223], v1 offset:16864
 v_mfma_f32_16x16x32_bf16 v[156:159], a[192:195], v[96:99], v[156:159]
 s_waitcnt lgkmcnt(4)
 v_cvt_pk_bf16_f32 v42, v32, v33
 v_add_f32 v11, v11, v34
 v_mfma_f32_16x16x32_bf16 v[156:159], a[200:203], v[104:107], v[156:159]
 ds_read_b128 a[192:195], v1 offset:17152
 v_add_f32 v11, v11, v35
 v_mfma_f32_16x16x32_bf16 v[156:159], a[204:207], v[108:111], v[156:159]
 v_exp_f32 v32, v216
 v_mfma_f32_16x16x32_bf16 v[152:155], a[204:207], v[76:79], v[152:155]
 s_add_u32 m0, s74, 0x118a0
 ds_read_b128 a[196:199], v1 offset:17184
 v_mfma_f32_16x16x32_bf16 v[152:155], a[200:203], v[72:75], v[152:155]
 s_waitcnt lgkmcnt(4)
 buffer_load_dwordx4 v4, s[52:55], s76 offen offset:1024 nt lds
 v_mfma_f32_16x16x32_bf16 v[152:155], a[208:211], v[80:83], v[152:155]
 ds_read_b128 a[200:203], v1 offset:17216
 v_mfma_f32_16x16x32_bf16 v[152:155], a[212:215], v[84:87], v[152:155]
 v_exp_f32 v33, v217
 v_mfma_f32_16x16x32_bf16 v[156:159], a[212:215], v[116:119], v[156:159]
 ds_read_b128 a[204:207], v1 offset:17248
 v_mfma_f32_16x16x32_bf16 v[156:159], a[208:211], v[112:115], v[156:159]
 s_waitcnt lgkmcnt(4)
 v_cvt_pk_bf16_f32 v43, v34, v35
 v_add_f32 v12, v12, v28
 v_mfma_f32_16x16x32_bf16 v[156:159], a[216:219], v[120:123], v[156:159]
 ds_read_b128 a[208:211], v1 offset:17280
 v_mfma_f32_16x16x32_bf16 v[156:159], a[220:223], v[124:127], v[156:159]
 v_exp_f32 v34, v218
 v_mfma_f32_16x16x32_bf16 v[152:155], a[220:223], v[92:95], v[152:155]
 s_add_u32 m0, s74, 0x118c0
 ds_read_b128 a[212:215], v1 offset:17312
 v_mfma_f32_16x16x32_bf16 v[152:155], a[216:219], v[88:91], v[152:155]
 s_waitcnt lgkmcnt(4)
 buffer_load_dwordx4 v4, s[52:55], s76 offen offset:2048 nt lds
 v_mfma_f32_16x16x32_bf16 v[164:167], a[192:195], v[64:67], v[16:19]
 ds_read_b128 a[216:219], v1 offset:17344
 v_add_f32 v12, v12, v29
 v_mfma_f32_16x16x32_bf16 v[164:167], a[196:199], v[68:71], v[164:167]
 v_exp_f32 v35, v219
 v_mfma_f32_16x16x32_bf16 v[168:171], a[196:199], v[100:103], v[20:23]
 ds_read_b128 a[220:223], v1 offset:17376
 v_mfma_f32_16x16x32_bf16 v[168:171], a[192:195], v[96:99], v[168:171]
 s_waitcnt lgkmcnt(4)
 v_add_f32 v12, v12, v30
 v_mfma_f32_16x16x32_bf16 v[168:171], a[200:203], v[104:107], v[168:171]
 v_add_f32 v12, v12, v31
 v_add_f32 v12, v12, v32
 v_mfma_f32_16x16x32_bf16 v[168:171], a[204:207], v[108:111], v[168:171]
 v_add_f32 v12, v12, v33
 v_mfma_f32_16x16x32_bf16 v[164:167], a[204:207], v[76:79], v[164:167]
 s_add_u32 m0, s74, 0x118e0
 v_add_f32 v12, v12, v34
 v_mfma_f32_16x16x32_bf16 v[164:167], a[200:203], v[72:75], v[164:167]
 s_waitcnt lgkmcnt(2)
 buffer_load_dwordx4 v4, s[52:55], s76 offen offset:3072 nt lds
 v_mfma_f32_16x16x32_bf16 v[164:167], a[208:211], v[80:83], v[164:167]
 v_add_f32 v12, v12, v35
 v_max_f32 v14, v11, v12
 v_mfma_f32_16x16x32_bf16 v[164:167], a[212:215], v[84:87], v[164:167]
 v_cmp_nge_f32 vcc, s78, v14
 v_mfma_f32_16x16x32_bf16 v[168:171], a[212:215], v[116:119], v[168:171]
 v_cvt_pk_bf16_f32 v44, v28, v29
 v_mfma_f32_16x16x32_bf16 v[168:171], a[208:211], v[112:115], v[168:171]
 s_waitcnt lgkmcnt(0)
 v_cvt_pk_bf16_f32 v45, v30, v31
 v_mfma_f32_16x16x32_bf16 v[168:171], a[216:219], v[120:123], v[168:171]
 v_cvt_pk_bf16_f32 v46, v32, v33
 v_cvt_pk_bf16_f32 v47, v34, v35
 v_mfma_f32_16x16x32_bf16 v[168:171], a[220:223], v[124:127], v[168:171]
 s_waitcnt vmcnt(16)
 s_barrier
 v_mfma_f32_16x16x32_bf16 v[164:167], a[220:223], v[92:95], v[164:167]
 s_add_u32 s76, s76, 0x8000
 ds_read_b64_tr_b16 a[192:193], v2 offset:33792
 v_mfma_f32_16x16x32_bf16 v[164:167], a[216:219], v[88:91], v[164:167]
 s_waitcnt lgkmcnt(0)
 s_mov_b32 s90, 3
 ds_read_b64_tr_b16 a[194:195], v2 offset:34304
 ds_read_b64_tr_b16 a[196:197], v2 offset:50688
 ds_read_b64_tr_b16 a[198:199], v2 offset:51200
 ds_read_b64_tr_b16 a[200:201], v2 offset:33824
 ds_read_b64_tr_b16 a[202:203], v2 offset:34336
 ds_read_b64_tr_b16 a[204:205], v2 offset:50720
 ds_read_b64_tr_b16 a[206:207], v2 offset:51232
 ds_read_b64_tr_b16 a[208:209], v2 offset:33856
 ds_read_b64_tr_b16 a[210:211], v2 offset:34368
 ds_read_b64_tr_b16 a[212:213], v2 offset:50752
 ds_read_b64_tr_b16 a[214:215], v2 offset:51264
 s_cbranch_vccnz L1_RARE1_W3
L1_BACK3_W3:
 s_waitcnt lgkmcnt(8)
 v_mfma_f32_16x16x32_bf16 a[0:3], a[192:195], v[224:227], a[0:3]
 s_add_u32 m0, s74, 0x0
 ds_read_b64_tr_b16 a[216:217], v2 offset:33888
 v_add_f32 v8, v8, v11
 v_mfma_f32_16x16x32_bf16 a[0:3], a[196:199], v[40:43], a[0:3]
 buffer_load_dwordx4 v3, s[52:55], s76 offen offset:0 nt lds
 ds_read_b64_tr_b16 a[218:219], v2 offset:34400
 v_mfma_f32_16x16x32_bf16 a[4:7], a[196:199], v[44:47], a[4:7]
 ds_read_b64_tr_b16 a[220:221], v2 offset:50784
 v_mfma_f32_16x16x32_bf16 a[4:7], a[192:195], v[228:231], a[4:7]
 s_waitcnt lgkmcnt(7)
 ds_read_b64_tr_b16 a[222:223], v2 offset:51296
 v_mfma_f32_16x16x32_bf16 a[16:19], a[200:203], v[228:231], a[16:19]
 ds_read_b64_tr_b16 a[192:193], v2 offset:33920
 v_mfma_f32_16x16x32_bf16 a[16:19], a[204:207], v[44:47], a[16:19]
 ds_read_b64_tr_b16 a[194:195], v2 offset:34432
 v_mfma_f32_16x16x32_bf16 a[12:15], a[204:207], v[40:43], a[12:15]
 s_add_u32 m0, s74, 0x20
 ds_read_b64_tr_b16 a[196:197], v2 offset:50816
 v_mfma_f32_16x16x32_bf16 a[12:15], a[200:203], v[224:227], a[12:15]
 s_waitcnt lgkmcnt(7)
 buffer_load_dwordx4 v3, s[52:55], s76 offen offset:1024 nt lds
 ds_read_b64_tr_b16 a[198:199], v2 offset:51328
 v_mfma_f32_16x16x32_bf16 a[24:27], a[208:211], v[224:227], a[24:27]
 ds_read_b64_tr_b16 a[200:201], v2 offset:33952
 v_mfma_f32_16x16x32_bf16 a[24:27], a[212:215], v[40:43], a[24:27]
 ds_read_b64_tr_b16 a[202:203], v2 offset:34464
 v_mfma_f32_16x16x32_bf16 a[28:31], a[212:215], v[44:47], a[28:31]
 ds_read_b64_tr_b16 a[204:205], v2 offset:50848
 v_mfma_f32_16x16x32_bf16 a[28:31], a[208:211], v[228:231], a[28:31]
 s_waitcnt lgkmcnt(7)
 ds_read_b64_tr_b16 a[206:207], v2 offset:51360
 v_mfma_f32_16x16x32_bf16 a[40:43], a[216:219], v[228:231], a[40:43]
 ds_read_b64_tr_b16 a[208:209], v2 offset:33984
 v_mfma_f32_16x16x32_bf16 a[40:43], a[220:223], v[44:47], a[40:43]
 s_add_u32 m0, s74, 0x40
 ds_read_b64_tr_b16 a[210:211], v2 offset:34496
 v_mfma_f32_16x16x32_bf16 a[36:39], a[220:223], v[40:43], a[36:39]
 buffer_load_dwordx4 v3, s[52:55], s76 offen offset:2048 nt lds
 ds_read_b64_tr_b16 a[212:213], v2 offset:50880
 v_mfma_f32_16x16x32_bf16 a[36:39], a[216:219], v[224:227], a[36:39]
 s_waitcnt lgkmcnt(7)
 ds_read_b64_tr_b16 a[214:215], v2 offset:51392
 v_exp_f32 v28, v128
 v_mfma_f32_16x16x32_bf16 a[48:51], a[192:195], v[224:227], a[48:51]
 ds_read_b64_tr_b16 a[216:217], v2 offset:34016
 v_mfma_f32_16x16x32_bf16 a[48:51], a[196:199], v[40:43], a[48:51]
 ds_read_b64_tr_b16 a[218:219], v2 offset:34528
 v_mfma_f32_16x16x32_bf16 a[52:55], a[196:199], v[44:47], a[52:55]
 ds_read_b64_tr_b16 a[220:221], v2 offset:50912
 v_mfma_f32_16x16x32_bf16 a[52:55], a[192:195], v[228:231], a[52:55]
 s_waitcnt lgkmcnt(7)
 ds_read_b64_tr_b16 a[222:223], v2 offset:51424
 v_mfma_f32_16x16x32_bf16 a[64:67], a[200:203], v[228:231], a[64:67]
 s_add_u32 m0, s74, 0x60
 ds_read_b64_tr_b16 a[192:193], v2 offset:34048
 v_exp_f32 v29, v129
 v_mfma_f32_16x16x32_bf16 a[64:67], a[204:207], v[44:47], a[64:67]
 buffer_load_dwordx4 v3, s[52:55], s76 offen offset:3072 nt lds
 ds_read_b64_tr_b16 a[194:195], v2 offset:34560
 v_mfma_f32_16x16x32_bf16 a[60:63], a[204:207], v[40:43], a[60:63]
 ds_read_b64_tr_b16 a[196:197], v2 offset:50944
 v_add_f32 v11, v28, v29
 v_mfma_f32_16x16x32_bf16 a[60:63], a[200:203], v[224:227], a[60:63]
 s_waitcnt lgkmcnt(7)
 ds_read_b64_tr_b16 a[198:199], v2 offset:51456
 v_cvt_pk_bf16_f32 v52, v28, v29
 v_mfma_f32_16x16x32_bf16 a[72:75], a[208:211], v[224:227], a[72:75]
 ds_read_b64_tr_b16 a[200:201], v2 offset:34080
 v_exp_f32 v30, v130
 v_mfma_f32_16x16x32_bf16 a[72:75], a[212:215], v[40:43], a[72:75]
 ds_read_b64_tr_b16 a[202:203], v2 offset:34592
 v_add_f32 v11, v11, v30
 v_mfma_f32_16x16x32_bf16 a[76:79], a[212:215], v[44:47], a[76:79]
 ds_read_b64_tr_b16 a[204:205], v2 offset:50976
 v_mfma_f32_16x16x32_bf16 a[76:79], a[208:211], v[228:231], a[76:79]
 s_waitcnt lgkmcnt(7)
 s_add_u32 m0, s74, 0x1080
 ds_read_b64_tr_b16 a[206:207], v2 offset:51488
 v_mfma_f32_16x16x32_bf16 a[88:91], a[216:219], v[228:231], a[88:91]
 buffer_load_dwordx4 v4, s[52:55], s76 offen offset:0 nt lds
 ds_read_b64_tr_b16 a[208:209], v2 offset:34112
 v_mfma_f32_16x16x32_bf16 a[88:91], a[220:223], v[44:47], a[88:91]
 ds_read_b64_tr_b16 a[210:211], v2 offset:34624
 v_mfma_f32_16x16x32_bf16 a[84:87], a[220:223], v[40:43], a[84:87]
 ds_read_b64_tr_b16 a[212:213], v2 offset:51008
 v_mfma_f32_16x16x32_bf16 a[84:87], a[216:219], v[224:227], a[84:87]
 s_waitcnt lgkmcnt(7)
 ds_read_b64_tr_b16 a[214:215], v2 offset:51520
 v_exp_f32 v31, v131
 v_mfma_f32_16x16x32_bf16 a[96:99], a[192:195], v[224:227], a[96:99]
 ds_read_b64_tr_b16 a[216:217], v2 offset:34144
 v_add_f32 v11, v11, v31
 v_mfma_f32_16x16x32_bf16 a[96:99], a[196:199], v[40:43], a[96:99]
 ds_read_b64_tr_b16 a[218:219], v2 offset:34656
 v_cvt_pk_bf16_f32 v53, v30, v31
 v_mfma_f32_16x16x32_bf16 a[100:103], a[196:199], v[44:47], a[100:103]
 s_add_u32 m0, s74, 0x10a0
 ds_read_b64_tr_b16 a[220:221], v2 offset:51040
 v_exp_f32 v32, v140
 v_mfma_f32_16x16x32_bf16 a[100:103], a[192:195], v[228:231], a[100:103]
 s_waitcnt lgkmcnt(7)
 buffer_load_dwordx4 v4, s[52:55], s76 offen offset:1024 nt lds
 ds_read_b64_tr_b16 a[222:223], v2 offset:51552
 v_mfma_f32_16x16x32_bf16 a[112:115], a[200:203], v[228:231], a[112:115]
 ds_read_b64_tr_b16 a[192:193], v2 offset:34176
 v_exp_f32 v33, v141
 v_mfma_f32_16x16x32_bf16 a[112:115], a[204:207], v[44:47], a[112:115]
 ds_read_b64_tr_b16 a[194:195], v2 offset:34688
 v_add_f32 v11, v11, v32
 v_mfma_f32_16x16x32_bf16 a[108:111], a[204:207], v[40:43], a[108:111]
 ds_read_b64_tr_b16 a[196:197], v2 offset:51072
 v_add_f32 v11, v11, v33
 v_mfma_f32_16x16x32_bf16 a[108:111], a[200:203], v[224:227], a[108:111]
 s_waitcnt lgkmcnt(7)
 ds_read_b64_tr_b16 a[198:199], v2 offset:51584
 v_exp_f32 v34, v142
 v_mfma_f32_16x16x32_bf16 a[120:123], a[208:211], v[224:227], a[120:123]
 ds_read_b64_tr_b16 a[200:201], v2 offset:34208
 v_cvt_pk_bf16_f32 v54, v32, v33
 v_mfma_f32_16x16x32_bf16 a[120:123], a[212:215], v[40:43], a[120:123]
 s_add_u32 m0, s74, 0x10c0
 ds_read_b64_tr_b16 a[202:203], v2 offset:34720
 v_add_f32 v11, v11, v34
 v_mfma_f32_16x16x32_bf16 a[124:127], a[212:215], v[44:47], a[124:127]
 buffer_load_dwordx4 v4, s[52:55], s76 offen offset:2048 nt lds
 ds_read_b64_tr_b16 a[204:205], v2 offset:51104
 v_add_f32 v9, v9, v12
 v_mfma_f32_16x16x32_bf16 a[124:127], a[208:211], v[228:231], a[124:127]
 s_waitcnt lgkmcnt(7)
 ds_read_b64_tr_b16 a[206:207], v2 offset:51616
 v_mfma_f32_16x16x32_bf16 a[136:139], a[216:219], v[228:231], a[136:139]
 ds_read_b64_tr_b16 a[208:209], v2 offset:34240
L1_PADW0:
 s_cbranch_execz L1_PRL1
 v_exp_f32 v35, v143
 v_mfma_f32_16x16x32_bf16 a[136:139], a[220:223], v[44:47], a[136:139]
 ds_read_b64_tr_b16 a[210:211], v2 offset:34752
 v_add_f32 v11, v11, v35
 v_mfma_f32_16x16x32_bf16 a[132:135], a[220:223], v[40:43], a[132:135]
 ds_read_b64_tr_b16 a[212:213], v2 offset:51136
 v_cvt_pk_bf16_f32 v55, v34, v35
 v_mfma_f32_16x16x32_bf16 a[132:135], a[216:219], v[224:227], a[132:135]
 s_waitcnt lgkmcnt(7)
 ds_read_b64_tr_b16 a[214:215], v2 offset:51648
 v_exp_f32 v28, v132
 v_mfma_f32_16x16x32_bf16 a[144:147], a[192:195], v[224:227], a[144:147]
 s_add_u32 m0, s74, 0x10e0
 ds_read_b64_tr_b16 a[216:217], v2 offset:34272
 v_mfma_f32_16x16x32_bf16 a[144:147], a[196:199], v[40:43], a[144:147]
 buffer_load_dwordx4 v4, s[52:55], s76 offen offset:3072 nt lds
 ds_read_b64_tr_b16 a[218:219], v2 offset:34784
 v_mfma_f32_16x16x32_bf16 a[148:151], a[196:199], v[44:47], a[148:151]
 ds_read_b64_tr_b16 a[220:221], v2 offset:51168
 v_mfma_f32_16x16x32_bf16 a[148:151], a[192:195], v[228:231], a[148:151]
 s_waitcnt lgkmcnt(7)
 ds_read_b64_tr_b16 a[222:223], v2 offset:51680
 v_exp_f32 v29, v133
 v_mfma_f32_16x16x32_bf16 a[160:163], a[200:203], v[228:231], a[160:163]
 v_exp_f32 v30, v134
 v_add_f32 v12, v28, v29
 v_mfma_f32_16x16x32_bf16 a[160:163], a[204:207], v[44:47], a[160:163]
 v_exp_f32 v31, v135
 v_mfma_f32_16x16x32_bf16 a[156:159], a[204:207], v[40:43], a[156:159]
 v_exp_f32 v32, v144
 v_cvt_pk_bf16_f32 v56, v28, v29
 v_mfma_f32_16x16x32_bf16 a[156:159], a[200:203], v[224:227], a[156:159]
 s_waitcnt lgkmcnt(4)
 v_lshlrev_b32 v254, 7, v7
 v_exp_f32 v33, v145
 v_add_f32 v12, v12, v30
 v_mfma_f32_16x16x32_bf16 a[168:171], a[208:211], v[224:227], a[168:171]
 buffer_load_dword v255, v254, s[60:63], s70 offen offset:0
 v_mfma_f32_16x16x32_bf16 a[168:171], a[212:215], v[40:43], a[168:171]
 v_exp_f32 v34, v146
 v_add_f32 v12, v12, v31
 v_mfma_f32_16x16x32_bf16 a[172:175], a[212:215], v[44:47], a[172:175]
 v_exp_f32 v35, v147
 v_mfma_f32_16x16x32_bf16 a[172:175], a[208:211], v[228:231], a[172:175]
 s_waitcnt lgkmcnt(0)
 v_cvt_pk_bf16_f32 v57, v30, v31
 v_add_f32 v12, v12, v32
 v_add_f32 v12, v12, v33
 v_mfma_f32_16x16x32_bf16 a[184:187], a[216:219], v[228:231], a[184:187]
 v_cvt_pk_bf16_f32 v58, v32, v33
 v_add_f32 v12, v12, v34
 v_mfma_f32_16x16x32_bf16 a[184:187], a[220:223], v[44:47], a[184:187]
 v_add_f32 v12, v12, v35
 s_waitcnt vmcnt(17)
 s_barrier
 v_mfma_f32_16x16x32_bf16 a[180:183], a[220:223], v[40:43], a[180:183]
 ds_read_b128 a[192:195], v1 offset:33792
 v_cvt_pk_bf16_f32 v59, v34, v35
 v_add_u32 v253, 0xfffef800, v2
 v_mfma_f32_16x16x32_bf16 a[180:183], a[216:219], v[224:227], a[180:183]
 s_waitcnt lgkmcnt(0)
 ds_read_b128 a[196:199], v1 offset:33824
 ds_read_b128 a[200:203], v1 offset:33856
 ds_read_b128 a[204:207], v1 offset:33888
 ds_read_b128 a[208:211], v1 offset:33920
 ds_read_b128 a[212:215], v1 offset:33952
 s_waitcnt lgkmcnt(4)
 v_mfma_f32_16x16x32_bf16 v[176:179], a[192:195], v[64:67], v[16:19]
 ds_read_b128 a[216:219], v1 offset:33984
 v_mfma_f32_16x16x32_bf16 v[176:179], a[196:199], v[68:71], v[176:179]
 v_exp_f32 v28, v152
 v_mfma_f32_16x16x32_bf16 v[180:183], a[196:199], v[100:103], v[20:23]
 ds_read_b128 a[220:223], v1 offset:34016
 v_add_f32 v11, v11, v28
 v_mfma_f32_16x16x32_bf16 v[180:183], a[192:195], v[96:99], v[180:183]
 s_waitcnt lgkmcnt(4)
 v_exp_f32 v29, v153
 v_mfma_f32_16x16x32_bf16 v[180:183], a[200:203], v[104:107], v[180:183]
 ds_read_b128 a[192:195], v1 offset:34304
 v_add_f32 v11, v11, v29
 v_mfma_f32_16x16x32_bf16 v[180:183], a[204:207], v[108:111], v[180:183]
 v_exp_f32 v30, v154
 v_mfma_f32_16x16x32_bf16 v[176:179], a[204:207], v[76:79], v[176:179]
 ds_read_b128 a[196:199], v1 offset:34336
 v_cvt_pk_bf16_f32 v40, v28, v29
 v_mfma_f32_16x16x32_bf16 v[176:179], a[200:203], v[72:75], v[176:179]
 s_waitcnt lgkmcnt(4)
 v_exp_f32 v31, v155
 v_add_f32 v11, v11, v30
 v_mfma_f32_16x16x32_bf16 v[176:179], a[208:211], v[80:83], v[176:179]
 ds_read_b128 a[200:203], v1 offset:34368
 v_add_f32 v11, v11, v31
 v_mfma_f32_16x16x32_bf16 v[176:179], a[212:215], v[84:87], v[176:179]
 v_exp_f32 v32, v164
 v_mfma_f32_16x16x32_bf16 v[180:183], a[212:215], v[116:119], v[180:183]
 ds_read_b128 a[204:207], v1 offset:34400
 v_cvt_pk_bf16_f32 v41, v30, v31
 v_mfma_f32_16x16x32_bf16 v[180:183], a[208:211], v[112:115], v[180:183]
 s_waitcnt lgkmcnt(4)
 v_exp_f32 v33, v165
 v_mfma_f32_16x16x32_bf16 v[180:183], a[216:219], v[120:123], v[180:183]
 ds_read_b128 a[208:211], v1 offset:34432
 v_add_f32 v11, v11, v32
 v_mfma_f32_16x16x32_bf16 v[180:183], a[220:223], v[124:127], v[180:183]
 v_exp_f32 v34, v166
 v_mfma_f32_16x16x32_bf16 v[176:179], a[220:223], v[92:95], v[176:179]
 ds_read_b128 a[212:215], v1 offset:34464
 v_exp_f32 v35, v167
 v_mfma_f32_16x16x32_bf16 v[176:179], a[216:219], v[88:91], v[176:179]
 s_waitcnt lgkmcnt(4)
 v_exp_f32 v28, v156
 v_mfma_f32_16x16x32_bf16 v[188:191], a[192:195], v[64:67], v[16:19]
 ds_read_b128 a[216:219], v1 offset:34496
 v_add_f32 v11, v11, v33
 v_mfma_f32_16x16x32_bf16 v[188:191], a[196:199], v[68:71], v[188:191]
 v_exp_f32 v29, v157
 v_mfma_f32_16x16x32_bf16 v[192:195], a[196:199], v[100:103], v[20:23]
 ds_read_b128 a[220:223], v1 offset:34528
 v_cvt_pk_bf16_f32 v42, v32, v33
 v_mfma_f32_16x16x32_bf16 v[192:195], a[192:195], v[96:99], v[192:195]
 s_waitcnt lgkmcnt(4)
 v_exp_f32 v30, v158
 v_mfma_f32_16x16x32_bf16 v[192:195], a[200:203], v[104:107], v[192:195]
 ds_read_b128 a[192:195], v1 offset:50432
 v_add_f32 v11, v11, v34
 v_mfma_f32_16x16x32_bf16 v[192:195], a[204:207], v[108:111], v[192:195]
 v_exp_f32 v31, v159
 v_add_f32 v11, v11, v35
 v_mfma_f32_16x16x32_bf16 v[188:191], a[204:207], v[76:79], v[188:191]
 ds_read_b128 a[196:199], v1 offset:50464
 v_cvt_pk_bf16_f32 v43, v34, v35
 v_mfma_f32_16x16x32_bf16 v[188:191], a[200:203], v[72:75], v[188:191]
 s_waitcnt lgkmcnt(4)
 v_exp_f32 v32, v168
 v_mfma_f32_16x16x32_bf16 v[188:191], a[208:211], v[80:83], v[188:191]
 ds_read_b128 a[200:203], v1 offset:50496
 v_add_f32 v12, v12, v28
 v_mfma_f32_16x16x32_bf16 v[188:191], a[212:215], v[84:87], v[188:191]
 v_exp_f32 v33, v169
 v_mfma_f32_16x16x32_bf16 v[192:195], a[212:215], v[116:119], v[192:195]
 ds_read_b128 a[204:207], v1 offset:50528
 v_add_f32 v12, v12, v29
 v_mfma_f32_16x16x32_bf16 v[192:195], a[208:211], v[112:115], v[192:195]
 s_waitcnt lgkmcnt(4)
 v_exp_f32 v34, v170
 v_mfma_f32_16x16x32_bf16 v[192:195], a[216:219], v[120:123], v[192:195]
 ds_read_b128 a[208:211], v1 offset:50560
 v_cvt_pk_bf16_f32 v44, v28, v29
 v_mfma_f32_16x16x32_bf16 v[192:195], a[220:223], v[124:127], v[192:195]
 v_exp_f32 v35, v171
 v_add_f32 v12, v12, v30
 v_mfma_f32_16x16x32_bf16 v[188:191], a[220:223], v[92:95], v[188:191]
 ds_read_b128 a[212:215], v1 offset:50592
 v_add_f32 v12, v12, v31
 v_mfma_f32_16x16x32_bf16 v[188:191], a[216:219], v[88:91], v[188:191]
 s_waitcnt lgkmcnt(4)
 v_cvt_pk_bf16_f32 v45, v30, v31
 v_add_f32 v12, v12, v32
 v_mfma_f32_16x16x32_bf16 v[200:203], a[192:195], v[64:67], v[16:19]
 ds_read_b128 a[216:219], v1 offset:50624
 v_add_f32 v12, v12, v33
 v_mfma_f32_16x16x32_bf16 v[200:203], a[196:199], v[68:71], v[200:203]
 v_cvt_pk_bf16_f32 v46, v32, v33
 v_add_f32 v12, v12, v34
 v_mfma_f32_16x16x32_bf16 v[204:207], a[196:199], v[100:103], v[20:23]
 ds_read_b128 a[220:223], v1 offset:50656
 v_add_f32 v12, v12, v35
 v_mfma_f32_16x16x32_bf16 v[204:207], a[192:195], v[96:99], v[204:207]
 s_waitcnt lgkmcnt(4)
 v_exp_f32 v28, v180
 v_mfma_f32_16x16x32_bf16 v[204:207], a[200:203], v[104:107], v[204:207]
 ds_read_b128 a[192:195], v1 offset:50944
 v_cvt_pk_bf16_f32 v47, v34, v35
 v_mfma_f32_16x16x32_bf16 v[204:207], a[204:207], v[108:111], v[204:207]
 v_exp_f32 v29, v181
 v_mfma_f32_16x16x32_bf16 v[200:203], a[204:207], v[76:79], v[200:203]
 ds_read_b128 a[196:199], v1 offset:50976
 v_exp_f32 v30, v182
 v_mfma_f32_16x16x32_bf16 v[200:203], a[200:203], v[72:75], v[200:203]
 s_waitcnt lgkmcnt(4)
 v_exp_f32 v31, v183
 v_mfma_f32_16x16x32_bf16 v[200:203], a[208:211], v[80:83], v[200:203]
 ds_read_b128 a[200:203], v1 offset:51008
 v_max_f32 v14, v11, v12
 v_mfma_f32_16x16x32_bf16 v[200:203], a[212:215], v[84:87], v[200:203]
 v_exp_f32 v32, v192
 v_mfma_f32_16x16x32_bf16 v[204:207], a[212:215], v[116:119], v[204:207]
 ds_read_b128 a[204:207], v1 offset:51040
 v_cmp_nge_f32 vcc, s78, v14
 v_mfma_f32_16x16x32_bf16 v[204:207], a[208:211], v[112:115], v[204:207]
 s_waitcnt lgkmcnt(4)
 v_exp_f32 v33, v193
 v_mfma_f32_16x16x32_bf16 v[204:207], a[216:219], v[120:123], v[204:207]
 ds_read_b128 a[208:211], v1 offset:51072
 v_add_f32 v249, v28, v29
 v_mfma_f32_16x16x32_bf16 v[204:207], a[220:223], v[124:127], v[204:207]
 v_exp_f32 v34, v194
 v_mfma_f32_16x16x32_bf16 v[200:203], a[220:223], v[92:95], v[200:203]
 ds_read_b128 a[212:215], v1 offset:51104
 v_cvt_pk_bf16_f32 v228, v28, v29
 v_mfma_f32_16x16x32_bf16 v[200:203], a[216:219], v[88:91], v[200:203]
 s_waitcnt lgkmcnt(4)
 v_exp_f32 v35, v195
 v_mfma_f32_16x16x32_bf16 v[212:215], a[192:195], v[64:67], v[16:19]
 ds_read_b128 a[216:219], v1 offset:51136
 v_exp_f32 v28, v176
 v_mfma_f32_16x16x32_bf16 v[212:215], a[196:199], v[68:71], v[212:215]
 v_exp_f32 v29, v177
 v_mfma_f32_16x16x32_bf16 v[216:219], a[196:199], v[100:103], v[20:23]
 ds_read_b128 a[220:223], v1 offset:51168
 v_add_f32 v249, v249, v30
 v_mfma_f32_16x16x32_bf16 v[216:219], a[192:195], v[96:99], v[216:219]
 s_waitcnt lgkmcnt(4)
 v_add_f32 v249, v249, v31
 v_cvt_pk_bf16_f32 v229, v30, v31
 v_mfma_f32_16x16x32_bf16 v[216:219], a[200:203], v[104:107], v[216:219]
 v_exp_f32 v30, v178
 v_mfma_f32_16x16x32_bf16 v[216:219], a[204:207], v[108:111], v[216:219]
 v_exp_f32 v31, v179
 v_mfma_f32_16x16x32_bf16 v[212:215], a[204:207], v[76:79], v[212:215]
 v_add_f32 v249, v249, v32
 v_add_f32 v249, v249, v33
 v_mfma_f32_16x16x32_bf16 v[212:215], a[200:203], v[72:75], v[212:215]
 s_waitcnt lgkmcnt(2)
 v_cvt_pk_bf16_f32 v230, v32, v33
 v_add_f32 v249, v249, v34
 v_mfma_f32_16x16x32_bf16 v[212:215], a[208:211], v[80:83], v[212:215]
 v_exp_f32 v32, v188
 v_mfma_f32_16x16x32_bf16 v[212:215], a[212:215], v[84:87], v[212:215]
 v_exp_f32 v33, v189
 v_mfma_f32_16x16x32_bf16 v[216:219], a[212:215], v[116:119], v[216:219]
 v_add_f32 v249, v249, v35
 v_cvt_pk_bf16_f32 v231, v34, v35
 v_mfma_f32_16x16x32_bf16 v[216:219], a[208:211], v[112:115], v[216:219]
 s_waitcnt lgkmcnt(0)
 v_add_f32 v248, v28, v29
 v_cvt_pk_bf16_f32 v224, v28, v29
 v_mfma_f32_16x16x32_bf16 v[216:219], a[216:219], v[120:123], v[216:219]
 v_add_f32 v248, v248, v30
 v_add_f32 v248, v248, v31
 v_mfma_f32_16x16x32_bf16 v[216:219], a[220:223], v[124:127], v[216:219]
 s_waitcnt vmcnt(9)
 s_barrier
 v_mfma_f32_16x16x32_bf16 v[212:215], a[220:223], v[92:95], v[212:215]
 ds_read_b64_tr_b16 a[192:193], v2 offset:0
 v_cvt_pk_bf16_f32 v225, v30, v31
 v_mfma_f32_16x16x32_bf16 v[212:215], a[216:219], v[88:91], v[212:215]
 s_waitcnt lgkmcnt(0)
 s_mov_b32 s90, 4
 ds_read_b64_tr_b16 a[194:195], v2 offset:512
 ds_read_b64_tr_b16 a[196:197], v2 offset:16896
 ds_read_b64_tr_b16 a[198:199], v2 offset:17408
 ds_read_b64_tr_b16 a[200:201], v2 offset:32
 ds_read_b64_tr_b16 a[202:203], v2 offset:544
 ds_read_b64_tr_b16 a[204:205], v2 offset:16928
 ds_read_b64_tr_b16 a[206:207], v2 offset:17440
 ds_read_b64_tr_b16 a[208:209], v2 offset:64
 ds_read_b64_tr_b16 a[210:211], v2 offset:576
 ds_read_b64_tr_b16 a[212:213], v2 offset:16960
 ds_read_b64_tr_b16 a[214:215], v2 offset:17472
 s_cbranch_vccnz L1_RARE0_W3
L1_BACK4_W3:
 s_waitcnt lgkmcnt(8)
 v_mfma_f32_16x16x32_bf16 a[0:3], a[192:195], v[52:55], a[0:3]
 s_mov_b32 s82, 0x0
 s_add_u32 m0, s89, 0x20000
 ds_read_b64_tr_b16 a[216:217], v2 offset:96
 v_add_f32 v248, v248, v32
 v_mfma_f32_16x16x32_bf16 a[0:3], a[196:199], v[40:43], a[0:3]
 buffer_load_dwordx4 v6, s[60:63], s82 offen lds
 ds_read_b64_tr_b16 a[218:219], v2 offset:608
 v_mfma_f32_16x16x32_bf16 a[4:7], a[196:199], v[44:47], a[4:7]
 ds_read_b64_tr_b16 a[220:221], v2 offset:16992
 v_add_f32 v248, v248, v33
 v_mfma_f32_16x16x32_bf16 a[4:7], a[192:195], v[56:59], a[4:7]
 s_waitcnt lgkmcnt(7)
 ds_read_b64_tr_b16 a[222:223], v2 offset:17504
 v_cvt_pk_bf16_f32 v226, v32, v33
 v_mfma_f32_16x16x32_bf16 a[16:19], a[200:203], v[56:59], a[16:19]
 ds_read_b64_tr_b16 a[192:193], v2 offset:128
 v_mfma_f32_16x16x32_bf16 a[16:19], a[204:207], v[44:47], a[16:19]
 ds_read_b64_tr_b16 a[194:195], v2 offset:640
 v_mfma_f32_16x16x32_bf16 a[12:15], a[204:207], v[40:43], a[12:15]
 ds_read_b64_tr_b16 a[196:197], v2 offset:17024
 v_exp_f32 v34, v190
 v_mfma_f32_16x16x32_bf16 a[12:15], a[200:203], v[52:55], a[12:15]
 s_waitcnt lgkmcnt(7)
 s_mov_b32 s83, 0x1c00
 s_add_u32 m0, s89, 0x20400
 ds_read_b64_tr_b16 a[198:199], v2 offset:17536
 v_add_f32 v248, v248, v34
 v_mfma_f32_16x16x32_bf16 a[24:27], a[208:211], v[52:55], a[24:27]
 buffer_load_dwordx4 v6, s[60:63], s83 offen lds
 ds_read_b64_tr_b16 a[200:201], v2 offset:160
 v_mfma_f32_16x16x32_bf16 a[24:27], a[212:215], v[40:43], a[24:27]
 ds_read_b64_tr_b16 a[202:203], v2 offset:672
 v_mfma_f32_16x16x32_bf16 a[28:31], a[212:215], v[44:47], a[28:31]
 ds_read_b64_tr_b16 a[204:205], v2 offset:17056
 v_mfma_f32_16x16x32_bf16 a[28:31], a[208:211], v[56:59], a[28:31]
 s_waitcnt lgkmcnt(7)
 ds_read_b64_tr_b16 a[206:207], v2 offset:17568
 v_exp_f32 v35, v191
 v_mfma_f32_16x16x32_bf16 a[40:43], a[216:219], v[56:59], a[40:43]
 ds_read_b64_tr_b16 a[208:209], v2 offset:192
 v_add_f32 v248, v248, v35
 v_mfma_f32_16x16x32_bf16 a[40:43], a[220:223], v[44:47], a[40:43]
 ds_read_b64_tr_b16 a[210:211], v2 offset:704
 v_cvt_pk_bf16_f32 v227, v34, v35
 v_mfma_f32_16x16x32_bf16 a[36:39], a[220:223], v[40:43], a[36:39]
 s_mov_b32 s82, 0x3800
 s_add_u32 m0, s89, 0x20800
 ds_read_b64_tr_b16 a[212:213], v2 offset:17088
 v_mfma_f32_16x16x32_bf16 a[36:39], a[216:219], v[52:55], a[36:39]
 s_waitcnt lgkmcnt(7)
 buffer_load_dwordx4 v6, s[60:63], s82 offen lds
 ds_read_b64_tr_b16 a[214:215], v2 offset:17600
 v_mfma_f32_16x16x32_bf16 a[48:51], a[192:195], v[52:55], a[48:51]
 ds_read_b64_tr_b16 a[216:217], v2 offset:224
 v_exp_f32 v28, v200
 v_mfma_f32_16x16x32_bf16 a[48:51], a[196:199], v[40:43], a[48:51]
 ds_read_b64_tr_b16 a[218:219], v2 offset:736
 v_add_f32 v248, v248, v28
 v_mfma_f32_16x16x32_bf16 a[52:55], a[196:199], v[44:47], a[52:55]
 ds_read_b64_tr_b16 a[220:221], v2 offset:17120
 v_mfma_f32_16x16x32_bf16 a[52:55], a[192:195], v[56:59], a[52:55]
 s_waitcnt lgkmcnt(7)
 ds_read_b64_tr_b16 a[222:223], v2 offset:17632
 v_mfma_f32_16x16x32_bf16 a[64:67], a[200:203], v[56:59], a[64:67]
 ds_read_b64_tr_b16 a[192:193], v2 offset:256
 v_exp_f32 v29, v201
 v_mfma_f32_16x16x32_bf16 a[64:67], a[204:207], v[44:47], a[64:67]
 s_mov_b32 s83, 0x5400
 s_add_u32 m0, s89, 0x20c00
 ds_read_b64_tr_b16 a[194:195], v2 offset:768
 v_add_f32 v248, v248, v29
 v_mfma_f32_16x16x32_bf16 a[60:63], a[204:207], v[40:43], a[60:63]
 buffer_load_dwordx4 v6, s[60:63], s83 offen lds
 ds_read_b64_tr_b16 a[196:197], v2 offset:17152
 v_mfma_f32_16x16x32_bf16 a[60:63], a[200:203], v[52:55], a[60:63]
 s_waitcnt lgkmcnt(7)
 ds_read_b64_tr_b16 a[198:199], v2 offset:17664
 v_cvt_pk_bf16_f32 v160, v28, v29
 v_mfma_f32_16x16x32_bf16 a[72:75], a[208:211], v[52:55], a[72:75]
 ds_read_b64_tr_b16 a[200:201], v2 offset:288
 v_exp_f32 v30, v202
 v_mfma_f32_16x16x32_bf16 a[72:75], a[212:215], v[40:43], a[72:75]
 ds_read_b64_tr_b16 a[202:203], v2 offset:800
 v_add_f32 v248, v248, v30
 v_mfma_f32_16x16x32_bf16 a[76:79], a[212:215], v[44:47], a[76:79]
 ds_read_b64_tr_b16 a[204:205], v2 offset:17184
 v_mfma_f32_16x16x32_bf16 a[76:79], a[208:211], v[56:59], a[76:79]
 s_waitcnt lgkmcnt(7)
 ds_read_b64_tr_b16 a[206:207], v2 offset:17696
 v_exp_f32 v31, v203
 v_mfma_f32_16x16x32_bf16 a[88:91], a[216:219], v[56:59], a[88:91]
 ds_read_b64_tr_b16 a[208:209], v2 offset:320
 v_add_f32 v248, v248, v31
 v_mfma_f32_16x16x32_bf16 a[88:91], a[220:223], v[44:47], a[88:91]
 s_mov_b32 s82, 0x7000
 s_add_u32 m0, s89, 0x21000
 ds_read_b64_tr_b16 a[210:211], v2 offset:832
 v_cvt_pk_bf16_f32 v161, v30, v31
 v_mfma_f32_16x16x32_bf16 a[84:87], a[220:223], v[40:43], a[84:87]
 buffer_load_dwordx4 v6, s[60:63], s82 offen lds
 ds_read_b64_tr_b16 a[212:213], v2 offset:17216
 v_mfma_f32_16x16x32_bf16 a[84:87], a[216:219], v[52:55], a[84:87]
 s_waitcnt lgkmcnt(7)
 ds_read_b64_tr_b16 a[214:215], v2 offset:17728
 v_exp_f32 v32, v212
 v_mfma_f32_16x16x32_bf16 a[96:99], a[192:195], v[52:55], a[96:99]
 ds_read_b64_tr_b16 a[216:217], v2 offset:352
 v_add_f32 v248, v248, v32
 v_mfma_f32_16x16x32_bf16 a[96:99], a[196:199], v[40:43], a[96:99]
 ds_read_b64_tr_b16 a[218:219], v2 offset:864
 v_mfma_f32_16x16x32_bf16 a[100:103], a[196:199], v[44:47], a[100:103]
 ds_read_b64_tr_b16 a[220:221], v2 offset:17248
 v_exp_f32 v33, v213
 v_mfma_f32_16x16x32_bf16 a[100:103], a[192:195], v[56:59], a[100:103]
 s_waitcnt lgkmcnt(7)
 ds_read_b64_tr_b16 a[222:223], v2 offset:17760
 v_add_f32 v248, v248, v33
 v_mfma_f32_16x16x32_bf16 a[112:115], a[200:203], v[56:59], a[112:115]
 s_mov_b32 s83, 0x8c00
 s_add_u32 m0, s89, 0x21400
 ds_read_b64_tr_b16 a[192:193], v2 offset:384
 v_cvt_pk_bf16_f32 v162, v32, v33
 v_mfma_f32_16x16x32_bf16 a[112:115], a[204:207], v[44:47], a[112:115]
 buffer_load_dwordx4 v6, s[60:63], s83 offen lds
 ds_read_b64_tr_b16 a[194:195], v2 offset:896
 v_mfma_f32_16x16x32_bf16 a[108:111], a[204:207], v[40:43], a[108:111]
 ds_read_b64_tr_b16 a[196:197], v2 offset:17280
 v_mfma_f32_16x16x32_bf16 a[108:111], a[200:203], v[52:55], a[108:111]
 s_waitcnt lgkmcnt(7)
 ds_read_b64_tr_b16 a[198:199], v2 offset:17792
 v_mfma_f32_16x16x32_bf16 a[120:123], a[208:211], v[52:55], a[120:123]
 ds_read_b64_tr_b16 a[200:201], v2 offset:416
 v_exp_f32 v34, v214
 v_mfma_f32_16x16x32_bf16 a[120:123], a[212:215], v[40:43], a[120:123]
 ds_read_b64_tr_b16 a[202:203], v2 offset:928
 v_add_f32 v248, v248, v34
 v_mfma_f32_16x16x32_bf16 a[124:127], a[212:215], v[44:47], a[124:127]
 ds_read_b64_tr_b16 a[204:205], v2 offset:17312
 v_exp_f32 v35, v215
 v_mfma_f32_16x16x32_bf16 a[124:127], a[208:211], v[56:59], a[124:127]
 s_waitcnt lgkmcnt(7)
 s_mov_b32 s82, 0xa800
 s_add_u32 m0, s89, 0x21800
 ds_read_b64_tr_b16 a[206:207], v2 offset:17824
 v_add_f32 v248, v248, v35
 v_mfma_f32_16x16x32_bf16 a[136:139], a[216:219], v[56:59], a[136:139]
 buffer_load_dwordx4 v6, s[60:63], s82 offen lds
 ds_read_b64_tr_b16 a[208:209], v2 offset:448
 v_mfma_f32_16x16x32_bf16 a[136:139], a[220:223], v[44:47], a[136:139]
 ds_read_b64_tr_b16 a[210:211], v2 offset:960
 v_exp_f32 v28, v204
 v_mfma_f32_16x16x32_bf16 a[132:135], a[220:223], v[40:43], a[132:135]
 ds_read_b64_tr_b16 a[212:213], v2 offset:17344
 v_cvt_pk_bf16_f32 v163, v34, v35
 v_mfma_f32_16x16x32_bf16 a[132:135], a[216:219], v[52:55], a[132:135]
 s_waitcnt lgkmcnt(7)
 ds_read_b64_tr_b16 a[214:215], v2 offset:17856
 v_exp_f32 v29, v205
 v_mfma_f32_16x16x32_bf16 a[144:147], a[192:195], v[52:55], a[144:147]
 ds_read_b64_tr_b16 a[216:217], v2 offset:480
 v_add_f32 v249, v249, v28
 v_mfma_f32_16x16x32_bf16 a[144:147], a[196:199], v[40:43], a[144:147]
 ds_read_b64_tr_b16 a[218:219], v2 offset:992
 v_exp_f32 v30, v206
 v_mfma_f32_16x16x32_bf16 a[148:151], a[196:199], v[44:47], a[148:151]
 s_mov_b32 s83, 0xc400
 s_add_u32 m0, s89, 0x21c00
 ds_read_b64_tr_b16 a[220:221], v2 offset:17376
 v_add_f32 v249, v249, v29
 v_mfma_f32_16x16x32_bf16 a[148:151], a[192:195], v[56:59], a[148:151]
 s_waitcnt lgkmcnt(7)
 buffer_load_dwordx4 v6, s[60:63], s83 offen lds
 ds_read_b64_tr_b16 a[222:223], v2 offset:17888
 v_add_f32 v249, v249, v30
 v_mfma_f32_16x16x32_bf16 a[160:163], a[200:203], v[56:59], a[160:163]
 v_exp_f32 v31, v207
 v_mfma_f32_16x16x32_bf16 a[160:163], a[204:207], v[44:47], a[160:163]
 v_exp_f32 v32, v216
 v_mfma_f32_16x16x32_bf16 a[156:159], a[204:207], v[40:43], a[156:159]
 v_exp_f32 v33, v217
 v_add_f32 v249, v249, v31
 v_mfma_f32_16x16x32_bf16 a[156:159], a[200:203], v[52:55], a[156:159]
 s_waitcnt lgkmcnt(4)
 v_exp_f32 v34, v218
 v_mfma_f32_16x16x32_bf16 a[168:171], a[208:211], v[52:55], a[168:171]
 v_exp_f32 v35, v219
 v_add_f32 v249, v249, v32
 v_mfma_f32_16x16x32_bf16 a[168:171], a[212:215], v[40:43], a[168:171]
 v_add_f32 v249, v249, v33
 v_add_f32 v249, v249, v34
 v_mfma_f32_16x16x32_bf16 a[172:175], a[212:215], v[44:47], a[172:175]
 v_add_f32 v249, v249, v35
 v_max_f32 v14, v248, v249
 v_mfma_f32_16x16x32_bf16 a[172:175], a[208:211], v[56:59], a[172:175]
 s_waitcnt lgkmcnt(0)
 v_cmp_nge_f32 vcc, s78, v14
 v_add_f32 v8, v8, v11
 v_add_f32 v9, v9, v12
 v_mfma_f32_16x16x32_bf16 a[184:187], a[216:219], v[56:59], a[184:187]
 v_cvt_pk_bf16_f32 v164, v28, v29
 v_cvt_pk_bf16_f32 v165, v30, v31
 v_mfma_f32_16x16x32_bf16 a[184:187], a[220:223], v[44:47], a[184:187]
 s_waitcnt vmcnt(9)
 s_barrier
 v_mfma_f32_16x16x32_bf16 a[180:183], a[220:223], v[40:43], a[180:183]
 ds_read_b64_tr_b16 a[192:193], v253 offset:0
 v_cvt_pk_bf16_f32 v166, v32, v33
 v_cvt_pk_bf16_f32 v167, v34, v35
 v_mfma_f32_16x16x32_bf16 a[180:183], a[216:219], v[52:55], a[180:183]
 s_waitcnt lgkmcnt(0)
 s_mov_b32 s90, 5
 ds_read_b64_tr_b16 a[194:195], v253 offset:512
 ds_read_b64_tr_b16 a[196:197], v253 offset:16896
 ds_read_b64_tr_b16 a[198:199], v253 offset:17408
 ds_read_b64_tr_b16 a[200:201], v253 offset:32
 ds_read_b64_tr_b16 a[202:203], v253 offset:544
 ds_read_b64_tr_b16 a[204:205], v253 offset:16928
 ds_read_b64_tr_b16 a[206:207], v253 offset:17440
 ds_read_b64_tr_b16 a[208:209], v253 offset:64
 ds_read_b64_tr_b16 a[210:211], v253 offset:576
 ds_read_b64_tr_b16 a[212:213], v253 offset:16960
 ds_read_b64_tr_b16 a[214:215], v253 offset:17472
 s_cbranch_vccnz L1_RARE1_W3
L1_BACK5_W3:
 s_waitcnt lgkmcnt(8)
 v_mfma_f32_16x16x32_bf16 a[0:3], a[192:195], v[224:227], a[0:3]
 s_mov_b32 s82, 0x80
 s_add_u32 m0, s89, 0x10000
 ds_read_b64_tr_b16 a[216:217], v253 offset:96
 v_add_u32 v24, 0x20000, v36
 v_mfma_f32_16x16x32_bf16 a[0:3], a[196:199], v[160:163], a[0:3]
 buffer_load_dwordx4 v6, s[60:63], s82 offen lds
 ds_read_b64_tr_b16 a[218:219], v253 offset:608
 v_add_u32 v25, 0x20000, v37
 v_mfma_f32_16x16x32_bf16 a[4:7], a[196:199], v[164:167], a[4:7]
 ds_read_b64_tr_b16 a[220:221], v253 offset:16992
 v_add_u32 v26, 0x20000, v38
 v_add_u32 v27, 0x20000, v39
 v_mfma_f32_16x16x32_bf16 a[4:7], a[192:195], v[228:231], a[4:7]
 s_waitcnt lgkmcnt(7)
 s_mov_b32 s83, 0x1c80
 s_add_u32 m0, s89, 0x10400
 ds_read_b64_tr_b16 a[222:223], v253 offset:17504
 v_add_u32 v236, 0x10000, v36
 v_add_u32 v237, 0x10000, v37
 v_mfma_f32_16x16x32_bf16 a[16:19], a[200:203], v[228:231], a[16:19]
 buffer_load_dwordx4 v6, s[60:63], s83 offen lds
 ds_read_b64_tr_b16 a[192:193], v253 offset:128
 v_add_u32 v238, 0x10000, v38
 v_mfma_f32_16x16x32_bf16 a[16:19], a[204:207], v[164:167], a[16:19]
 ds_read_b64_tr_b16 a[194:195], v253 offset:640
 v_add_u32 v239, 0x10000, v39
 v_add_u32 v240, 0x38000, v5
 v_mfma_f32_16x16x32_bf16 a[12:15], a[204:207], v[160:163], a[12:15]
 ds_read_b64_tr_b16 a[196:197], v253 offset:17024
 v_add_u32 v241, 0x70000, v5
 v_add_f32 v8, v8, v248
 v_mfma_f32_16x16x32_bf16 a[12:15], a[200:203], v[224:227], a[12:15]
 s_waitcnt lgkmcnt(7)
 s_mov_b32 s82, 0x3880
 s_add_u32 m0, s89, 0x10800
 ds_read_b64_tr_b16 a[198:199], v253 offset:17536
 v_add_f32 v9, v9, v249
 v_mfma_f32_16x16x32_bf16 a[24:27], a[208:211], v[224:227], a[24:27]
 buffer_load_dwordx4 v6, s[60:63], s82 offen lds
 ds_read_b64_tr_b16 a[200:201], v253 offset:160
 v_mfma_f32_16x16x32_bf16 a[24:27], a[212:215], v[160:163], a[24:27]
 ds_read_b64_tr_b16 a[202:203], v253 offset:672
 v_mfma_f32_16x16x32_bf16 a[28:31], a[212:215], v[164:167], a[28:31]
 s_mov_b32 s83, 0x5480
 s_add_u32 m0, s89, 0x10c00
 ds_read_b64_tr_b16 a[204:205], v253 offset:17056
 v_accvgpr_read_b32 v28, a4
 v_accvgpr_read_b32 v29, a5
 v_mfma_f32_16x16x32_bf16 a[28:31], a[208:211], v[228:231], a[28:31]
 s_waitcnt lgkmcnt(7)
 buffer_load_dwordx4 v6, s[60:63], s83 offen lds
 ds_read_b64_tr_b16 a[206:207], v253 offset:17568
 v_accvgpr_read_b32 v30, a6
 v_mfma_f32_16x16x32_bf16 a[40:43], a[216:219], v[228:231], a[40:43]
 ds_read_b64_tr_b16 a[208:209], v253 offset:192
 v_accvgpr_read_b32 v31, a7
 v_cvt_pk_bf16_f32 v68, v28, v29
 v_mfma_f32_16x16x32_bf16 a[40:43], a[220:223], v[164:167], a[40:43]
 ds_read_b64_tr_b16 a[210:211], v253 offset:704
 v_cvt_pk_bf16_f32 v69, v30, v31
 v_accvgpr_read_b32 v32, a16
 v_mfma_f32_16x16x32_bf16 a[36:39], a[220:223], v[160:163], a[36:39]
 s_mov_b32 s82, 0x7080
 s_add_u32 m0, s89, 0x11000
 ds_read_b64_tr_b16 a[212:213], v253 offset:17088
 v_accvgpr_read_b32 v33, a17
 v_accvgpr_read_b32 v34, a18
 v_mfma_f32_16x16x32_bf16 a[36:39], a[216:219], v[224:227], a[36:39]
 s_waitcnt lgkmcnt(7)
 buffer_load_dwordx4 v6, s[60:63], s82 offen lds
 ds_read_b64_tr_b16 a[214:215], v253 offset:17600
 v_accvgpr_read_b32 v35, a19
 v_mfma_f32_16x16x32_bf16 a[48:51], a[192:195], v[224:227], a[48:51]
 ds_read_b64_tr_b16 a[216:217], v253 offset:224
 v_cvt_pk_bf16_f32 v70, v32, v33
 v_cvt_pk_bf16_f32 v71, v34, v35
 v_mfma_f32_16x16x32_bf16 a[48:51], a[196:199], v[160:163], a[48:51]
 ds_read_b64_tr_b16 a[218:219], v253 offset:736
 v_accvgpr_read_b32 v28, a0
 v_accvgpr_read_b32 v29, a1
 v_mfma_f32_16x16x32_bf16 a[52:55], a[196:199], v[164:167], a[52:55]
 s_mov_b32 s83, 0x8c80
 s_add_u32 m0, s89, 0x11400
 ds_read_b64_tr_b16 a[220:221], v253 offset:17120
 v_accvgpr_read_b32 v30, a2
 v_accvgpr_read_b32 v31, a3
 v_mfma_f32_16x16x32_bf16 a[52:55], a[192:195], v[228:231], a[52:55]
 s_waitcnt lgkmcnt(7)
 buffer_load_dwordx4 v6, s[60:63], s83 offen lds
 ds_read_b64_tr_b16 a[222:223], v253 offset:17632
 v_cvt_pk_bf16_f32 v64, v28, v29
 v_mfma_f32_16x16x32_bf16 a[64:67], a[200:203], v[228:231], a[64:67]
 ds_read_b64_tr_b16 a[192:193], v253 offset:256
 v_cvt_pk_bf16_f32 v65, v30, v31
 v_mfma_f32_16x16x32_bf16 a[64:67], a[204:207], v[164:167], a[64:67]
 s_mov_b32 s82, 0xa880
 s_add_u32 m0, s89, 0x11800
 ds_read_b64_tr_b16 a[194:195], v253 offset:768
 v_accvgpr_read_b32 v32, a12
 v_accvgpr_read_b32 v33, a13
 v_mfma_f32_16x16x32_bf16 a[60:63], a[204:207], v[160:163], a[60:63]
 buffer_load_dwordx4 v6, s[60:63], s82 offen lds
 ds_read_b64_tr_b16 a[196:197], v253 offset:17152
 v_accvgpr_read_b32 v34, a14
 v_mfma_f32_16x16x32_bf16 a[60:63], a[200:203], v[224:227], a[60:63]
 s_waitcnt lgkmcnt(7)
 ds_read_b64_tr_b16 a[198:199], v253 offset:17664
 v_accvgpr_read_b32 v35, a15
 v_cvt_pk_bf16_f32 v66, v32, v33
 v_mfma_f32_16x16x32_bf16 a[72:75], a[208:211], v[224:227], a[72:75]
 ds_read_b64_tr_b16 a[200:201], v253 offset:288
 v_cvt_pk_bf16_f32 v67, v34, v35
L1_PADW1:
 s_cbranch_execz L1_PRL1
 v_accvgpr_read_b32 v28, a28
 v_mfma_f32_16x16x32_bf16 a[72:75], a[212:215], v[160:163], a[72:75]
 s_mov_b32 s83, 0xc480
 s_add_u32 m0, s89, 0x11c00
 ds_read_b64_tr_b16 a[202:203], v253 offset:800
 v_accvgpr_read_b32 v29, a29
 v_accvgpr_read_b32 v30, a30
 v_mfma_f32_16x16x32_bf16 a[76:79], a[212:215], v[164:167], a[76:79]
 buffer_load_dwordx4 v6, s[60:63], s83 offen lds
 ds_read_b64_tr_b16 a[204:205], v253 offset:17184
 v_accvgpr_read_b32 v31, a31
 v_mfma_f32_16x16x32_bf16 a[76:79], a[208:211], v[228:231], a[76:79]
 s_waitcnt lgkmcnt(7)
 ds_read_b64_tr_b16 a[206:207], v253 offset:17696
 v_cvt_pk_bf16_f32 v80, v28, v29
 v_cvt_pk_bf16_f32 v81, v30, v31
 v_mfma_f32_16x16x32_bf16 a[88:91], a[216:219], v[228:231], a[88:91]
 ds_read_b64_tr_b16 a[208:209], v253 offset:320
 v_accvgpr_read_b32 v32, a40
 v_accvgpr_read_b32 v33, a41
 v_mfma_f32_16x16x32_bf16 a[88:91], a[220:223], v[164:167], a[88:91]
 s_mov_b32 s82, 0x100
 s_add_u32 m0, s89, 0x18000
 ds_read_b64_tr_b16 a[210:211], v253 offset:832
 v_accvgpr_read_b32 v34, a42
 v_accvgpr_read_b32 v35, a43
 v_mfma_f32_16x16x32_bf16 a[84:87], a[220:223], v[160:163], a[84:87]
 buffer_load_dwordx4 v6, s[60:63], s82 offen lds
 ds_read_b64_tr_b16 a[212:213], v253 offset:17216
 v_cvt_pk_bf16_f32 v82, v32, v33
 v_mfma_f32_16x16x32_bf16 a[84:87], a[216:219], v[224:227], a[84:87]
 s_waitcnt lgkmcnt(7)
 ds_read_b64_tr_b16 a[214:215], v253 offset:17728
 v_cvt_pk_bf16_f32 v83, v34, v35
 v_accvgpr_read_b32 v28, a24
 v_mfma_f32_16x16x32_bf16 a[96:99], a[192:195], v[224:227], a[96:99]
 s_mov_b32 s83, 0x1d00
 s_add_u32 m0, s89, 0x18400
 ds_read_b64_tr_b16 a[216:217], v253 offset:352
 v_accvgpr_read_b32 v29, a25
 v_mfma_f32_16x16x32_bf16 a[96:99], a[196:199], v[160:163], a[96:99]
 buffer_load_dwordx4 v6, s[60:63], s83 offen lds
 ds_read_b64_tr_b16 a[218:219], v253 offset:864
 v_accvgpr_read_b32 v30, a26
 v_mfma_f32_16x16x32_bf16 a[100:103], a[196:199], v[164:167], a[100:103]
 ds_read_b64_tr_b16 a[220:221], v253 offset:17248
 v_accvgpr_read_b32 v31, a27
 v_cvt_pk_bf16_f32 v76, v28, v29
 v_mfma_f32_16x16x32_bf16 a[100:103], a[192:195], v[228:231], a[100:103]
 s_waitcnt lgkmcnt(7)
 ds_read_b64_tr_b16 a[222:223], v253 offset:17760
 v_cvt_pk_bf16_f32 v77, v30, v31
 v_accvgpr_read_b32 v32, a36
 v_mfma_f32_16x16x32_bf16 a[112:115], a[200:203], v[228:231], a[112:115]
 s_mov_b32 s82, 0x3900
 s_add_u32 m0, s89, 0x18800
 ds_read_b64_tr_b16 a[192:193], v253 offset:384
 v_accvgpr_read_b32 v33, a37
 v_accvgpr_read_b32 v34, a38
 v_mfma_f32_16x16x32_bf16 a[112:115], a[204:207], v[164:167], a[112:115]
 buffer_load_dwordx4 v6, s[60:63], s82 offen lds
 ds_read_b64_tr_b16 a[194:195], v253 offset:896
 v_accvgpr_read_b32 v35, a39
 v_mfma_f32_16x16x32_bf16 a[108:111], a[204:207], v[160:163], a[108:111]
 ds_read_b64_tr_b16 a[196:197], v253 offset:17280
 v_cvt_pk_bf16_f32 v78, v32, v33
 v_cvt_pk_bf16_f32 v79, v34, v35
 v_mfma_f32_16x16x32_bf16 a[108:111], a[200:203], v[224:227], a[108:111]
 s_waitcnt lgkmcnt(7)
 s_mov_b32 s83, 0x5500
 s_add_u32 m0, s89, 0x18c00
 ds_read_b64_tr_b16 a[198:199], v253 offset:17792
 v_accvgpr_read_b32 v28, a52
 v_accvgpr_read_b32 v29, a53
 v_mfma_f32_16x16x32_bf16 a[120:123], a[208:211], v[224:227], a[120:123]
 buffer_load_dwordx4 v6, s[60:63], s83 offen lds
 ds_read_b64_tr_b16 a[200:201], v253 offset:416
 v_accvgpr_read_b32 v30, a54
 v_mfma_f32_16x16x32_bf16 a[120:123], a[212:215], v[160:163], a[120:123]
 ds_read_b64_tr_b16 a[202:203], v253 offset:928
 v_accvgpr_read_b32 v31, a55
 v_cvt_pk_bf16_f32 v92, v28, v29
 v_mfma_f32_16x16x32_bf16 a[124:127], a[212:215], v[164:167], a[124:127]
 ds_read_b64_tr_b16 a[204:205], v253 offset:17312
 v_cvt_pk_bf16_f32 v93, v30, v31
 v_accvgpr_read_b32 v32, a64
 v_mfma_f32_16x16x32_bf16 a[124:127], a[208:211], v[228:231], a[124:127]
 s_waitcnt lgkmcnt(7)
 s_mov_b32 s82, 0x7100
 s_add_u32 m0, s89, 0x19000
 ds_read_b64_tr_b16 a[206:207], v253 offset:17824
 v_accvgpr_read_b32 v33, a65
 v_accvgpr_read_b32 v34, a66
 v_mfma_f32_16x16x32_bf16 a[136:139], a[216:219], v[228:231], a[136:139]
 buffer_load_dwordx4 v6, s[60:63], s82 offen lds
 ds_read_b64_tr_b16 a[208:209], v253 offset:448
 v_mfma_f32_16x16x32_bf16 a[136:139], a[220:223], v[164:167], a[136:139]
 ds_read_b64_tr_b16 a[210:211], v253 offset:960
 v_accvgpr_read_b32 v35, a67
 v_cvt_pk_bf16_f32 v94, v32, v33
 v_mfma_f32_16x16x32_bf16 a[132:135], a[220:223], v[160:163], a[132:135]
 ds_read_b64_tr_b16 a[212:213], v253 offset:17344
 v_cvt_pk_bf16_f32 v95, v34, v35
 v_accvgpr_read_b32 v28, a48
 v_mfma_f32_16x16x32_bf16 a[132:135], a[216:219], v[224:227], a[132:135]
 s_waitcnt lgkmcnt(7)
 s_mov_b32 s83, 0x8d00
 s_add_u32 m0, s89, 0x19400
 ds_read_b64_tr_b16 a[214:215], v253 offset:17856
 v_accvgpr_read_b32 v29, a49
 v_accvgpr_read_b32 v30, a50
 v_mfma_f32_16x16x32_bf16 a[144:147], a[192:195], v[224:227], a[144:147]
 buffer_load_dwordx4 v6, s[60:63], s83 offen lds
 ds_read_b64_tr_b16 a[216:217], v253 offset:480
 v_accvgpr_read_b32 v31, a51
 v_mfma_f32_16x16x32_bf16 a[144:147], a[196:199], v[160:163], a[144:147]
 ds_read_b64_tr_b16 a[218:219], v253 offset:992
 v_cvt_pk_bf16_f32 v88, v28, v29
 v_cvt_pk_bf16_f32 v89, v30, v31
 v_mfma_f32_16x16x32_bf16 a[148:151], a[196:199], v[164:167], a[148:151]
 s_mov_b32 s82, 0xa900
 s_add_u32 m0, s89, 0x19800
 ds_read_b64_tr_b16 a[220:221], v253 offset:17376
 v_accvgpr_read_b32 v32, a60
 v_accvgpr_read_b32 v33, a61
 v_mfma_f32_16x16x32_bf16 a[148:151], a[192:195], v[228:231], a[148:151]
 s_waitcnt lgkmcnt(7)
 buffer_load_dwordx4 v6, s[60:63], s82 offen lds
 ds_read_b64_tr_b16 a[222:223], v253 offset:17888
 v_accvgpr_read_b32 v34, a62
 v_mfma_f32_16x16x32_bf16 a[160:163], a[200:203], v[228:231], a[160:163]
 v_accvgpr_read_b32 v35, a63
 v_cvt_pk_bf16_f32 v90, v32, v33
 v_cvt_pk_bf16_f32 v91, v34, v35
 v_mfma_f32_16x16x32_bf16 a[160:163], a[204:207], v[164:167], a[160:163]
 v_accvgpr_read_b32 v28, a76
 v_accvgpr_read_b32 v29, a77
 v_accvgpr_read_b32 v30, a78
 v_mfma_f32_16x16x32_bf16 a[156:159], a[204:207], v[160:163], a[156:159]
 s_mov_b32 s83, 0xc500
 s_add_u32 m0, s89, 0x19c00
 v_accvgpr_read_b32 v31, a79
 v_cvt_pk_bf16_f32 v104, v28, v29
 v_mfma_f32_16x16x32_bf16 a[156:159], a[200:203], v[224:227], a[156:159]
 s_waitcnt lgkmcnt(4)
 buffer_load_dwordx4 v6, s[60:63], s83 offen lds
 v_cvt_pk_bf16_f32 v105, v30, v31
 v_mfma_f32_16x16x32_bf16 a[168:171], a[208:211], v[224:227], a[168:171]
 v_accvgpr_read_b32 v32, a88
 v_accvgpr_read_b32 v33, a89
 v_accvgpr_read_b32 v34, a90
 v_mfma_f32_16x16x32_bf16 a[168:171], a[212:215], v[160:163], a[168:171]
 v_accvgpr_read_b32 v35, a91
 v_cvt_pk_bf16_f32 v106, v32, v33
 v_cvt_pk_bf16_f32 v107, v34, v35
 v_mfma_f32_16x16x32_bf16 a[172:175], a[212:215], v[164:167], a[172:175]
 v_accvgpr_read_b32 v28, a72
 v_accvgpr_read_b32 v29, a73
 v_accvgpr_read_b32 v30, a74
 v_mfma_f32_16x16x32_bf16 a[172:175], a[208:211], v[228:231], a[172:175]
 s_waitcnt lgkmcnt(0)
 v_accvgpr_read_b32 v31, a75
 v_cvt_pk_bf16_f32 v100, v28, v29
 v_cvt_pk_bf16_f32 v101, v30, v31
 v_mfma_f32_16x16x32_bf16 a[184:187], a[216:219], v[228:231], a[184:187]
 v_accvgpr_read_b32 v32, a84
 v_accvgpr_read_b32 v33, a85
 v_accvgpr_read_b32 v34, a86
 v_mfma_f32_16x16x32_bf16 a[184:187], a[220:223], v[164:167], a[184:187]
 s_waitcnt vmcnt(16)
 s_barrier
 v_mfma_f32_16x16x32_bf16 a[180:183], a[220:223], v[160:163], a[180:183]
 ds_read_b64_tr_b16 a[192:193], v24 offset:0
 v_accvgpr_read_b32 v35, a87
 v_cvt_pk_bf16_f32 v102, v32, v33
 v_mfma_f32_16x16x32_bf16 a[180:183], a[216:219], v[224:227], a[180:183]
 s_waitcnt lgkmcnt(0)
 ds_read_b64_tr_b16 a[194:195], v24 offset:2048
 ds_read_b64_tr_b16 a[196:197], v24 offset:4096
 ds_read_b64_tr_b16 a[198:199], v24 offset:6144
 ds_read_b64_tr_b16 a[200:201], v25 offset:0
 ds_read_b64_tr_b16 a[202:203], v25 offset:2048
 ds_read_b64_tr_b16 a[204:205], v25 offset:4096
 ds_read_b64_tr_b16 a[206:207], v25 offset:6144
 ds_read_b64_tr_b16 a[208:209], v26 offset:0
 ds_read_b64_tr_b16 a[210:211], v26 offset:2048
 ds_read_b64_tr_b16 a[212:213], v26 offset:4096
 ds_read_b64_tr_b16 a[214:215], v26 offset:6144
 v_cvt_pk_bf16_f32 v103, v34, v35
 s_waitcnt lgkmcnt(8)
 v_mfma_f32_16x16x32_bf16 v[176:179], a[192:195], v[64:67], 0
 s_mov_b32 s82, 0x180
 s_add_u32 m0, s89, 0x0
 ds_read_b64_tr_b16 a[216:217], v27 offset:0
 v_accvgpr_read_b32 v28, a96
 v_accvgpr_read_b32 v29, a97
 v_mfma_f32_16x16x32_bf16 v[176:179], a[196:199], v[76:79], v[176:179]
 buffer_load_dwordx4 v6, s[60:63], s82 offen lds
 ds_read_b64_tr_b16 a[218:219], v27 offset:2048
 v_accvgpr_read_b32 v30, a98
 v_mfma_f32_16x16x32_bf16 v[180:183], a[196:199], v[80:83], 0
 ds_read_b64_tr_b16 a[220:221], v27 offset:4096
 v_accvgpr_read_b32 v31, a99
 v_cvt_pk_bf16_f32 v112, v28, v29
 v_mfma_f32_16x16x32_bf16 v[180:183], a[192:195], v[68:71], v[180:183]
 s_waitcnt lgkmcnt(7)
 s_mov_b32 s83, 0x1d80
 s_add_u32 m0, s89, 0x400
 ds_read_b64_tr_b16 a[222:223], v27 offset:6144
 v_cvt_pk_bf16_f32 v113, v30, v31
 v_accvgpr_read_b32 v32, a108
 v_accvgpr_read_b32 v33, a109
 v_mfma_f32_16x16x32_bf16 v[192:195], a[200:203], v[68:71], 0
 buffer_load_dwordx4 v6, s[60:63], s83 offen lds
 ds_read_b64_tr_b16 a[192:193], v24 offset:8192
 v_accvgpr_read_b32 v34, a110
 v_mfma_f32_16x16x32_bf16 v[192:195], a[204:207], v[80:83], v[192:195]
 ds_read_b64_tr_b16 a[194:195], v24 offset:10240
 v_accvgpr_read_b32 v35, a111
 v_cvt_pk_bf16_f32 v114, v32, v33
 v_mfma_f32_16x16x32_bf16 v[188:191], a[204:207], v[76:79], 0
 ds_read_b64_tr_b16 a[196:197], v24 offset:12288
 v_cvt_pk_bf16_f32 v115, v34, v35
 v_accvgpr_read_b32 v28, a100
 v_accvgpr_read_b32 v29, a101
 v_mfma_f32_16x16x32_bf16 v[188:191], a[200:203], v[64:67], v[188:191]
 s_waitcnt lgkmcnt(7)
 s_mov_b32 s82, 0x3980
 s_add_u32 m0, s89, 0x800
 ds_read_b64_tr_b16 a[198:199], v24 offset:14336
 v_accvgpr_read_b32 v30, a102
 v_accvgpr_read_b32 v31, a103
 v_mfma_f32_16x16x32_bf16 v[200:203], a[208:211], v[64:67], 0
 buffer_load_dwordx4 v6, s[60:63], s82 offen lds
 ds_read_b64_tr_b16 a[200:201], v25 offset:8192
 v_cvt_pk_bf16_f32 v116, v28, v29
 v_mfma_f32_16x16x32_bf16 v[200:203], a[212:215], v[76:79], v[200:203]
 ds_read_b64_tr_b16 a[202:203], v25 offset:10240
 v_cvt_pk_bf16_f32 v117, v30, v31
 v_accvgpr_read_b32 v32, a112
 v_accvgpr_read_b32 v33, a113
 v_mfma_f32_16x16x32_bf16 v[204:207], a[212:215], v[80:83], 0
 s_mov_b32 s83, 0x5580
 s_add_u32 m0, s89, 0xc00
 ds_read_b64_tr_b16 a[204:205], v25 offset:12288
 v_accvgpr_read_b32 v34, a114
 v_accvgpr_read_b32 v35, a115
 v_mfma_f32_16x16x32_bf16 v[204:207], a[208:211], v[68:71], v[204:207]
 s_waitcnt lgkmcnt(7)
 buffer_load_dwordx4 v6, s[60:63], s83 offen lds
 ds_read_b64_tr_b16 a[206:207], v25 offset:14336
 v_cvt_pk_bf16_f32 v118, v32, v33
 v_mfma_f32_16x16x32_bf16 v[216:219], a[216:219], v[68:71], 0
 ds_read_b64_tr_b16 a[208:209], v26 offset:8192
 v_cvt_pk_bf16_f32 v119, v34, v35
 v_accvgpr_read_b32 v28, a120
 v_mfma_f32_16x16x32_bf16 v[216:219], a[220:223], v[80:83], v[216:219]
 ds_read_b64_tr_b16 a[210:211], v26 offset:10240
 v_accvgpr_read_b32 v29, a121
 v_accvgpr_read_b32 v30, a122
 v_accvgpr_read_b32 v31, a123
 v_mfma_f32_16x16x32_bf16 v[212:215], a[220:223], v[76:79], 0
 s_mov_b32 s82, 0x7180
 s_add_u32 m0, s89, 0x1000
 ds_read_b64_tr_b16 a[212:213], v26 offset:12288
 v_cvt_pk_bf16_f32 v124, v28, v29
 v_cvt_pk_bf16_f32 v125, v30, v31
 v_mfma_f32_16x16x32_bf16 v[212:215], a[216:219], v[64:67], v[212:215]
 s_waitcnt lgkmcnt(7)
 buffer_load_dwordx4 v6, s[60:63], s82 offen lds
 ds_read_b64_tr_b16 a[214:215], v26 offset:14336
 v_accvgpr_read_b32 v32, a132
 v_mfma_f32_16x16x32_bf16 v[176:179], a[192:195], v[88:91], v[176:179]
 ds_read_b64_tr_b16 a[216:217], v27 offset:8192
 v_accvgpr_read_b32 v33, a133
 v_accvgpr_read_b32 v34, a134
 v_accvgpr_read_b32 v35, a135
 v_mfma_f32_16x16x32_bf16 v[176:179], a[196:199], v[100:103], v[176:179]
 ds_read_b64_tr_b16 a[218:219], v27 offset:10240
 v_cvt_pk_bf16_f32 v126, v32, v33
 v_cvt_pk_bf16_f32 v127, v34, v35
 v_mfma_f32_16x16x32_bf16 v[180:183], a[196:199], v[104:107], v[180:183]
 s_mov_b32 s83, 0x8d80
 s_add_u32 m0, s89, 0x1400
 ds_read_b64_tr_b16 a[220:221], v27 offset:12288
 v_accvgpr_read_b32 v28, a124
 v_accvgpr_read_b32 v29, a125
 v_mfma_f32_16x16x32_bf16 v[180:183], a[192:195], v[92:95], v[180:183]
 s_waitcnt lgkmcnt(7)
 buffer_load_dwordx4 v6, s[60:63], s83 offen lds
 ds_read_b64_tr_b16 a[222:223], v27 offset:14336
 v_accvgpr_read_b32 v30, a126
 v_mfma_f32_16x16x32_bf16 v[192:195], a[200:203], v[92:95], v[192:195]
 ds_read_b64_tr_b16 a[192:193], v24 offset:16384
 v_accvgpr_read_b32 v31, a127
 v_cvt_pk_bf16_f32 v128, v28, v29
 v_cvt_pk_bf16_f32 v129, v30, v31
 v_mfma_f32_16x16x32_bf16 v[192:195], a[204:207], v[104:107], v[192:195]
 s_mov_b32 s82, 0xa980
 s_add_u32 m0, s89, 0x1800
 ds_read_b64_tr_b16 a[194:195], v24 offset:18432
 v_accvgpr_read_b32 v32, a136
 v_accvgpr_read_b32 v33, a137
 v_mfma_f32_16x16x32_bf16 v[188:191], a[204:207], v[100:103], v[188:191]
 buffer_load_dwordx4 v6, s[60:63], s82 offen lds
 ds_read_b64_tr_b16 a[196:197], v24 offset:20480
 v_accvgpr_read_b32 v34, a138
 v_mfma_f32_16x16x32_bf16 v[188:191], a[200:203], v[88:91], v[188:191]
 s_waitcnt lgkmcnt(7)
 ds_read_b64_tr_b16 a[198:199], v24 offset:22528
 v_accvgpr_read_b32 v35, a139
 v_cvt_pk_bf16_f32 v130, v32, v33
 v_cvt_pk_bf16_f32 v131, v34, v35
 v_mfma_f32_16x16x32_bf16 v[200:203], a[208:211], v[88:91], v[200:203]
 ds_read_b64_tr_b16 a[200:201], v25 offset:16384
 v_accvgpr_read_b32 v28, a144
 v_accvgpr_read_b32 v29, a145
 v_mfma_f32_16x16x32_bf16 v[200:203], a[212:215], v[100:103], v[200:203]
 s_mov_b32 s83, 0xc580
 s_add_u32 m0, s89, 0x1c00
 ds_read_b64_tr_b16 a[202:203], v25 offset:18432
 v_accvgpr_read_b32 v30, a146
 v_accvgpr_read_b32 v31, a147
 v_mfma_f32_16x16x32_bf16 v[204:207], a[212:215], v[104:107], v[204:207]
 buffer_load_dwordx4 v6, s[60:63], s83 offen lds
 ds_read_b64_tr_b16 a[204:205], v25 offset:20480
 v_cvt_pk_bf16_f32 v136, v28, v29
 v_mfma_f32_16x16x32_bf16 v[204:207], a[208:211], v[92:95], v[204:207]
 s_waitcnt lgkmcnt(7)
 ds_read_b64_tr_b16 a[206:207], v25 offset:22528
 v_cvt_pk_bf16_f32 v137, v30, v31
 v_accvgpr_read_b32 v32, a156
 v_accvgpr_read_b32 v33, a157
 v_mfma_f32_16x16x32_bf16 v[216:219], a[216:219], v[92:95], v[216:219]
 ds_read_b64_tr_b16 a[208:209], v26 offset:16384
 v_accvgpr_read_b32 v34, a158
 v_accvgpr_read_b32 v35, a159
 v_mfma_f32_16x16x32_bf16 v[216:219], a[220:223], v[104:107], v[216:219]
 s_mov_b32 s82, 0x200
 s_add_u32 m0, s89, 0x8000
 ds_read_b64_tr_b16 a[210:211], v26 offset:18432
 v_cvt_pk_bf16_f32 v138, v32, v33
 v_cvt_pk_bf16_f32 v139, v34, v35
 v_mfma_f32_16x16x32_bf16 v[212:215], a[220:223], v[100:103], v[212:215]
 buffer_load_dwordx4 v6, s[60:63], s82 offen lds
 ds_read_b64_tr_b16 a[212:213], v26 offset:20480
 v_accvgpr_read_b32 v28, a148
 v_accvgpr_read_b32 v29, a149
 v_mfma_f32_16x16x32_bf16 v[212:215], a[216:219], v[88:91], v[212:215]
 s_waitcnt lgkmcnt(7)
 ds_read_b64_tr_b16 a[214:215], v26 offset:22528
 v_accvgpr_read_b32 v30, a150
 v_accvgpr_read_b32 v31, a151
 v_mfma_f32_16x16x32_bf16 v[176:179], a[192:195], v[112:115], v[176:179]
 s_mov_b32 s83, 0x1e00
 s_add_u32 m0, s89, 0x8400
 ds_read_b64_tr_b16 a[216:217], v27 offset:16384
 v_cvt_pk_bf16_f32 v140, v28, v29
 v_cvt_pk_bf16_f32 v141, v30, v31
 v_mfma_f32_16x16x32_bf16 v[176:179], a[196:199], v[124:127], v[176:179]
 buffer_load_dwordx4 v6, s[60:63], s83 offen lds
 ds_read_b64_tr_b16 a[218:219], v27 offset:18432
 v_accvgpr_read_b32 v32, a160
 v_mfma_f32_16x16x32_bf16 v[180:183], a[196:199], v[128:131], v[180:183]
 ds_read_b64_tr_b16 a[220:221], v27 offset:20480
 v_accvgpr_read_b32 v33, a161
 v_accvgpr_read_b32 v34, a162
 v_accvgpr_read_b32 v35, a163
 v_mfma_f32_16x16x32_bf16 v[180:183], a[192:195], v[116:119], v[180:183]
 s_waitcnt lgkmcnt(7)
 ds_read_b64_tr_b16 a[222:223], v27 offset:22528
 v_cvt_pk_bf16_f32 v142, v32, v33
 v_cvt_pk_bf16_f32 v143, v34, v35
 v_mfma_f32_16x16x32_bf16 v[192:195], a[200:203], v[116:119], v[192:195]
 s_mov_b32 s82, 0x3a00
 s_add_u32 m0, s89, 0x8800
 ds_read_b64_tr_b16 a[192:193], v24 offset:24576
 v_accvgpr_read_b32 v28, a168
 v_accvgpr_read_b32 v29, a169
 v_mfma_f32_16x16x32_bf16 v[192:195], a[204:207], v[128:131], v[192:195]
 buffer_load_dwordx4 v6, s[60:63], s82 offen lds
 ds_read_b64_tr_b16 a[194:195], v24 offset:26624
 v_accvgpr_read_b32 v30, a170
 v_accvgpr_read_b32 v31, a171
 v_mfma_f32_16x16x32_bf16 v[188:191], a[204:207], v[124:127], v[188:191]
 ds_read_b64_tr_b16 a[196:197], v24 offset:28672
 v_cvt_pk_bf16_f32 v148, v28, v29
 v_cvt_pk_bf16_f32 v149, v30, v31
 v_mfma_f32_16x16x32_bf16 v[188:191], a[200:203], v[112:115], v[188:191]
 s_waitcnt lgkmcnt(7)
 s_mov_b32 s83, 0x5600
 s_add_u32 m0, s89, 0x8c00
 ds_read_b64_tr_b16 a[198:199], v24 offset:30720
 v_accvgpr_read_b32 v32, a180
 v_accvgpr_read_b32 v33, a181
 v_mfma_f32_16x16x32_bf16 v[200:203], a[208:211], v[112:115], v[200:203]
 buffer_load_dwordx4 v6, s[60:63], s83 offen lds
 ds_read_b64_tr_b16 a[200:201], v25 offset:24576
 v_accvgpr_read_b32 v34, a182
 v_mfma_f32_16x16x32_bf16 v[200:203], a[212:215], v[124:127], v[200:203]
 ds_read_b64_tr_b16 a[202:203], v25 offset:26624
 v_accvgpr_read_b32 v35, a183
 v_cvt_pk_bf16_f32 v150, v32, v33
 v_cvt_pk_bf16_f32 v151, v34, v35
 v_mfma_f32_16x16x32_bf16 v[204:207], a[212:215], v[128:131], v[204:207]
 ds_read_b64_tr_b16 a[204:205], v25 offset:28672
 v_accvgpr_read_b32 v28, a172
 v_accvgpr_read_b32 v29, a173
 v_mfma_f32_16x16x32_bf16 v[204:207], a[208:211], v[116:119], v[204:207]
 s_waitcnt lgkmcnt(7)
 s_mov_b32 s82, 0x7200
 s_add_u32 m0, s89, 0x9000
 ds_read_b64_tr_b16 a[206:207], v25 offset:30720
 v_accvgpr_read_b32 v30, a174
 v_accvgpr_read_b32 v31, a175
 v_mfma_f32_16x16x32_bf16 v[216:219], a[216:219], v[116:119], v[216:219]
 buffer_load_dwordx4 v6, s[60:63], s82 offen lds
 ds_read_b64_tr_b16 a[208:209], v26 offset:24576
 v_cvt_pk_bf16_f32 v152, v28, v29
 v_mfma_f32_16x16x32_bf16 v[216:219], a[220:223], v[128:131], v[216:219]
 ds_read_b64_tr_b16 a[210:211], v26 offset:26624
 v_cvt_pk_bf16_f32 v153, v30, v31
 v_accvgpr_read_b32 v32, a184
 v_accvgpr_read_b32 v33, a185
 v_mfma_f32_16x16x32_bf16 v[212:215], a[220:223], v[124:127], v[212:215]
 ds_read_b64_tr_b16 a[212:213], v26 offset:28672
 v_accvgpr_read_b32 v34, a186
 v_accvgpr_read_b32 v35, a187
 v_mfma_f32_16x16x32_bf16 v[212:215], a[216:219], v[112:115], v[212:215]
 s_waitcnt lgkmcnt(7)
 s_mov_b32 s83, 0x8e00
 s_add_u32 m0, s89, 0x9400
 ds_read_b64_tr_b16 a[214:215], v26 offset:30720
 v_cvt_pk_bf16_f32 v154, v32, v33
 v_cvt_pk_bf16_f32 v155, v34, v35
 v_mfma_f32_16x16x32_bf16 v[176:179], a[192:195], v[136:139], v[176:179]
 buffer_load_dwordx4 v6, s[60:63], s83 offen lds
 ds_read_b64_tr_b16 a[216:217], v27 offset:24576
 v_mfma_f32_16x16x32_bf16 v[176:179], a[196:199], v[148:151], v[176:179]
 ds_read_b64_tr_b16 a[218:219], v27 offset:26624
 v_mfma_f32_16x16x32_bf16 v[180:183], a[196:199], v[152:155], v[180:183]
 s_mov_b32 s82, 0xaa00
 s_add_u32 m0, s89, 0x9800
 ds_read_b64_tr_b16 a[220:221], v27 offset:28672
 v_mfma_f32_16x16x32_bf16 v[180:183], a[192:195], v[140:143], v[180:183]
 s_waitcnt lgkmcnt(7)
 buffer_load_dwordx4 v6, s[60:63], s82 offen lds
 ds_read_b64_tr_b16 a[222:223], v27 offset:30720
 v_mfma_f32_16x16x32_bf16 v[192:195], a[200:203], v[140:143], v[192:195]
 s_waitcnt vmcnt(23) lgkmcnt(0)
 s_barrier
 v_mfma_f32_16x16x32_bf16 v[192:195], a[204:207], v[152:155], v[192:195]
 ds_read_b64_tr_b16 a[192:193], v236 offset:0
 v_mfma_f32_16x16x32_bf16 v[188:191], a[204:207], v[148:151], v[188:191]
 s_mov_b32 s83, 0xc600
 s_add_u32 m0, s89, 0x9c00
 ds_read_b64_tr_b16 a[194:195], v236 offset:2048
 v_mfma_f32_16x16x32_bf16 v[188:191], a[200:203], v[136:139], v[188:191]
 buffer_load_dwordx4 v6, s[60:63], s83 offen lds
 ds_read_b64_tr_b16 a[196:197], v236 offset:4096
 v_mfma_f32_16x16x32_bf16 v[200:203], a[208:211], v[136:139], v[200:203]
 ds_read_b64_tr_b16 a[198:199], v236 offset:6144
 v_mfma_f32_16x16x32_bf16 v[200:203], a[212:215], v[148:151], v[200:203]
 ds_read_b64_tr_b16 a[200:201], v236 offset:8192
 v_mfma_f32_16x16x32_bf16 v[204:207], a[212:215], v[152:155], v[204:207]
 ds_read_b64_tr_b16 a[202:203], v236 offset:10240
 v_mfma_f32_16x16x32_bf16 v[204:207], a[208:211], v[140:143], v[204:207]
 ds_read_b64_tr_b16 a[204:205], v236 offset:12288
 v_mfma_f32_16x16x32_bf16 v[216:219], a[216:219], v[140:143], v[216:219]
 ds_read_b64_tr_b16 a[206:207], v236 offset:14336
 v_mfma_f32_16x16x32_bf16 v[216:219], a[220:223], v[152:155], v[216:219]
 ds_read_b64_tr_b16 a[208:209], v236 offset:16384
 v_mfma_f32_16x16x32_bf16 v[212:215], a[220:223], v[148:151], v[212:215]
 ds_read_b64_tr_b16 a[210:211], v236 offset:18432
 v_mfma_f32_16x16x32_bf16 v[212:215], a[216:219], v[136:139], v[212:215]
 s_waitcnt lgkmcnt(6)
 ds_read_b64_tr_b16 a[212:213], v236 offset:20480
 ds_read_b64_tr_b16 a[214:215], v236 offset:22528
 v_mfma_f32_16x16x32_bf16 v[160:163], a[192:195], v[64:67], 0
 s_mov_b32 s82, 0x280
 s_add_u32 m0, s89, 0x20000
 ds_read_b64_tr_b16 a[216:217], v236 offset:24576
 v_mov_b32 v11, v8
 s_mov_b32 s87, 0x0
 v_mfma_f32_16x16x32_bf16 v[160:163], a[196:199], v[76:79], v[160:163]
 buffer_load_dwordx4 v6, s[60:63], s82 offen lds
 ds_read_b64_tr_b16 a[218:219], v236 offset:26624
 v_mfma_f32_16x16x32_bf16 v[164:167], a[196:199], v[80:83], 0
 ds_read_b64_tr_b16 a[220:221], v236 offset:28672
 v_mov_b32 v12, v9
 v_mfma_f32_16x16x32_bf16 v[164:167], a[192:195], v[68:71], v[164:167]
 s_waitcnt lgkmcnt(7)
 ds_read_b64_tr_b16 a[222:223], v236 offset:30720
 v_permlane32_swap_b32 v8, v11
 v_add_f32 v8, v8, v11
 v_mfma_f32_16x16x32_bf16 v[164:167], a[200:203], v[92:95], v[164:167]
 ds_read_b64_tr_b16 a[192:193], v237 offset:0
 v_permlane32_swap_b32 v9, v12
 v_mfma_f32_16x16x32_bf16 v[164:167], a[204:207], v[104:107], v[164:167]
 ds_read_b64_tr_b16 a[194:195], v237 offset:2048
 v_add_f32 v9, v9, v12
 v_mfma_f32_16x16x32_bf16 v[160:163], a[204:207], v[100:103], v[160:163]
 ds_read_b64_tr_b16 a[196:197], v237 offset:4096
 v_mov_b32 v11, v8
 v_mov_b32 v12, v9
 v_mfma_f32_16x16x32_bf16 v[160:163], a[200:203], v[88:91], v[160:163]
 s_waitcnt lgkmcnt(7)
 s_mov_b32 s83, 0x1e80
 s_add_u32 m0, s89, 0x20400
 ds_read_b64_tr_b16 a[198:199], v237 offset:6144
 v_mfma_f32_16x16x32_bf16 v[160:163], a[208:211], v[112:115], v[160:163]
 buffer_load_dwordx4 v6, s[60:63], s83 offen lds
 ds_read_b64_tr_b16 a[200:201], v237 offset:8192
 v_mfma_f32_16x16x32_bf16 v[160:163], a[212:215], v[124:127], v[160:163]
 ds_read_b64_tr_b16 a[202:203], v237 offset:10240
 v_permlane16_swap_b32 v8, v11
 v_permlane16_swap_b32 v9, v12
 v_mfma_f32_16x16x32_bf16 v[164:167], a[212:215], v[128:131], v[164:167]
 ds_read_b64_tr_b16 a[204:205], v237 offset:12288
 v_add_f32 v8, v8, v11
 v_mfma_f32_16x16x32_bf16 v[164:167], a[208:211], v[116:119], v[164:167]
 s_waitcnt lgkmcnt(7)
 ds_read_b64_tr_b16 a[206:207], v237 offset:14336
 v_add_f32 v9, v9, v12
 v_mfma_f32_16x16x32_bf16 v[164:167], a[216:219], v[140:143], v[164:167]
 ds_read_b64_tr_b16 a[208:209], v237 offset:16384
 v_rcp_f32 v8, v8
 v_mfma_f32_16x16x32_bf16 v[164:167], a[220:223], v[152:155], v[164:167]
 ds_read_b64_tr_b16 a[210:211], v237 offset:18432
 v_mfma_f32_16x16x32_bf16 v[160:163], a[220:223], v[148:151], v[160:163]
 s_mov_b32 s82, 0x3a80
 s_add_u32 m0, s89, 0x20800
 ds_read_b64_tr_b16 a[212:213], v237 offset:20480
 v_mfma_f32_16x16x32_bf16 v[160:163], a[216:219], v[136:139], v[160:163]
 s_waitcnt lgkmcnt(7)
 buffer_load_dwordx4 v6, s[60:63], s82 offen lds
 ds_read_b64_tr_b16 a[214:215], v237 offset:22528
 v_mfma_f32_16x16x32_bf16 v[172:175], a[192:195], v[64:67], 0
L1_PADW2:
 s_cbranch_execz L1_PRL1
 ds_read_b64_tr_b16 a[216:217], v237 offset:24576
 v_rcp_f32 v9, v9
 v_mfma_f32_16x16x32_bf16 v[172:175], a[196:199], v[76:79], v[172:175]
 ds_read_b64_tr_b16 a[218:219], v237 offset:26624
 v_mul_f32 v180, v180, v9
 v_mfma_f32_16x16x32_bf16 v[224:227], a[196:199], v[80:83], 0
 ds_read_b64_tr_b16 a[220:221], v237 offset:28672
 v_mul_f32 v181, v181, v9
 v_mul_f32 v182, v182, v9
 v_mfma_f32_16x16x32_bf16 v[224:227], a[192:195], v[68:71], v[224:227]
 s_waitcnt lgkmcnt(7)
 ds_read_b64_tr_b16 a[222:223], v237 offset:30720
 v_mul_f32 v183, v183, v9
 v_mfma_f32_16x16x32_bf16 v[224:227], a[200:203], v[92:95], v[224:227]
 ds_read_b64_tr_b16 a[192:193], v238 offset:0
 v_mul_f32 v192, v192, v9
 v_mfma_f32_16x16x32_bf16 v[224:227], a[204:207], v[104:107], v[224:227]
 s_mov_b32 s83, 0x5680
 s_add_u32 m0, s89, 0x20c00
 ds_read_b64_tr_b16 a[194:195], v238 offset:2048
 v_mul_f32 v193, v193, v9
 v_mul_f32 v194, v194, v9
 v_mfma_f32_16x16x32_bf16 v[172:175], a[204:207], v[100:103], v[172:175]
 buffer_load_dwordx4 v6, s[60:63], s83 offen lds
 ds_read_b64_tr_b16 a[196:197], v238 offset:4096
 v_mfma_f32_16x16x32_bf16 v[172:175], a[200:203], v[88:91], v[172:175]
 s_waitcnt lgkmcnt(7)
 ds_read_b64_tr_b16 a[198:199], v238 offset:6144
 v_mul_f32 v195, v195, v9
 v_mfma_f32_16x16x32_bf16 v[172:175], a[208:211], v[112:115], v[172:175]
 ds_read_b64_tr_b16 a[200:201], v238 offset:8192
 v_cvt_pk_bf16_f32 v180, v180, v181
 v_cvt_pk_bf16_f32 v181, v182, v183
 v_mfma_f32_16x16x32_bf16 v[172:175], a[212:215], v[124:127], v[172:175]
 ds_read_b64_tr_b16 a[202:203], v238 offset:10240
 v_cvt_pk_bf16_f32 v182, v192, v193
 v_mfma_f32_16x16x32_bf16 v[224:227], a[212:215], v[128:131], v[224:227]
 ds_read_b64_tr_b16 a[204:205], v238 offset:12288
 v_cvt_pk_bf16_f32 v183, v194, v195
 v_mul_f32 v176, v176, v8
 s_mov_b32 s88, 0x4000
 v_mfma_f32_16x16x32_bf16 v[224:227], a[208:211], v[116:119], v[224:227]
 s_waitcnt lgkmcnt(7)
 ds_read_b64_tr_b16 a[206:207], v238 offset:14336
 v_mul_f32 v177, v177, v8
 v_mfma_f32_16x16x32_bf16 v[224:227], a[216:219], v[140:143], v[224:227]
 ds_read_b64_tr_b16 a[208:209], v238 offset:16384
 v_mul_f32 v178, v178, v8
 v_mfma_f32_16x16x32_bf16 v[224:227], a[220:223], v[152:155], v[224:227]
 s_mov_b32 s82, 0x7280
 s_add_u32 m0, s89, 0x21000
 ds_read_b64_tr_b16 a[210:211], v238 offset:18432
 buffer_store_dwordx4 v[180:183], v240, s[64:67], s87 offen sc0 sc1
 v_mfma_f32_16x16x32_bf16 v[172:175], a[220:223], v[148:151], v[172:175]
 buffer_load_dwordx4 v6, s[60:63], s82 offen lds
 ds_read_b64_tr_b16 a[212:213], v238 offset:20480
 v_mfma_f32_16x16x32_bf16 v[172:175], a[216:219], v[136:139], v[172:175]
 s_waitcnt lgkmcnt(7)
 ds_read_b64_tr_b16 a[214:215], v238 offset:22528
 v_mul_f32 v179, v179, v8
 v_mfma_f32_16x16x32_bf16 v[232:235], a[192:195], v[64:67], 0
 ds_read_b64_tr_b16 a[216:217], v238 offset:24576
 v_mul_f32 v188, v188, v8
 v_mul_f32 v189, v189, v8
 v_mfma_f32_16x16x32_bf16 v[232:235], a[196:199], v[76:79], v[232:235]
 ds_read_b64_tr_b16 a[218:219], v238 offset:26624
 v_mul_f32 v190, v190, v8
 v_mfma_f32_16x16x32_bf16 v[244:247], a[196:199], v[80:83], 0
 ds_read_b64_tr_b16 a[220:221], v238 offset:28672
 v_mul_f32 v191, v191, v8
 v_mfma_f32_16x16x32_bf16 v[244:247], a[192:195], v[68:71], v[244:247]
 s_waitcnt lgkmcnt(7)
 ds_read_b64_tr_b16 a[222:223], v238 offset:30720
 v_cvt_pk_bf16_f32 v176, v176, v177
 v_cvt_pk_bf16_f32 v177, v178, v179
 v_mfma_f32_16x16x32_bf16 v[244:247], a[200:203], v[92:95], v[244:247]
 s_mov_b32 s83, 0x8e80
 s_add_u32 m0, s89, 0x21400
 ds_read_b64_tr_b16 a[192:193], v239 offset:0
 v_cvt_pk_bf16_f32 v178, v188, v189
 v_mfma_f32_16x16x32_bf16 v[244:247], a[204:207], v[104:107], v[244:247]
 buffer_load_dwordx4 v6, s[60:63], s83 offen lds
 ds_read_b64_tr_b16 a[194:195], v239 offset:2048
 v_mfma_f32_16x16x32_bf16 v[232:235], a[204:207], v[100:103], v[232:235]
 ds_read_b64_tr_b16 a[196:197], v239 offset:4096
 v_cvt_pk_bf16_f32 v179, v190, v191
 v_mul_f32 v204, v204, v9
 v_mfma_f32_16x16x32_bf16 v[232:235], a[200:203], v[88:91], v[232:235]
 s_waitcnt lgkmcnt(7)
 ds_read_b64_tr_b16 a[198:199], v239 offset:6144
 v_mul_f32 v205, v205, v9
 v_mfma_f32_16x16x32_bf16 v[232:235], a[208:211], v[112:115], v[232:235]
 ds_read_b64_tr_b16 a[200:201], v239 offset:8192
 buffer_store_dwordx4 v[176:179], v5, s[64:67], s87 offen sc0 sc1
 v_mfma_f32_16x16x32_bf16 v[232:235], a[212:215], v[124:127], v[232:235]
 ds_read_b64_tr_b16 a[202:203], v239 offset:10240
 v_mul_f32 v206, v206, v9
 v_mfma_f32_16x16x32_bf16 v[244:247], a[212:215], v[128:131], v[244:247]
 ds_read_b64_tr_b16 a[204:205], v239 offset:12288
 v_mul_f32 v207, v207, v9
 v_mfma_f32_16x16x32_bf16 v[244:247], a[208:211], v[116:119], v[244:247]
 s_waitcnt lgkmcnt(7)
 s_mov_b32 s82, 0xaa80
 s_add_u32 m0, s89, 0x21800
 ds_read_b64_tr_b16 a[206:207], v239 offset:14336
 v_mul_f32 v216, v216, v9
 v_mul_f32 v217, v217, v9
 v_mfma_f32_16x16x32_bf16 v[244:247], a[216:219], v[140:143], v[244:247]
 buffer_load_dwordx4 v6, s[60:63], s82 offen lds
 ds_read_b64_tr_b16 a[208:209], v239 offset:16384
 v_mfma_f32_16x16x32_bf16 v[244:247], a[220:223], v[152:155], v[244:247]
 ds_read_b64_tr_b16 a[210:211], v239 offset:18432
 v_mul_f32 v218, v218, v9
 v_mfma_f32_16x16x32_bf16 v[232:235], a[220:223], v[148:151], v[232:235]
 ds_read_b64_tr_b16 a[212:213], v239 offset:20480
 v_mul_f32 v219, v219, v9
 v_cvt_pk_bf16_f32 v204, v204, v205
 v_mfma_f32_16x16x32_bf16 v[232:235], a[216:219], v[136:139], v[232:235]
 s_waitcnt lgkmcnt(7)
 ds_read_b64_tr_b16 a[214:215], v239 offset:22528
 v_cvt_pk_bf16_f32 v205, v206, v207
 v_mfma_f32_16x16x32_bf16 v[252:255], a[192:195], v[64:67], 0
 ds_read_b64_tr_b16 a[216:217], v239 offset:24576
 v_cvt_pk_bf16_f32 v206, v216, v217
 v_mfma_f32_16x16x32_bf16 v[252:255], a[196:199], v[76:79], v[252:255]
 ds_read_b64_tr_b16 a[218:219], v239 offset:26624
 v_cvt_pk_bf16_f32 v207, v218, v219
 v_mul_f32 v200, v200, v8
 v_mfma_f32_16x16x32_bf16 v[16:19], a[196:199], v[80:83], 0
 s_mov_b32 s83, 0xc680
 s_add_u32 m0, s89, 0x21c00
 ds_read_b64_tr_b16 a[220:221], v239 offset:28672
 v_mul_f32 v201, v201, v8
 v_mfma_f32_16x16x32_bf16 v[16:19], a[192:195], v[68:71], v[16:19]
 s_waitcnt lgkmcnt(7)
 buffer_load_dwordx4 v6, s[60:63], s83 offen lds
 ds_read_b64_tr_b16 a[222:223], v239 offset:30720
 v_mfma_f32_16x16x32_bf16 v[16:19], a[200:203], v[92:95], v[16:19]
 v_mul_f32 v202, v202, v8
 s_waitcnt vmcnt(26) lgkmcnt(0)
 s_barrier
 v_mfma_f32_16x16x32_bf16 v[16:19], a[204:207], v[104:107], v[16:19]
 ds_read_b64_tr_b16 a[192:193], v236 offset:32768
 v_mul_f32 v203, v203, v8
 v_mfma_f32_16x16x32_bf16 v[252:255], a[204:207], v[100:103], v[252:255]
 ds_read_b64_tr_b16 a[194:195], v236 offset:34816
 v_mul_f32 v212, v212, v8
 v_mfma_f32_16x16x32_bf16 v[252:255], a[200:203], v[88:91], v[252:255]
 ds_read_b64_tr_b16 a[196:197], v236 offset:36864
 buffer_store_dwordx4 v[204:207], v240, s[64:67], s88 offen sc0 sc1
 v_mfma_f32_16x16x32_bf16 v[252:255], a[208:211], v[112:115], v[252:255]
 ds_read_b64_tr_b16 a[198:199], v236 offset:38912
 v_mul_f32 v213, v213, v8
 v_mfma_f32_16x16x32_bf16 v[252:255], a[212:215], v[124:127], v[252:255]
 ds_read_b64_tr_b16 a[200:201], v236 offset:40960
 v_mul_f32 v214, v214, v8
 v_mfma_f32_16x16x32_bf16 v[16:19], a[212:215], v[128:131], v[16:19]
 ds_read_b64_tr_b16 a[202:203], v236 offset:43008
 v_mul_f32 v215, v215, v8
 v_cvt_pk_bf16_f32 v200, v200, v201
 v_mfma_f32_16x16x32_bf16 v[16:19], a[208:211], v[116:119], v[16:19]
 ds_read_b64_tr_b16 a[204:205], v236 offset:45056
 v_cvt_pk_bf16_f32 v201, v202, v203
 v_mfma_f32_16x16x32_bf16 v[16:19], a[216:219], v[140:143], v[16:19]
 ds_read_b64_tr_b16 a[206:207], v236 offset:47104
 v_cvt_pk_bf16_f32 v202, v212, v213
 v_mfma_f32_16x16x32_bf16 v[16:19], a[220:223], v[152:155], v[16:19]
 ds_read_b64_tr_b16 a[208:209], v236 offset:49152
 v_cvt_pk_bf16_f32 v203, v214, v215
 v_mfma_f32_16x16x32_bf16 v[252:255], a[220:223], v[148:151], v[252:255]
 ds_read_b64_tr_b16 a[210:211], v236 offset:51200
 buffer_store_dwordx4 v[200:203], v5, s[64:67], s88 offen sc0 sc1
 v_mfma_f32_16x16x32_bf16 v[252:255], a[216:219], v[136:139], v[252:255]
 s_waitcnt lgkmcnt(6)
 ds_read_b64_tr_b16 a[212:213], v236 offset:53248
 ds_read_b64_tr_b16 a[214:215], v236 offset:55296
 v_mfma_f32_16x16x32_bf16 v[176:179], a[192:195], v[64:67], 0
 s_mov_b32 s82, 0x300
 s_add_u32 m0, s89, 0x10000
 ds_read_b64_tr_b16 a[216:217], v236 offset:57344
 s_mov_b32 s84, 0x8000
 v_mfma_f32_16x16x32_bf16 v[176:179], a[196:199], v[76:79], v[176:179]
 buffer_load_dwordx4 v6, s[60:63], s82 offen lds
 s_mov_b32 s83, 0x1f00
 s_add_u32 m0, s89, 0x10400
 ds_read_b64_tr_b16 a[218:219], v236 offset:59392
 v_mfma_f32_16x16x32_bf16 v[180:183], a[196:199], v[80:83], 0
 buffer_load_dwordx4 v6, s[60:63], s83 offen lds
 s_mov_b32 s82, 0x3b00
 s_add_u32 m0, s89, 0x10800
 ds_read_b64_tr_b16 a[220:221], v236 offset:61440
 v_mfma_f32_16x16x32_bf16 v[180:183], a[192:195], v[68:71], v[180:183]
 s_waitcnt lgkmcnt(7)
 buffer_load_dwordx4 v6, s[60:63], s82 offen lds
 s_mov_b32 s83, 0x5700
 s_add_u32 m0, s89, 0x10c00
 ds_read_b64_tr_b16 a[222:223], v236 offset:63488
 v_mfma_f32_16x16x32_bf16 v[180:183], a[200:203], v[92:95], v[180:183]
 buffer_load_dwordx4 v6, s[60:63], s83 offen lds
 ds_read_b64_tr_b16 a[192:193], v237 offset:32768
 v_mfma_f32_16x16x32_bf16 v[180:183], a[204:207], v[104:107], v[180:183]
 s_mov_b32 s82, 0x7300
 s_add_u32 m0, s89, 0x11000
 ds_read_b64_tr_b16 a[194:195], v237 offset:34816
 v_mul_f32 v164, v164, v9
 v_mfma_f32_16x16x32_bf16 v[176:179], a[204:207], v[100:103], v[176:179]
 buffer_load_dwordx4 v6, s[60:63], s82 offen lds
 s_mov_b32 s83, 0x8f00
 s_add_u32 m0, s89, 0x11400
 ds_read_b64_tr_b16 a[196:197], v237 offset:36864
 v_mfma_f32_16x16x32_bf16 v[176:179], a[200:203], v[88:91], v[176:179]
 s_waitcnt lgkmcnt(7)
 buffer_load_dwordx4 v6, s[60:63], s83 offen lds
 s_mov_b32 s82, 0xab00
 s_add_u32 m0, s89, 0x11800
 ds_read_b64_tr_b16 a[198:199], v237 offset:38912
 v_mfma_f32_16x16x32_bf16 v[176:179], a[208:211], v[112:115], v[176:179]
 buffer_load_dwordx4 v6, s[60:63], s82 offen lds
 s_mov_b32 s83, 0xc700
 s_add_u32 m0, s89, 0x11c00
 ds_read_b64_tr_b16 a[200:201], v237 offset:40960
 v_mfma_f32_16x16x32_bf16 v[176:179], a[212:215], v[124:127], v[176:179]
 buffer_load_dwordx4 v6, s[60:63], s83 offen lds
 ds_read_b64_tr_b16 a[202:203], v237 offset:43008
 v_mfma_f32_16x16x32_bf16 v[180:183], a[212:215], v[128:131], v[180:183]
 ds_read_b64_tr_b16 a[204:205], v237 offset:45056
 v_mul_f32 v165, v165, v9
 v_mfma_f32_16x16x32_bf16 v[180:183], a[208:211], v[116:119], v[180:183]
 s_waitcnt lgkmcnt(7)
 ds_read_b64_tr_b16 a[206:207], v237 offset:47104
 v_mul_f32 v166, v166, v9
 v_mfma_f32_16x16x32_bf16 v[180:183], a[216:219], v[140:143], v[180:183]
 ds_read_b64_tr_b16 a[208:209], v237 offset:49152
 v_mul_f32 v167, v167, v9
 v_mul_f32 v224, v224, v9
 v_mfma_f32_16x16x32_bf16 v[180:183], a[220:223], v[152:155], v[180:183]
 ds_read_b64_tr_b16 a[210:211], v237 offset:51200
 v_mul_f32 v225, v225, v9
 v_mfma_f32_16x16x32_bf16 v[176:179], a[220:223], v[148:151], v[176:179]
 ds_read_b64_tr_b16 a[212:213], v237 offset:53248
 v_mul_f32 v226, v226, v9
 v_mfma_f32_16x16x32_bf16 v[176:179], a[216:219], v[136:139], v[176:179]
 s_waitcnt lgkmcnt(7)
 ds_read_b64_tr_b16 a[214:215], v237 offset:55296
 v_mul_f32 v227, v227, v9
 v_mfma_f32_16x16x32_bf16 v[188:191], a[192:195], v[64:67], 0
 ds_read_b64_tr_b16 a[216:217], v237 offset:57344
 v_cvt_pk_bf16_f32 v164, v164, v165
 v_mfma_f32_16x16x32_bf16 v[188:191], a[196:199], v[76:79], v[188:191]
 ds_read_b64_tr_b16 a[218:219], v237 offset:59392
 v_cvt_pk_bf16_f32 v165, v166, v167
 v_mfma_f32_16x16x32_bf16 v[192:195], a[196:199], v[80:83], 0
 ds_read_b64_tr_b16 a[220:221], v237 offset:61440
 v_cvt_pk_bf16_f32 v166, v224, v225
 v_mfma_f32_16x16x32_bf16 v[192:195], a[192:195], v[68:71], v[192:195]
 s_waitcnt lgkmcnt(7)
 ds_read_b64_tr_b16 a[222:223], v237 offset:63488
 v_cvt_pk_bf16_f32 v167, v226, v227
 v_mfma_f32_16x16x32_bf16 v[192:195], a[200:203], v[92:95], v[192:195]
 ds_read_b64_tr_b16 a[192:193], v238 offset:32768
 v_mul_f32 v160, v160, v8
 s_mov_b32 s85, 0xc000
 v_mfma_f32_16x16x32_bf16 v[192:195], a[204:207], v[104:107], v[192:195]
 ds_read_b64_tr_b16 a[194:195], v238 offset:34816
 v_mul_f32 v161, v161, v8
 v_mfma_f32_16x16x32_bf16 v[188:191], a[204:207], v[100:103], v[188:191]
 ds_read_b64_tr_b16 a[196:197], v238 offset:36864
 v_mul_f32 v162, v162, v8
 v_mfma_f32_16x16x32_bf16 v[188:191], a[200:203], v[88:91], v[188:191]
 s_waitcnt lgkmcnt(7)
 ds_read_b64_tr_b16 a[198:199], v238 offset:38912
 v_mul_f32 v163, v163, v8
 v_mfma_f32_16x16x32_bf16 v[188:191], a[208:211], v[112:115], v[188:191]
 ds_read_b64_tr_b16 a[200:201], v238 offset:40960
 v_mul_f32 v172, v172, v8
 v_mfma_f32_16x16x32_bf16 v[188:191], a[212:215], v[124:127], v[188:191]
 ds_read_b64_tr_b16 a[202:203], v238 offset:43008
 v_mul_f32 v173, v173, v8
 v_mfma_f32_16x16x32_bf16 v[192:195], a[212:215], v[128:131], v[192:195]
 ds_read_b64_tr_b16 a[204:205], v238 offset:45056
 buffer_store_dwordx4 v[164:167], v240, s[64:67], s84 offen sc0 sc1
 v_mfma_f32_16x16x32_bf16 v[192:195], a[208:211], v[116:119], v[192:195]
 s_waitcnt lgkmcnt(7)
 ds_read_b64_tr_b16 a[206:207], v238 offset:47104
 v_mul_f32 v174, v174, v8
 v_mfma_f32_16x16x32_bf16 v[192:195], a[216:219], v[140:143], v[192:195]
 ds_read_b64_tr_b16 a[208:209], v238 offset:49152
 v_mul_f32 v175, v175, v8
 v_mfma_f32_16x16x32_bf16 v[192:195], a[220:223], v[152:155], v[192:195]
 ds_read_b64_tr_b16 a[210:211], v238 offset:51200
 v_cvt_pk_bf16_f32 v160, v160, v161
 v_mfma_f32_16x16x32_bf16 v[188:191], a[220:223], v[148:151], v[188:191]
 ds_read_b64_tr_b16 a[212:213], v238 offset:53248
 v_cvt_pk_bf16_f32 v161, v162, v163
 v_mfma_f32_16x16x32_bf16 v[188:191], a[216:219], v[136:139], v[188:191]
 s_waitcnt lgkmcnt(7)
 ds_read_b64_tr_b16 a[214:215], v238 offset:55296
 v_cvt_pk_bf16_f32 v162, v172, v173
 v_mfma_f32_16x16x32_bf16 v[200:203], a[192:195], v[64:67], 0
 ds_read_b64_tr_b16 a[216:217], v238 offset:57344
 v_cvt_pk_bf16_f32 v163, v174, v175
 v_mfma_f32_16x16x32_bf16 v[200:203], a[196:199], v[76:79], v[200:203]
 ds_read_b64_tr_b16 a[218:219], v238 offset:59392
 v_mul_f32 v244, v244, v9
 v_mfma_f32_16x16x32_bf16 v[204:207], a[196:199], v[80:83], 0
 ds_read_b64_tr_b16 a[220:221], v238 offset:61440
 v_mul_f32 v245, v245, v9
 v_mfma_f32_16x16x32_bf16 v[204:207], a[192:195], v[68:71], v[204:207]
 s_waitcnt lgkmcnt(7)
 ds_read_b64_tr_b16 a[222:223], v238 offset:63488
 v_mul_f32 v246, v246, v9
 v_mfma_f32_16x16x32_bf16 v[204:207], a[200:203], v[92:95], v[204:207]
 ds_read_b64_tr_b16 a[192:193], v239 offset:32768
 v_mul_f32 v247, v247, v9
 v_mfma_f32_16x16x32_bf16 v[204:207], a[204:207], v[104:107], v[204:207]
 ds_read_b64_tr_b16 a[194:195], v239 offset:34816
 v_mul_f32 v16, v16, v9
 v_mfma_f32_16x16x32_bf16 v[200:203], a[204:207], v[100:103], v[200:203]
 ds_read_b64_tr_b16 a[196:197], v239 offset:36864
 v_mul_f32 v17, v17, v9
 v_mfma_f32_16x16x32_bf16 v[200:203], a[200:203], v[88:91], v[200:203]
 s_waitcnt lgkmcnt(7)
 ds_read_b64_tr_b16 a[198:199], v239 offset:38912
 v_mul_f32 v18, v18, v9
 v_mfma_f32_16x16x32_bf16 v[200:203], a[208:211], v[112:115], v[200:203]
 ds_read_b64_tr_b16 a[200:201], v239 offset:40960
 v_mul_f32 v19, v19, v9
 v_mfma_f32_16x16x32_bf16 v[200:203], a[212:215], v[124:127], v[200:203]
 ds_read_b64_tr_b16 a[202:203], v239 offset:43008
 v_cvt_pk_bf16_f32 v244, v244, v245
 v_mfma_f32_16x16x32_bf16 v[204:207], a[212:215], v[128:131], v[204:207]
 ds_read_b64_tr_b16 a[204:205], v239 offset:45056
 buffer_store_dwordx4 v[160:163], v5, s[64:67], s84 offen sc0 sc1
 v_mfma_f32_16x16x32_bf16 v[204:207], a[208:211], v[116:119], v[204:207]
 s_waitcnt lgkmcnt(7)
 ds_read_b64_tr_b16 a[206:207], v239 offset:47104
 v_cvt_pk_bf16_f32 v245, v246, v247
 v_mfma_f32_16x16x32_bf16 v[204:207], a[216:219], v[140:143], v[204:207]
 ds_read_b64_tr_b16 a[208:209], v239 offset:49152
 v_cvt_pk_bf16_f32 v246, v16, v17
 v_mfma_f32_16x16x32_bf16 v[204:207], a[220:223], v[152:155], v[204:207]
 ds_read_b64_tr_b16 a[210:211], v239 offset:51200
 v_cvt_pk_bf16_f32 v247, v18, v19
 v_mfma_f32_16x16x32_bf16 v[200:203], a[220:223], v[148:151], v[200:203]
 ds_read_b64_tr_b16 a[212:213], v239 offset:53248
 v_mul_f32 v232, v232, v8
 v_mfma_f32_16x16x32_bf16 v[200:203], a[216:219], v[136:139], v[200:203]
 s_waitcnt lgkmcnt(7)
 ds_read_b64_tr_b16 a[214:215], v239 offset:55296
 v_mul_f32 v233, v233, v8
 v_mfma_f32_16x16x32_bf16 v[212:215], a[192:195], v[64:67], 0
 ds_read_b64_tr_b16 a[216:217], v239 offset:57344
 v_mul_f32 v234, v234, v8
 v_mfma_f32_16x16x32_bf16 v[212:215], a[196:199], v[76:79], v[212:215]
 ds_read_b64_tr_b16 a[218:219], v239 offset:59392
 v_mul_f32 v235, v235, v8
 v_mfma_f32_16x16x32_bf16 v[216:219], a[196:199], v[80:83], 0
 ds_read_b64_tr_b16 a[220:221], v239 offset:61440
 v_mul_f32 v252, v252, v8
 v_mfma_f32_16x16x32_bf16 v[216:219], a[192:195], v[68:71], v[216:219]
 s_waitcnt lgkmcnt(7)
 ds_read_b64_tr_b16 a[222:223], v239 offset:63488
 v_mul_f32 v253, v253, v8
 v_mfma_f32_16x16x32_bf16 v[216:219], a[200:203], v[92:95], v[216:219]
 s_waitcnt vmcnt(30) lgkmcnt(0)
 s_barrier
 v_mfma_f32_16x16x32_bf16 v[216:219], a[204:207], v[104:107], v[216:219]
 ds_read_b64_tr_b16 a[192:193], v36 offset:0
 v_mul_f32 v254, v254, v8
 v_mfma_f32_16x16x32_bf16 v[212:215], a[204:207], v[100:103], v[212:215]
 ds_read_b64_tr_b16 a[194:195], v36 offset:2048
 v_mul_f32 v255, v255, v8
 v_mfma_f32_16x16x32_bf16 v[212:215], a[200:203], v[88:91], v[212:215]
 ds_read_b64_tr_b16 a[196:197], v36 offset:4096
 v_cvt_pk_bf16_f32 v232, v232, v233
 v_mfma_f32_16x16x32_bf16 v[212:215], a[208:211], v[112:115], v[212:215]
 ds_read_b64_tr_b16 a[198:199], v36 offset:6144
 v_cvt_pk_bf16_f32 v233, v234, v235
 v_mfma_f32_16x16x32_bf16 v[212:215], a[212:215], v[124:127], v[212:215]
 ds_read_b64_tr_b16 a[200:201], v36 offset:8192
 v_cvt_pk_bf16_f32 v234, v252, v253
 v_mfma_f32_16x16x32_bf16 v[216:219], a[212:215], v[128:131], v[216:219]
 ds_read_b64_tr_b16 a[202:203], v36 offset:10240
 v_cvt_pk_bf16_f32 v235, v254, v255
 v_mfma_f32_16x16x32_bf16 v[216:219], a[208:211], v[116:119], v[216:219]
 ds_read_b64_tr_b16 a[204:205], v36 offset:12288
 v_mfma_f32_16x16x32_bf16 v[216:219], a[216:219], v[140:143], v[216:219]
 ds_read_b64_tr_b16 a[206:207], v36 offset:14336
 v_mfma_f32_16x16x32_bf16 v[216:219], a[220:223], v[152:155], v[216:219]
 ds_read_b64_tr_b16 a[208:209], v36 offset:16384
 buffer_store_dwordx4 v[244:247], v240, s[64:67], s85 offen sc0 sc1
 v_mfma_f32_16x16x32_bf16 v[212:215], a[220:223], v[148:151], v[212:215]
 ds_read_b64_tr_b16 a[210:211], v36 offset:18432
 v_mfma_f32_16x16x32_bf16 v[212:215], a[216:219], v[136:139], v[212:215]
 s_waitcnt lgkmcnt(6)
 ds_read_b64_tr_b16 a[212:213], v36 offset:20480
 ds_read_b64_tr_b16 a[214:215], v36 offset:22528
 buffer_store_dwordx4 v[232:235], v5, s[64:67], s85 offen sc0 sc1
 v_mfma_f32_16x16x32_bf16 v[160:163], a[192:195], v[64:67], 0
 ds_read_b64_tr_b16 a[216:217], v36 offset:24576
 s_mov_b32 s84, 0x10000
 v_mfma_f32_16x16x32_bf16 v[160:163], a[196:199], v[76:79], v[160:163]
 ds_read_b64_tr_b16 a[218:219], v36 offset:26624
 v_mfma_f32_16x16x32_bf16 v[164:167], a[196:199], v[80:83], 0
 ds_read_b64_tr_b16 a[220:221], v36 offset:28672
 v_mfma_f32_16x16x32_bf16 v[164:167], a[192:195], v[68:71], v[164:167]
 s_waitcnt lgkmcnt(7)
 ds_read_b64_tr_b16 a[222:223], v36 offset:30720
 v_mul_f32 v180, v180, v9
 v_mfma_f32_16x16x32_bf16 v[164:167], a[200:203], v[92:95], v[164:167]
 ds_read_b64_tr_b16 a[192:193], v37 offset:0
 v_mul_f32 v181, v181, v9
 v_mul_f32 v182, v182, v9
 v_mfma_f32_16x16x32_bf16 v[164:167], a[204:207], v[104:107], v[164:167]
 ds_read_b64_tr_b16 a[194:195], v37 offset:2048
 v_mul_f32 v183, v183, v9
 v_mfma_f32_16x16x32_bf16 v[160:163], a[204:207], v[100:103], v[160:163]
 ds_read_b64_tr_b16 a[196:197], v37 offset:4096
 v_mul_f32 v192, v192, v9
 v_mul_f32 v193, v193, v9
 v_mfma_f32_16x16x32_bf16 v[160:163], a[200:203], v[88:91], v[160:163]
 s_waitcnt lgkmcnt(7)
 ds_read_b64_tr_b16 a[198:199], v37 offset:6144
 v_mul_f32 v194, v194, v9
 v_mfma_f32_16x16x32_bf16 v[160:163], a[208:211], v[112:115], v[160:163]
 ds_read_b64_tr_b16 a[200:201], v37 offset:8192
 v_mul_f32 v195, v195, v9
 v_cvt_pk_bf16_f32 v180, v180, v181
 v_mfma_f32_16x16x32_bf16 v[160:163], a[212:215], v[124:127], v[160:163]
 ds_read_b64_tr_b16 a[202:203], v37 offset:10240
 v_cvt_pk_bf16_f32 v181, v182, v183
 v_mfma_f32_16x16x32_bf16 v[164:167], a[212:215], v[128:131], v[164:167]
 ds_read_b64_tr_b16 a[204:205], v37 offset:12288
 v_cvt_pk_bf16_f32 v182, v192, v193
 v_cvt_pk_bf16_f32 v183, v194, v195
 v_mfma_f32_16x16x32_bf16 v[164:167], a[208:211], v[116:119], v[164:167]
 s_waitcnt lgkmcnt(7)
 ds_read_b64_tr_b16 a[206:207], v37 offset:14336
 v_mul_f32 v176, v176, v8
 s_mov_b32 s85, 0x14000
 v_mfma_f32_16x16x32_bf16 v[164:167], a[216:219], v[140:143], v[164:167]
 ds_read_b64_tr_b16 a[208:209], v37 offset:16384
 buffer_store_dwordx4 v[180:183], v240, s[64:67], s84 offen sc0 sc1
 v_mfma_f32_16x16x32_bf16 v[164:167], a[220:223], v[152:155], v[164:167]
 ds_read_b64_tr_b16 a[210:211], v37 offset:18432
 v_mul_f32 v177, v177, v8
 v_mfma_f32_16x16x32_bf16 v[160:163], a[220:223], v[148:151], v[160:163]
 ds_read_b64_tr_b16 a[212:213], v37 offset:20480
 v_mul_f32 v178, v178, v8
 v_mul_f32 v179, v179, v8
 v_mfma_f32_16x16x32_bf16 v[160:163], a[216:219], v[136:139], v[160:163]
 s_waitcnt lgkmcnt(7)
 ds_read_b64_tr_b16 a[214:215], v37 offset:22528
 v_mul_f32 v188, v188, v8
 v_mfma_f32_16x16x32_bf16 v[172:175], a[192:195], v[64:67], 0
 ds_read_b64_tr_b16 a[216:217], v37 offset:24576
 v_mul_f32 v189, v189, v8
 v_mul_f32 v190, v190, v8
 v_mfma_f32_16x16x32_bf16 v[172:175], a[196:199], v[76:79], v[172:175]
 ds_read_b64_tr_b16 a[218:219], v37 offset:26624
 v_mul_f32 v191, v191, v8
 v_mfma_f32_16x16x32_bf16 v[224:227], a[196:199], v[80:83], 0
 ds_read_b64_tr_b16 a[220:221], v37 offset:28672
 v_cvt_pk_bf16_f32 v176, v176, v177
 v_cvt_pk_bf16_f32 v177, v178, v179
 v_mfma_f32_16x16x32_bf16 v[224:227], a[192:195], v[68:71], v[224:227]
 s_waitcnt lgkmcnt(7)
 ds_read_b64_tr_b16 a[222:223], v37 offset:30720
 v_cvt_pk_bf16_f32 v178, v188, v189
 v_mfma_f32_16x16x32_bf16 v[224:227], a[200:203], v[92:95], v[224:227]
 ds_read_b64_tr_b16 a[192:193], v38 offset:0
 v_cvt_pk_bf16_f32 v179, v190, v191
 v_mul_f32 v204, v204, v9
 v_mfma_f32_16x16x32_bf16 v[224:227], a[204:207], v[104:107], v[224:227]
 ds_read_b64_tr_b16 a[194:195], v38 offset:2048
 v_mul_f32 v205, v205, v9
 v_mfma_f32_16x16x32_bf16 v[172:175], a[204:207], v[100:103], v[172:175]
 ds_read_b64_tr_b16 a[196:197], v38 offset:4096
 buffer_store_dwordx4 v[176:179], v5, s[64:67], s84 offen sc0 sc1
 v_mfma_f32_16x16x32_bf16 v[172:175], a[200:203], v[88:91], v[172:175]
 s_waitcnt lgkmcnt(7)
 ds_read_b64_tr_b16 a[198:199], v38 offset:6144
 v_mul_f32 v206, v206, v9
 v_mfma_f32_16x16x32_bf16 v[172:175], a[208:211], v[112:115], v[172:175]
 ds_read_b64_tr_b16 a[200:201], v38 offset:8192
 v_mul_f32 v207, v207, v9
 v_mul_f32 v216, v216, v9
 v_mfma_f32_16x16x32_bf16 v[172:175], a[212:215], v[124:127], v[172:175]
 ds_read_b64_tr_b16 a[202:203], v38 offset:10240
 v_mul_f32 v217, v217, v9
 v_mfma_f32_16x16x32_bf16 v[224:227], a[212:215], v[128:131], v[224:227]
 ds_read_b64_tr_b16 a[204:205], v38 offset:12288
 v_mul_f32 v218, v218, v9
 v_mul_f32 v219, v219, v9
 v_mfma_f32_16x16x32_bf16 v[224:227], a[208:211], v[116:119], v[224:227]
 s_waitcnt lgkmcnt(7)
 ds_read_b64_tr_b16 a[206:207], v38 offset:14336
 v_cvt_pk_bf16_f32 v204, v204, v205
 v_mfma_f32_16x16x32_bf16 v[224:227], a[216:219], v[140:143], v[224:227]
 ds_read_b64_tr_b16 a[208:209], v38 offset:16384
 v_cvt_pk_bf16_f32 v205, v206, v207
 v_cvt_pk_bf16_f32 v206, v216, v217
 v_mfma_f32_16x16x32_bf16 v[224:227], a[220:223], v[152:155], v[224:227]
 ds_read_b64_tr_b16 a[210:211], v38 offset:18432
 v_cvt_pk_bf16_f32 v207, v218, v219
 v_mfma_f32_16x16x32_bf16 v[172:175], a[220:223], v[148:151], v[172:175]
 ds_read_b64_tr_b16 a[212:213], v38 offset:20480
 buffer_store_dwordx4 v[204:207], v240, s[64:67], s85 offen sc0 sc1
 s_mov_b32 s84, 0x18000
 v_mfma_f32_16x16x32_bf16 v[172:175], a[216:219], v[136:139], v[172:175]
 s_waitcnt lgkmcnt(7)
 ds_read_b64_tr_b16 a[214:215], v38 offset:22528
 v_mul_f32 v200, v200, v8
 v_mfma_f32_16x16x32_bf16 v[232:235], a[192:195], v[64:67], 0
 ds_read_b64_tr_b16 a[216:217], v38 offset:24576
 v_mul_f32 v201, v201, v8
 v_mul_f32 v202, v202, v8
 v_mfma_f32_16x16x32_bf16 v[232:235], a[196:199], v[76:79], v[232:235]
 ds_read_b64_tr_b16 a[218:219], v38 offset:26624
 v_mul_f32 v203, v203, v8
 v_mfma_f32_16x16x32_bf16 v[244:247], a[196:199], v[80:83], 0
 ds_read_b64_tr_b16 a[220:221], v38 offset:28672
 v_mul_f32 v212, v212, v8
 v_mfma_f32_16x16x32_bf16 v[244:247], a[192:195], v[68:71], v[244:247]
 s_waitcnt lgkmcnt(7)
 ds_read_b64_tr_b16 a[222:223], v38 offset:30720
 v_mul_f32 v213, v213, v8
 v_mul_f32 v214, v214, v8
 v_mfma_f32_16x16x32_bf16 v[244:247], a[200:203], v[92:95], v[244:247]
 ds_read_b64_tr_b16 a[192:193], v39 offset:0
 v_mul_f32 v215, v215, v8
 v_mfma_f32_16x16x32_bf16 v[244:247], a[204:207], v[104:107], v[244:247]
 ds_read_b64_tr_b16 a[194:195], v39 offset:2048
 v_cvt_pk_bf16_f32 v200, v200, v201
 v_cvt_pk_bf16_f32 v201, v202, v203
 v_mfma_f32_16x16x32_bf16 v[232:235], a[204:207], v[100:103], v[232:235]
 ds_read_b64_tr_b16 a[196:197], v39 offset:4096
 v_cvt_pk_bf16_f32 v202, v212, v213
 v_mfma_f32_16x16x32_bf16 v[232:235], a[200:203], v[88:91], v[232:235]
 s_waitcnt lgkmcnt(7)
 ds_read_b64_tr_b16 a[198:199], v39 offset:6144
 v_cvt_pk_bf16_f32 v203, v214, v215
 v_mul_f32 v164, v164, v9
 v_mfma_f32_16x16x32_bf16 v[232:235], a[208:211], v[112:115], v[232:235]
 ds_read_b64_tr_b16 a[200:201], v39 offset:8192
 buffer_store_dwordx4 v[200:203], v5, s[64:67], s85 offen sc0 sc1
 v_mfma_f32_16x16x32_bf16 v[232:235], a[212:215], v[124:127], v[232:235]
 ds_read_b64_tr_b16 a[202:203], v39 offset:10240
 v_mul_f32 v165, v165, v9
 v_mfma_f32_16x16x32_bf16 v[244:247], a[212:215], v[128:131], v[244:247]
 ds_read_b64_tr_b16 a[204:205], v39 offset:12288
 v_mul_f32 v166, v166, v9
 v_mfma_f32_16x16x32_bf16 v[244:247], a[208:211], v[116:119], v[244:247]
 s_waitcnt lgkmcnt(7)
 ds_read_b64_tr_b16 a[206:207], v39 offset:14336
 v_mul_f32 v167, v167, v9
 v_mul_f32 v224, v224, v9
 v_mfma_f32_16x16x32_bf16 v[244:247], a[216:219], v[140:143], v[244:247]
 ds_read_b64_tr_b16 a[208:209], v39 offset:16384
 v_mul_f32 v225, v225, v9
 v_mfma_f32_16x16x32_bf16 v[244:247], a[220:223], v[152:155], v[244:247]
 ds_read_b64_tr_b16 a[210:211], v39 offset:18432
 v_mul_f32 v226, v226, v9
 v_mfma_f32_16x16x32_bf16 v[232:235], a[220:223], v[148:151], v[232:235]
 ds_read_b64_tr_b16 a[212:213], v39 offset:20480
 v_mul_f32 v227, v227, v9
 v_cvt_pk_bf16_f32 v164, v164, v165
 v_mfma_f32_16x16x32_bf16 v[232:235], a[216:219], v[136:139], v[232:235]
 s_waitcnt lgkmcnt(7)
 ds_read_b64_tr_b16 a[214:215], v39 offset:22528
 v_cvt_pk_bf16_f32 v165, v166, v167
 v_mfma_f32_16x16x32_bf16 v[252:255], a[192:195], v[64:67], 0
 ds_read_b64_tr_b16 a[216:217], v39 offset:24576
 v_cvt_pk_bf16_f32 v166, v224, v225
 v_mfma_f32_16x16x32_bf16 v[252:255], a[196:199], v[76:79], v[252:255]
 ds_read_b64_tr_b16 a[218:219], v39 offset:26624
 v_cvt_pk_bf16_f32 v167, v226, v227
 v_mfma_f32_16x16x32_bf16 v[16:19], a[196:199], v[80:83], 0
 ds_read_b64_tr_b16 a[220:221], v39 offset:28672
 buffer_store_dwordx4 v[164:167], v240, s[64:67], s84 offen sc0 sc1
 v_mfma_f32_16x16x32_bf16 v[16:19], a[192:195], v[68:71], v[16:19]
 s_waitcnt lgkmcnt(7)
 ds_read_b64_tr_b16 a[222:223], v39 offset:30720
 v_mul_f32 v160, v160, v8
 v_mfma_f32_16x16x32_bf16 v[16:19], a[200:203], v[92:95], v[16:19]
 s_waitcnt vmcnt(29) lgkmcnt(0)
 s_barrier
 v_mfma_f32_16x16x32_bf16 v[16:19], a[204:207], v[104:107], v[16:19]
 ds_read_b64_tr_b16 a[192:193], v36 offset:32768
 v_mul_f32 v161, v161, v8
 v_mul_f32 v162, v162, v8
 v_mfma_f32_16x16x32_bf16 v[252:255], a[204:207], v[100:103], v[252:255]
L1_PADW3:
 s_cbranch_execz L1_PRL1
 ds_read_b64_tr_b16 a[194:195], v36 offset:34816
 v_mul_f32 v163, v163, v8
 v_mfma_f32_16x16x32_bf16 v[252:255], a[200:203], v[88:91], v[252:255]
 ds_read_b64_tr_b16 a[196:197], v36 offset:36864
 v_mul_f32 v172, v172, v8
 v_mfma_f32_16x16x32_bf16 v[252:255], a[208:211], v[112:115], v[252:255]
 ds_read_b64_tr_b16 a[198:199], v36 offset:38912
 v_mul_f32 v173, v173, v8
 v_mfma_f32_16x16x32_bf16 v[252:255], a[212:215], v[124:127], v[252:255]
 ds_read_b64_tr_b16 a[200:201], v36 offset:40960
 v_mul_f32 v174, v174, v8
 v_mul_f32 v175, v175, v8
 v_mfma_f32_16x16x32_bf16 v[16:19], a[212:215], v[128:131], v[16:19]
 ds_read_b64_tr_b16 a[202:203], v36 offset:43008
 v_cvt_pk_bf16_f32 v160, v160, v161
 v_mfma_f32_16x16x32_bf16 v[16:19], a[208:211], v[116:119], v[16:19]
 ds_read_b64_tr_b16 a[204:205], v36 offset:45056
 v_cvt_pk_bf16_f32 v161, v162, v163
 v_mfma_f32_16x16x32_bf16 v[16:19], a[216:219], v[140:143], v[16:19]
 ds_read_b64_tr_b16 a[206:207], v36 offset:47104
 v_cvt_pk_bf16_f32 v162, v172, v173
 v_mfma_f32_16x16x32_bf16 v[16:19], a[220:223], v[152:155], v[16:19]
 ds_read_b64_tr_b16 a[208:209], v36 offset:49152
 v_cvt_pk_bf16_f32 v163, v174, v175
 v_mfma_f32_16x16x32_bf16 v[252:255], a[220:223], v[148:151], v[252:255]
 ds_read_b64_tr_b16 a[210:211], v36 offset:51200
 v_mfma_f32_16x16x32_bf16 v[252:255], a[216:219], v[136:139], v[252:255]
 s_waitcnt lgkmcnt(6)
 ds_read_b64_tr_b16 a[212:213], v36 offset:53248
 ds_read_b64_tr_b16 a[214:215], v36 offset:55296
 buffer_store_dwordx4 v[160:163], v5, s[64:67], s84 offen sc0 sc1
 v_mfma_f32_16x16x32_bf16 v[176:179], a[192:195], v[64:67], 0
 ds_read_b64_tr_b16 a[216:217], v36 offset:57344
 s_mov_b32 s85, 0x1c000
 v_mfma_f32_16x16x32_bf16 v[176:179], a[196:199], v[76:79], v[176:179]
 ds_read_b64_tr_b16 a[218:219], v36 offset:59392
 s_lshl_b32 s10, s6, 3
 s_add_u32 s10, s10, s7
 s_lshl_b32 s10, s10, 4
 v_mov_b32 v197, s10
 v_mov_b32 v198, 1
 s_mov_b64 exec, 1
 global_atomic_add v209, v197, v198, s[38:39] offset:4 sc0
 s_mov_b64 exec, -1
 v_mfma_f32_16x16x32_bf16 v[180:183], a[196:199], v[80:83], 0
 ds_read_b64_tr_b16 a[220:221], v36 offset:61440
 v_mfma_f32_16x16x32_bf16 v[180:183], a[192:195], v[68:71], v[180:183]
 s_waitcnt lgkmcnt(7)
 ds_read_b64_tr_b16 a[222:223], v36 offset:63488
 v_mul_f32 v244, v244, v9
 v_mfma_f32_16x16x32_bf16 v[180:183], a[200:203], v[92:95], v[180:183]
 ds_read_b64_tr_b16 a[192:193], v37 offset:32768
 v_mul_f32 v245, v245, v9
 v_mfma_f32_16x16x32_bf16 v[180:183], a[204:207], v[104:107], v[180:183]
 ds_read_b64_tr_b16 a[194:195], v37 offset:34816
 v_mul_f32 v246, v246, v9
 v_mfma_f32_16x16x32_bf16 v[176:179], a[204:207], v[100:103], v[176:179]
 ds_read_b64_tr_b16 a[196:197], v37 offset:36864
 v_mul_f32 v247, v247, v9
 v_mfma_f32_16x16x32_bf16 v[176:179], a[200:203], v[88:91], v[176:179]
 s_waitcnt lgkmcnt(7)
 ds_read_b64_tr_b16 a[198:199], v37 offset:38912
 v_mul_f32 v16, v16, v9
 v_mfma_f32_16x16x32_bf16 v[176:179], a[208:211], v[112:115], v[176:179]
 ds_read_b64_tr_b16 a[200:201], v37 offset:40960
 v_mul_f32 v17, v17, v9
 v_mfma_f32_16x16x32_bf16 v[176:179], a[212:215], v[124:127], v[176:179]
 ds_read_b64_tr_b16 a[202:203], v37 offset:43008
 v_mul_f32 v18, v18, v9
 v_mfma_f32_16x16x32_bf16 v[180:183], a[212:215], v[128:131], v[180:183]
 ds_read_b64_tr_b16 a[204:205], v37 offset:45056
 v_mul_f32 v19, v19, v9
 v_mfma_f32_16x16x32_bf16 v[180:183], a[208:211], v[116:119], v[180:183]
 s_waitcnt lgkmcnt(7)
 ds_read_b64_tr_b16 a[206:207], v37 offset:47104
 v_cvt_pk_bf16_f32 v244, v244, v245
 v_mfma_f32_16x16x32_bf16 v[180:183], a[216:219], v[140:143], v[180:183]
 ds_read_b64_tr_b16 a[208:209], v37 offset:49152
 v_cvt_pk_bf16_f32 v245, v246, v247
 v_mfma_f32_16x16x32_bf16 v[180:183], a[220:223], v[152:155], v[180:183]
 ds_read_b64_tr_b16 a[210:211], v37 offset:51200
 v_cvt_pk_bf16_f32 v246, v16, v17
 v_mfma_f32_16x16x32_bf16 v[176:179], a[220:223], v[148:151], v[176:179]
 ds_read_b64_tr_b16 a[212:213], v37 offset:53248
 v_cvt_pk_bf16_f32 v247, v18, v19
 v_mfma_f32_16x16x32_bf16 v[176:179], a[216:219], v[136:139], v[176:179]
 s_waitcnt lgkmcnt(7)
 ds_read_b64_tr_b16 a[214:215], v37 offset:55296
 v_mul_f32 v232, v232, v8
 s_mov_b32 s84, 0x20000
 v_mfma_f32_16x16x32_bf16 v[188:191], a[192:195], v[64:67], 0
 ds_read_b64_tr_b16 a[216:217], v37 offset:57344
 v_mul_f32 v233, v233, v8
 v_mfma_f32_16x16x32_bf16 v[188:191], a[196:199], v[76:79], v[188:191]
 ds_read_b64_tr_b16 a[218:219], v37 offset:59392
 v_mul_f32 v234, v234, v8
 v_mfma_f32_16x16x32_bf16 v[192:195], a[196:199], v[80:83], 0
 ds_read_b64_tr_b16 a[220:221], v37 offset:61440
 v_mul_f32 v235, v235, v8
 v_mfma_f32_16x16x32_bf16 v[192:195], a[192:195], v[68:71], v[192:195]
 s_waitcnt lgkmcnt(7)
 ds_read_b64_tr_b16 a[222:223], v37 offset:63488
 v_mul_f32 v252, v252, v8
 v_mfma_f32_16x16x32_bf16 v[192:195], a[200:203], v[92:95], v[192:195]
 ds_read_b64_tr_b16 a[192:193], v38 offset:32768
 v_mul_f32 v253, v253, v8
 v_mfma_f32_16x16x32_bf16 v[192:195], a[204:207], v[104:107], v[192:195]
 ds_read_b64_tr_b16 a[194:195], v38 offset:34816
 v_mul_f32 v254, v254, v8
 v_mfma_f32_16x16x32_bf16 v[188:191], a[204:207], v[100:103], v[188:191]
 ds_read_b64_tr_b16 a[196:197], v38 offset:36864
 v_mul_f32 v255, v255, v8
 v_mfma_f32_16x16x32_bf16 v[188:191], a[200:203], v[88:91], v[188:191]
 s_waitcnt lgkmcnt(7)
 ds_read_b64_tr_b16 a[198:199], v38 offset:38912
 v_cvt_pk_bf16_f32 v232, v232, v233
 v_mfma_f32_16x16x32_bf16 v[188:191], a[208:211], v[112:115], v[188:191]
 ds_read_b64_tr_b16 a[200:201], v38 offset:40960
 v_cvt_pk_bf16_f32 v233, v234, v235
 v_mfma_f32_16x16x32_bf16 v[188:191], a[212:215], v[124:127], v[188:191]
 ds_read_b64_tr_b16 a[202:203], v38 offset:43008
 v_cvt_pk_bf16_f32 v234, v252, v253
 v_mfma_f32_16x16x32_bf16 v[192:195], a[212:215], v[128:131], v[192:195]
 ds_read_b64_tr_b16 a[204:205], v38 offset:45056
 v_cvt_pk_bf16_f32 v235, v254, v255
 v_mfma_f32_16x16x32_bf16 v[192:195], a[208:211], v[116:119], v[192:195]
 s_waitcnt lgkmcnt(7)
 ds_read_b64_tr_b16 a[206:207], v38 offset:47104
 v_mfma_f32_16x16x32_bf16 v[192:195], a[216:219], v[140:143], v[192:195]
 ds_read_b64_tr_b16 a[208:209], v38 offset:49152
 v_mfma_f32_16x16x32_bf16 v[192:195], a[220:223], v[152:155], v[192:195]
 ds_read_b64_tr_b16 a[210:211], v38 offset:51200
 v_mfma_f32_16x16x32_bf16 v[188:191], a[220:223], v[148:151], v[188:191]
 ds_read_b64_tr_b16 a[212:213], v38 offset:53248
 v_mfma_f32_16x16x32_bf16 v[188:191], a[216:219], v[136:139], v[188:191]
 s_waitcnt lgkmcnt(7)
 ds_read_b64_tr_b16 a[214:215], v38 offset:55296
 buffer_store_dwordx4 v[244:247], v240, s[64:67], s85 offen sc0 sc1
 v_mfma_f32_16x16x32_bf16 v[200:203], a[192:195], v[64:67], 0
 ds_read_b64_tr_b16 a[216:217], v38 offset:57344
 buffer_store_dwordx4 v[232:235], v5, s[64:67], s85 offen sc0 sc1
 v_mfma_f32_16x16x32_bf16 v[200:203], a[196:199], v[76:79], v[200:203]
 ds_read_b64_tr_b16 a[218:219], v38 offset:59392
 v_mfma_f32_16x16x32_bf16 v[204:207], a[196:199], v[80:83], 0
 ds_read_b64_tr_b16 a[220:221], v38 offset:61440
 v_mul_f32 v180, v180, v9
 v_mfma_f32_16x16x32_bf16 v[204:207], a[192:195], v[68:71], v[204:207]
 s_waitcnt lgkmcnt(7)
 ds_read_b64_tr_b16 a[222:223], v38 offset:63488
 v_mul_f32 v181, v181, v9
 v_mfma_f32_16x16x32_bf16 v[204:207], a[200:203], v[92:95], v[204:207]
 ds_read_b64_tr_b16 a[192:193], v39 offset:32768
 v_mul_f32 v182, v182, v9
 v_mfma_f32_16x16x32_bf16 v[204:207], a[204:207], v[104:107], v[204:207]
 ds_read_b64_tr_b16 a[194:195], v39 offset:34816
 v_mul_f32 v183, v183, v9
 v_mfma_f32_16x16x32_bf16 v[200:203], a[204:207], v[100:103], v[200:203]
 ds_read_b64_tr_b16 a[196:197], v39 offset:36864
 v_mul_f32 v192, v192, v9
 v_mfma_f32_16x16x32_bf16 v[200:203], a[200:203], v[88:91], v[200:203]
 s_waitcnt lgkmcnt(7)
 ds_read_b64_tr_b16 a[198:199], v39 offset:38912
 v_mul_f32 v193, v193, v9
 v_mfma_f32_16x16x32_bf16 v[200:203], a[208:211], v[112:115], v[200:203]
 ds_read_b64_tr_b16 a[200:201], v39 offset:40960
 v_mul_f32 v194, v194, v9
 v_mfma_f32_16x16x32_bf16 v[200:203], a[212:215], v[124:127], v[200:203]
 ds_read_b64_tr_b16 a[202:203], v39 offset:43008
 v_mul_f32 v195, v195, v9
 v_cvt_pk_bf16_f32 v180, v180, v181
 v_mfma_f32_16x16x32_bf16 v[204:207], a[212:215], v[128:131], v[204:207]
 ds_read_b64_tr_b16 a[204:205], v39 offset:45056
 v_cvt_pk_bf16_f32 v181, v182, v183
 v_mfma_f32_16x16x32_bf16 v[204:207], a[208:211], v[116:119], v[204:207]
 s_waitcnt lgkmcnt(7)
 ds_read_b64_tr_b16 a[206:207], v39 offset:47104
 v_cvt_pk_bf16_f32 v182, v192, v193
 v_mfma_f32_16x16x32_bf16 v[204:207], a[216:219], v[140:143], v[204:207]
 ds_read_b64_tr_b16 a[208:209], v39 offset:49152
 v_cvt_pk_bf16_f32 v183, v194, v195
 v_mfma_f32_16x16x32_bf16 v[204:207], a[220:223], v[152:155], v[204:207]
 ds_read_b64_tr_b16 a[210:211], v39 offset:51200
 v_mul_f32 v176, v176, v8
 v_mfma_f32_16x16x32_bf16 v[200:203], a[220:223], v[148:151], v[200:203]
 ds_read_b64_tr_b16 a[212:213], v39 offset:53248
 v_mul_f32 v177, v177, v8
 v_mfma_f32_16x16x32_bf16 v[200:203], a[216:219], v[136:139], v[200:203]
 s_waitcnt lgkmcnt(7)
 ds_read_b64_tr_b16 a[214:215], v39 offset:55296
 v_mul_f32 v178, v178, v8
 v_mfma_f32_16x16x32_bf16 v[212:215], a[192:195], v[64:67], 0
 ds_read_b64_tr_b16 a[216:217], v39 offset:57344
 v_mul_f32 v179, v179, v8
 v_mfma_f32_16x16x32_bf16 v[212:215], a[196:199], v[76:79], v[212:215]
 ds_read_b64_tr_b16 a[218:219], v39 offset:59392
 v_mul_f32 v188, v188, v8
 v_mfma_f32_16x16x32_bf16 v[216:219], a[196:199], v[80:83], 0
 ds_read_b64_tr_b16 a[220:221], v39 offset:61440
 v_mul_f32 v189, v189, v8
 v_mfma_f32_16x16x32_bf16 v[216:219], a[192:195], v[68:71], v[216:219]
 s_waitcnt lgkmcnt(7)
 ds_read_b64_tr_b16 a[222:223], v39 offset:63488
 v_mul_f32 v190, v190, v8
 v_mfma_f32_16x16x32_bf16 v[216:219], a[200:203], v[92:95], v[216:219]
 s_waitcnt vmcnt(23) lgkmcnt(0)
 s_barrier
 v_mfma_f32_16x16x32_bf16 v[216:219], a[204:207], v[104:107], v[216:219]
 ds_read_b64_tr_b16 a[192:193], v24 offset:0
 v_mul_f32 v191, v191, v8
 v_mfma_f32_16x16x32_bf16 v[212:215], a[204:207], v[100:103], v[212:215]
 ds_read_b64_tr_b16 a[194:195], v24 offset:2048
 v_cvt_pk_bf16_f32 v176, v176, v177
 v_mfma_f32_16x16x32_bf16 v[212:215], a[200:203], v[88:91], v[212:215]
 ds_read_b64_tr_b16 a[196:197], v24 offset:4096
 v_cvt_pk_bf16_f32 v177, v178, v179
 v_mfma_f32_16x16x32_bf16 v[212:215], a[208:211], v[112:115], v[212:215]
 ds_read_b64_tr_b16 a[198:199], v24 offset:6144
 v_cvt_pk_bf16_f32 v178, v188, v189
 v_mfma_f32_16x16x32_bf16 v[212:215], a[212:215], v[124:127], v[212:215]
 ds_read_b64_tr_b16 a[200:201], v24 offset:8192
 v_cvt_pk_bf16_f32 v179, v190, v191
 v_mfma_f32_16x16x32_bf16 v[216:219], a[212:215], v[128:131], v[216:219]
 ds_read_b64_tr_b16 a[202:203], v24 offset:10240
 v_mov_b32 v31, 0x18000
 v_mfma_f32_16x16x32_bf16 v[216:219], a[208:211], v[116:119], v[216:219]
 ds_read_b64_tr_b16 a[204:205], v24 offset:12288
 v_mfma_f32_16x16x32_bf16 v[216:219], a[216:219], v[140:143], v[216:219]
 ds_read_b64_tr_b16 a[206:207], v24 offset:14336
 v_mfma_f32_16x16x32_bf16 v[216:219], a[220:223], v[152:155], v[216:219]
 ds_read_b64_tr_b16 a[208:209], v24 offset:16384
 buffer_store_dwordx4 v[180:183], v240, s[64:67], s84 offen sc0 sc1
 v_mfma_f32_16x16x32_bf16 v[212:215], a[220:223], v[148:151], v[212:215]
 ds_read_b64_tr_b16 a[210:211], v24 offset:18432
 v_mfma_f32_16x16x32_bf16 v[212:215], a[216:219], v[136:139], v[212:215]
 s_waitcnt lgkmcnt(6)
 ds_read_b64_tr_b16 a[212:213], v24 offset:20480
 ds_read_b64_tr_b16 a[214:215], v24 offset:22528
 buffer_store_dwordx4 v[176:179], v5, s[64:67], s84 offen sc0 sc1
 v_mfma_f32_16x16x32_bf16 v[160:163], a[192:195], v[64:67], 0
 ds_read_b64_tr_b16 a[216:217], v24 offset:24576
 s_mov_b32 s85, 0x24000
 v_mfma_f32_16x16x32_bf16 v[160:163], a[196:199], v[76:79], v[160:163]
 ds_read_b64_tr_b16 a[218:219], v24 offset:26624
 v_mfma_f32_16x16x32_bf16 v[164:167], a[196:199], v[80:83], 0
 ds_read_b64_tr_b16 a[220:221], v24 offset:28672
 v_mfma_f32_16x16x32_bf16 v[164:167], a[192:195], v[68:71], v[164:167]
 s_waitcnt lgkmcnt(7)
 ds_read_b64_tr_b16 a[222:223], v24 offset:30720
 v_mul_f32 v204, v204, v9
 v_mfma_f32_16x16x32_bf16 v[164:167], a[200:203], v[92:95], v[164:167]
 ds_read_b64_tr_b16 a[192:193], v25 offset:0
 v_mul_f32 v205, v205, v9
 v_mfma_f32_16x16x32_bf16 v[164:167], a[204:207], v[104:107], v[164:167]
 ds_read_b64_tr_b16 a[194:195], v25 offset:2048
 v_mul_f32 v206, v206, v9
 v_mfma_f32_16x16x32_bf16 v[160:163], a[204:207], v[100:103], v[160:163]
 ds_read_b64_tr_b16 a[196:197], v25 offset:4096
 v_mul_f32 v207, v207, v9
 v_mfma_f32_16x16x32_bf16 v[160:163], a[200:203], v[88:91], v[160:163]
 s_waitcnt lgkmcnt(7)
 ds_read_b64_tr_b16 a[198:199], v25 offset:6144
 v_mul_f32 v216, v216, v9
 v_mfma_f32_16x16x32_bf16 v[160:163], a[208:211], v[112:115], v[160:163]
 ds_read_b64_tr_b16 a[200:201], v25 offset:8192
 v_mul_f32 v217, v217, v9
 v_mfma_f32_16x16x32_bf16 v[160:163], a[212:215], v[124:127], v[160:163]
 ds_read_b64_tr_b16 a[202:203], v25 offset:10240
 v_mul_f32 v218, v218, v9
 v_mfma_f32_16x16x32_bf16 v[164:167], a[212:215], v[128:131], v[164:167]
 ds_read_b64_tr_b16 a[204:205], v25 offset:12288
 v_mul_f32 v219, v219, v9
 v_mfma_f32_16x16x32_bf16 v[164:167], a[208:211], v[116:119], v[164:167]
 s_waitcnt lgkmcnt(7)
 ds_read_b64_tr_b16 a[206:207], v25 offset:14336
 v_cvt_pk_bf16_f32 v204, v204, v205
 v_mfma_f32_16x16x32_bf16 v[164:167], a[216:219], v[140:143], v[164:167]
 ds_read_b64_tr_b16 a[208:209], v25 offset:16384
 v_cvt_pk_bf16_f32 v205, v206, v207
 v_mfma_f32_16x16x32_bf16 v[164:167], a[220:223], v[152:155], v[164:167]
 ds_read_b64_tr_b16 a[210:211], v25 offset:18432
 v_cvt_pk_bf16_f32 v206, v216, v217
 v_mfma_f32_16x16x32_bf16 v[160:163], a[220:223], v[148:151], v[160:163]
 ds_read_b64_tr_b16 a[212:213], v25 offset:20480
 v_cvt_pk_bf16_f32 v207, v218, v219
 v_mfma_f32_16x16x32_bf16 v[160:163], a[216:219], v[136:139], v[160:163]
 s_waitcnt lgkmcnt(7)
 ds_read_b64_tr_b16 a[214:215], v25 offset:22528
 v_mul_f32 v200, v200, v8
 s_mov_b32 s84, 0x28000
 v_mfma_f32_16x16x32_bf16 v[172:175], a[192:195], v[64:67], 0
 ds_read_b64_tr_b16 a[216:217], v25 offset:24576
 v_mul_f32 v201, v201, v8
 v_mfma_f32_16x16x32_bf16 v[172:175], a[196:199], v[76:79], v[172:175]
 ds_read_b64_tr_b16 a[218:219], v25 offset:26624
 v_mul_f32 v202, v202, v8
 v_mfma_f32_16x16x32_bf16 v[224:227], a[196:199], v[80:83], 0
 ds_read_b64_tr_b16 a[220:221], v25 offset:28672
 v_mul_f32 v203, v203, v8
 v_mfma_f32_16x16x32_bf16 v[224:227], a[192:195], v[68:71], v[224:227]
 s_waitcnt lgkmcnt(7)
 ds_read_b64_tr_b16 a[222:223], v25 offset:30720
 v_mul_f32 v212, v212, v8
 v_mfma_f32_16x16x32_bf16 v[224:227], a[200:203], v[92:95], v[224:227]
 ds_read_b64_tr_b16 a[192:193], v26 offset:0
 v_mul_f32 v213, v213, v8
 v_mfma_f32_16x16x32_bf16 v[224:227], a[204:207], v[104:107], v[224:227]
 ds_read_b64_tr_b16 a[194:195], v26 offset:2048
 v_mul_f32 v214, v214, v8
 v_mfma_f32_16x16x32_bf16 v[172:175], a[204:207], v[100:103], v[172:175]
 ds_read_b64_tr_b16 a[196:197], v26 offset:4096
 v_mul_f32 v215, v215, v8
 v_mfma_f32_16x16x32_bf16 v[172:175], a[200:203], v[88:91], v[172:175]
 s_waitcnt lgkmcnt(7)
 ds_read_b64_tr_b16 a[198:199], v26 offset:6144
 v_cvt_pk_bf16_f32 v200, v200, v201
 v_mfma_f32_16x16x32_bf16 v[172:175], a[208:211], v[112:115], v[172:175]
 ds_read_b64_tr_b16 a[200:201], v26 offset:8192
 v_cvt_pk_bf16_f32 v201, v202, v203
 v_mfma_f32_16x16x32_bf16 v[172:175], a[212:215], v[124:127], v[172:175]
 ds_read_b64_tr_b16 a[202:203], v26 offset:10240
 v_cvt_pk_bf16_f32 v202, v212, v213
 v_mfma_f32_16x16x32_bf16 v[224:227], a[212:215], v[128:131], v[224:227]
 ds_read_b64_tr_b16 a[204:205], v26 offset:12288
 v_cvt_pk_bf16_f32 v203, v214, v215
 v_mfma_f32_16x16x32_bf16 v[224:227], a[208:211], v[116:119], v[224:227]
 s_waitcnt lgkmcnt(7)
 ds_read_b64_tr_b16 a[206:207], v26 offset:14336
 v_mfma_f32_16x16x32_bf16 v[224:227], a[216:219], v[140:143], v[224:227]
 ds_read_b64_tr_b16 a[208:209], v26 offset:16384
 v_mfma_f32_16x16x32_bf16 v[224:227], a[220:223], v[152:155], v[224:227]
 ds_read_b64_tr_b16 a[210:211], v26 offset:18432
 v_mfma_f32_16x16x32_bf16 v[172:175], a[220:223], v[148:151], v[172:175]
 ds_read_b64_tr_b16 a[212:213], v26 offset:20480
 v_mfma_f32_16x16x32_bf16 v[172:175], a[216:219], v[136:139], v[172:175]
 s_waitcnt lgkmcnt(7)
 ds_read_b64_tr_b16 a[214:215], v26 offset:22528
 buffer_store_dwordx4 v[204:207], v240, s[64:67], s85 offen sc0 sc1
 v_mfma_f32_16x16x32_bf16 v[232:235], a[192:195], v[64:67], 0
 ds_read_b64_tr_b16 a[216:217], v26 offset:24576
 buffer_store_dwordx4 v[200:203], v5, s[64:67], s85 offen sc0 sc1
 v_mfma_f32_16x16x32_bf16 v[232:235], a[196:199], v[76:79], v[232:235]
 ds_read_b64_tr_b16 a[218:219], v26 offset:26624
 v_mfma_f32_16x16x32_bf16 v[244:247], a[196:199], v[80:83], 0
 ds_read_b64_tr_b16 a[220:221], v26 offset:28672
 v_mul_f32 v164, v164, v9
 v_mfma_f32_16x16x32_bf16 v[244:247], a[192:195], v[68:71], v[244:247]
 s_waitcnt lgkmcnt(7)
 ds_read_b64_tr_b16 a[222:223], v26 offset:30720
 v_mul_f32 v165, v165, v9
 v_mfma_f32_16x16x32_bf16 v[244:247], a[200:203], v[92:95], v[244:247]
 ds_read_b64_tr_b16 a[192:193], v27 offset:0
 v_mul_f32 v166, v166, v9
 v_mfma_f32_16x16x32_bf16 v[244:247], a[204:207], v[104:107], v[244:247]
 ds_read_b64_tr_b16 a[194:195], v27 offset:2048
 v_mul_f32 v167, v167, v9
 v_mfma_f32_16x16x32_bf16 v[232:235], a[204:207], v[100:103], v[232:235]
 ds_read_b64_tr_b16 a[196:197], v27 offset:4096
 v_mul_f32 v224, v224, v9
 v_mfma_f32_16x16x32_bf16 v[232:235], a[200:203], v[88:91], v[232:235]
 s_waitcnt lgkmcnt(7)
 ds_read_b64_tr_b16 a[198:199], v27 offset:6144
 v_mul_f32 v225, v225, v9
 v_mfma_f32_16x16x32_bf16 v[232:235], a[208:211], v[112:115], v[232:235]
 ds_read_b64_tr_b16 a[200:201], v27 offset:8192
 v_mul_f32 v226, v226, v9
 v_mfma_f32_16x16x32_bf16 v[232:235], a[212:215], v[124:127], v[232:235]
 ds_read_b64_tr_b16 a[202:203], v27 offset:10240
 v_mul_f32 v227, v227, v9
 v_mfma_f32_16x16x32_bf16 v[244:247], a[212:215], v[128:131], v[244:247]
 ds_read_b64_tr_b16 a[204:205], v27 offset:12288
 v_cvt_pk_bf16_f32 v164, v164, v165
 v_mfma_f32_16x16x32_bf16 v[244:247], a[208:211], v[116:119], v[244:247]
 s_waitcnt lgkmcnt(7)
 ds_read_b64_tr_b16 a[206:207], v27 offset:14336
 v_cvt_pk_bf16_f32 v165, v166, v167
 v_mfma_f32_16x16x32_bf16 v[244:247], a[216:219], v[140:143], v[244:247]
 ds_read_b64_tr_b16 a[208:209], v27 offset:16384
 v_cvt_pk_bf16_f32 v166, v224, v225
 v_mfma_f32_16x16x32_bf16 v[244:247], a[220:223], v[152:155], v[244:247]
 ds_read_b64_tr_b16 a[210:211], v27 offset:18432
 v_cvt_pk_bf16_f32 v167, v226, v227
 v_mfma_f32_16x16x32_bf16 v[232:235], a[220:223], v[148:151], v[232:235]
 ds_read_b64_tr_b16 a[212:213], v27 offset:20480
 v_mul_f32 v160, v160, v8
 v_mfma_f32_16x16x32_bf16 v[232:235], a[216:219], v[136:139], v[232:235]
 s_waitcnt lgkmcnt(7)
 ds_read_b64_tr_b16 a[214:215], v27 offset:22528
 v_mul_f32 v161, v161, v8
 v_mfma_f32_16x16x32_bf16 v[252:255], a[192:195], v[64:67], 0
 ds_read_b64_tr_b16 a[216:217], v27 offset:24576
 v_mul_f32 v162, v162, v8
 v_mfma_f32_16x16x32_bf16 v[252:255], a[196:199], v[76:79], v[252:255]
 ds_read_b64_tr_b16 a[218:219], v27 offset:26624
 v_mul_f32 v163, v163, v8
 v_mfma_f32_16x16x32_bf16 v[16:19], a[196:199], v[80:83], 0
 ds_read_b64_tr_b16 a[220:221], v27 offset:28672
 v_mul_f32 v172, v172, v8
 v_mfma_f32_16x16x32_bf16 v[16:19], a[192:195], v[68:71], v[16:19]
 s_waitcnt lgkmcnt(7)
 ds_read_b64_tr_b16 a[222:223], v27 offset:30720
 v_mul_f32 v173, v173, v8
 v_mfma_f32_16x16x32_bf16 v[16:19], a[200:203], v[92:95], v[16:19]
 s_waitcnt vmcnt(6)
 v_readfirstlane_b32 s22, v209
 s_mov_b64 exec, 1
 ds_write_b32 v31, v209 offset:4
 s_mov_b64 exec, -1
 s_waitcnt lgkmcnt(0)
 s_barrier
 v_mfma_f32_16x16x32_bf16 v[16:19], a[204:207], v[104:107], v[16:19]
 ds_read_b64_tr_b16 a[192:193], v236 offset:0
 v_mul_f32 v174, v174, v8
 v_mfma_f32_16x16x32_bf16 v[252:255], a[204:207], v[100:103], v[252:255]
 ds_read_b64_tr_b16 a[194:195], v236 offset:2048
 buffer_store_dwordx4 v[164:167], v240, s[64:67], s84 offen sc0 sc1
 v_mfma_f32_16x16x32_bf16 v[252:255], a[200:203], v[88:91], v[252:255]
 ds_read_b64_tr_b16 a[196:197], v236 offset:4096
 v_mul_f32 v175, v175, v8
 v_mfma_f32_16x16x32_bf16 v[252:255], a[208:211], v[112:115], v[252:255]
 ds_read_b64_tr_b16 a[198:199], v236 offset:6144
 v_cvt_pk_bf16_f32 v160, v160, v161
 v_mfma_f32_16x16x32_bf16 v[252:255], a[212:215], v[124:127], v[252:255]
 ds_read_b64_tr_b16 a[200:201], v236 offset:8192
 v_cvt_pk_bf16_f32 v161, v162, v163
 v_mfma_f32_16x16x32_bf16 v[16:19], a[212:215], v[128:131], v[16:19]
 ds_read_b64_tr_b16 a[202:203], v236 offset:10240
 v_cvt_pk_bf16_f32 v162, v172, v173
 v_mfma_f32_16x16x32_bf16 v[16:19], a[208:211], v[116:119], v[16:19]
 ds_read_b64_tr_b16 a[204:205], v236 offset:12288
 v_cvt_pk_bf16_f32 v163, v174, v175
 v_mfma_f32_16x16x32_bf16 v[16:19], a[216:219], v[140:143], v[16:19]
 ds_read_b64_tr_b16 a[206:207], v236 offset:14336
 v_mfma_f32_16x16x32_bf16 v[16:19], a[220:223], v[152:155], v[16:19]
 ds_read_b64_tr_b16 a[208:209], v236 offset:16384
 v_mfma_f32_16x16x32_bf16 v[252:255], a[220:223], v[148:151], v[252:255]
 ds_read_b64_tr_b16 a[210:211], v236 offset:18432
 v_mfma_f32_16x16x32_bf16 v[252:255], a[216:219], v[136:139], v[252:255]
 s_waitcnt lgkmcnt(6)
 ds_read_b64_tr_b16 a[212:213], v236 offset:20480
 ds_read_b64_tr_b16 a[214:215], v236 offset:22528
 buffer_store_dwordx4 v[160:163], v5, s[64:67], s84 offen sc0 sc1
 v_mfma_f32_16x16x32_bf16 v[176:179], a[192:195], v[64:67], 0
 ds_read_b64_tr_b16 a[216:217], v236 offset:24576
 s_mov_b32 s85, 0x2c000
 v_mfma_f32_16x16x32_bf16 v[176:179], a[196:199], v[76:79], v[176:179]
 ds_read_b64_tr_b16 a[218:219], v236 offset:26624
 v_mfma_f32_16x16x32_bf16 v[180:183], a[196:199], v[80:83], 0
 ds_read_b64_tr_b16 a[220:221], v236 offset:28672
 v_mfma_f32_16x16x32_bf16 v[180:183], a[192:195], v[68:71], v[180:183]
 s_waitcnt lgkmcnt(7)
 ds_read_b64_tr_b16 a[222:223], v236 offset:30720
 v_mul_f32 v244, v244, v9
 v_mfma_f32_16x16x32_bf16 v[180:183], a[200:203], v[92:95], v[180:183]
 ds_read_b64_tr_b16 a[192:193], v237 offset:0
 v_mul_f32 v245, v245, v9
 v_mfma_f32_16x16x32_bf16 v[180:183], a[204:207], v[104:107], v[180:183]
 ds_read_b64_tr_b16 a[194:195], v237 offset:2048
 v_mul_f32 v246, v246, v9
 v_mfma_f32_16x16x32_bf16 v[176:179], a[204:207], v[100:103], v[176:179]
 ds_read_b64_tr_b16 a[196:197], v237 offset:4096
 v_mul_f32 v247, v247, v9
 v_mfma_f32_16x16x32_bf16 v[176:179], a[200:203], v[88:91], v[176:179]
 s_waitcnt lgkmcnt(7)
 ds_read_b64_tr_b16 a[198:199], v237 offset:6144
 v_mul_f32 v16, v16, v9
 v_mfma_f32_16x16x32_bf16 v[176:179], a[208:211], v[112:115], v[176:179]
 ds_read_b64_tr_b16 a[200:201], v237 offset:8192
 v_mul_f32 v17, v17, v9
 v_mfma_f32_16x16x32_bf16 v[176:179], a[212:215], v[124:127], v[176:179]
 ds_read_b64_tr_b16 a[202:203], v237 offset:10240
 v_mul_f32 v18, v18, v9
 v_mfma_f32_16x16x32_bf16 v[180:183], a[212:215], v[128:131], v[180:183]
 ds_read_b64_tr_b16 a[204:205], v237 offset:12288
 v_mul_f32 v19, v19, v9
 v_mfma_f32_16x16x32_bf16 v[180:183], a[208:211], v[116:119], v[180:183]
 s_waitcnt lgkmcnt(7)
 ds_read_b64_tr_b16 a[206:207], v237 offset:14336
 v_cvt_pk_bf16_f32 v244, v244, v245
 v_mfma_f32_16x16x32_bf16 v[180:183], a[216:219], v[140:143], v[180:183]
 ds_read_b64_tr_b16 a[208:209], v237 offset:16384
 v_cvt_pk_bf16_f32 v245, v246, v247
 v_mfma_f32_16x16x32_bf16 v[180:183], a[220:223], v[152:155], v[180:183]
 ds_read_b64_tr_b16 a[210:211], v237 offset:18432
 v_cvt_pk_bf16_f32 v246, v16, v17
 v_mfma_f32_16x16x32_bf16 v[176:179], a[220:223], v[148:151], v[176:179]
 ds_read_b64_tr_b16 a[212:213], v237 offset:20480
 v_cvt_pk_bf16_f32 v247, v18, v19
 v_mfma_f32_16x16x32_bf16 v[176:179], a[216:219], v[136:139], v[176:179]
 s_waitcnt lgkmcnt(7)
 ds_read_b64_tr_b16 a[214:215], v237 offset:22528
 v_mul_f32 v232, v232, v8
 s_mov_b32 s84, 0x30000
 v_mfma_f32_16x16x32_bf16 v[188:191], a[192:195], v[64:67], 0
 ds_read_b64_tr_b16 a[216:217], v237 offset:24576
 v_mul_f32 v233, v233, v8
 v_mfma_f32_16x16x32_bf16 v[188:191], a[196:199], v[76:79], v[188:191]
 ds_read_b64_tr_b16 a[218:219], v237 offset:26624
 v_mul_f32 v234, v234, v8
 v_mfma_f32_16x16x32_bf16 v[192:195], a[196:199], v[80:83], 0
 ds_read_b64_tr_b16 a[220:221], v237 offset:28672
 v_mul_f32 v235, v235, v8
 v_mfma_f32_16x16x32_bf16 v[192:195], a[192:195], v[68:71], v[192:195]
 s_waitcnt lgkmcnt(7)
 ds_read_b64_tr_b16 a[222:223], v237 offset:30720
 v_mul_f32 v252, v252, v8
 v_mfma_f32_16x16x32_bf16 v[192:195], a[200:203], v[92:95], v[192:195]
 ds_read_b64_tr_b16 a[192:193], v238 offset:0
 v_mul_f32 v253, v253, v8
 v_mfma_f32_16x16x32_bf16 v[192:195], a[204:207], v[104:107], v[192:195]
 ds_read_b64_tr_b16 a[194:195], v238 offset:2048
 v_mul_f32 v254, v254, v8
 v_mfma_f32_16x16x32_bf16 v[188:191], a[204:207], v[100:103], v[188:191]
 ds_read_b64_tr_b16 a[196:197], v238 offset:4096
 v_mul_f32 v255, v255, v8
 v_mfma_f32_16x16x32_bf16 v[188:191], a[200:203], v[88:91], v[188:191]
 s_waitcnt lgkmcnt(7)
 ds_read_b64_tr_b16 a[198:199], v238 offset:6144
 v_cvt_pk_bf16_f32 v232, v232, v233
 v_mfma_f32_16x16x32_bf16 v[188:191], a[208:211], v[112:115], v[188:191]
 ds_read_b64_tr_b16 a[200:201], v238 offset:8192
 v_cvt_pk_bf16_f32 v233, v234, v235
 v_mfma_f32_16x16x32_bf16 v[188:191], a[212:215], v[124:127], v[188:191]
 ds_read_b64_tr_b16 a[202:203], v238 offset:10240
 v_cvt_pk_bf16_f32 v234, v252, v253
 v_mfma_f32_16x16x32_bf16 v[192:195], a[212:215], v[128:131], v[192:195]
 ds_read_b64_tr_b16 a[204:205], v238 offset:12288
 v_cvt_pk_bf16_f32 v235, v254, v255
 v_mfma_f32_16x16x32_bf16 v[192:195], a[208:211], v[116:119], v[192:195]
 s_waitcnt lgkmcnt(7)
 ds_read_b64_tr_b16 a[206:207], v238 offset:14336
 v_mfma_f32_16x16x32_bf16 v[192:195], a[216:219], v[140:143], v[192:195]
 ds_read_b64_tr_b16 a[208:209], v238 offset:16384
 v_mfma_f32_16x16x32_bf16 v[192:195], a[220:223], v[152:155], v[192:195]
 ds_read_b64_tr_b16 a[210:211], v238 offset:18432
 v_mfma_f32_16x16x32_bf16 v[188:191], a[220:223], v[148:151], v[188:191]
 ds_read_b64_tr_b16 a[212:213], v238 offset:20480
 v_mfma_f32_16x16x32_bf16 v[188:191], a[216:219], v[136:139], v[188:191]
 s_waitcnt lgkmcnt(7)
 ds_read_b64_tr_b16 a[214:215], v238 offset:22528
 buffer_store_dwordx4 v[244:247], v240, s[64:67], s85 offen sc0 sc1
 v_mfma_f32_16x16x32_bf16 v[200:203], a[192:195], v[64:67], 0
 ds_read_b64_tr_b16 a[216:217], v238 offset:24576
 buffer_store_dwordx4 v[232:235], v5, s[64:67], s85 offen sc0 sc1
 v_mfma_f32_16x16x32_bf16 v[200:203], a[196:199], v[76:79], v[200:203]
 ds_read_b64_tr_b16 a[218:219], v238 offset:26624
 v_mfma_f32_16x16x32_bf16 v[204:207], a[196:199], v[80:83], 0
 ds_read_b64_tr_b16 a[220:221], v238 offset:28672
 v_mul_f32 v180, v180, v9
 v_mfma_f32_16x16x32_bf16 v[204:207], a[192:195], v[68:71], v[204:207]
 s_waitcnt lgkmcnt(7)
 ds_read_b64_tr_b16 a[222:223], v238 offset:30720
 v_mul_f32 v181, v181, v9
 v_mfma_f32_16x16x32_bf16 v[204:207], a[200:203], v[92:95], v[204:207]
 ds_read_b64_tr_b16 a[192:193], v239 offset:0
 v_mul_f32 v182, v182, v9
 v_mfma_f32_16x16x32_bf16 v[204:207], a[204:207], v[104:107], v[204:207]
 ds_read_b64_tr_b16 a[194:195], v239 offset:2048
 v_mul_f32 v183, v183, v9
 v_mfma_f32_16x16x32_bf16 v[200:203], a[204:207], v[100:103], v[200:203]
 ds_read_b64_tr_b16 a[196:197], v239 offset:4096
 v_mul_f32 v192, v192, v9
 v_mfma_f32_16x16x32_bf16 v[200:203], a[200:203], v[88:91], v[200:203]
 s_waitcnt lgkmcnt(7)
 ds_read_b64_tr_b16 a[198:199], v239 offset:6144
 v_mul_f32 v193, v193, v9
 v_mfma_f32_16x16x32_bf16 v[200:203], a[208:211], v[112:115], v[200:203]
 ds_read_b64_tr_b16 a[200:201], v239 offset:8192
 v_mfma_f32_16x16x32_bf16 v[200:203], a[212:215], v[124:127], v[200:203]
 ds_read_b64_tr_b16 a[202:203], v239 offset:10240
 v_mul_f32 v194, v194, v9
 v_mfma_f32_16x16x32_bf16 v[204:207], a[212:215], v[128:131], v[204:207]
 ds_read_b64_tr_b16 a[204:205], v239 offset:12288
 v_mul_f32 v195, v195, v9
 v_mfma_f32_16x16x32_bf16 v[204:207], a[208:211], v[116:119], v[204:207]
 s_waitcnt lgkmcnt(7)
 ds_read_b64_tr_b16 a[206:207], v239 offset:14336
 v_mfma_f32_16x16x32_bf16 v[204:207], a[216:219], v[140:143], v[204:207]
 ds_read_b64_tr_b16 a[208:209], v239 offset:16384
 v_cvt_pk_bf16_f32 v180, v180, v181
 v_mfma_f32_16x16x32_bf16 v[204:207], a[220:223], v[152:155], v[204:207]
L1_PADW4:
 s_cbranch_execz L1_PRL1
 ds_read_b64_tr_b16 a[210:211], v239 offset:18432
 v_mfma_f32_16x16x32_bf16 v[200:203], a[220:223], v[148:151], v[200:203]
 ds_read_b64_tr_b16 a[212:213], v239 offset:20480
 v_cvt_pk_bf16_f32 v181, v182, v183
 v_mfma_f32_16x16x32_bf16 v[200:203], a[216:219], v[136:139], v[200:203]
 s_waitcnt lgkmcnt(7)
 ds_read_b64_tr_b16 a[214:215], v239 offset:22528
 v_cvt_pk_bf16_f32 v182, v192, v193
 v_mfma_f32_16x16x32_bf16 v[212:215], a[192:195], v[64:67], 0
 ds_read_b64_tr_b16 a[216:217], v239 offset:24576
 v_mfma_f32_16x16x32_bf16 v[212:215], a[196:199], v[76:79], v[212:215]
 ds_read_b64_tr_b16 a[218:219], v239 offset:26624
 v_cvt_pk_bf16_f32 v183, v194, v195
 v_mfma_f32_16x16x32_bf16 v[216:219], a[196:199], v[80:83], 0
 ds_read_b64_tr_b16 a[220:221], v239 offset:28672
 v_mul_f32 v176, v176, v8
 v_mfma_f32_16x16x32_bf16 v[216:219], a[192:195], v[68:71], v[216:219]
 s_waitcnt lgkmcnt(7)
 ds_read_b64_tr_b16 a[222:223], v239 offset:30720
 v_mfma_f32_16x16x32_bf16 v[216:219], a[200:203], v[92:95], v[216:219]
 buffer_store_dwordx4 v[180:183], v240, s[64:67], s84 offen sc0 sc1
 v_mfma_f32_16x16x32_bf16 v[216:219], a[204:207], v[104:107], v[216:219]
 v_mul_f32 v177, v177, v8
 v_mfma_f32_16x16x32_bf16 v[212:215], a[204:207], v[100:103], v[212:215]
 v_mul_f32 v178, v178, v8
 v_mfma_f32_16x16x32_bf16 v[212:215], a[200:203], v[88:91], v[212:215]
 s_waitcnt lgkmcnt(4)
 v_mul_f32 v179, v179, v8
 v_mul_f32 v188, v188, v8
 v_mfma_f32_16x16x32_bf16 v[212:215], a[208:211], v[112:115], v[212:215]
 v_mul_f32 v189, v189, v8
 v_mfma_f32_16x16x32_bf16 v[212:215], a[212:215], v[124:127], v[212:215]
 v_mul_f32 v190, v190, v8
 v_mfma_f32_16x16x32_bf16 v[216:219], a[212:215], v[128:131], v[216:219]
 v_mul_f32 v191, v191, v8
 v_mfma_f32_16x16x32_bf16 v[216:219], a[208:211], v[116:119], v[216:219]
 s_waitcnt lgkmcnt(0)
 v_cvt_pk_bf16_f32 v176, v176, v177
 v_mfma_f32_16x16x32_bf16 v[216:219], a[216:219], v[140:143], v[216:219]
 v_cvt_pk_bf16_f32 v177, v178, v179
 v_cvt_pk_bf16_f32 v178, v188, v189
 v_mfma_f32_16x16x32_bf16 v[216:219], a[220:223], v[152:155], v[216:219]
 v_cvt_pk_bf16_f32 v179, v190, v191
 v_mfma_f32_16x16x32_bf16 v[212:215], a[220:223], v[148:151], v[212:215]
 buffer_store_dwordx4 v[176:179], v5, s[64:67], s84 offen sc0 sc1
 v_mfma_f32_16x16x32_bf16 v[212:215], a[216:219], v[136:139], v[212:215]
 s_mov_b32 s85, 0x34000
 v_mul_f32 v204, v204, v9
 v_mul_f32 v205, v205, v9
 v_mul_f32 v206, v206, v9
 v_mul_f32 v207, v207, v9
 v_mul_f32 v216, v216, v9
 v_mul_f32 v217, v217, v9
 v_mul_f32 v218, v218, v9
 v_mul_f32 v219, v219, v9
 v_cvt_pk_bf16_f32 v204, v204, v205
 v_cvt_pk_bf16_f32 v205, v206, v207
 v_cvt_pk_bf16_f32 v206, v216, v217
 v_cvt_pk_bf16_f32 v207, v218, v219
 buffer_store_dwordx4 v[204:207], v240, s[64:67], s85 offen sc0 sc1
 v_mul_f32 v200, v200, v8
 v_mul_f32 v201, v201, v8
 v_mul_f32 v202, v202, v8
 v_mul_f32 v203, v203, v8
 v_mul_f32 v212, v212, v8
 v_mul_f32 v213, v213, v8
 v_mul_f32 v214, v214, v8
 v_mul_f32 v215, v215, v8
 v_cvt_pk_bf16_f32 v200, v200, v201
 v_cvt_pk_bf16_f32 v201, v202, v203
 v_cvt_pk_bf16_f32 v202, v212, v213
 v_cvt_pk_bf16_f32 v203, v214, v215
 buffer_store_dwordx4 v[200:203], v5, s[64:67], s85 offen sc0 sc1
 s_setprio 3
 s_mov_b64 exec, 0xffff
 global_load_dword v199, v196, s[40:41] sc0 sc1
 v_add_u32 v198, 1, v208
 s_lshl_b32 s10, 1, s8
 s_mov_b32 s11, 0
 v_mov_b32 v30, s10
 s_mov_b32 s46, 0
 s_waitcnt vmcnt(0)
 v_cmp_ne_u32 vcc, v208, v199
 s_or_b32 s55, vcc_lo, s10
 v_mov_b32 v28, s55
 ds_write_b32 v31, v28
 s_mov_b64 exec, s[10:11]
 s_waitcnt lgkmcnt(0)
 s_barrier
 global_store_dword v196, v198, s[40:41] sc0 sc1
 global_atomic_add v28, v197, v30, s[38:39] sc0
 s_waitcnt vmcnt(0)
 v_readfirstlane_b32 s11, v28
 s_mov_b64 exec, 0xffff
 s_or_b32 s11, s11, s10
 s_and_b32 s12, s11, 0xffff
 s_cmp_eq_u32 s12, 0xffff
 s_cselect_b32 s12, s11, s12
 s_or_b32 s55, s55, s12
L1_DTELL_W3:
 v_mov_b32 v28, s55
 ds_write_b32 v31, v28
 s_and_b32 s12, s55, 0xffff
 s_cmp_eq_u32 s12, 0xffff
 s_cbranch_scc1 L1_DEND_W3
L1_DNEXT_W3:
 global_load_dword v199, v196, s[40:41] sc0 sc1
 s_add_u32 s46, s46, 1
 s_mov_b32 s12, s55
 s_waitcnt vmcnt(0)
 v_cmp_ne_u32 vcc, v208, v199
 s_or_b32 s55, vcc_lo, s55
 s_cmp_lg_u32 s12, s55
 s_cbranch_scc1 L1_DTELL_W3
 s_cmp_lt_u32 s46, 1024
 s_cbranch_scc1 L1_DNEXT_W3
 s_add_u32 s10, s22, 16
 s_lshl_b32 s10, 1, s10
 v_mov_b32 v30, s10
 s_mov_b64 exec, 1
 global_atomic_add v28, v197, v30, s[38:39] sc0
 s_waitcnt vmcnt(0)
 v_readfirstlane_b32 s11, v28
 s_and_b32 s11, s11, 0xffff
 s_cmp_eq_u32 s11, 0xffff
 s_cselect_b32 s55, s11, 0
 v_mov_b32 v28, s55
 ds_write_b32 v31, v28
L1_DEND_W3:
 s_waitcnt vmcnt(0) lgkmcnt(0)
 s_barrier
L1_FIN_W3:
 s_endpgm
L1_RARE0_W3:
 s_nop 7
 v_max3_f32 v236, v128, v129, v130
 v_max3_f32 v236, v236, v131, v140
 v_max3_f32 v236, v236, v141, v142
 v_max3_f32 v236, v236, v143, v152
 v_max3_f32 v236, v236, v153, v154
 v_max3_f32 v236, v236, v155, v164
 v_max3_f32 v236, v236, v165, v166
 v_max_f32 v236, v236, v167
 v_max3_f32 v237, v132, v133, v134
 v_max3_f32 v237, v237, v135, v144
 v_max3_f32 v237, v237, v145, v146
 v_max3_f32 v237, v237, v147, v156
 v_max3_f32 v237, v237, v157, v158
 v_max3_f32 v237, v237, v159, v168
 v_max3_f32 v237, v237, v169, v170
 v_max_f32 v237, v237, v171
 v_mov_b32 v244, v236
 v_mov_b32 v245, v237
 s_nop 0
 v_permlane32_swap_b32 v236, v244
 v_permlane32_swap_b32 v237, v245
 v_max_f32 v236, v236, v244
 v_max_f32 v237, v237, v245
 v_mov_b32 v244, v236
 v_mov_b32 v245, v237
 s_nop 0
 v_permlane16_swap_b32 v236, v244
 v_permlane16_swap_b32 v237, v245
 v_max_f32 v236, v236, v244
 v_max_f32 v237, v237, v245
 s_branch L1_RESC_W3
L1_RARE1_W3:
 s_nop 7
 v_max3_f32 v236, v176, v177, v178
 v_max3_f32 v236, v236, v179, v188
 v_max3_f32 v236, v236, v189, v190
 v_max3_f32 v236, v236, v191, v200
 v_max3_f32 v236, v236, v201, v202
 v_max3_f32 v236, v236, v203, v212
 v_max3_f32 v236, v236, v213, v214
 v_max_f32 v236, v236, v215
 v_max3_f32 v237, v180, v181, v182
 v_max3_f32 v237, v237, v183, v192
 v_max3_f32 v237, v237, v193, v194
 v_max3_f32 v237, v237, v195, v204
 v_max3_f32 v237, v237, v205, v206
 v_max3_f32 v237, v237, v207, v216
 v_max3_f32 v237, v237, v217, v218
 v_max_f32 v237, v237, v219
 v_mov_b32 v244, v236
 v_mov_b32 v245, v237
 s_nop 0
 v_permlane32_swap_b32 v236, v244
 v_permlane32_swap_b32 v237, v245
 v_max_f32 v236, v236, v244
 v_max_f32 v237, v237, v245
 v_mov_b32 v244, v236
 v_mov_b32 v245, v237
 s_nop 0
 v_permlane16_swap_b32 v236, v244
 v_permlane16_swap_b32 v237, v245
 v_max_f32 v236, v236, v244
 v_max_f32 v237, v237, v245
L1_RESC_W3:
 v_max_f32 v236, 0, v236
 v_max_f32 v237, 0, v237
 v_exp_f32 v240, -v236
 v_exp_f32 v241, -v237
 v_sub_f32 v128, v128, v236
 v_sub_f32 v129, v129, v236
 v_sub_f32 v130, v130, v236
 v_sub_f32 v131, v131, v236
 v_sub_f32 v140, v140, v236
 v_sub_f32 v141, v141, v236
 v_sub_f32 v142, v142, v236
 v_sub_f32 v143, v143, v236
 v_sub_f32 v152, v152, v236
 v_sub_f32 v153, v153, v236
 v_sub_f32 v154, v154, v236
 v_sub_f32 v155, v155, v236
 v_sub_f32 v164, v164, v236
 v_sub_f32 v165, v165, v236
 v_sub_f32 v166, v166, v236
 v_sub_f32 v167, v167, v236
 v_sub_f32 v132, v132, v237
 v_sub_f32 v133, v133, v237
 v_sub_f32 v134, v134, v237
 v_sub_f32 v135, v135, v237
 v_sub_f32 v144, v144, v237
 v_sub_f32 v145, v145, v237
 v_sub_f32 v146, v146, v237
 v_sub_f32 v147, v147, v237
 v_sub_f32 v156, v156, v237
 v_sub_f32 v157, v157, v237
 v_sub_f32 v158, v158, v237
 v_sub_f32 v159, v159, v237
 v_sub_f32 v168, v168, v237
 v_sub_f32 v169, v169, v237
 v_sub_f32 v170, v170, v237
 v_sub_f32 v171, v171, v237
 v_sub_f32 v176, v176, v236
 v_sub_f32 v177, v177, v236
 v_sub_f32 v178, v178, v236
 v_sub_f32 v179, v179, v236
 v_sub_f32 v188, v188, v236
 v_sub_f32 v189, v189, v236
 v_sub_f32 v190, v190, v236
 v_sub_f32 v191, v191, v236
 v_sub_f32 v200, v200, v236
 v_sub_f32 v201, v201, v236
 v_sub_f32 v202, v202, v236
 v_sub_f32 v203, v203, v236
 v_sub_f32 v212, v212, v236
 v_sub_f32 v213, v213, v236
 v_sub_f32 v214, v214, v236
 v_sub_f32 v215, v215, v236
 v_sub_f32 v180, v180, v237
 v_sub_f32 v181, v181, v237
 v_sub_f32 v182, v182, v237
 v_sub_f32 v183, v183, v237
 v_sub_f32 v192, v192, v237
 v_sub_f32 v193, v193, v237
 v_sub_f32 v194, v194, v237
 v_sub_f32 v195, v195, v237
 v_sub_f32 v204, v204, v237
 v_sub_f32 v205, v205, v237
 v_sub_f32 v206, v206, v237
 v_sub_f32 v207, v207, v237
 v_sub_f32 v216, v216, v237
 v_sub_f32 v217, v217, v237
 v_sub_f32 v218, v218, v237
 v_sub_f32 v219, v219, v237
 v_sub_f32 v16, v16, v236
 v_sub_f32 v17, v17, v236
 v_sub_f32 v18, v18, v236
 v_sub_f32 v19, v19, v236
 v_mul_f32 v8, v8, v240
 v_sub_f32 v20, v20, v237
 v_sub_f32 v21, v21, v237
 v_sub_f32 v22, v22, v237
 v_sub_f32 v23, v23, v237
 v_mul_f32 v9, v9, v241
 v_accvgpr_read_b32 v28, a0
 v_accvgpr_read_b32 v29, a1
 v_accvgpr_read_b32 v30, a2
 v_accvgpr_read_b32 v31, a3
 v_mul_f32 v28, v28, v240
 v_mul_f32 v29, v29, v240
 v_mul_f32 v30, v30, v240
 v_mul_f32 v31, v31, v240
 v_accvgpr_write_b32 a0, v28
 v_accvgpr_write_b32 a1, v29
 v_accvgpr_write_b32 a2, v30
 v_accvgpr_write_b32 a3, v31
 v_accvgpr_read_b32 v28, a4
 v_accvgpr_read_b32 v29, a5
 v_accvgpr_read_b32 v30, a6
 v_accvgpr_read_b32 v31, a7
 v_mul_f32 v28, v28, v241
 v_mul_f32 v29, v29, v241
 v_mul_f32 v30, v30, v241
 v_mul_f32 v31, v31, v241
 v_accvgpr_write_b32 a4, v28
 v_accvgpr_write_b32 a5, v29
 v_accvgpr_write_b32 a6, v30
 v_accvgpr_write_b32 a7, v31
 v_accvgpr_read_b32 v28, a12
 v_accvgpr_read_b32 v29, a13
 v_accvgpr_read_b32 v30, a14
 v_accvgpr_read_b32 v31, a15
 v_mul_f32 v28, v28, v240
 v_mul_f32 v29, v29, v240
 v_mul_f32 v30, v30, v240
 v_mul_f32 v31, v31, v240
 v_accvgpr_write_b32 a12, v28
 v_accvgpr_write_b32 a13, v29
 v_accvgpr_write_b32 a14, v30
 v_accvgpr_write_b32 a15, v31
 v_accvgpr_read_b32 v28, a16
 v_accvgpr_read_b32 v29, a17
 v_accvgpr_read_b32 v30, a18
 v_accvgpr_read_b32 v31, a19
 v_mul_f32 v28, v28, v241
 v_mul_f32 v29, v29, v241
 v_mul_f32 v30, v30, v241
 v_mul_f32 v31, v31, v241
 v_accvgpr_write_b32 a16, v28
 v_accvgpr_write_b32 a17, v29
 v_accvgpr_write_b32 a18, v30
 v_accvgpr_write_b32 a19, v31
 v_accvgpr_read_b32 v28, a24
 v_accvgpr_read_b32 v29, a25
 v_accvgpr_read_b32 v30, a26
 v_accvgpr_read_b32 v31, a27
 v_mul_f32 v28, v28, v240
 v_mul_f32 v29, v29, v240
 v_mul_f32 v30, v30, v240
 v_mul_f32 v31, v31, v240
 v_accvgpr_write_b32 a24, v28
 v_accvgpr_write_b32 a25, v29
 v_accvgpr_write_b32 a26, v30
 v_accvgpr_write_b32 a27, v31
 v_accvgpr_read_b32 v28, a28
 v_accvgpr_read_b32 v29, a29
 v_accvgpr_read_b32 v30, a30
 v_accvgpr_read_b32 v31, a31
 v_mul_f32 v28, v28, v241
 v_mul_f32 v29, v29, v241
 v_mul_f32 v30, v30, v241
 v_mul_f32 v31, v31, v241
 v_accvgpr_write_b32 a28, v28
 v_accvgpr_write_b32 a29, v29
 v_accvgpr_write_b32 a30, v30
 v_accvgpr_write_b32 a31, v31
 v_accvgpr_read_b32 v28, a36
 v_accvgpr_read_b32 v29, a37
 v_accvgpr_read_b32 v30, a38
 v_accvgpr_read_b32 v31, a39
 v_mul_f32 v28, v28, v240
 v_mul_f32 v29, v29, v240
 v_mul_f32 v30, v30, v240
 v_mul_f32 v31, v31, v240
 v_accvgpr_write_b32 a36, v28
 v_accvgpr_write_b32 a37, v29
 v_accvgpr_write_b32 a38, v30
 v_accvgpr_write_b32 a39, v31
 v_accvgpr_read_b32 v28, a40
 v_accvgpr_read_b32 v29, a41
 v_accvgpr_read_b32 v30, a42
 v_accvgpr_read_b32 v31, a43
 v_mul_f32 v28, v28, v241
 v_mul_f32 v29, v29, v241
 v_mul_f32 v30, v30, v241
 v_mul_f32 v31, v31, v241
 v_accvgpr_write_b32 a40, v28
 v_accvgpr_write_b32 a41, v29
 v_accvgpr_write_b32 a42, v30
 v_accvgpr_write_b32 a43, v31
 v_accvgpr_read_b32 v28, a48
 v_accvgpr_read_b32 v29, a49
 v_accvgpr_read_b32 v30, a50
 v_accvgpr_read_b32 v31, a51
 v_mul_f32 v28, v28, v240
 v_mul_f32 v29, v29, v240
 v_mul_f32 v30, v30, v240
 v_mul_f32 v31, v31, v240
 v_accvgpr_write_b32 a48, v28
 v_accvgpr_write_b32 a49, v29
 v_accvgpr_write_b32 a50, v30
 v_accvgpr_write_b32 a51, v31
 v_accvgpr_read_b32 v28, a52
 v_accvgpr_read_b32 v29, a53
 v_accvgpr_read_b32 v30, a54
 v_accvgpr_read_b32 v31, a55
 v_mul_f32 v28, v28, v241
 v_mul_f32 v29, v29, v241
 v_mul_f32 v30, v30, v241
 v_mul_f32 v31, v31, v241
 v_accvgpr_write_b32 a52, v28
 v_accvgpr_write_b32 a53, v29
 v_accvgpr_write_b32 a54, v30
 v_accvgpr_write_b32 a55, v31
 v_accvgpr_read_b32 v28, a60
 v_accvgpr_read_b32 v29, a61
 v_accvgpr_read_b32 v30, a62
 v_accvgpr_read_b32 v31, a63
 v_mul_f32 v28, v28, v240
 v_mul_f32 v29, v29, v240
 v_mul_f32 v30, v30, v240
 v_mul_f32 v31, v31, v240
 v_accvgpr_write_b32 a60, v28
 v_accvgpr_write_b32 a61, v29
 v_accvgpr_write_b32 a62, v30
 v_accvgpr_write_b32 a63, v31
 v_accvgpr_read_b32 v28, a64
 v_accvgpr_read_b32 v29, a65
 v_accvgpr_read_b32 v30, a66
 v_accvgpr_read_b32 v31, a67
 v_mul_f32 v28, v28, v241
 v_mul_f32 v29, v29, v241
 v_mul_f32 v30, v30, v241
 v_mul_f32 v31, v31, v241
 v_accvgpr_write_b32 a64, v28
 v_accvgpr_write_b32 a65, v29
 v_accvgpr_write_b32 a66, v30
 v_accvgpr_write_b32 a67, v31
 v_accvgpr_read_b32 v28, a72
 v_accvgpr_read_b32 v29, a73
 v_accvgpr_read_b32 v30, a74
 v_accvgpr_read_b32 v31, a75
 v_mul_f32 v28, v28, v240
 v_mul_f32 v29, v29, v240
 v_mul_f32 v30, v30, v240
 v_mul_f32 v31, v31, v240
 v_accvgpr_write_b32 a72, v28
 v_accvgpr_write_b32 a73, v29
 v_accvgpr_write_b32 a74, v30
 v_accvgpr_write_b32 a75, v31
 v_accvgpr_read_b32 v28, a76
 v_accvgpr_read_b32 v29, a77
 v_accvgpr_read_b32 v30, a78
 v_accvgpr_read_b32 v31, a79
 v_mul_f32 v28, v28, v241
 v_mul_f32 v29, v29, v241
 v_mul_f32 v30, v30, v241
 v_mul_f32 v31, v31, v241
 v_accvgpr_write_b32 a76, v28
 v_accvgpr_write_b32 a77, v29
 v_accvgpr_write_b32 a78, v30
 v_accvgpr_write_b32 a79, v31
 v_accvgpr_read_b32 v28, a84
 v_accvgpr_read_b32 v29, a85
 v_accvgpr_read_b32 v30, a86
 v_accvgpr_read_b32 v31, a87
 v_mul_f32 v28, v28, v240
 v_mul_f32 v29, v29, v240
 v_mul_f32 v30, v30, v240
 v_mul_f32 v31, v31, v240
 v_accvgpr_write_b32 a84, v28
 v_accvgpr_write_b32 a85, v29
 v_accvgpr_write_b32 a86, v30
 v_accvgpr_write_b32 a87, v31
 v_accvgpr_read_b32 v28, a88
 v_accvgpr_read_b32 v29, a89
 v_accvgpr_read_b32 v30, a90
 v_accvgpr_read_b32 v31, a91
 v_mul_f32 v28, v28, v241
 v_mul_f32 v29, v29, v241
 v_mul_f32 v30, v30, v241
 v_mul_f32 v31, v31, v241
 v_accvgpr_write_b32 a88, v28
 v_accvgpr_write_b32 a89, v29
 v_accvgpr_write_b32 a90, v30
 v_accvgpr_write_b32 a91, v31
 v_accvgpr_read_b32 v28, a96
 v_accvgpr_read_b32 v29, a97
 v_accvgpr_read_b32 v30, a98
 v_accvgpr_read_b32 v31, a99
 v_mul_f32 v28, v28, v240
 v_mul_f32 v29, v29, v240
 v_mul_f32 v30, v30, v240
 v_mul_f32 v31, v31, v240
 v_accvgpr_write_b32 a96, v28
 v_accvgpr_write_b32 a97, v29
 v_accvgpr_write_b32 a98, v30
 v_accvgpr_write_b32 a99, v31
 v_accvgpr_read_b32 v28, a100
 v_accvgpr_read_b32 v29, a101
 v_accvgpr_read_b32 v30, a102
 v_accvgpr_read_b32 v31, a103
 v_mul_f32 v28, v28, v241
 v_mul_f32 v29, v29, v241
 v_mul_f32 v30, v30, v241
 v_mul_f32 v31, v31, v241
 v_accvgpr_write_b32 a100, v28
 v_accvgpr_write_b32 a101, v29
 v_accvgpr_write_b32 a102, v30
 v_accvgpr_write_b32 a103, v31
 v_accvgpr_read_b32 v28, a108
 v_accvgpr_read_b32 v29, a109
 v_accvgpr_read_b32 v30, a110
 v_accvgpr_read_b32 v31, a111
 v_mul_f32 v28, v28, v240
 v_mul_f32 v29, v29, v240
 v_mul_f32 v30, v30, v240
 v_mul_f32 v31, v31, v240
 v_accvgpr_write_b32 a108, v28
 v_accvgpr_write_b32 a109, v29
 v_accvgpr_write_b32 a110, v30
 v_accvgpr_write_b32 a111, v31
 v_accvgpr_read_b32 v28, a112
 v_accvgpr_read_b32 v29, a113
 v_accvgpr_read_b32 v30, a114
 v_accvgpr_read_b32 v31, a115
 v_mul_f32 v28, v28, v241
 v_mul_f32 v29, v29, v241
 v_mul_f32 v30, v30, v241
 v_mul_f32 v31, v31, v241
 v_accvgpr_write_b32 a112, v28
 v_accvgpr_write_b32 a113, v29
 v_accvgpr_write_b32 a114, v30
 v_accvgpr_write_b32 a115, v31
 v_accvgpr_read_b32 v28, a120
 v_accvgpr_read_b32 v29, a121
 v_accvgpr_read_b32 v30, a122
 v_accvgpr_read_b32 v31, a123
 v_mul_f32 v28, v28, v240
 v_mul_f32 v29, v29, v240
 v_mul_f32 v30, v30, v240
 v_mul_f32 v31, v31, v240
 v_accvgpr_write_b32 a120, v28
 v_accvgpr_write_b32 a121, v29
 v_accvgpr_write_b32 a122, v30
 v_accvgpr_write_b32 a123, v31
 v_accvgpr_read_b32 v28, a124
 v_accvgpr_read_b32 v29, a125
 v_accvgpr_read_b32 v30, a126
 v_accvgpr_read_b32 v31, a127
 v_mul_f32 v28, v28, v241
 v_mul_f32 v29, v29, v241
 v_mul_f32 v30, v30, v241
 v_mul_f32 v31, v31, v241
 v_accvgpr_write_b32 a124, v28
 v_accvgpr_write_b32 a125, v29
 v_accvgpr_write_b32 a126, v30
 v_accvgpr_write_b32 a127, v31
 v_accvgpr_read_b32 v28, a132
 v_accvgpr_read_b32 v29, a133
 v_accvgpr_read_b32 v30, a134
 v_accvgpr_read_b32 v31, a135
 v_mul_f32 v28, v28, v240
 v_mul_f32 v29, v29, v240
 v_mul_f32 v30, v30, v240
 v_mul_f32 v31, v31, v240
 v_accvgpr_write_b32 a132, v28
 v_accvgpr_write_b32 a133, v29
 v_accvgpr_write_b32 a134, v30
 v_accvgpr_write_b32 a135, v31
 v_accvgpr_read_b32 v28, a136
 v_accvgpr_read_b32 v29, a137
 v_accvgpr_read_b32 v30, a138
 v_accvgpr_read_b32 v31, a139
 v_mul_f32 v28, v28, v241
 v_mul_f32 v29, v29, v241
 v_mul_f32 v30, v30, v241
 v_mul_f32 v31, v31, v241
 v_accvgpr_write_b32 a136, v28
 v_accvgpr_write_b32 a137, v29
 v_accvgpr_write_b32 a138, v30
 v_accvgpr_write_b32 a139, v31
 v_accvgpr_read_b32 v28, a144
 v_accvgpr_read_b32 v29, a145
 v_accvgpr_read_b32 v30, a146
 v_accvgpr_read_b32 v31, a147
 v_mul_f32 v28, v28, v240
 v_mul_f32 v29, v29, v240
 v_mul_f32 v30, v30, v240
 v_mul_f32 v31, v31, v240
 v_accvgpr_write_b32 a144, v28
 v_accvgpr_write_b32 a145, v29
 v_accvgpr_write_b32 a146, v30
 v_accvgpr_write_b32 a147, v31
 v_accvgpr_read_b32 v28, a148
 v_accvgpr_read_b32 v29, a149
 v_accvgpr_read_b32 v30, a150
 v_accvgpr_read_b32 v31, a151
 v_mul_f32 v28, v28, v241
 v_mul_f32 v29, v29, v241
 v_mul_f32 v30, v30, v241
 v_mul_f32 v31, v31, v241
 v_accvgpr_write_b32 a148, v28
 v_accvgpr_write_b32 a149, v29
 v_accvgpr_write_b32 a150, v30
 v_accvgpr_write_b32 a151, v31
 v_accvgpr_read_b32 v28, a156
 v_accvgpr_read_b32 v29, a157
 v_accvgpr_read_b32 v30, a158
 v_accvgpr_read_b32 v31, a159
 v_mul_f32 v28, v28, v240
 v_mul_f32 v29, v29, v240
 v_mul_f32 v30, v30, v240
 v_mul_f32 v31, v31, v240
 v_accvgpr_write_b32 a156, v28
 v_accvgpr_write_b32 a157, v29
 v_accvgpr_write_b32 a158, v30
 v_accvgpr_write_b32 a159, v31
 v_accvgpr_read_b32 v28, a160
 v_accvgpr_read_b32 v29, a161
 v_accvgpr_read_b32 v30, a162
 v_accvgpr_read_b32 v31, a163
 v_mul_f32 v28, v28, v241
 v_mul_f32 v29, v29, v241
 v_mul_f32 v30, v30, v241
 v_mul_f32 v31, v31, v241
 v_accvgpr_write_b32 a160, v28
 v_accvgpr_write_b32 a161, v29
 v_accvgpr_write_b32 a162, v30
 v_accvgpr_write_b32 a163, v31
 v_accvgpr_read_b32 v28, a168
 v_accvgpr_read_b32 v29, a169
 v_accvgpr_read_b32 v30, a170
 v_accvgpr_read_b32 v31, a171
 v_mul_f32 v28, v28, v240
 v_mul_f32 v29, v29, v240
 v_mul_f32 v30, v30, v240
 v_mul_f32 v31, v31, v240
 v_accvgpr_write_b32 a168, v28
 v_accvgpr_write_b32 a169, v29
 v_accvgpr_write_b32 a170, v30
 v_accvgpr_write_b32 a171, v31
 v_accvgpr_read_b32 v28, a172
 v_accvgpr_read_b32 v29, a173
 v_accvgpr_read_b32 v30, a174
 v_accvgpr_read_b32 v31, a175
 v_mul_f32 v28, v28, v241
 v_mul_f32 v29, v29, v241
 v_mul_f32 v30, v30, v241
 v_mul_f32 v31, v31, v241
 v_accvgpr_write_b32 a172, v28
 v_accvgpr_write_b32 a173, v29
 v_accvgpr_write_b32 a174, v30
 v_accvgpr_write_b32 a175, v31
 v_accvgpr_read_b32 v28, a180
 v_accvgpr_read_b32 v29, a181
 v_accvgpr_read_b32 v30, a182
 v_accvgpr_read_b32 v31, a183
 v_mul_f32 v28, v28, v240
 v_mul_f32 v29, v29, v240
 v_mul_f32 v30, v30, v240
 v_mul_f32 v31, v31, v240
 v_accvgpr_write_b32 a180, v28
 v_accvgpr_write_b32 a181, v29
 v_accvgpr_write_b32 a182, v30
 v_accvgpr_write_b32 a183, v31
 v_accvgpr_read_b32 v28, a184
 v_accvgpr_read_b32 v29, a185
 v_accvgpr_read_b32 v30, a186
 v_accvgpr_read_b32 v31, a187
 v_mul_f32 v28, v28, v241
 v_mul_f32 v29, v29, v241
 v_mul_f32 v30, v30, v241
 v_mul_f32 v31, v31, v241
 v_accvgpr_write_b32 a184, v28
 v_accvgpr_write_b32 a185, v29
 v_accvgpr_write_b32 a186, v30
 v_accvgpr_write_b32 a187, v31
 s_cmp_eq_u32 s90, 4
 s_cbranch_scc1 L1_POST1_W3
 s_cmp_eq_u32 s90, 1
 s_cbranch_scc1 L1_POST2_W3
 s_cmp_eq_u32 s90, 3
 s_cbranch_scc1 L1_POST2_W3
 s_cmp_eq_u32 s90, 5
 s_cbranch_scc1 L1_POST3_W3
L1_POST0_W3:
 v_exp_f32 v28, v128
 v_exp_f32 v29, v129
 v_exp_f32 v30, v130
 v_exp_f32 v31, v131
 v_cvt_pk_bf16_f32 v52, v28, v29
 v_exp_f32 v32, v140
 v_dot2_f32_bf16 v11, v52, s79, 0
 v_exp_f32 v33, v141
 v_cvt_pk_bf16_f32 v53, v30, v31
 v_exp_f32 v34, v142
 v_dot2c_f32_bf16 v11, s79, v53
 v_exp_f32 v35, v143
 v_cvt_pk_bf16_f32 v54, v32, v33
 v_dot2c_f32_bf16 v11, s79, v54
 v_cvt_pk_bf16_f32 v55, v34, v35
 v_dot2c_f32_bf16 v11, s79, v55
 v_exp_f32 v28, v132
 v_exp_f32 v29, v133
 v_exp_f32 v30, v134
 v_exp_f32 v31, v135
 v_cvt_pk_bf16_f32 v56, v28, v29
 v_exp_f32 v32, v144
 v_dot2_f32_bf16 v12, v56, s79, 0
 v_exp_f32 v33, v145
 v_cvt_pk_bf16_f32 v57, v30, v31
 v_exp_f32 v34, v146
 v_dot2c_f32_bf16 v12, s79, v57
 v_exp_f32 v35, v147
 v_cvt_pk_bf16_f32 v58, v32, v33
 v_dot2c_f32_bf16 v12, s79, v58
 v_cvt_pk_bf16_f32 v59, v34, v35
 v_dot2c_f32_bf16 v12, s79, v59
 v_exp_f32 v28, v152
 v_exp_f32 v29, v153
 v_exp_f32 v30, v154
 v_exp_f32 v31, v155
 v_cvt_pk_bf16_f32 v40, v28, v29
 v_exp_f32 v32, v164
 v_dot2c_f32_bf16 v11, s79, v40
 v_exp_f32 v33, v165
 v_cvt_pk_bf16_f32 v41, v30, v31
 v_exp_f32 v34, v166
 v_dot2c_f32_bf16 v11, s79, v41
 v_exp_f32 v35, v167
 v_cvt_pk_bf16_f32 v42, v32, v33
 v_dot2c_f32_bf16 v11, s79, v42
 v_cvt_pk_bf16_f32 v43, v34, v35
 v_dot2c_f32_bf16 v11, s79, v43
 v_exp_f32 v28, v156
 v_exp_f32 v29, v157
 v_exp_f32 v30, v158
 v_exp_f32 v31, v159
 v_cvt_pk_bf16_f32 v44, v28, v29
 v_exp_f32 v32, v168
 v_dot2c_f32_bf16 v12, s79, v44
 v_exp_f32 v33, v169
 v_cvt_pk_bf16_f32 v45, v30, v31
 v_exp_f32 v34, v170
 v_dot2c_f32_bf16 v12, s79, v45
 v_exp_f32 v35, v171
 v_cvt_pk_bf16_f32 v46, v32, v33
 v_dot2c_f32_bf16 v12, s79, v46
 v_cvt_pk_bf16_f32 v47, v34, v35
 v_dot2c_f32_bf16 v12, s79, v47
 s_cmp_eq_u32 s90, 0
 s_cbranch_scc1 L1_BACK0_W3
 s_nop 1
 s_branch L1_BACK2_W3
L1_POST1_W3:
 v_exp_f32 v28, v128
 v_exp_f32 v29, v129
 v_exp_f32 v30, v130
 v_exp_f32 v31, v131
 v_cvt_pk_bf16_f32 v52, v28, v29
 v_exp_f32 v32, v140
 v_dot2_f32_bf16 v11, v52, s79, 0
 v_exp_f32 v33, v141
 v_cvt_pk_bf16_f32 v53, v30, v31
 v_exp_f32 v34, v142
 v_dot2c_f32_bf16 v11, s79, v53
 v_exp_f32 v35, v143
 v_cvt_pk_bf16_f32 v54, v32, v33
 v_dot2c_f32_bf16 v11, s79, v54
 v_cvt_pk_bf16_f32 v55, v34, v35
 v_dot2c_f32_bf16 v11, s79, v55
 v_exp_f32 v28, v132
 v_exp_f32 v29, v133
 v_exp_f32 v30, v134
 v_exp_f32 v31, v135
 v_cvt_pk_bf16_f32 v56, v28, v29
 v_exp_f32 v32, v144
 v_dot2_f32_bf16 v12, v56, s79, 0
 v_exp_f32 v33, v145
 v_cvt_pk_bf16_f32 v57, v30, v31
 v_exp_f32 v34, v146
 v_dot2c_f32_bf16 v12, s79, v57
 v_exp_f32 v35, v147
 v_cvt_pk_bf16_f32 v58, v32, v33
 v_dot2c_f32_bf16 v12, s79, v58
 v_cvt_pk_bf16_f32 v59, v34, v35
 v_dot2c_f32_bf16 v12, s79, v59
 v_exp_f32 v28, v152
 v_exp_f32 v29, v153
 v_exp_f32 v30, v154
 v_exp_f32 v31, v155
 v_cvt_pk_bf16_f32 v40, v28, v29
 v_exp_f32 v32, v164
 v_dot2c_f32_bf16 v11, s79, v40
 v_exp_f32 v33, v165
 v_cvt_pk_bf16_f32 v41, v30, v31
 v_exp_f32 v34, v166
 v_dot2c_f32_bf16 v11, s79, v41
 v_exp_f32 v35, v167
 v_cvt_pk_bf16_f32 v42, v32, v33
 v_dot2c_f32_bf16 v11, s79, v42
 v_cvt_pk_bf16_f32 v43, v34, v35
 v_dot2c_f32_bf16 v11, s79, v43
 v_exp_f32 v28, v156
 v_exp_f32 v29, v157
 v_exp_f32 v30, v158
 v_exp_f32 v31, v159
 v_cvt_pk_bf16_f32 v44, v28, v29
 v_exp_f32 v32, v168
 v_dot2c_f32_bf16 v12, s79, v44
 v_exp_f32 v33, v169
 v_cvt_pk_bf16_f32 v45, v30, v31
 v_exp_f32 v34, v170
 v_dot2c_f32_bf16 v12, s79, v45
 v_exp_f32 v35, v171
 v_cvt_pk_bf16_f32 v46, v32, v33
 v_dot2c_f32_bf16 v12, s79, v46
 v_cvt_pk_bf16_f32 v47, v34, v35
 v_dot2c_f32_bf16 v12, s79, v47
 v_exp_f32 v28, v180
 v_exp_f32 v29, v181
 v_exp_f32 v30, v182
 v_exp_f32 v31, v183
 v_add_f32 v249, v28, v29
 v_cvt_pk_bf16_f32 v228, v28, v29
 v_exp_f32 v32, v192
 v_add_f32 v249, v249, v30
 v_exp_f32 v33, v193
 v_add_f32 v249, v249, v31
 v_cvt_pk_bf16_f32 v229, v30, v31
 v_exp_f32 v34, v194
 v_add_f32 v249, v249, v32
 v_exp_f32 v35, v195
 v_add_f32 v249, v249, v33
 v_cvt_pk_bf16_f32 v230, v32, v33
 v_add_f32 v249, v249, v34
 v_add_f32 v249, v249, v35
 v_cvt_pk_bf16_f32 v231, v34, v35
 v_exp_f32 v28, v176
 v_exp_f32 v29, v177
 v_exp_f32 v30, v178
 v_exp_f32 v31, v179
 v_add_f32 v248, v28, v29
 v_cvt_pk_bf16_f32 v224, v28, v29
 v_exp_f32 v32, v188
 v_add_f32 v248, v248, v30
 v_exp_f32 v33, v189
 v_add_f32 v248, v248, v31
 v_cvt_pk_bf16_f32 v225, v30, v31
 s_nop 1
 s_branch L1_BACK4_W3
L1_POST2_W3:
 v_exp_f32 v28, v176
 v_exp_f32 v29, v177
 v_exp_f32 v30, v178
 v_exp_f32 v31, v179
 v_cvt_pk_bf16_f32 v224, v28, v29
 v_exp_f32 v32, v188
 v_dot2_f32_bf16 v11, v224, s79, 0
 v_exp_f32 v33, v189
 v_cvt_pk_bf16_f32 v225, v30, v31
 v_exp_f32 v34, v190
 v_dot2c_f32_bf16 v11, s79, v225
 v_exp_f32 v35, v191
 v_cvt_pk_bf16_f32 v226, v32, v33
 v_dot2c_f32_bf16 v11, s79, v226
 v_cvt_pk_bf16_f32 v227, v34, v35
 v_dot2c_f32_bf16 v11, s79, v227
 v_exp_f32 v28, v180
 v_exp_f32 v29, v181
 v_exp_f32 v30, v182
 v_exp_f32 v31, v183
 v_cvt_pk_bf16_f32 v228, v28, v29
 v_exp_f32 v32, v192
 v_dot2_f32_bf16 v12, v228, s79, 0
 v_exp_f32 v33, v193
 v_cvt_pk_bf16_f32 v229, v30, v31
 v_exp_f32 v34, v194
 v_dot2c_f32_bf16 v12, s79, v229
 v_exp_f32 v35, v195
 v_cvt_pk_bf16_f32 v230, v32, v33
 v_dot2c_f32_bf16 v12, s79, v230
 v_cvt_pk_bf16_f32 v231, v34, v35
 v_dot2c_f32_bf16 v12, s79, v231
 v_exp_f32 v28, v200
 v_exp_f32 v29, v201
 v_exp_f32 v30, v202
 v_exp_f32 v31, v203
 v_cvt_pk_bf16_f32 v40, v28, v29
 v_exp_f32 v32, v212
 v_dot2c_f32_bf16 v11, s79, v40
 v_exp_f32 v33, v213
 v_cvt_pk_bf16_f32 v41, v30, v31
 v_exp_f32 v34, v214
 v_dot2c_f32_bf16 v11, s79, v41
 v_exp_f32 v35, v215
 v_cvt_pk_bf16_f32 v42, v32, v33
 v_dot2c_f32_bf16 v11, s79, v42
 v_cvt_pk_bf16_f32 v43, v34, v35
 v_dot2c_f32_bf16 v11, s79, v43
 v_exp_f32 v28, v204
 v_exp_f32 v29, v205
 v_exp_f32 v30, v206
 v_exp_f32 v31, v207
 v_cvt_pk_bf16_f32 v44, v28, v29
 v_exp_f32 v32, v216
 v_dot2c_f32_bf16 v12, s79, v44
 v_exp_f32 v33, v217
 v_cvt_pk_bf16_f32 v45, v30, v31
 v_exp_f32 v34, v218
 v_dot2c_f32_bf16 v12, s79, v45
 v_exp_f32 v35, v219
 v_cvt_pk_bf16_f32 v46, v32, v33
 v_dot2c_f32_bf16 v12, s79, v46
 v_cvt_pk_bf16_f32 v47, v34, v35
 v_dot2c_f32_bf16 v12, s79, v47
 s_cmp_eq_u32 s90, 1
 s_cbranch_scc1 L1_BACK1_W3
 s_nop 1
 s_branch L1_BACK3_W3
L1_POST3_W3:
 v_exp_f32 v28, v176
 v_exp_f32 v29, v177
 v_exp_f32 v30, v178
 v_exp_f32 v31, v179
 v_cvt_pk_bf16_f32 v224, v28, v29
 v_exp_f32 v32, v188
 v_dot2_f32_bf16 v248, v224, s79, 0
 v_exp_f32 v33, v189
 v_cvt_pk_bf16_f32 v225, v30, v31
 v_exp_f32 v34, v190
 v_dot2c_f32_bf16 v248, s79, v225
 v_exp_f32 v35, v191
 v_cvt_pk_bf16_f32 v226, v32, v33
 v_dot2c_f32_bf16 v248, s79, v226
 v_cvt_pk_bf16_f32 v227, v34, v35
 v_dot2c_f32_bf16 v248, s79, v227
 v_exp_f32 v28, v180
 v_exp_f32 v29, v181
 v_exp_f32 v30, v182
 v_exp_f32 v31, v183
 v_cvt_pk_bf16_f32 v228, v28, v29
 v_exp_f32 v32, v192
 v_dot2_f32_bf16 v249, v228, s79, 0
 v_exp_f32 v33, v193
 v_cvt_pk_bf16_f32 v229, v30, v31
 v_exp_f32 v34, v194
 v_dot2c_f32_bf16 v249, s79, v229
 v_exp_f32 v35, v195
 v_cvt_pk_bf16_f32 v230, v32, v33
 v_dot2c_f32_bf16 v249, s79, v230
 v_cvt_pk_bf16_f32 v231, v34, v35
 v_dot2c_f32_bf16 v249, s79, v231
 v_exp_f32 v28, v200
 v_exp_f32 v29, v201
 v_exp_f32 v30, v202
 v_exp_f32 v31, v203
 v_cvt_pk_bf16_f32 v160, v28, v29
 v_exp_f32 v32, v212
 v_dot2c_f32_bf16 v248, s79, v160
 v_exp_f32 v33, v213
 v_cvt_pk_bf16_f32 v161, v30, v31
 v_exp_f32 v34, v214
 v_dot2c_f32_bf16 v248, s79, v161
 v_exp_f32 v35, v215
 v_cvt_pk_bf16_f32 v162, v32, v33
 v_dot2c_f32_bf16 v248, s79, v162
 v_cvt_pk_bf16_f32 v163, v34, v35
 v_dot2c_f32_bf16 v248, s79, v163
 v_exp_f32 v28, v204
 v_exp_f32 v29, v205
 v_exp_f32 v30, v206
 v_exp_f32 v31, v207
 v_cvt_pk_bf16_f32 v164, v28, v29
 v_exp_f32 v32, v216
 v_dot2c_f32_bf16 v249, s79, v164
 v_exp_f32 v33, v217
 v_cvt_pk_bf16_f32 v165, v30, v31
 v_exp_f32 v34, v218
 v_dot2c_f32_bf16 v249, s79, v165
 v_exp_f32 v35, v219
 v_cvt_pk_bf16_f32 v166, v32, v33
 v_dot2c_f32_bf16 v249, s79, v166
 v_cvt_pk_bf16_f32 v167, v34, v35
 v_dot2c_f32_bf16 v249, s79, v167
 s_nop 1
 s_branch L1_BACK5_W3
L2_END:
 s_endpgm
.section .rodata,"a"
.p2align 6
.amdhsa_kernel concat_heads__gqa_block_cached__mha_block_cached__near_ridge_kernel
  .amdhsa_next_free_vgpr 512
  .amdhsa_next_free_sgpr 102
  .amdhsa_accum_offset 256
  .amdhsa_group_segment_fixed_size 0
  .amdhsa_kernarg_size 104
  .amdhsa_user_sgpr_count 2
  .amdhsa_user_sgpr_kernarg_segment_ptr 1
  .amdhsa_system_sgpr_workgroup_id_x 1
.end_amdhsa_kernel
```
